```python
import torch

def _softmax(x, axis=-1):
    return torch.softmax(x, dim=axis)

def _gelu(x):
    return torch.nn.functional.gelu(x, approximate='tanh')

def _silu(x):
    return torch.nn.functional.silu(x)

def _sigmoid(x):
    return torch.sigmoid(x)

def _layernorm(x, axis=-1, eps=1e-05):
    m = x.mean(dim=axis, keepdim=True)
    v = x.var(dim=axis, keepdim=True, unbiased=False)
    return (x - m) / torch.sqrt(v + eps)

def _scatter_add(tgt, idx, src, axis=0):
    return tgt.clone().index_add_(axis, idx, src)

def _segment_sum(src, seg, n):
    out = torch.zeros((n,) + src.shape[1:], dtype=src.dtype)
    return out.index_add_(0, seg, src)

def _pad(x, pw):
    flat = tuple((v for pair in reversed(pw) for v in pair))
    return torch.nn.functional.pad(x, flat)
kernel_name = 'adaLN_cond__memory_aug_recurrent_mem_tr__dense_activation_squared_relu__prompt'

def setup_inputs():

    _w = lambda a: (lambda t: t.to(torch.bfloat16) if t.is_floating_point() else t)(torch.as_tensor(a))

    def _A_setup():
        B, S, Dm = (1, 2048, 640)
        H, Dh = (32, 192)
        M, seg = (8, 32)
        seg = min(seg, S)
        S = S // seg * seg
        return {'x': _w((lambda *s: torch.randn(*s, dtype=torch.bfloat16) * 0.05)(B, S, Dm)), 'mem0': _w((lambda *s: torch.randn(*s, dtype=torch.bfloat16) * 0.4)(B, M, Dm)), 'Wq': _w((lambda *s: torch.randn(*s, dtype=torch.bfloat16) * 3.2)(Dm, H, Dh) * Dm ** (-0.5)), 'Wk': _w((lambda *s: torch.randn(*s, dtype=torch.bfloat16) * 3.2)(Dm, H, Dh) * Dm ** (-0.5)), 'Wv': _w((lambda *s: torch.randn(*s, dtype=torch.bfloat16) * 0.4)(Dm, H, Dh) * Dm ** (-0.5)), 'Wo': _w((lambda *s: torch.randn(*s, dtype=torch.bfloat16) * 0.4)(H, Dh, Dm) * (H * Dh) ** (-0.5)), 'seg_len': seg}
    _A_in = _A_setup()

    def _B_setup():
        B, S, D, F = (1, 2048, 640, 1536)
        return {'x': _w((lambda *s: torch.randn(*s, dtype=torch.bfloat16) * 0.05)(B, S, D)), 'w1': _w((lambda *s: torch.randn(*s, dtype=torch.bfloat16) * 0.05)(D, F)), 'b1': _w((lambda *s: torch.randn(*s, dtype=torch.bfloat16) * 0.4)(F)), 'w2': _w((lambda *s: torch.randn(*s, dtype=torch.bfloat16) * 0.05)(F, D)), 'b2': _w((lambda *s: torch.randn(*s, dtype=torch.bfloat16) * 3.2)(D))}
    _B_in = _B_setup()
    return {'A_x': _A_in['x'], 'A_mem0': _A_in['mem0'], 'A_Wq': _A_in['Wq'], 'A_Wk': _A_in['Wk'], 'A_Wv': _A_in['Wv'], 'A_Wo': _A_in['Wo'], 'A_seg_len': _A_in['seg_len'], 'B_x': _B_in['x'], 'B_w1': _B_in['w1'], 'B_b1': _B_in['b1'], 'B_w2': _B_in['w2'], 'B_b2': _B_in['b2'], 'c': _w((lambda *s: torch.randn(*s, dtype=torch.bfloat16) * 0.1)(1, 640) * 8.0), 'w_mod': _w((lambda *s: torch.randn(*s, dtype=torch.bfloat16) * 0.1)(640, 6 * 640) * 640 ** (-0.5) * 8.0)}

def reference(A_x, A_mem0, A_Wq, A_Wk, A_Wv, A_Wo, A_seg_len, B_x, B_w1, B_b1, B_w2, B_b2, c, w_mod):

    def _A_ref(x, mem0, Wq, Wk, Wv, Wo, seg_len):
        B, S, Dm = x.shape
        H, Dh = (Wq.shape[1], Wq.shape[2])
        M = mem0.shape[1]
        scale = Dh ** (-0.5)
        n_seg = S // seg_len
        L = M + seg_len
        idx = torch.arange(L)
        mask = (idx[:, None] < M) | (idx[:, None] >= idx[None, :])
        mem = mem0
        outs = []
        for s in range(n_seg):
            xs = x[:, s * seg_len:(s + 1) * seg_len, :].clone()
            h = torch.concatenate([mem, xs], axis=1)
            q = torch.einsum('btd,dhe->bhte', h, Wq)
            k = torch.einsum('btd,dhe->bhte', h, Wk)
            v = torch.einsum('btd,dhe->bhte', h, Wv)
            scores = torch.einsum('bhqe,bhke->bhqk', q, k) * scale
            scores = torch.where(mask[None, None], scores, -1000000000.0)
            p = _softmax(scores, axis=-1)
            o = torch.einsum('bhqk,bhke->bhqe', p, v)
            o = torch.einsum('bhte,hed->btd', o, Wo)
            mem = o[:, :M, :].clone()
            outs.append(o[:, M:, :])
        return torch.concatenate(outs, axis=1)

    def _B_ref(x, w1, b1, w2, b2):
        h = torch.einsum('bsd,df->bsf', x, w1) + b1
        zero = torch.zeros_like(h)
        r = torch.where(h > zero, h, zero)
        h = r * r
        out = torch.einsum('bsf,fd->bsd', h, w2) + b2
        return out
    x = A_x
    mod = (_silu(c) @ w_mod).reshape(c.shape[0], 6, 1, -1)
    sa, ca, ga, sb, cb, gb = (mod[:, 0].clone(), mod[:, 1].clone(), mod[:, 2].clone(), mod[:, 3].clone(), mod[:, 4].clone(), mod[:, 5].clone())
    h = _layernorm(x, axis=-1) * (1 + ca) + sa
    x = x + ga * _A_ref(h, A_mem0, A_Wq, A_Wk, A_Wv, A_Wo, A_seg_len)
    h = _layernorm(x, axis=-1) * (1 + cb) + sb
    x = x + gb * _B_ref(h, B_w1, B_b1, B_w2, B_b2)
    return x
```

```asm
; @launch kernel=prep_kernel grid=(160,1,1) block=(256,1,1) lds=8192
; @launch kernel=mega_kernel grid=(256,1,1) block=(256,1,1) lds=163840
.amdgcn_target "amdgcn-amd-amdhsa--gfx950"
.macro mf a,b,c,d
v_mfma_f32_16x16x32_bf16 \a,\b,\c,\d
.endm
.macro tr a,b,c
ds_read_b64_tr_b16 \a,\b offset:\c
.endm
.macro cv a,b,c
v_cvt_pk_bf16_f32 \a,\b,\c
.endm
.text
.globl prep_kernel
.p2align 8
.type prep_kernel,@function
prep_kernel:
s_cmp_ge_u32 s2,160
s_cbranch_scc1 prep_end
s_load_dwordx2 s[4:5],s[0:1],128
s_load_dwordx4 s[8:11],s[0:1],96
s_load_dwordx2 s[12:13],s[0:1],8
s_waitcnt lgkmcnt(0)
s_cmp_ge_u32 s2,120
s_cbranch_scc1 prep_clear
s_mov_b32 s16,s8
s_mov_b32 s17,s9
s_mov_b32 s18,0x500
s_mov_b32 s19,0x00020000
s_mov_b32 s20,s10
s_mov_b32 s21,s11
s_mov_b32 s22,0x4b0000
s_mov_b32 s23,0x00020000
s_mov_b32 s24,s4
s_mov_b32 s25,s5
s_mov_b32 s26,0x4000
s_mov_b32 s27,0x00020000
v_add_u32 v1,0,v0
v_lshlrev_b32 v2,1,v1
buffer_load_ushort v3,v2,s[16:19],0 offen
v_add_u32 v1,256,v0
v_lshlrev_b32 v2,1,v1
buffer_load_ushort v4,v2,s[16:19],0 offen
v_add_u32 v1,512,v0
v_lshlrev_b32 v2,1,v1
buffer_load_ushort v5,v2,s[16:19],0 offen
s_waitcnt vmcnt(0)
v_lshlrev_b32 v3,16,v3
v_mul_f32 v6,0xbfb8aa3b,v3
v_exp_f32 v6,v6
s_nop 0
v_add_f32 v6,1.0,v6
v_rcp_f32 v6,v6
s_nop 0
v_mul_f32 v6,v3,v6
cv v6,v6,v6
v_lshlrev_b32 v6,16,v6
v_add_u32 v1,0,v0
v_lshlrev_b32 v2,2,v1
ds_write_b32 v2,v6
v_lshlrev_b32 v4,16,v4
v_mul_f32 v6,0xbfb8aa3b,v4
v_exp_f32 v6,v6
s_nop 0
v_add_f32 v6,1.0,v6
v_rcp_f32 v6,v6
s_nop 0
v_mul_f32 v6,v4,v6
cv v6,v6,v6
v_lshlrev_b32 v6,16,v6
v_add_u32 v1,256,v0
v_lshlrev_b32 v2,2,v1
ds_write_b32 v2,v6
v_lshlrev_b32 v5,16,v5
v_mul_f32 v6,0xbfb8aa3b,v5
v_exp_f32 v6,v6
s_nop 0
v_add_f32 v6,1.0,v6
v_rcp_f32 v6,v6
s_nop 0
v_mul_f32 v6,v5,v6
cv v6,v6,v6
v_lshlrev_b32 v6,16,v6
v_add_u32 v1,512,v0
v_lshlrev_b32 v2,2,v1
ds_write_b32 v2,v6
s_waitcnt lgkmcnt(0)
s_barrier
v_and_b32 v1,15,v0
v_lshrrev_b32 v2,4,v0
v_mul_u32_u24 v3,7680,v2
v_lshlrev_b32 v4,2,v1
v_add_u32 v3,v3,v4
s_lshl_b32 s3,s2,6
v_add_u32 v3,s3,v3
v_lshlrev_b32 v5,2,v2
v_mov_b32 v6,0
v_mov_b32 v7,0
s_mov_b32 s14,0
buffer_load_dword v16,v3,s[20:23],s14 offen
ds_read_b32 v24,v5 offset:0
s_mov_b32 s14,122880
buffer_load_dword v17,v3,s[20:23],s14 offen
ds_read_b32 v25,v5 offset:64
s_mov_b32 s14,245760
buffer_load_dword v18,v3,s[20:23],s14 offen
ds_read_b32 v26,v5 offset:128
s_mov_b32 s14,368640
buffer_load_dword v19,v3,s[20:23],s14 offen
ds_read_b32 v27,v5 offset:192
s_mov_b32 s14,491520
buffer_load_dword v20,v3,s[20:23],s14 offen
ds_read_b32 v28,v5 offset:256
s_mov_b32 s14,614400
buffer_load_dword v21,v3,s[20:23],s14 offen
ds_read_b32 v29,v5 offset:320
s_mov_b32 s14,737280
buffer_load_dword v22,v3,s[20:23],s14 offen
ds_read_b32 v30,v5 offset:384
s_mov_b32 s14,860160
buffer_load_dword v23,v3,s[20:23],s14 offen
ds_read_b32 v31,v5 offset:448
s_waitcnt vmcnt(0) lgkmcnt(0)
v_lshlrev_b32 v8,16,v16
v_and_b32 v9,0xffff0000,v16
v_fmac_f32 v6,v8,v24
v_fmac_f32 v7,v9,v24
v_lshlrev_b32 v8,16,v17
v_and_b32 v9,0xffff0000,v17
v_fmac_f32 v6,v8,v25
v_fmac_f32 v7,v9,v25
v_lshlrev_b32 v8,16,v18
v_and_b32 v9,0xffff0000,v18
v_fmac_f32 v6,v8,v26
v_fmac_f32 v7,v9,v26
v_lshlrev_b32 v8,16,v19
v_and_b32 v9,0xffff0000,v19
v_fmac_f32 v6,v8,v27
v_fmac_f32 v7,v9,v27
v_lshlrev_b32 v8,16,v20
v_and_b32 v9,0xffff0000,v20
v_fmac_f32 v6,v8,v28
v_fmac_f32 v7,v9,v28
v_lshlrev_b32 v8,16,v21
v_and_b32 v9,0xffff0000,v21
v_fmac_f32 v6,v8,v29
v_fmac_f32 v7,v9,v29
v_lshlrev_b32 v8,16,v22
v_and_b32 v9,0xffff0000,v22
v_fmac_f32 v6,v8,v30
v_fmac_f32 v7,v9,v30
v_lshlrev_b32 v8,16,v23
v_and_b32 v9,0xffff0000,v23
v_fmac_f32 v6,v8,v31
v_fmac_f32 v7,v9,v31
s_mov_b32 s14,983040
buffer_load_dword v16,v3,s[20:23],s14 offen
ds_read_b32 v24,v5 offset:512
s_mov_b32 s14,1105920
buffer_load_dword v17,v3,s[20:23],s14 offen
ds_read_b32 v25,v5 offset:576
s_mov_b32 s14,1228800
buffer_load_dword v18,v3,s[20:23],s14 offen
ds_read_b32 v26,v5 offset:640
s_mov_b32 s14,1351680
buffer_load_dword v19,v3,s[20:23],s14 offen
ds_read_b32 v27,v5 offset:704
s_mov_b32 s14,1474560
buffer_load_dword v20,v3,s[20:23],s14 offen
ds_read_b32 v28,v5 offset:768
s_mov_b32 s14,1597440
buffer_load_dword v21,v3,s[20:23],s14 offen
ds_read_b32 v29,v5 offset:832
s_mov_b32 s14,1720320
buffer_load_dword v22,v3,s[20:23],s14 offen
ds_read_b32 v30,v5 offset:896
s_mov_b32 s14,1843200
buffer_load_dword v23,v3,s[20:23],s14 offen
ds_read_b32 v31,v5 offset:960
s_waitcnt vmcnt(0) lgkmcnt(0)
v_lshlrev_b32 v8,16,v16
v_and_b32 v9,0xffff0000,v16
v_fmac_f32 v6,v8,v24
v_fmac_f32 v7,v9,v24
v_lshlrev_b32 v8,16,v17
v_and_b32 v9,0xffff0000,v17
v_fmac_f32 v6,v8,v25
v_fmac_f32 v7,v9,v25
v_lshlrev_b32 v8,16,v18
v_and_b32 v9,0xffff0000,v18
v_fmac_f32 v6,v8,v26
v_fmac_f32 v7,v9,v26
v_lshlrev_b32 v8,16,v19
v_and_b32 v9,0xffff0000,v19
v_fmac_f32 v6,v8,v27
v_fmac_f32 v7,v9,v27
v_lshlrev_b32 v8,16,v20
v_and_b32 v9,0xffff0000,v20
v_fmac_f32 v6,v8,v28
v_fmac_f32 v7,v9,v28
v_lshlrev_b32 v8,16,v21
v_and_b32 v9,0xffff0000,v21
v_fmac_f32 v6,v8,v29
v_fmac_f32 v7,v9,v29
v_lshlrev_b32 v8,16,v22
v_and_b32 v9,0xffff0000,v22
v_fmac_f32 v6,v8,v30
v_fmac_f32 v7,v9,v30
v_lshlrev_b32 v8,16,v23
v_and_b32 v9,0xffff0000,v23
v_fmac_f32 v6,v8,v31
v_fmac_f32 v7,v9,v31
s_mov_b32 s14,1966080
buffer_load_dword v16,v3,s[20:23],s14 offen
ds_read_b32 v24,v5 offset:1024
s_mov_b32 s14,2088960
buffer_load_dword v17,v3,s[20:23],s14 offen
ds_read_b32 v25,v5 offset:1088
s_mov_b32 s14,2211840
buffer_load_dword v18,v3,s[20:23],s14 offen
ds_read_b32 v26,v5 offset:1152
s_mov_b32 s14,2334720
buffer_load_dword v19,v3,s[20:23],s14 offen
ds_read_b32 v27,v5 offset:1216
s_mov_b32 s14,2457600
buffer_load_dword v20,v3,s[20:23],s14 offen
ds_read_b32 v28,v5 offset:1280
s_mov_b32 s14,2580480
buffer_load_dword v21,v3,s[20:23],s14 offen
ds_read_b32 v29,v5 offset:1344
s_mov_b32 s14,2703360
buffer_load_dword v22,v3,s[20:23],s14 offen
ds_read_b32 v30,v5 offset:1408
s_mov_b32 s14,2826240
buffer_load_dword v23,v3,s[20:23],s14 offen
ds_read_b32 v31,v5 offset:1472
s_waitcnt vmcnt(0) lgkmcnt(0)
v_lshlrev_b32 v8,16,v16
v_and_b32 v9,0xffff0000,v16
v_fmac_f32 v6,v8,v24
v_fmac_f32 v7,v9,v24
v_lshlrev_b32 v8,16,v17
v_and_b32 v9,0xffff0000,v17
v_fmac_f32 v6,v8,v25
v_fmac_f32 v7,v9,v25
v_lshlrev_b32 v8,16,v18
v_and_b32 v9,0xffff0000,v18
v_fmac_f32 v6,v8,v26
v_fmac_f32 v7,v9,v26
v_lshlrev_b32 v8,16,v19
v_and_b32 v9,0xffff0000,v19
v_fmac_f32 v6,v8,v27
v_fmac_f32 v7,v9,v27
v_lshlrev_b32 v8,16,v20
v_and_b32 v9,0xffff0000,v20
v_fmac_f32 v6,v8,v28
v_fmac_f32 v7,v9,v28
v_lshlrev_b32 v8,16,v21
v_and_b32 v9,0xffff0000,v21
v_fmac_f32 v6,v8,v29
v_fmac_f32 v7,v9,v29
v_lshlrev_b32 v8,16,v22
v_and_b32 v9,0xffff0000,v22
v_fmac_f32 v6,v8,v30
v_fmac_f32 v7,v9,v30
v_lshlrev_b32 v8,16,v23
v_and_b32 v9,0xffff0000,v23
v_fmac_f32 v6,v8,v31
v_fmac_f32 v7,v9,v31
s_mov_b32 s14,2949120
buffer_load_dword v16,v3,s[20:23],s14 offen
ds_read_b32 v24,v5 offset:1536
s_mov_b32 s14,3072000
buffer_load_dword v17,v3,s[20:23],s14 offen
ds_read_b32 v25,v5 offset:1600
s_mov_b32 s14,3194880
buffer_load_dword v18,v3,s[20:23],s14 offen
ds_read_b32 v26,v5 offset:1664
s_mov_b32 s14,3317760
buffer_load_dword v19,v3,s[20:23],s14 offen
ds_read_b32 v27,v5 offset:1728
s_mov_b32 s14,3440640
buffer_load_dword v20,v3,s[20:23],s14 offen
ds_read_b32 v28,v5 offset:1792
s_mov_b32 s14,3563520
buffer_load_dword v21,v3,s[20:23],s14 offen
ds_read_b32 v29,v5 offset:1856
s_mov_b32 s14,3686400
buffer_load_dword v22,v3,s[20:23],s14 offen
ds_read_b32 v30,v5 offset:1920
s_mov_b32 s14,3809280
buffer_load_dword v23,v3,s[20:23],s14 offen
ds_read_b32 v31,v5 offset:1984
s_waitcnt vmcnt(0) lgkmcnt(0)
v_lshlrev_b32 v8,16,v16
v_and_b32 v9,0xffff0000,v16
v_fmac_f32 v6,v8,v24
v_fmac_f32 v7,v9,v24
v_lshlrev_b32 v8,16,v17
v_and_b32 v9,0xffff0000,v17
v_fmac_f32 v6,v8,v25
v_fmac_f32 v7,v9,v25
v_lshlrev_b32 v8,16,v18
v_and_b32 v9,0xffff0000,v18
v_fmac_f32 v6,v8,v26
v_fmac_f32 v7,v9,v26
v_lshlrev_b32 v8,16,v19
v_and_b32 v9,0xffff0000,v19
v_fmac_f32 v6,v8,v27
v_fmac_f32 v7,v9,v27
v_lshlrev_b32 v8,16,v20
v_and_b32 v9,0xffff0000,v20
v_fmac_f32 v6,v8,v28
v_fmac_f32 v7,v9,v28
v_lshlrev_b32 v8,16,v21
v_and_b32 v9,0xffff0000,v21
v_fmac_f32 v6,v8,v29
v_fmac_f32 v7,v9,v29
v_lshlrev_b32 v8,16,v22
v_and_b32 v9,0xffff0000,v22
v_fmac_f32 v6,v8,v30
v_fmac_f32 v7,v9,v30
v_lshlrev_b32 v8,16,v23
v_and_b32 v9,0xffff0000,v23
v_fmac_f32 v6,v8,v31
v_fmac_f32 v7,v9,v31
s_mov_b32 s14,3932160
buffer_load_dword v16,v3,s[20:23],s14 offen
ds_read_b32 v24,v5 offset:2048
s_mov_b32 s14,4055040
buffer_load_dword v17,v3,s[20:23],s14 offen
ds_read_b32 v25,v5 offset:2112
s_mov_b32 s14,4177920
buffer_load_dword v18,v3,s[20:23],s14 offen
ds_read_b32 v26,v5 offset:2176
s_mov_b32 s14,4300800
buffer_load_dword v19,v3,s[20:23],s14 offen
ds_read_b32 v27,v5 offset:2240
s_mov_b32 s14,4423680
buffer_load_dword v20,v3,s[20:23],s14 offen
ds_read_b32 v28,v5 offset:2304
s_mov_b32 s14,4546560
buffer_load_dword v21,v3,s[20:23],s14 offen
ds_read_b32 v29,v5 offset:2368
s_mov_b32 s14,4669440
buffer_load_dword v22,v3,s[20:23],s14 offen
ds_read_b32 v30,v5 offset:2432
s_mov_b32 s14,4792320
buffer_load_dword v23,v3,s[20:23],s14 offen
ds_read_b32 v31,v5 offset:2496
s_waitcnt vmcnt(0) lgkmcnt(0)
v_lshlrev_b32 v8,16,v16
v_and_b32 v9,0xffff0000,v16
v_fmac_f32 v6,v8,v24
v_fmac_f32 v7,v9,v24
v_lshlrev_b32 v8,16,v17
v_and_b32 v9,0xffff0000,v17
v_fmac_f32 v6,v8,v25
v_fmac_f32 v7,v9,v25
v_lshlrev_b32 v8,16,v18
v_and_b32 v9,0xffff0000,v18
v_fmac_f32 v6,v8,v26
v_fmac_f32 v7,v9,v26
v_lshlrev_b32 v8,16,v19
v_and_b32 v9,0xffff0000,v19
v_fmac_f32 v6,v8,v27
v_fmac_f32 v7,v9,v27
v_lshlrev_b32 v8,16,v20
v_and_b32 v9,0xffff0000,v20
v_fmac_f32 v6,v8,v28
v_fmac_f32 v7,v9,v28
v_lshlrev_b32 v8,16,v21
v_and_b32 v9,0xffff0000,v21
v_fmac_f32 v6,v8,v29
v_fmac_f32 v7,v9,v29
v_lshlrev_b32 v8,16,v22
v_and_b32 v9,0xffff0000,v22
v_fmac_f32 v6,v8,v30
v_fmac_f32 v7,v9,v30
v_lshlrev_b32 v8,16,v23
v_and_b32 v9,0xffff0000,v23
v_fmac_f32 v6,v8,v31
v_fmac_f32 v7,v9,v31
s_barrier
v_lshlrev_b32 v8,7,v2
v_lshlrev_b32 v9,3,v1
v_add_u32 v8,v8,v9
ds_write_b64 v8,v[6:7] offset:4096
s_waitcnt lgkmcnt(0)
s_barrier
v_cmp_gt_u32 vcc,32,v0
s_and_saveexec_b64 s[14:15],vcc
s_cbranch_execz prep_end
v_lshlrev_b32 v8,2,v0
ds_read_b32 v16,v8 offset:4096
ds_read_b32 v17,v8 offset:4224
ds_read_b32 v18,v8 offset:4352
ds_read_b32 v19,v8 offset:4480
ds_read_b32 v20,v8 offset:4608
ds_read_b32 v21,v8 offset:4736
ds_read_b32 v22,v8 offset:4864
ds_read_b32 v23,v8 offset:4992
ds_read_b32 v24,v8 offset:5120
ds_read_b32 v25,v8 offset:5248
ds_read_b32 v26,v8 offset:5376
ds_read_b32 v27,v8 offset:5504
ds_read_b32 v28,v8 offset:5632
ds_read_b32 v29,v8 offset:5760
ds_read_b32 v30,v8 offset:5888
ds_read_b32 v31,v8 offset:6016
s_waitcnt lgkmcnt(0)
v_add_f32 v16,v16,v24
v_add_f32 v17,v17,v25
v_add_f32 v18,v18,v26
v_add_f32 v19,v19,v27
v_add_f32 v20,v20,v28
v_add_f32 v21,v21,v29
v_add_f32 v22,v22,v30
v_add_f32 v23,v23,v31
v_add_f32 v16,v16,v20
v_add_f32 v17,v17,v21
v_add_f32 v18,v18,v22
v_add_f32 v19,v19,v23
v_add_f32 v16,v16,v18
v_add_f32 v17,v17,v19
v_add_f32 v16,v16,v17
cv v16,v16,v16
v_lshlrev_b32 v16,16,v16
s_lshl_b32 s3,s2,7
v_add_u32 v8,s3,v8
buffer_store_dword v16,v8,s[24:27],0 offen
s_branch prep_end
prep_clear:
s_add_u32 s16,s4,0x12800
s_addc_u32 s17,s5,0
s_mov_b32 s18,0x232800
s_mov_b32 s19,0x00020000
s_sub_u32 s3,s2,120
s_lshl_b32 s14,s3,8
v_add_u32 v1,s14,v0
v_lshlrev_b32 v1,4,v1
v_mov_b32 v4,-1
v_mov_b32 v5,-1
v_mov_b32 v6,-1
v_mov_b32 v7,-1
s_mov_b32 s14,0
buffer_store_dwordx4 v[4:7],v1,s[16:19],s14 offen
s_mov_b32 s14,163840
buffer_store_dwordx4 v[4:7],v1,s[16:19],s14 offen
s_mov_b32 s14,327680
buffer_store_dwordx4 v[4:7],v1,s[16:19],s14 offen
s_mov_b32 s14,491520
buffer_store_dwordx4 v[4:7],v1,s[16:19],s14 offen
s_mov_b32 s14,655360
buffer_store_dwordx4 v[4:7],v1,s[16:19],s14 offen
s_mov_b32 s14,819200
buffer_store_dwordx4 v[4:7],v1,s[16:19],s14 offen
s_mov_b32 s14,983040
buffer_store_dwordx4 v[4:7],v1,s[16:19],s14 offen
s_mov_b32 s14,1146880
buffer_store_dwordx4 v[4:7],v1,s[16:19],s14 offen
s_mov_b32 s14,1310720
buffer_store_dwordx4 v[4:7],v1,s[16:19],s14 offen
s_mov_b32 s14,1474560
buffer_store_dwordx4 v[4:7],v1,s[16:19],s14 offen
s_mov_b32 s14,1638400
buffer_store_dwordx4 v[4:7],v1,s[16:19],s14 offen
s_mov_b32 s14,1802240
buffer_store_dwordx4 v[4:7],v1,s[16:19],s14 offen
s_mov_b32 s14,1966080
buffer_store_dwordx4 v[4:7],v1,s[16:19],s14 offen
s_mov_b32 s14,2129920
buffer_store_dwordx4 v[4:7],v1,s[16:19],s14 offen
s_mov_b32 s14,2293760
buffer_store_dwordx4 v[4:7],v1,s[16:19],s14 offen
s_cmp_lg_u32 s3,1
s_cbranch_scc1 prep_nf
s_mov_b32 s28,s4
s_mov_b32 s29,s5
s_mov_b32 s30,0x10000
s_mov_b32 s31,0x00020000
v_lshlrev_b32 v1,4,v0
s_mov_b32 s14,32768
buffer_store_dwordx4 v[4:7],v1,s[28:31],s14 offen
s_mov_b32 s14,36864
buffer_store_dwordx4 v[4:7],v1,s[28:31],s14 offen
s_mov_b32 s14,40960
buffer_store_dwordx4 v[4:7],v1,s[28:31],s14 offen
s_mov_b32 s14,45056
buffer_store_dwordx4 v[4:7],v1,s[28:31],s14 offen
s_mov_b32 s14,49152
buffer_store_dwordx4 v[4:7],v1,s[28:31],s14 offen
s_mov_b32 s14,53248
buffer_store_dwordx4 v[4:7],v1,s[28:31],s14 offen
s_mov_b32 s14,57344
buffer_store_dwordx4 v[4:7],v1,s[28:31],s14 offen
s_mov_b32 s14,61440
buffer_store_dwordx4 v[4:7],v1,s[28:31],s14 offen
v_mov_b32 v12,0
v_mov_b32 v13,0
v_mov_b32 v14,0
v_mov_b32 v15,0
v_cmp_gt_u32 vcc,16,v0
s_and_saveexec_b64 s[14:15],vcc
s_cbranch_execz prep_end
s_mov_b32 s16,32512
buffer_store_dwordx4 v[12:15],v1,s[28:31],s16 offen
s_branch prep_end
prep_nf:
s_cmp_lg_u32 s3,0
s_cbranch_scc1 prep_end
s_mov_b32 s20,s12
s_mov_b32 s21,s13
s_mov_b32 s22,0x2800
s_mov_b32 s23,0x00020000
s_add_u32 s24,s4,0x10000
s_addc_u32 s25,s5,0
s_mov_b32 s26,0x2800
s_mov_b32 s27,0x00020000
v_add_u32 v1,0,v0
v_mul_u32_u24 v2,0x334,v1
v_lshrrev_b32 v2,16,v2
v_mul_u32_u24 v3,80,v2
v_sub_u32 v3,v1,v3
v_lshlrev_b32 v8,4,v1
buffer_load_dwordx4 v[12:15],v8,s[20:23],0 offen
v_lshlrev_b32 v9,7,v3
v_lshlrev_b32 v10,4,v2
v_add_u32 v9,v9,v10
v_mov_b32 v10,0x7fffff00
v_cmp_gt_u32 vcc,640,v1
s_nop 1
v_cndmask_b32 v9,v10,v9,vcc
s_waitcnt vmcnt(0)
buffer_store_dwordx4 v[12:15],v9,s[24:27],0 offen
s_nop 1
v_add_u32 v1,256,v0
v_mul_u32_u24 v2,0x334,v1
v_lshrrev_b32 v2,16,v2
v_mul_u32_u24 v3,80,v2
v_sub_u32 v3,v1,v3
v_lshlrev_b32 v8,4,v1
buffer_load_dwordx4 v[12:15],v8,s[20:23],0 offen
v_lshlrev_b32 v9,7,v3
v_lshlrev_b32 v10,4,v2
v_add_u32 v9,v9,v10
v_mov_b32 v10,0x7fffff00
v_cmp_gt_u32 vcc,640,v1
s_nop 1
v_cndmask_b32 v9,v10,v9,vcc
s_waitcnt vmcnt(0)
buffer_store_dwordx4 v[12:15],v9,s[24:27],0 offen
s_nop 1
v_add_u32 v1,512,v0
v_mul_u32_u24 v2,0x334,v1
v_lshrrev_b32 v2,16,v2
v_mul_u32_u24 v3,80,v2
v_sub_u32 v3,v1,v3
v_lshlrev_b32 v8,4,v1
buffer_load_dwordx4 v[12:15],v8,s[20:23],0 offen
v_lshlrev_b32 v9,7,v3
v_lshlrev_b32 v10,4,v2
v_add_u32 v9,v9,v10
v_mov_b32 v10,0x7fffff00
v_cmp_gt_u32 vcc,640,v1
s_nop 1
v_cndmask_b32 v9,v10,v9,vcc
s_waitcnt vmcnt(0)
buffer_store_dwordx4 v[12:15],v9,s[24:27],0 offen
s_nop 1
prep_end:
s_endpgm
.section .rodata,"a"
.p2align 6
.amdhsa_kernel prep_kernel
.amdhsa_next_free_vgpr 64
.amdhsa_next_free_sgpr 102
.amdhsa_accum_offset 64
.amdhsa_group_segment_fixed_size 0
.amdhsa_kernarg_size 136
.amdhsa_user_sgpr_count 2
.amdhsa_user_sgpr_kernarg_segment_ptr 1
.amdhsa_system_sgpr_workgroup_id_x 1
.end_amdhsa_kernel
.text
.text
.globl mega_kernel
.p2align 8
.type mega_kernel,@function
mega_kernel:
s_cmp_ge_u32 s2,256
s_cbranch_scc1 mega_exit2
s_load_dwordx2 s[12:13],s[0:1],128
v_lshrrev_b32 v4,6,v0
s_nop 0
v_readfirstlane_b32 s100,v4
s_waitcnt lgkmcnt(0)
s_mov_b32 s92,s12
s_mov_b32 s93,s13
s_mov_b32 s94,0x10000
s_mov_b32 s95,0x00020000
s_add_u32 s88,s12,0x10000
s_addc_u32 s89,s13,0
s_mov_b32 s90,0x235000
s_mov_b32 s91,0x00020000
s_mov_b32 s96,s2
s_mov_b32 s101,0
s_mov_b32 s2,s96
s_mov_b32 s97,0x7fffffff
s_cmp_lt_u32 s96,32
s_cbranch_scc1 chain_entry
s_cmp_ge_u32 s96,160
s_cbranch_scc1 task_take
s_cmp_lt_u32 s96,112
s_cselect_b32 s101,1,0
s_sub_u32 s2,s96,32
s_lshl_b32 s98,s2,2
s_add_u32 s98,s98,49152
s_branch vo_kernel_entry
task_done:
s_mov_b64 exec,-1
s_waitcnt vmcnt(0) lgkmcnt(0)
s_barrier
s_cmp_lg_u32 s100,0
s_cbranch_scc1 task_take
v_mov_b32 v251,0
s_mov_b64 exec,1
buffer_store_dword v251,off,s[92:95],s98 sc1
s_mov_b64 exec,-1
s_branch task_take
task_next:
s_mov_b64 exec,-1
s_waitcnt vmcnt(0) lgkmcnt(0)
s_barrier
task_take:
s_cmp_eq_u32 s101,0
s_cbranch_scc1 task_take2
s_mov_b32 s101,0
s_mov_b32 s2,s96
s_branch chain_entry
task_take2:
s_cmp_lt_u32 s96,112
s_cbranch_scc1 tq_post
s_cmp_ge_u32 s96,1000
s_cbranch_scc1 tq_x
s_cmp_lg_u32 s100,0
s_cbranch_scc1 tk_1
v_mov_b32 v251,1
s_mov_b32 s23,32640
s_mov_b64 exec,1
buffer_atomic_add v251,off,s[92:95],s23 sc0 sc1
s_waitcnt vmcnt(0)
v_mov_b32 v252,0
ds_write_b32 v252,v251
s_waitcnt lgkmcnt(0)
s_mov_b64 exec,-1
tk_1:
s_barrier
v_mov_b32 v252,0
ds_read_b32 v251,v252
s_waitcnt lgkmcnt(0)
s_nop 0
v_readfirstlane_b32 s97,v251
s_nop 3
s_barrier
s_cmp_lt_u32 s97,64
s_cbranch_scc1 task_l1
s_mov_b32 s96,1000
tq_x:
s_cmp_ge_u32 s96,1008
s_cbranch_scc1 tq_post
s_getreg_b32 s22,hwreg(HW_REG_XCC_ID)
s_add_u32 s22,s22,s96
s_and_b32 s61,s22,7
s_lshl_b32 s62,s61,2
s_add_u32 s62,s62,32512
s_cmp_lg_u32 s100,0
s_cbranch_scc1 tk_2
v_mov_b32 v251,1
s_mov_b32 s23,s62
s_mov_b64 exec,1
buffer_atomic_add v251,off,s[92:95],s23 sc0 sc1
s_waitcnt vmcnt(0)
v_mov_b32 v252,0
ds_write_b32 v252,v251
s_waitcnt lgkmcnt(0)
s_mov_b64 exec,-1
tk_2:
s_barrier
v_mov_b32 v252,0
ds_read_b32 v251,v252
s_waitcnt lgkmcnt(0)
s_nop 0
v_readfirstlane_b32 s97,v251
s_nop 3
s_barrier
s_cmp_lt_u32 s97,72
s_cbranch_scc1 tq_go
s_add_u32 s96,s96,1
s_branch tq_x
tq_go:
s_mov_b32 s22,s97
s_lshr_b32 s62,s22,3
s_bfe_u32 s23,s22,0x20001
s_lshl_b32 s23,s23,3
s_add_u32 s23,s23,s61
s_lshl_b32 s23,s23,1
s_and_b32 s22,s22,1
s_add_u32 s23,s23,s22
s_mov_b32 s97,100
s_cmp_ge_u32 s62,2
s_cbranch_scc1 tq_full
s_lshl_b32 s24,s62,6
s_add_u32 s24,s24,s23
s_branch task_h_in
tq_full:
s_sub_u32 s62,s62,1
s_lshl_b32 s24,s62,6
s_add_u32 s24,s24,s23
s_branch task_t
tq_post:
s_cmp_lg_u32 s100,0
s_cbranch_scc1 tk_3
v_mov_b32 v251,1
s_mov_b32 s23,32576
s_mov_b64 exec,1
buffer_atomic_add v251,off,s[92:95],s23 sc0 sc1
s_waitcnt vmcnt(0)
v_mov_b32 v252,0
ds_write_b32 v252,v251
s_waitcnt lgkmcnt(0)
s_mov_b64 exec,-1
tk_3:
s_barrier
v_mov_b32 v252,0
ds_read_b32 v251,v252
s_waitcnt lgkmcnt(0)
s_nop 0
v_readfirstlane_b32 s97,v251
s_nop 3
s_barrier
s_add_u32 s97,s97,576
s_branch task_post
s_cmp_lg_u32 s100,0
s_cbranch_scc1 tk_4
v_mov_b32 v251,1
s_mov_b32 s23,32640
s_mov_b64 exec,1
buffer_atomic_add v251,off,s[92:95],s23 sc0 sc1
s_waitcnt vmcnt(0)
v_mov_b32 v252,0
ds_write_b32 v252,v251
s_waitcnt lgkmcnt(0)
s_mov_b64 exec,-1
tk_4:
s_barrier
v_mov_b32 v252,0
ds_read_b32 v251,v252
s_waitcnt lgkmcnt(0)
s_nop 0
v_readfirstlane_b32 s97,v251
s_nop 3
s_barrier
s_cmp_lt_u32 s97,8
s_cbranch_scc1 task_l1
s_cmp_ge_u32 s97,56
s_cbranch_scc1 task_nv
s_add_u32 s2,s97,72
s_lshl_b32 s98,s2,2
s_add_u32 s98,s98,49152
s_branch vo_kernel_entry
task_nv:
s_sub_u32 s97,s97,48
s_cmp_lt_u32 s97,64
s_cbranch_scc1 task_l1
s_sub_u32 s24,s97,64
s_cmp_ge_u32 s24,128
s_cbranch_scc1 task_nh
task_h_in:
s_cmp_lg_u32 s100,0
s_cbranch_scc1 task_h_go
s_mov_b32 s22,45312
v_and_b32 v250,63,v0
v_add_u32 v250,0,v250
v_min_u32 v250,7,v250
v_lshlrev_b32 v252,2,v250
s_mov_b32 s60,0
w_h:
buffer_load_dword v250,v252,s[92:95],s22 offen sc1
s_waitcnt vmcnt(0)
v_cmp_ne_u32 vcc,-1,v250
s_nop 1
s_cmp_eq_u64 vcc,exec
s_cbranch_scc1 w_h_ok
s_sleep 8
s_add_u32 s60,s60,1
s_cmp_gt_u32 s60,400000
s_cbranch_scc1 mega_exit
s_branch w_h
w_h_ok:
task_h_go:
s_barrier
s_lshr_b32 s2,s24,1
s_and_b32 s22,s2,31
s_lshl_b32 s22,s22,2
s_cmp_ge_u32 s2,32
s_cbranch_scc1 task_h1
s_add_u32 s98,s22,32768
s_add_u32 s99,s22,33792
s_add_u32 s23,s22,34816
s_branch task_h2
task_h1:
s_add_u32 s98,s22,53248
s_add_u32 s99,s22,53376
s_add_u32 s23,s22,53504
task_h2:
s_bitcmp1_b32 s24,0
s_cbranch_scc0 t2h_kernel_entry
s_mov_b32 s98,s23
s_branch t1h_kernel_entry
task_nh:
s_sub_u32 s97,s97,64
s_cmp_ge_u32 s97,576
s_cbranch_scc1 task_post
s_sub_u32 s24,s97,64
s_cmp_ge_u32 s97,64
s_cbranch_scc1 task_t
task_l1:
s_mov_b32 s2,s97
s_lshl_b32 s98,s97,2
s_add_u32 s98,s98,45312
s_branch ln1_kernel_entry
task_t:
s_cmp_lg_u32 s100,0
s_cbranch_scc1 task_t_go
s_lshr_b32 s22,s24,6
s_lshl_b32 s22,s22,5
s_add_u32 s22,s22,45312
v_and_b32 v250,63,v0
v_add_u32 v250,0,v250
v_min_u32 v250,7,v250
v_lshlrev_b32 v252,2,v250
s_mov_b32 s60,0
w_t:
buffer_load_dword v250,v252,s[92:95],s22 offen sc1
s_waitcnt vmcnt(0)
v_cmp_ne_u32 vcc,-1,v250
s_nop 1
s_cmp_eq_u64 vcc,exec
s_cbranch_scc1 w_t_ok
s_sleep 8
s_add_u32 s60,s60,1
s_cmp_gt_u32 s60,400000
s_cbranch_scc1 mega_exit
s_branch w_t
w_t_ok:
task_t_go:
s_barrier
s_lshr_b32 s22,s24,6
s_bfe_u32 s23,s24,0x50001
s_lshl_b32 s2,s22,5
s_add_u32 s2,s2,s23
s_lshl_b32 s22,s2,2
s_bitcmp1_b32 s24,0
s_cbranch_scc1 task_t1
s_add_u32 s98,s22,32768
s_branch t2_kernel_entry
task_t1:
s_add_u32 s98,s22,34816
s_add_u32 s99,s22,33792
s_branch t1_kernel_entry
task_post:
s_sub_u32 s22,s97,576
s_mul_i32 s24,s22,1425
s_lshr_b32 s24,s24,16
s_mul_i32 s23,s24,46
s_sub_u32 s25,s22,s23
s_cmp_ge_u32 s24,73
s_cbranch_scc1 mega_exit
s_cmp_ge_u32 s25,41
s_cbranch_scc1 task_f2
s_cmp_ge_u32 s25,29
s_cbranch_scc1 task_f1
s_cmp_ge_u32 s25,28
s_cbranch_scc1 task_ln2
s_cmp_ge_u32 s25,8
s_cbranch_scc1 task_po
s_cmp_ge_u32 s24,64
s_cbranch_scc1 task_take
s_lshl_b32 s2,s24,3
s_add_u32 s2,s2,s25
s_lshl_b32 s98,s2,2
s_add_u32 s98,s98,36864
s_cmp_lg_u32 s100,0
s_cbranch_scc1 task_pa_go
s_lshr_b32 s22,s24,3
s_lshl_b32 s22,s22,7
s_add_u32 s22,s22,34816
v_and_b32 v250,63,v0
v_add_u32 v250,0,v250
v_min_u32 v250,31,v250
v_lshlrev_b32 v252,2,v250
s_mov_b32 s60,0
w_pa1:
buffer_load_dword v250,v252,s[92:95],s22 offen sc1
s_waitcnt vmcnt(0)
v_cmp_ne_u32 vcc,-1,v250
s_nop 1
s_cmp_eq_u64 vcc,exec
s_cbranch_scc1 w_pa1_ok
s_sleep 32
s_add_u32 s60,s60,1
s_cmp_gt_u32 s60,400000
s_cbranch_scc1 mega_exit
s_branch w_pa1
w_pa1_ok:
s_cmp_ge_u32 s24,8
s_cbranch_scc1 w_pa1x_ok
s_mov_b32 s22,53504
v_and_b32 v250,63,v0
v_add_u32 v250,0,v250
v_min_u32 v250,31,v250
v_lshlrev_b32 v252,2,v250
s_mov_b32 s60,0
w_pa1x:
buffer_load_dword v250,v252,s[92:95],s22 offen sc1
s_waitcnt vmcnt(0)
v_cmp_ne_u32 vcc,-1,v250
s_nop 1
s_cmp_eq_u64 vcc,exec
s_cbranch_scc1 w_pa1x_ok
s_sleep 32
s_add_u32 s60,s60,1
s_cmp_gt_u32 s60,400000
s_cbranch_scc1 mega_exit
s_branch w_pa1x
w_pa1x_ok:
task_pa_go:
s_add_u32 s99,s24,1
s_mul_i32 s99,s99,20480
s_mul_i32 s22,s25,2560
s_add_u32 s99,s99,s22
s_add_u32 s99,s99,983040
s_barrier
s_branch pattn_kernel_entry
task_po:
s_sub_u32 s24,s24,2
s_cmp_ge_u32 s24,64
s_cbranch_scc1 task_take
s_sub_u32 s25,s25,8
s_lshl_b32 s2,s24,5
s_add_u32 s2,s2,s25
s_lshl_b32 s98,s2,2
s_add_u32 s98,s98,57344
s_cmp_lg_u32 s100,0
s_cbranch_scc1 task_po_go
s_add_u32 s22,s24,1
s_mul_i32 s22,s22,10240
v_and_b32 v250,63,v0
v_add_u32 v250,0,v250
v_min_u32 v250,79,v250
v_lshlrev_b32 v252,7,v250
v_and_b32 v250,63,v0
v_add_u32 v250,64,v250
v_min_u32 v250,79,v250
v_lshlrev_b32 v253,7,v250
s_mov_b32 s60,0
w_po:
buffer_load_dword v250,v252,s[88:91],s22 offen sc1
buffer_load_dword v251,v253,s[88:91],s22 offen sc1
s_waitcnt vmcnt(0)
v_max_u32 v250,v250,v251
v_cmp_ne_u32 vcc,-1,v250
s_nop 1
s_cmp_eq_u64 vcc,exec
s_cbranch_scc1 w_po_ok
s_sleep 32
s_add_u32 s60,s60,1
s_cmp_gt_u32 s60,400000
s_cbranch_scc1 mega_exit
s_branch w_po
w_po_ok:
task_po_go:
s_lshl_b32 s99,s24,5
s_add_u32 s99,s99,36864
s_barrier
s_branch pout_kernel_entry
task_ln2:
s_sub_u32 s24,s24,4
s_cmp_ge_u32 s24,64
s_cbranch_scc1 task_take
s_mov_b32 s2,s24
s_lshl_b32 s98,s24,2
s_add_u32 s98,s98,45056
s_cmp_lg_u32 s100,0
s_cbranch_scc1 task_ln2_go
s_lshl_b32 s22,s24,7
s_add_u32 s22,s22,57344
v_and_b32 v250,63,v0
v_add_u32 v250,0,v250
v_min_u32 v250,19,v250
v_lshlrev_b32 v252,2,v250
s_mov_b32 s60,0
w_ln2:
buffer_load_dword v250,v252,s[92:95],s22 offen sc1
s_waitcnt vmcnt(0)
v_cmp_ne_u32 vcc,-1,v250
s_nop 1
s_cmp_eq_u64 vcc,exec
s_cbranch_scc1 w_ln2_ok
s_sleep 32
s_add_u32 s60,s60,1
s_cmp_gt_u32 s60,400000
s_cbranch_scc1 mega_exit
s_branch w_ln2
w_ln2_ok:
task_ln2_go:
s_barrier
s_branch ln2_kernel_entry
task_f1:
s_sub_u32 s24,s24,7
s_cmp_ge_u32 s24,64
s_cbranch_scc1 task_take
s_sub_u32 s25,s25,29
s_and_b32 s22,s24,1
s_mul_i32 s22,s22,12
s_add_u32 s25,s25,s22
s_lshr_b32 s24,s24,1
s_lshl_b32 s2,s24,5
s_add_u32 s2,s2,s25
s_lshl_b32 s98,s2,2
s_add_u32 s98,s98,40960
s_lshl_b32 s99,s24,3
s_add_u32 s99,s99,45056
task_f1_go:
s_barrier
s_branch ffn1_kernel_entry
task_f2:
s_sub_u32 s24,s24,9
s_cmp_ge_u32 s24,64
s_cbranch_scc1 task_take
s_sub_u32 s25,s25,41
s_and_b32 s22,s24,1
s_mul_i32 s22,s22,5
s_add_u32 s25,s25,s22
s_lshr_b32 s24,s24,1
s_lshl_b32 s2,s24,4
s_add_u32 s2,s2,s25
s_mov_b32 s98,46080
s_lshl_b32 s99,s24,7
s_add_u32 s99,s99,40960
task_f2_go:
s_barrier
s_branch ffn2_kernel_entry
mega_exit:
s_endpgm
mega_exit2:
s_endpgm
chain_entry:
s_load_dwordx4 s[4:7],s[0:1],16
s_load_dwordx2 s[12:13],s[0:1],128
v_and_b32 v1,63,v0
v_lshrrev_b32 v2,4,v1
v_and_b32 v3,15,v0
v_lshrrev_b32 v4,6,v0
s_nop 0
v_readfirstlane_b32 s20,v4
s_nop 3
s_lshl_b32 s21,s20,10
s_waitcnt lgkmcnt(0)
s_add_u32 s44,s12,0x10000
s_addc_u32 s45,s13,0
s_mov_b32 s46,0xa5000
s_mov_b32 s47,0x00020000
s_add_u32 s48,s12,0x100000
s_addc_u32 s49,s13,0
s_mov_b32 s50,0x145000
s_mov_b32 s51,0x00020000
s_mul_i32 s22,s20,2560
v_lshlrev_b32 v5,4,v1
v_add_u32 v5,s22,v5
v_add_u32 v6,1024,v5
v_and_b32 v7,31,v1
v_lshlrev_b32 v7,4,v7
v_add_u32 v7,s22,v7
v_add_u32 v7,2048,v7
v_and_b32 v9,7,v3
v_lshlrev_b32 v8,7,v2
v_lshl_add_u32 v8,v9,4,v8
s_mov_b32 s40,0
s_mov_b32 s41,0
s_mov_b32 s42,0
s_cmp_lt_u32 s2,32
s_cselect_b32 s64,64,130
s_mov_b32 s65,100
s_cmp_ge_u32 s2,32
s_cbranch_scc1 chain_R
s_mul_i32 s26,s2,384
s_sub_u32 s27,7864320,s26
s_add_u32 s32,s4,s26
s_addc_u32 s33,s5,0
s_mov_b32 s34,s27
s_mov_b32 s35,0x00020000
s_add_u32 s36,s6,s26
s_addc_u32 s37,s7,0
s_mov_b32 s38,s27
s_mov_b32 s39,0x00020000
s_add_u32 s28,s26,58720256
s_add_u32 s52,s12,s28
s_addc_u32 s53,s13,0
s_mov_b32 s54,0x1800000
s_mov_b32 s55,0x00020000
s_mul_i32 s28,s2,3072
s_add_u32 s28,s28,2621440
s_add_u32 s56,s12,s28
s_addc_u32 s57,s13,0
s_mov_b32 s58,0x600000
s_mov_b32 s59,0x00020000
v_lshrrev_b32 v16,3,v1
v_lshl_add_u32 v17,v4,3,v16
v_bfe_u32 v18,v17,1,1
v_lshrrev_b32 v10,2,v17
v_lshrrev_b32 v16,3,v17
v_xor_b32 v10,v10,v16
v_and_b32 v10,1,v10
v_lshl_or_b32 v18,v10,1,v18
v_bfe_u32 v16,v1,1,2
v_xor_b32 v18,v18,v16
v_and_b32 v16,1,v1
v_lshl_or_b32 v18,v18,1,v16
v_lshlrev_b32 v18,4,v18
s_mov_b32 s22,12288
v_mul_lo_u32 v10,s22,v17
v_add_u32 v10,v10,v18
v_bfe_u32 v16,v1,2,2
v_lshl_add_u32 v17,v2,2,v16
v_lshlrev_b32 v17,7,v17
v_and_b32 v18,3,v1
v_lshl_add_u32 v17,v18,3,v17
v_lshrrev_b32 v16,1,v16
v_lshrrev_b32 v18,1,v2
v_xor_b32 v18,v18,v2
v_and_b32 v18,1,v18
v_lshl_or_b32 v19,v18,1,v16
v_xor_b32 v19,v4,v19
v_lshl_add_u32 v11,v19,5,v17
v_add_u32 v12,2048,v11
s_mul_i32 s22,s20,24576
s_add_u32 s22,s22,65536
v_lshlrev_b32 v13,4,v1
v_add_u32 v13,s22,v13
s_add_u32 m0,s21,0
s_mov_b32 s23,0
buffer_load_dwordx4 v10,s[32:35],s23 offen lds
s_add_u32 m0,s21,4096
s_mov_b32 s23,393216
buffer_load_dwordx4 v10,s[32:35],s23 offen lds
s_add_u32 m0,s21,8192
s_mov_b32 s23,786432
buffer_load_dwordx4 v10,s[32:35],s23 offen lds
s_add_u32 m0,s21,12288
s_mov_b32 s23,1179648
buffer_load_dwordx4 v10,s[32:35],s23 offen lds
s_add_u32 m0,s21,16384
s_mov_b32 s23,1572864
buffer_load_dwordx4 v10,s[32:35],s23 offen lds
s_add_u32 m0,s21,20480
s_mov_b32 s23,1966080
buffer_load_dwordx4 v10,s[32:35],s23 offen lds
s_add_u32 m0,s21,24576
s_mov_b32 s23,2359296
buffer_load_dwordx4 v10,s[32:35],s23 offen lds
s_add_u32 m0,s21,28672
s_mov_b32 s23,2752512
buffer_load_dwordx4 v10,s[32:35],s23 offen lds
s_add_u32 m0,s21,32768
s_mov_b32 s23,3145728
buffer_load_dwordx4 v10,s[32:35],s23 offen lds
s_add_u32 m0,s21,36864
s_mov_b32 s23,3538944
buffer_load_dwordx4 v10,s[32:35],s23 offen lds
s_add_u32 m0,s21,40960
s_mov_b32 s23,3932160
buffer_load_dwordx4 v10,s[32:35],s23 offen lds
s_add_u32 m0,s21,45056
s_mov_b32 s23,4325376
buffer_load_dwordx4 v10,s[32:35],s23 offen lds
s_add_u32 m0,s21,49152
s_mov_b32 s23,4718592
buffer_load_dwordx4 v10,s[32:35],s23 offen lds
s_add_u32 m0,s21,53248
s_mov_b32 s23,5111808
buffer_load_dwordx4 v10,s[32:35],s23 offen lds
s_add_u32 m0,s21,57344
s_mov_b32 s23,5505024
buffer_load_dwordx4 v10,s[32:35],s23 offen lds
s_waitcnt vmcnt(10)
s_barrier
tr v[40:41],v11,0
tr v[42:43],v12,0
tr v[44:45],v11,4096
tr v[46:47],v12,4096
tr v[48:49],v11,8192
tr v[50:51],v12,8192
tr v[52:53],v11,12288
tr v[54:55],v12,12288
tr v[56:57],v11,16384
tr v[58:59],v12,16384
s_waitcnt lgkmcnt(0)
v_accvgpr_write_b32 a0,v40
v_accvgpr_write_b32 a2,v41
v_accvgpr_write_b32 a4,v42
v_accvgpr_write_b32 a6,v43
v_accvgpr_write_b32 a1,v44
v_accvgpr_write_b32 a3,v45
v_accvgpr_write_b32 a5,v46
v_accvgpr_write_b32 a7,v47
v_accvgpr_write_b32 a8,v48
v_accvgpr_write_b32 a10,v49
v_accvgpr_write_b32 a12,v50
v_accvgpr_write_b32 a14,v51
v_accvgpr_write_b32 a9,v52
v_accvgpr_write_b32 a11,v53
v_accvgpr_write_b32 a13,v54
v_accvgpr_write_b32 a15,v55
v_accvgpr_write_b32 a16,v56
v_accvgpr_write_b32 a18,v57
v_accvgpr_write_b32 a20,v58
v_accvgpr_write_b32 a22,v59
s_waitcnt lgkmcnt(0)
s_barrier
s_add_u32 m0,s21,0
s_mov_b32 s23,5898240
buffer_load_dwordx4 v10,s[32:35],s23 offen lds
s_add_u32 m0,s21,4096
s_mov_b32 s23,6291456
buffer_load_dwordx4 v10,s[32:35],s23 offen lds
s_add_u32 m0,s21,8192
s_mov_b32 s23,6684672
buffer_load_dwordx4 v10,s[32:35],s23 offen lds
s_add_u32 m0,s21,12288
s_mov_b32 s23,7077888
buffer_load_dwordx4 v10,s[32:35],s23 offen lds
s_add_u32 m0,s21,16384
s_mov_b32 s23,7471104
buffer_load_dwordx4 v10,s[32:35],s23 offen lds
s_waitcnt vmcnt(10)
s_barrier
tr v[40:41],v11,20480
tr v[42:43],v12,20480
tr v[44:45],v11,24576
tr v[46:47],v12,24576
tr v[48:49],v11,28672
tr v[50:51],v12,28672
tr v[52:53],v11,32768
tr v[54:55],v12,32768
tr v[56:57],v11,36864
tr v[58:59],v12,36864
s_waitcnt lgkmcnt(0)
v_accvgpr_write_b32 a17,v40
v_accvgpr_write_b32 a19,v41
v_accvgpr_write_b32 a21,v42
v_accvgpr_write_b32 a23,v43
v_accvgpr_write_b32 a24,v44
v_accvgpr_write_b32 a26,v45
v_accvgpr_write_b32 a28,v46
v_accvgpr_write_b32 a30,v47
v_accvgpr_write_b32 a25,v48
v_accvgpr_write_b32 a27,v49
v_accvgpr_write_b32 a29,v50
v_accvgpr_write_b32 a31,v51
v_accvgpr_write_b32 a32,v52
v_accvgpr_write_b32 a34,v53
v_accvgpr_write_b32 a36,v54
v_accvgpr_write_b32 a38,v55
v_accvgpr_write_b32 a33,v56
v_accvgpr_write_b32 a35,v57
v_accvgpr_write_b32 a37,v58
v_accvgpr_write_b32 a39,v59
s_waitcnt lgkmcnt(0)
s_barrier
s_add_u32 m0,s21,20480
s_mov_b32 s23,128
buffer_load_dwordx4 v10,s[32:35],s23 offen lds
s_add_u32 m0,s21,24576
s_mov_b32 s23,393344
buffer_load_dwordx4 v10,s[32:35],s23 offen lds
s_add_u32 m0,s21,28672
s_mov_b32 s23,786560
buffer_load_dwordx4 v10,s[32:35],s23 offen lds
s_add_u32 m0,s21,32768
s_mov_b32 s23,1179776
buffer_load_dwordx4 v10,s[32:35],s23 offen lds
s_add_u32 m0,s21,36864
s_mov_b32 s23,1572992
buffer_load_dwordx4 v10,s[32:35],s23 offen lds
s_waitcnt vmcnt(10)
s_barrier
tr v[40:41],v11,40960
tr v[42:43],v12,40960
tr v[44:45],v11,45056
tr v[46:47],v12,45056
tr v[48:49],v11,49152
tr v[50:51],v12,49152
tr v[52:53],v11,53248
tr v[54:55],v12,53248
tr v[56:57],v11,57344
tr v[58:59],v12,57344
s_waitcnt lgkmcnt(0)
v_accvgpr_write_b32 a40,v40
v_accvgpr_write_b32 a42,v41
v_accvgpr_write_b32 a44,v42
v_accvgpr_write_b32 a46,v43
v_accvgpr_write_b32 a41,v44
v_accvgpr_write_b32 a43,v45
v_accvgpr_write_b32 a45,v46
v_accvgpr_write_b32 a47,v47
v_accvgpr_write_b32 a48,v48
v_accvgpr_write_b32 a50,v49
v_accvgpr_write_b32 a52,v50
v_accvgpr_write_b32 a54,v51
v_accvgpr_write_b32 a49,v52
v_accvgpr_write_b32 a51,v53
v_accvgpr_write_b32 a53,v54
v_accvgpr_write_b32 a55,v55
v_accvgpr_write_b32 a56,v56
v_accvgpr_write_b32 a58,v57
v_accvgpr_write_b32 a60,v58
v_accvgpr_write_b32 a62,v59
s_waitcnt lgkmcnt(0)
s_barrier
s_add_u32 m0,s21,40960
s_mov_b32 s23,1966208
buffer_load_dwordx4 v10,s[32:35],s23 offen lds
s_add_u32 m0,s21,45056
s_mov_b32 s23,2359424
buffer_load_dwordx4 v10,s[32:35],s23 offen lds
s_add_u32 m0,s21,49152
s_mov_b32 s23,2752640
buffer_load_dwordx4 v10,s[32:35],s23 offen lds
s_add_u32 m0,s21,53248
s_mov_b32 s23,3145856
buffer_load_dwordx4 v10,s[32:35],s23 offen lds
s_add_u32 m0,s21,57344
s_mov_b32 s23,3539072
buffer_load_dwordx4 v10,s[32:35],s23 offen lds
s_waitcnt vmcnt(10)
s_barrier
tr v[40:41],v11,0
tr v[42:43],v12,0
tr v[44:45],v11,4096
tr v[46:47],v12,4096
tr v[48:49],v11,8192
tr v[50:51],v12,8192
tr v[52:53],v11,12288
tr v[54:55],v12,12288
tr v[56:57],v11,16384
tr v[58:59],v12,16384
s_waitcnt lgkmcnt(0)
v_accvgpr_write_b32 a57,v40
v_accvgpr_write_b32 a59,v41
v_accvgpr_write_b32 a61,v42
v_accvgpr_write_b32 a63,v43
v_accvgpr_write_b32 a64,v44
v_accvgpr_write_b32 a66,v45
v_accvgpr_write_b32 a68,v46
v_accvgpr_write_b32 a70,v47
v_accvgpr_write_b32 a65,v48
v_accvgpr_write_b32 a67,v49
v_accvgpr_write_b32 a69,v50
v_accvgpr_write_b32 a71,v51
v_accvgpr_write_b32 a72,v52
v_accvgpr_write_b32 a74,v53
v_accvgpr_write_b32 a76,v54
v_accvgpr_write_b32 a78,v55
v_accvgpr_write_b32 a73,v56
v_accvgpr_write_b32 a75,v57
v_accvgpr_write_b32 a77,v58
v_accvgpr_write_b32 a79,v59
s_waitcnt lgkmcnt(0)
s_barrier
s_add_u32 m0,s21,0
s_mov_b32 s23,3932288
buffer_load_dwordx4 v10,s[32:35],s23 offen lds
s_add_u32 m0,s21,4096
s_mov_b32 s23,4325504
buffer_load_dwordx4 v10,s[32:35],s23 offen lds
s_add_u32 m0,s21,8192
s_mov_b32 s23,4718720
buffer_load_dwordx4 v10,s[32:35],s23 offen lds
s_add_u32 m0,s21,12288
s_mov_b32 s23,5111936
buffer_load_dwordx4 v10,s[32:35],s23 offen lds
s_add_u32 m0,s21,16384
s_mov_b32 s23,5505152
buffer_load_dwordx4 v10,s[32:35],s23 offen lds
s_waitcnt vmcnt(10)
s_barrier
tr v[40:41],v11,20480
tr v[42:43],v12,20480
tr v[44:45],v11,24576
tr v[46:47],v12,24576
tr v[48:49],v11,28672
tr v[50:51],v12,28672
tr v[52:53],v11,32768
tr v[54:55],v12,32768
tr v[56:57],v11,36864
tr v[58:59],v12,36864
s_waitcnt lgkmcnt(0)
v_accvgpr_write_b32 a80,v40
v_accvgpr_write_b32 a82,v41
v_accvgpr_write_b32 a84,v42
v_accvgpr_write_b32 a86,v43
v_accvgpr_write_b32 a81,v44
v_accvgpr_write_b32 a83,v45
v_accvgpr_write_b32 a85,v46
v_accvgpr_write_b32 a87,v47
v_accvgpr_write_b32 a88,v48
v_accvgpr_write_b32 a90,v49
v_accvgpr_write_b32 a92,v50
v_accvgpr_write_b32 a94,v51
v_accvgpr_write_b32 a89,v52
v_accvgpr_write_b32 a91,v53
v_accvgpr_write_b32 a93,v54
v_accvgpr_write_b32 a95,v55
v_accvgpr_write_b32 a96,v56
v_accvgpr_write_b32 a98,v57
v_accvgpr_write_b32 a100,v58
v_accvgpr_write_b32 a102,v59
s_waitcnt lgkmcnt(0)
s_barrier
s_add_u32 m0,s21,20480
s_mov_b32 s23,5898368
buffer_load_dwordx4 v10,s[32:35],s23 offen lds
s_add_u32 m0,s21,24576
s_mov_b32 s23,6291584
buffer_load_dwordx4 v10,s[32:35],s23 offen lds
s_add_u32 m0,s21,28672
s_mov_b32 s23,6684800
buffer_load_dwordx4 v10,s[32:35],s23 offen lds
s_add_u32 m0,s21,32768
s_mov_b32 s23,7078016
buffer_load_dwordx4 v10,s[32:35],s23 offen lds
s_add_u32 m0,s21,36864
s_mov_b32 s23,7471232
buffer_load_dwordx4 v10,s[32:35],s23 offen lds
s_waitcnt vmcnt(10)
s_barrier
tr v[40:41],v11,40960
tr v[42:43],v12,40960
tr v[44:45],v11,45056
tr v[46:47],v12,45056
tr v[48:49],v11,49152
tr v[50:51],v12,49152
tr v[52:53],v11,53248
tr v[54:55],v12,53248
tr v[56:57],v11,57344
tr v[58:59],v12,57344
s_waitcnt lgkmcnt(0)
v_accvgpr_write_b32 a97,v40
v_accvgpr_write_b32 a99,v41
v_accvgpr_write_b32 a101,v42
v_accvgpr_write_b32 a103,v43
v_accvgpr_write_b32 a104,v44
v_accvgpr_write_b32 a106,v45
v_accvgpr_write_b32 a108,v46
v_accvgpr_write_b32 a110,v47
v_accvgpr_write_b32 a105,v48
v_accvgpr_write_b32 a107,v49
v_accvgpr_write_b32 a109,v50
v_accvgpr_write_b32 a111,v51
v_accvgpr_write_b32 a112,v52
v_accvgpr_write_b32 a114,v53
v_accvgpr_write_b32 a116,v54
v_accvgpr_write_b32 a118,v55
v_accvgpr_write_b32 a113,v56
v_accvgpr_write_b32 a115,v57
v_accvgpr_write_b32 a117,v58
v_accvgpr_write_b32 a119,v59
s_waitcnt lgkmcnt(0)
s_barrier
s_add_u32 m0,s21,40960
s_mov_b32 s23,256
buffer_load_dwordx4 v10,s[32:35],s23 offen lds
s_add_u32 m0,s21,45056
s_mov_b32 s23,393472
buffer_load_dwordx4 v10,s[32:35],s23 offen lds
s_add_u32 m0,s21,49152
s_mov_b32 s23,786688
buffer_load_dwordx4 v10,s[32:35],s23 offen lds
s_add_u32 m0,s21,53248
s_mov_b32 s23,1179904
buffer_load_dwordx4 v10,s[32:35],s23 offen lds
s_add_u32 m0,s21,57344
s_mov_b32 s23,1573120
buffer_load_dwordx4 v10,s[32:35],s23 offen lds
s_waitcnt vmcnt(10)
s_barrier
tr v[40:41],v11,0
tr v[42:43],v12,0
tr v[44:45],v11,4096
tr v[46:47],v12,4096
tr v[48:49],v11,8192
tr v[50:51],v12,8192
tr v[52:53],v11,12288
tr v[54:55],v12,12288
tr v[56:57],v11,16384
tr v[58:59],v12,16384
s_waitcnt lgkmcnt(0)
v_accvgpr_write_b32 a120,v40
v_accvgpr_write_b32 a122,v41
v_accvgpr_write_b32 a124,v42
v_accvgpr_write_b32 a126,v43
v_accvgpr_write_b32 a121,v44
v_accvgpr_write_b32 a123,v45
v_accvgpr_write_b32 a125,v46
v_accvgpr_write_b32 a127,v47
v_accvgpr_write_b32 a128,v48
v_accvgpr_write_b32 a130,v49
v_accvgpr_write_b32 a132,v50
v_accvgpr_write_b32 a134,v51
v_accvgpr_write_b32 a129,v52
v_accvgpr_write_b32 a131,v53
v_accvgpr_write_b32 a133,v54
v_accvgpr_write_b32 a135,v55
v_accvgpr_write_b32 a136,v56
v_accvgpr_write_b32 a138,v57
v_accvgpr_write_b32 a140,v58
v_accvgpr_write_b32 a142,v59
s_waitcnt lgkmcnt(0)
s_barrier
s_add_u32 m0,s21,0
s_mov_b32 s23,1966336
buffer_load_dwordx4 v10,s[32:35],s23 offen lds
s_add_u32 m0,s21,4096
s_mov_b32 s23,2359552
buffer_load_dwordx4 v10,s[32:35],s23 offen lds
s_add_u32 m0,s21,8192
s_mov_b32 s23,2752768
buffer_load_dwordx4 v10,s[32:35],s23 offen lds
s_add_u32 m0,s21,12288
s_mov_b32 s23,3145984
buffer_load_dwordx4 v10,s[32:35],s23 offen lds
s_add_u32 m0,s21,16384
s_mov_b32 s23,3539200
buffer_load_dwordx4 v10,s[32:35],s23 offen lds
s_waitcnt vmcnt(10)
s_barrier
tr v[40:41],v11,20480
tr v[42:43],v12,20480
tr v[44:45],v11,24576
tr v[46:47],v12,24576
tr v[48:49],v11,28672
tr v[50:51],v12,28672
tr v[52:53],v11,32768
tr v[54:55],v12,32768
tr v[56:57],v11,36864
tr v[58:59],v12,36864
s_waitcnt lgkmcnt(0)
v_accvgpr_write_b32 a137,v40
v_accvgpr_write_b32 a139,v41
v_accvgpr_write_b32 a141,v42
v_accvgpr_write_b32 a143,v43
v_accvgpr_write_b32 a144,v44
v_accvgpr_write_b32 a146,v45
v_accvgpr_write_b32 a148,v46
v_accvgpr_write_b32 a150,v47
v_accvgpr_write_b32 a145,v48
v_accvgpr_write_b32 a147,v49
v_accvgpr_write_b32 a149,v50
v_accvgpr_write_b32 a151,v51
v_accvgpr_write_b32 a152,v52
v_accvgpr_write_b32 a154,v53
v_accvgpr_write_b32 a156,v54
v_accvgpr_write_b32 a158,v55
v_accvgpr_write_b32 a153,v56
v_accvgpr_write_b32 a155,v57
v_accvgpr_write_b32 a157,v58
v_accvgpr_write_b32 a159,v59
s_waitcnt lgkmcnt(0)
s_barrier
s_add_u32 m0,s21,20480
s_mov_b32 s23,3932416
buffer_load_dwordx4 v10,s[32:35],s23 offen lds
s_add_u32 m0,s21,24576
s_mov_b32 s23,4325632
buffer_load_dwordx4 v10,s[32:35],s23 offen lds
s_add_u32 m0,s21,28672
s_mov_b32 s23,4718848
buffer_load_dwordx4 v10,s[32:35],s23 offen lds
s_add_u32 m0,s21,32768
s_mov_b32 s23,5112064
buffer_load_dwordx4 v10,s[32:35],s23 offen lds
s_add_u32 m0,s21,36864
s_mov_b32 s23,5505280
buffer_load_dwordx4 v10,s[32:35],s23 offen lds
s_waitcnt vmcnt(10)
s_barrier
tr v[40:41],v11,40960
tr v[42:43],v12,40960
tr v[44:45],v11,45056
tr v[46:47],v12,45056
tr v[48:49],v11,49152
tr v[50:51],v12,49152
tr v[52:53],v11,53248
tr v[54:55],v12,53248
tr v[56:57],v11,57344
tr v[58:59],v12,57344
s_waitcnt lgkmcnt(0)
v_accvgpr_write_b32 a160,v40
v_accvgpr_write_b32 a162,v41
v_accvgpr_write_b32 a164,v42
v_accvgpr_write_b32 a166,v43
v_accvgpr_write_b32 a161,v44
v_accvgpr_write_b32 a163,v45
v_accvgpr_write_b32 a165,v46
v_accvgpr_write_b32 a167,v47
v_accvgpr_write_b32 a168,v48
v_accvgpr_write_b32 a170,v49
v_accvgpr_write_b32 a172,v50
v_accvgpr_write_b32 a174,v51
v_accvgpr_write_b32 a169,v52
v_accvgpr_write_b32 a171,v53
v_accvgpr_write_b32 a173,v54
v_accvgpr_write_b32 a175,v55
v_accvgpr_write_b32 a176,v56
v_accvgpr_write_b32 a178,v57
v_accvgpr_write_b32 a180,v58
v_accvgpr_write_b32 a182,v59
s_waitcnt lgkmcnt(0)
s_barrier
s_add_u32 m0,s21,40960
s_mov_b32 s23,5898496
buffer_load_dwordx4 v10,s[32:35],s23 offen lds
s_add_u32 m0,s21,45056
s_mov_b32 s23,6291712
buffer_load_dwordx4 v10,s[32:35],s23 offen lds
s_add_u32 m0,s21,49152
s_mov_b32 s23,6684928
buffer_load_dwordx4 v10,s[32:35],s23 offen lds
s_add_u32 m0,s21,53248
s_mov_b32 s23,7078144
buffer_load_dwordx4 v10,s[32:35],s23 offen lds
s_add_u32 m0,s21,57344
s_mov_b32 s23,7471360
buffer_load_dwordx4 v10,s[32:35],s23 offen lds
s_waitcnt vmcnt(10)
s_barrier
tr v[40:41],v11,0
tr v[42:43],v12,0
tr v[44:45],v11,4096
tr v[46:47],v12,4096
tr v[48:49],v11,8192
tr v[50:51],v12,8192
tr v[52:53],v11,12288
tr v[54:55],v12,12288
tr v[56:57],v11,16384
tr v[58:59],v12,16384
s_waitcnt lgkmcnt(0)
v_accvgpr_write_b32 a177,v40
v_accvgpr_write_b32 a179,v41
v_accvgpr_write_b32 a181,v42
v_accvgpr_write_b32 a183,v43
v_accvgpr_write_b32 a184,v44
v_accvgpr_write_b32 a186,v45
v_accvgpr_write_b32 a188,v46
v_accvgpr_write_b32 a190,v47
v_accvgpr_write_b32 a185,v48
v_accvgpr_write_b32 a187,v49
v_accvgpr_write_b32 a189,v50
v_accvgpr_write_b32 a191,v51
v_accvgpr_write_b32 a192,v52
v_accvgpr_write_b32 a194,v53
v_accvgpr_write_b32 a196,v54
v_accvgpr_write_b32 a198,v55
v_accvgpr_write_b32 a193,v56
v_accvgpr_write_b32 a195,v57
v_accvgpr_write_b32 a197,v58
v_accvgpr_write_b32 a199,v59
s_waitcnt lgkmcnt(0)
s_barrier
s_add_u32 m0,s21,0
s_mov_b32 s23,0
buffer_load_dwordx4 v10,s[36:39],s23 offen lds
s_add_u32 m0,s21,4096
s_mov_b32 s23,393216
buffer_load_dwordx4 v10,s[36:39],s23 offen lds
s_add_u32 m0,s21,8192
s_mov_b32 s23,786432
buffer_load_dwordx4 v10,s[36:39],s23 offen lds
s_add_u32 m0,s21,12288
s_mov_b32 s23,1179648
buffer_load_dwordx4 v10,s[36:39],s23 offen lds
s_add_u32 m0,s21,16384
s_mov_b32 s23,1572864
buffer_load_dwordx4 v10,s[36:39],s23 offen lds
s_waitcnt vmcnt(10)
s_barrier
tr v[40:41],v11,20480
tr v[42:43],v12,20480
tr v[44:45],v11,24576
tr v[46:47],v12,24576
tr v[48:49],v11,28672
tr v[50:51],v12,28672
tr v[52:53],v11,32768
tr v[54:55],v12,32768
tr v[56:57],v11,36864
tr v[58:59],v12,36864
s_waitcnt lgkmcnt(0)
v_accvgpr_write_b32 a200,v40
v_accvgpr_write_b32 a202,v41
v_accvgpr_write_b32 a204,v42
v_accvgpr_write_b32 a206,v43
v_accvgpr_write_b32 a201,v44
v_accvgpr_write_b32 a203,v45
v_accvgpr_write_b32 a205,v46
v_accvgpr_write_b32 a207,v47
v_accvgpr_write_b32 a208,v48
v_accvgpr_write_b32 a210,v49
v_accvgpr_write_b32 a212,v50
v_accvgpr_write_b32 a214,v51
v_accvgpr_write_b32 a209,v52
v_accvgpr_write_b32 a211,v53
v_accvgpr_write_b32 a213,v54
v_accvgpr_write_b32 a215,v55
v_accvgpr_write_b32 a216,v56
v_accvgpr_write_b32 a218,v57
v_accvgpr_write_b32 a220,v58
v_accvgpr_write_b32 a222,v59
s_waitcnt lgkmcnt(0)
s_barrier
s_add_u32 m0,s21,20480
s_mov_b32 s23,1966080
buffer_load_dwordx4 v10,s[36:39],s23 offen lds
s_add_u32 m0,s21,24576
s_mov_b32 s23,2359296
buffer_load_dwordx4 v10,s[36:39],s23 offen lds
s_add_u32 m0,s21,28672
s_mov_b32 s23,2752512
buffer_load_dwordx4 v10,s[36:39],s23 offen lds
s_add_u32 m0,s21,32768
s_mov_b32 s23,3145728
buffer_load_dwordx4 v10,s[36:39],s23 offen lds
s_add_u32 m0,s21,36864
s_mov_b32 s23,3538944
buffer_load_dwordx4 v10,s[36:39],s23 offen lds
s_waitcnt vmcnt(10)
s_barrier
tr v[40:41],v11,40960
tr v[42:43],v12,40960
tr v[44:45],v11,45056
tr v[46:47],v12,45056
tr v[48:49],v11,49152
tr v[50:51],v12,49152
tr v[52:53],v11,53248
tr v[54:55],v12,53248
tr v[56:57],v11,57344
tr v[58:59],v12,57344
s_waitcnt lgkmcnt(0)
v_accvgpr_write_b32 a217,v40
v_accvgpr_write_b32 a219,v41
v_accvgpr_write_b32 a221,v42
v_accvgpr_write_b32 a223,v43
v_accvgpr_write_b32 a224,v44
v_accvgpr_write_b32 a226,v45
v_accvgpr_write_b32 a228,v46
v_accvgpr_write_b32 a230,v47
v_accvgpr_write_b32 a225,v48
v_accvgpr_write_b32 a227,v49
v_accvgpr_write_b32 a229,v50
v_accvgpr_write_b32 a231,v51
v_accvgpr_write_b32 a232,v52
v_accvgpr_write_b32 a234,v53
v_accvgpr_write_b32 a236,v54
v_accvgpr_write_b32 a238,v55
v_accvgpr_write_b32 a233,v56
v_accvgpr_write_b32 a235,v57
v_accvgpr_write_b32 a237,v58
v_accvgpr_write_b32 a239,v59
s_waitcnt lgkmcnt(0)
s_barrier
s_add_u32 m0,s21,40960
s_mov_b32 s23,3932160
buffer_load_dwordx4 v10,s[36:39],s23 offen lds
s_add_u32 m0,s21,45056
s_mov_b32 s23,4325376
buffer_load_dwordx4 v10,s[36:39],s23 offen lds
s_add_u32 m0,s21,49152
s_mov_b32 s23,4718592
buffer_load_dwordx4 v10,s[36:39],s23 offen lds
s_add_u32 m0,s21,53248
s_mov_b32 s23,5111808
buffer_load_dwordx4 v10,s[36:39],s23 offen lds
s_add_u32 m0,s21,57344
s_mov_b32 s23,5505024
buffer_load_dwordx4 v10,s[36:39],s23 offen lds
s_waitcnt vmcnt(10)
s_barrier
tr v[40:41],v11,0
tr v[42:43],v12,0
tr v[44:45],v11,4096
tr v[46:47],v12,4096
tr v[48:49],v11,8192
tr v[50:51],v12,8192
tr v[52:53],v11,12288
tr v[54:55],v12,12288
tr v[56:57],v11,16384
tr v[58:59],v12,16384
s_waitcnt lgkmcnt(0)
v_accvgpr_write_b32 a240,v40
v_accvgpr_write_b32 a242,v41
v_accvgpr_write_b32 a244,v42
v_accvgpr_write_b32 a246,v43
v_accvgpr_write_b32 a241,v44
v_accvgpr_write_b32 a243,v45
v_accvgpr_write_b32 a245,v46
v_accvgpr_write_b32 a247,v47
v_accvgpr_write_b32 a248,v48
v_accvgpr_write_b32 a250,v49
v_accvgpr_write_b32 a252,v50
v_accvgpr_write_b32 a254,v51
v_accvgpr_write_b32 a249,v52
v_accvgpr_write_b32 a251,v53
v_accvgpr_write_b32 a253,v54
v_accvgpr_write_b32 a255,v55
v_mov_b32 v128,v56
v_mov_b32 v130,v57
v_mov_b32 v132,v58
v_mov_b32 v134,v59
s_waitcnt lgkmcnt(0)
s_barrier
s_add_u32 m0,s21,0
s_mov_b32 s23,5898240
buffer_load_dwordx4 v10,s[36:39],s23 offen lds
s_add_u32 m0,s21,4096
s_mov_b32 s23,6291456
buffer_load_dwordx4 v10,s[36:39],s23 offen lds
s_add_u32 m0,s21,8192
s_mov_b32 s23,6684672
buffer_load_dwordx4 v10,s[36:39],s23 offen lds
s_add_u32 m0,s21,12288
s_mov_b32 s23,7077888
buffer_load_dwordx4 v10,s[36:39],s23 offen lds
s_add_u32 m0,s21,16384
s_mov_b32 s23,7471104
buffer_load_dwordx4 v10,s[36:39],s23 offen lds
s_waitcnt vmcnt(10)
s_barrier
tr v[40:41],v11,20480
tr v[42:43],v12,20480
tr v[44:45],v11,24576
tr v[46:47],v12,24576
tr v[48:49],v11,28672
tr v[50:51],v12,28672
tr v[52:53],v11,32768
tr v[54:55],v12,32768
tr v[56:57],v11,36864
tr v[58:59],v12,36864
s_waitcnt lgkmcnt(0)
v_mov_b32 v129,v40
v_mov_b32 v131,v41
v_mov_b32 v133,v42
v_mov_b32 v135,v43
v_mov_b32 v136,v44
v_mov_b32 v138,v45
v_mov_b32 v140,v46
v_mov_b32 v142,v47
v_mov_b32 v137,v48
v_mov_b32 v139,v49
v_mov_b32 v141,v50
v_mov_b32 v143,v51
v_mov_b32 v144,v52
v_mov_b32 v146,v53
v_mov_b32 v148,v54
v_mov_b32 v150,v55
v_mov_b32 v145,v56
v_mov_b32 v147,v57
v_mov_b32 v149,v58
v_mov_b32 v151,v59
s_waitcnt lgkmcnt(0)
s_barrier
s_add_u32 m0,s21,20480
s_mov_b32 s23,128
buffer_load_dwordx4 v10,s[36:39],s23 offen lds
s_add_u32 m0,s21,24576
s_mov_b32 s23,393344
buffer_load_dwordx4 v10,s[36:39],s23 offen lds
s_add_u32 m0,s21,28672
s_mov_b32 s23,786560
buffer_load_dwordx4 v10,s[36:39],s23 offen lds
s_add_u32 m0,s21,32768
s_mov_b32 s23,1179776
buffer_load_dwordx4 v10,s[36:39],s23 offen lds
s_add_u32 m0,s21,36864
s_mov_b32 s23,1572992
buffer_load_dwordx4 v10,s[36:39],s23 offen lds
s_waitcnt vmcnt(10)
s_barrier
tr v[40:41],v11,40960
tr v[42:43],v12,40960
tr v[44:45],v11,45056
tr v[46:47],v12,45056
tr v[48:49],v11,49152
tr v[50:51],v12,49152
tr v[52:53],v11,53248
tr v[54:55],v12,53248
tr v[56:57],v11,57344
tr v[58:59],v12,57344
s_waitcnt lgkmcnt(0)
v_mov_b32 v152,v40
v_mov_b32 v154,v41
v_mov_b32 v156,v42
v_mov_b32 v158,v43
v_mov_b32 v153,v44
v_mov_b32 v155,v45
v_mov_b32 v157,v46
v_mov_b32 v159,v47
v_mov_b32 v160,v48
v_mov_b32 v162,v49
v_mov_b32 v164,v50
v_mov_b32 v166,v51
v_mov_b32 v161,v52
v_mov_b32 v163,v53
v_mov_b32 v165,v54
v_mov_b32 v167,v55
v_mov_b32 v168,v56
v_mov_b32 v170,v57
v_mov_b32 v172,v58
v_mov_b32 v174,v59
s_waitcnt lgkmcnt(0)
s_barrier
s_add_u32 m0,s21,40960
s_mov_b32 s23,1966208
buffer_load_dwordx4 v10,s[36:39],s23 offen lds
s_add_u32 m0,s21,45056
s_mov_b32 s23,2359424
buffer_load_dwordx4 v10,s[36:39],s23 offen lds
s_add_u32 m0,s21,49152
s_mov_b32 s23,2752640
buffer_load_dwordx4 v10,s[36:39],s23 offen lds
s_add_u32 m0,s21,53248
s_mov_b32 s23,3145856
buffer_load_dwordx4 v10,s[36:39],s23 offen lds
s_add_u32 m0,s21,57344
s_mov_b32 s23,3539072
buffer_load_dwordx4 v10,s[36:39],s23 offen lds
s_waitcnt vmcnt(10)
s_barrier
tr v[40:41],v11,0
tr v[42:43],v12,0
tr v[44:45],v11,4096
tr v[46:47],v12,4096
tr v[48:49],v11,8192
tr v[50:51],v12,8192
tr v[52:53],v11,12288
tr v[54:55],v12,12288
tr v[56:57],v11,16384
tr v[58:59],v12,16384
s_waitcnt lgkmcnt(0)
v_mov_b32 v169,v40
v_mov_b32 v171,v41
v_mov_b32 v173,v42
v_mov_b32 v175,v43
v_mov_b32 v176,v44
v_mov_b32 v178,v45
v_mov_b32 v180,v46
v_mov_b32 v182,v47
v_mov_b32 v177,v48
v_mov_b32 v179,v49
v_mov_b32 v181,v50
v_mov_b32 v183,v51
v_mov_b32 v184,v52
v_mov_b32 v186,v53
v_mov_b32 v188,v54
v_mov_b32 v190,v55
v_mov_b32 v185,v56
v_mov_b32 v187,v57
v_mov_b32 v189,v58
v_mov_b32 v191,v59
s_waitcnt lgkmcnt(0)
s_barrier
s_add_u32 m0,s21,0
s_mov_b32 s23,3932288
buffer_load_dwordx4 v10,s[36:39],s23 offen lds
s_add_u32 m0,s21,4096
s_mov_b32 s23,4325504
buffer_load_dwordx4 v10,s[36:39],s23 offen lds
s_add_u32 m0,s21,8192
s_mov_b32 s23,4718720
buffer_load_dwordx4 v10,s[36:39],s23 offen lds
s_add_u32 m0,s21,12288
s_mov_b32 s23,5111936
buffer_load_dwordx4 v10,s[36:39],s23 offen lds
s_add_u32 m0,s21,16384
s_mov_b32 s23,5505152
buffer_load_dwordx4 v10,s[36:39],s23 offen lds
s_waitcnt vmcnt(10)
s_barrier
tr v[40:41],v11,20480
tr v[42:43],v12,20480
tr v[44:45],v11,24576
tr v[46:47],v12,24576
tr v[48:49],v11,28672
tr v[50:51],v12,28672
tr v[52:53],v11,32768
tr v[54:55],v12,32768
tr v[56:57],v11,36864
tr v[58:59],v12,36864
s_waitcnt lgkmcnt(0)
v_mov_b32 v192,v40
v_mov_b32 v194,v41
v_mov_b32 v196,v42
v_mov_b32 v198,v43
v_mov_b32 v193,v44
v_mov_b32 v195,v45
v_mov_b32 v197,v46
v_mov_b32 v199,v47
v_mov_b32 v200,v48
v_mov_b32 v202,v49
v_mov_b32 v204,v50
v_mov_b32 v206,v51
v_mov_b32 v201,v52
v_mov_b32 v203,v53
v_mov_b32 v205,v54
v_mov_b32 v207,v55
v_mov_b32 v208,v56
v_mov_b32 v210,v57
v_mov_b32 v212,v58
v_mov_b32 v214,v59
s_waitcnt lgkmcnt(0)
s_barrier
s_add_u32 m0,s21,20480
s_mov_b32 s23,5898368
buffer_load_dwordx4 v10,s[36:39],s23 offen lds
s_add_u32 m0,s21,24576
s_mov_b32 s23,6291584
buffer_load_dwordx4 v10,s[36:39],s23 offen lds
s_add_u32 m0,s21,28672
s_mov_b32 s23,6684800
buffer_load_dwordx4 v10,s[36:39],s23 offen lds
s_add_u32 m0,s21,32768
s_mov_b32 s23,7078016
buffer_load_dwordx4 v10,s[36:39],s23 offen lds
s_add_u32 m0,s21,36864
s_mov_b32 s23,7471232
buffer_load_dwordx4 v10,s[36:39],s23 offen lds
s_waitcnt vmcnt(10)
s_barrier
tr v[40:41],v11,40960
tr v[42:43],v12,40960
tr v[44:45],v11,45056
tr v[46:47],v12,45056
tr v[48:49],v11,49152
tr v[50:51],v12,49152
tr v[52:53],v11,53248
tr v[54:55],v12,53248
tr v[56:57],v11,57344
tr v[58:59],v12,57344
s_waitcnt lgkmcnt(0)
v_mov_b32 v209,v40
v_mov_b32 v211,v41
v_mov_b32 v213,v42
v_mov_b32 v215,v43
v_mov_b32 v216,v44
v_mov_b32 v218,v45
v_mov_b32 v220,v46
v_mov_b32 v222,v47
v_mov_b32 v217,v48
v_mov_b32 v219,v49
v_mov_b32 v221,v50
v_mov_b32 v223,v51
v_mov_b32 v224,v52
v_mov_b32 v226,v53
v_mov_b32 v228,v54
v_mov_b32 v230,v55
v_mov_b32 v225,v56
v_mov_b32 v227,v57
v_mov_b32 v229,v58
v_mov_b32 v231,v59
s_waitcnt lgkmcnt(0)
s_barrier
s_add_u32 m0,s21,40960
s_mov_b32 s23,256
buffer_load_dwordx4 v10,s[36:39],s23 offen lds
s_add_u32 m0,s21,45056
s_mov_b32 s23,393472
buffer_load_dwordx4 v10,s[36:39],s23 offen lds
s_add_u32 m0,s21,49152
s_mov_b32 s23,786688
buffer_load_dwordx4 v10,s[36:39],s23 offen lds
s_add_u32 m0,s21,53248
s_mov_b32 s23,1179904
buffer_load_dwordx4 v10,s[36:39],s23 offen lds
s_add_u32 m0,s21,57344
s_mov_b32 s23,1573120
buffer_load_dwordx4 v10,s[36:39],s23 offen lds
s_waitcnt vmcnt(10)
s_barrier
tr v[40:41],v11,0
tr v[42:43],v12,0
tr v[44:45],v11,4096
tr v[46:47],v12,4096
tr v[48:49],v11,8192
tr v[50:51],v12,8192
tr v[52:53],v11,12288
tr v[54:55],v12,12288
tr v[56:57],v11,16384
tr v[58:59],v12,16384
s_waitcnt lgkmcnt(0)
v_mov_b32 v232,v40
v_mov_b32 v234,v41
v_mov_b32 v236,v42
v_mov_b32 v238,v43
v_mov_b32 v233,v44
v_mov_b32 v235,v45
v_mov_b32 v237,v46
v_mov_b32 v239,v47
v_mov_b32 v240,v48
v_mov_b32 v242,v49
v_mov_b32 v244,v50
v_mov_b32 v246,v51
v_mov_b32 v241,v52
v_mov_b32 v243,v53
v_mov_b32 v245,v54
v_mov_b32 v247,v55
v_mov_b32 v248,v56
v_mov_b32 v250,v57
v_mov_b32 v252,v58
v_mov_b32 v254,v59
s_waitcnt lgkmcnt(0)
s_barrier
s_add_u32 m0,s21,0
s_mov_b32 s23,1966336
buffer_load_dwordx4 v10,s[36:39],s23 offen lds
s_add_u32 m0,s21,4096
s_mov_b32 s23,2359552
buffer_load_dwordx4 v10,s[36:39],s23 offen lds
s_add_u32 m0,s21,8192
s_mov_b32 s23,2752768
buffer_load_dwordx4 v10,s[36:39],s23 offen lds
s_add_u32 m0,s21,12288
s_mov_b32 s23,3145984
buffer_load_dwordx4 v10,s[36:39],s23 offen lds
s_add_u32 m0,s21,16384
s_mov_b32 s23,3539200
buffer_load_dwordx4 v10,s[36:39],s23 offen lds
s_waitcnt vmcnt(10)
s_barrier
tr v[40:41],v11,20480
tr v[42:43],v12,20480
tr v[44:45],v11,24576
tr v[46:47],v12,24576
tr v[48:49],v11,28672
tr v[50:51],v12,28672
tr v[52:53],v11,32768
tr v[54:55],v12,32768
tr v[56:57],v11,36864
tr v[58:59],v12,36864
s_waitcnt lgkmcnt(0)
v_mov_b32 v249,v40
v_mov_b32 v251,v41
v_mov_b32 v253,v42
v_mov_b32 v255,v43
ds_write_b32 v13,v44 offset:0
ds_write_b32 v13,v45 offset:8
ds_write_b32 v13,v46 offset:1024
ds_write_b32 v13,v47 offset:1032
ds_write_b32 v13,v48 offset:4
ds_write_b32 v13,v49 offset:12
ds_write_b32 v13,v50 offset:1028
ds_write_b32 v13,v51 offset:1036
ds_write_b32 v13,v52 offset:2048
ds_write_b32 v13,v53 offset:2056
ds_write_b32 v13,v54 offset:3072
ds_write_b32 v13,v55 offset:3080
ds_write_b32 v13,v56 offset:2052
ds_write_b32 v13,v57 offset:2060
ds_write_b32 v13,v58 offset:3076
ds_write_b32 v13,v59 offset:3084
s_waitcnt lgkmcnt(0)
s_barrier
s_add_u32 m0,s21,20480
s_mov_b32 s23,3932416
buffer_load_dwordx4 v10,s[36:39],s23 offen lds
s_add_u32 m0,s21,24576
s_mov_b32 s23,4325632
buffer_load_dwordx4 v10,s[36:39],s23 offen lds
s_add_u32 m0,s21,28672
s_mov_b32 s23,4718848
buffer_load_dwordx4 v10,s[36:39],s23 offen lds
s_add_u32 m0,s21,32768
s_mov_b32 s23,5112064
buffer_load_dwordx4 v10,s[36:39],s23 offen lds
s_add_u32 m0,s21,36864
s_mov_b32 s23,5505280
buffer_load_dwordx4 v10,s[36:39],s23 offen lds
s_waitcnt vmcnt(10)
s_barrier
tr v[40:41],v11,40960
tr v[42:43],v12,40960
tr v[44:45],v11,45056
tr v[46:47],v12,45056
tr v[48:49],v11,49152
tr v[50:51],v12,49152
tr v[52:53],v11,53248
tr v[54:55],v12,53248
tr v[56:57],v11,57344
tr v[58:59],v12,57344
s_waitcnt lgkmcnt(0)
ds_write_b32 v13,v40 offset:4096
ds_write_b32 v13,v41 offset:4104
ds_write_b32 v13,v42 offset:5120
ds_write_b32 v13,v43 offset:5128
ds_write_b32 v13,v44 offset:4100
ds_write_b32 v13,v45 offset:4108
ds_write_b32 v13,v46 offset:5124
ds_write_b32 v13,v47 offset:5132
ds_write_b32 v13,v48 offset:6144
ds_write_b32 v13,v49 offset:6152
ds_write_b32 v13,v50 offset:7168
ds_write_b32 v13,v51 offset:7176
ds_write_b32 v13,v52 offset:6148
ds_write_b32 v13,v53 offset:6156
ds_write_b32 v13,v54 offset:7172
ds_write_b32 v13,v55 offset:7180
ds_write_b32 v13,v56 offset:8192
ds_write_b32 v13,v57 offset:8200
ds_write_b32 v13,v58 offset:9216
ds_write_b32 v13,v59 offset:9224
s_waitcnt lgkmcnt(0)
s_barrier
s_add_u32 m0,s21,40960
s_mov_b32 s23,5898496
buffer_load_dwordx4 v10,s[36:39],s23 offen lds
s_add_u32 m0,s21,45056
s_mov_b32 s23,6291712
buffer_load_dwordx4 v10,s[36:39],s23 offen lds
s_add_u32 m0,s21,49152
s_mov_b32 s23,6684928
buffer_load_dwordx4 v10,s[36:39],s23 offen lds
s_add_u32 m0,s21,53248
s_mov_b32 s23,7078144
buffer_load_dwordx4 v10,s[36:39],s23 offen lds
s_add_u32 m0,s21,57344
s_mov_b32 s23,7471360
buffer_load_dwordx4 v10,s[36:39],s23 offen lds
s_waitcnt vmcnt(10)
s_barrier
tr v[40:41],v11,0
tr v[42:43],v12,0
tr v[44:45],v11,4096
tr v[46:47],v12,4096
tr v[48:49],v11,8192
tr v[50:51],v12,8192
tr v[52:53],v11,12288
tr v[54:55],v12,12288
tr v[56:57],v11,16384
tr v[58:59],v12,16384
s_waitcnt lgkmcnt(0)
ds_write_b32 v13,v40 offset:8196
ds_write_b32 v13,v41 offset:8204
ds_write_b32 v13,v42 offset:9220
ds_write_b32 v13,v43 offset:9228
ds_write_b32 v13,v44 offset:10240
ds_write_b32 v13,v45 offset:10248
ds_write_b32 v13,v46 offset:11264
ds_write_b32 v13,v47 offset:11272
ds_write_b32 v13,v48 offset:10244
ds_write_b32 v13,v49 offset:10252
ds_write_b32 v13,v50 offset:11268
ds_write_b32 v13,v51 offset:11276
ds_write_b32 v13,v52 offset:12288
ds_write_b32 v13,v53 offset:12296
ds_write_b32 v13,v54 offset:13312
ds_write_b32 v13,v55 offset:13320
ds_write_b32 v13,v56 offset:12292
ds_write_b32 v13,v57 offset:12300
ds_write_b32 v13,v58 offset:13316
ds_write_b32 v13,v59 offset:13324
s_waitcnt lgkmcnt(0)
s_barrier
s_waitcnt vmcnt(5)
s_barrier
tr v[40:41],v11,20480
tr v[42:43],v12,20480
tr v[44:45],v11,24576
tr v[46:47],v12,24576
tr v[48:49],v11,28672
tr v[50:51],v12,28672
tr v[52:53],v11,32768
tr v[54:55],v12,32768
tr v[56:57],v11,36864
tr v[58:59],v12,36864
s_waitcnt lgkmcnt(0)
ds_write_b32 v13,v40 offset:14336
ds_write_b32 v13,v41 offset:14344
ds_write_b32 v13,v42 offset:15360
ds_write_b32 v13,v43 offset:15368
ds_write_b32 v13,v44 offset:14340
ds_write_b32 v13,v45 offset:14348
ds_write_b32 v13,v46 offset:15364
ds_write_b32 v13,v47 offset:15372
ds_write_b32 v13,v48 offset:16384
ds_write_b32 v13,v49 offset:16392
ds_write_b32 v13,v50 offset:17408
ds_write_b32 v13,v51 offset:17416
ds_write_b32 v13,v52 offset:16388
ds_write_b32 v13,v53 offset:16396
ds_write_b32 v13,v54 offset:17412
ds_write_b32 v13,v55 offset:17420
ds_write_b32 v13,v56 offset:18432
ds_write_b32 v13,v57 offset:18440
ds_write_b32 v13,v58 offset:19456
ds_write_b32 v13,v59 offset:19464
s_waitcnt lgkmcnt(0)
s_barrier
s_waitcnt vmcnt(0)
s_barrier
tr v[40:41],v11,40960
tr v[42:43],v12,40960
tr v[44:45],v11,45056
tr v[46:47],v12,45056
tr v[48:49],v11,49152
tr v[50:51],v12,49152
tr v[52:53],v11,53248
tr v[54:55],v12,53248
tr v[56:57],v11,57344
tr v[58:59],v12,57344
s_waitcnt lgkmcnt(0)
ds_write_b32 v13,v40 offset:18436
ds_write_b32 v13,v41 offset:18444
ds_write_b32 v13,v42 offset:19460
ds_write_b32 v13,v43 offset:19468
ds_write_b32 v13,v44 offset:20480
ds_write_b32 v13,v45 offset:20488
ds_write_b32 v13,v46 offset:21504
ds_write_b32 v13,v47 offset:21512
ds_write_b32 v13,v48 offset:20484
ds_write_b32 v13,v49 offset:20492
ds_write_b32 v13,v50 offset:21508
ds_write_b32 v13,v51 offset:21516
ds_write_b32 v13,v52 offset:22528
ds_write_b32 v13,v53 offset:22536
ds_write_b32 v13,v54 offset:23552
ds_write_b32 v13,v55 offset:23560
ds_write_b32 v13,v56 offset:22532
ds_write_b32 v13,v57 offset:22540
ds_write_b32 v13,v58 offset:23556
ds_write_b32 v13,v59 offset:23564
s_waitcnt lgkmcnt(0)
s_barrier
v_mul_u32_u24 v9,12288,v3
v_lshl_add_u32 v9,v2,4,v9
s_lshr_b32 s22,s20,1
s_lshl_b32 s22,s22,6
s_and_b32 s23,s20,1
s_lshl_b32 s23,s23,3
s_add_u32 s22,s22,s23
v_add_u32 v9,s22,v9
v_mul_u32_u24 v10,384,v3
v_lshl_add_u32 v10,v2,4,v10
v_add_u32 v10,s22,v10
v_lshlrev_b32 v11,4,v1
v_lshrrev_b32 v12,1,v2
v_lshlrev_b32 v12,8,v12
v_lshl_add_u32 v12,v3,5,v12
v_and_b32 v14,1,v2
v_lshl_add_u32 v12,v14,4,v12
s_mul_i32 s22,s20,1280
s_add_u32 s22,s22,16384
v_add_u32 v12,s22,v12
v_lshlrev_b32 v14,5,v1
v_add_u32 v14,16384,v14
s_mul_i32 s43,s2,640
s_mov_b32 s61,0
s_mov_b32 s62,0
s_lshl_b32 s22,s2,2
s_add_u32 s22,s22,33792
s_mov_b32 s60,0
chA_fk0:
buffer_load_dword v15,off,s[92:95],s22 sc1
s_waitcnt vmcnt(0)
v_cmp_ne_u32 vcc,-1,v15
s_nop 1
s_cmp_eq_u64 vcc,exec
s_cbranch_scc1 chA_fk0_ok
s_sleep 8
s_add_u32 s60,s60,1
s_cmp_gt_u32 s60,400000
s_cbranch_scc1 chain_end
s_branch chA_fk0
chA_fk0_ok:
s_add_u32 s23,s61,0
buffer_load_dwordx2 v[40:41],v9,s[52:55],s23 offen
s_add_u32 s23,s61,128
buffer_load_dwordx2 v[42:43],v9,s[52:55],s23 offen
s_add_u32 s23,s61,256
buffer_load_dwordx2 v[44:45],v9,s[52:55],s23 offen
s_add_u32 s23,s61,196608
buffer_load_dwordx2 v[46:47],v9,s[52:55],s23 offen
s_add_u32 s23,s61,196736
buffer_load_dwordx2 v[48:49],v9,s[52:55],s23 offen
s_add_u32 s23,s61,196864
buffer_load_dwordx2 v[50:51],v9,s[52:55],s23 offen
s_mov_b32 s63,0
v_lshrrev_b32 v8,2,v3
v_and_b32 v100,1,v3
v_lshl_add_u32 v8,v8,1,v100
v_lshlrev_b32 v8,4,v8
v_lshl_add_u32 v8,v2,7,v8
v_bfe_u32 v100,v3,1,1
v_lshl_add_u32 v8,v100,9,v8
v_mul_u32_u24 v100,0xaaaaaa,v100
v_lshlrev_b32 v101,8,v100
v_and_b32 v102,0xff,v100
v_or_b32 v100,v101,v102
v_add_u32 v100,0x44444444,v100
s_mul_i32 s22,s20,1536
s_add_u32 s22,s22,24576
v_lshlrev_b32 v101,4,v3
v_lshl_add_u32 v101,v2,2,v101
v_add_u32 v101,s22,v101
v_lshrrev_b32 v102,2,v3
v_lshl_add_u32 v102,v2,2,v102
v_lshlrev_b32 v102,4,v102
v_and_b32 v103,1,v3
v_lshl_add_u32 v102,v103,3,v102
v_add_u32 v102,s22,v102
chA_loop:
v_mov_b32 v16,0
v_mov_b32 v17,0
v_mov_b32 v18,0
v_mov_b32 v19,0
v_mov_b32 v20,0
v_mov_b32 v21,0
v_mov_b32 v22,0
v_mov_b32 v23,0
v_mov_b32 v24,0
v_mov_b32 v25,0
v_mov_b32 v26,0
v_mov_b32 v27,0
v_mov_b32 v28,0
v_mov_b32 v29,0
v_mov_b32 v30,0
v_mov_b32 v31,0
v_mov_b32 v32,0
v_mov_b32 v33,0
v_mov_b32 v34,0
v_mov_b32 v35,0
v_mov_b32 v36,0
v_mov_b32 v37,0
v_mov_b32 v38,0
v_mov_b32 v39,0
ds_read_b128 v[104:107],v13 offset:4096
ds_read_b128 v[108:111],v13 offset:5120
ds_read_b128 v[112:115],v13 offset:6144
ds_read_b128 v[116:119],v13 offset:7168
ds_read_b128 v[120:123],v13 offset:8192
ds_read_b128 v[124:127],v13 offset:9216
s_mov_b32 s60,0
buffer_load_dwordx4 v[52:55],v5,s[44:47],s41 offen sc1
buffer_load_dwordx4 v[56:59],v6,s[44:47],s41 offen sc1
buffer_load_dwordx4 v[60:63],v7,s[44:47],s41 offen sc1
chA_lp:
s_waitcnt vmcnt(0)
v_max3_u32 v15,v52,v53,v54
v_max3_u32 v15,v15,v55,v56
v_max3_u32 v15,v15,v57,v58
v_max3_u32 v15,v15,v59,v60
v_max3_u32 v15,v15,v61,v62
v_max_u32 v15,v15,v63
v_cmp_ne_u32 vcc,-1,v15
s_nop 1
s_cmp_eq_u64 vcc,exec
s_cbranch_scc1 chA_ok0
buffer_load_dwordx4 v[52:55],v5,s[44:47],s41 offen sc1
buffer_load_dwordx4 v[56:59],v6,s[44:47],s41 offen sc1
buffer_load_dwordx4 v[60:63],v7,s[44:47],s41 offen sc1
s_add_u32 s60,s60,1
s_cmp_gt_u32 s60,400000
s_cbranch_scc1 chain_end
s_branch chA_lp
chA_ok0:
ds_write_b128 v5,v[52:55]
ds_write_b128 v6,v[56:59]
ds_write_b128 v7,v[60:63]
chA_done:
s_waitcnt lgkmcnt(0)
s_barrier
ds_read_b128 v[88:91],v8 offset:0
ds_read_b128 v[92:95],v8 offset:1024
ds_read_b128 v[96:99],v8 offset:2048
s_waitcnt lgkmcnt(2)
v_smfmac_f32_16x16x64_bf16 v[16:19],v[88:91],a[0:7],v100
v_smfmac_f32_16x16x64_bf16 v[20:23],v[88:91],a[80:87],v100
v_smfmac_f32_16x16x64_bf16 v[24:27],v[88:91],a[160:167],v100
v_smfmac_f32_16x16x64_bf16 v[28:31],v[88:91],a[240:247],v100
v_smfmac_f32_16x16x64_bf16 v[32:35],v[88:91],v[192:199],v100
v_smfmac_f32_16x16x64_bf16 v[36:39],v[88:91],v[104:111],v100
ds_read_b128 v[104:107],v13 offset:10240
ds_read_b128 v[108:111],v13 offset:11264
ds_read_b128 v[88:91],v8 offset:3072
s_waitcnt lgkmcnt(4)
v_smfmac_f32_16x16x64_bf16 v[16:19],v[92:95],a[8:15],v100
v_smfmac_f32_16x16x64_bf16 v[20:23],v[92:95],a[88:95],v100
v_smfmac_f32_16x16x64_bf16 v[24:27],v[92:95],a[168:175],v100
v_smfmac_f32_16x16x64_bf16 v[28:31],v[92:95],a[248:255],v100
v_smfmac_f32_16x16x64_bf16 v[32:35],v[92:95],v[200:207],v100
v_smfmac_f32_16x16x64_bf16 v[36:39],v[92:95],v[112:119],v100
ds_read_b128 v[112:115],v13 offset:12288
ds_read_b128 v[116:119],v13 offset:13312
ds_read_b128 v[92:95],v8 offset:4096
s_waitcnt lgkmcnt(6)
v_smfmac_f32_16x16x64_bf16 v[16:19],v[96:99],a[16:23],v100
v_smfmac_f32_16x16x64_bf16 v[20:23],v[96:99],a[96:103],v100
v_smfmac_f32_16x16x64_bf16 v[24:27],v[96:99],a[176:183],v100
v_smfmac_f32_16x16x64_bf16 v[28:31],v[96:99],v[128:135],v100
v_smfmac_f32_16x16x64_bf16 v[32:35],v[96:99],v[208:215],v100
v_smfmac_f32_16x16x64_bf16 v[36:39],v[96:99],v[120:127],v100
ds_read_b128 v[120:123],v13 offset:14336
ds_read_b128 v[124:127],v13 offset:15360
ds_read_b128 v[96:99],v8 offset:5120
s_waitcnt lgkmcnt(6)
v_smfmac_f32_16x16x64_bf16 v[16:19],v[88:91],a[24:31],v100
v_smfmac_f32_16x16x64_bf16 v[20:23],v[88:91],a[104:111],v100
v_smfmac_f32_16x16x64_bf16 v[24:27],v[88:91],a[184:191],v100
v_smfmac_f32_16x16x64_bf16 v[28:31],v[88:91],v[136:143],v100
v_smfmac_f32_16x16x64_bf16 v[32:35],v[88:91],v[216:223],v100
v_smfmac_f32_16x16x64_bf16 v[36:39],v[88:91],v[104:111],v100
ds_read_b128 v[104:107],v13 offset:16384
ds_read_b128 v[108:111],v13 offset:17408
ds_read_b128 v[88:91],v8 offset:6144
s_waitcnt lgkmcnt(6)
v_smfmac_f32_16x16x64_bf16 v[16:19],v[92:95],a[32:39],v100
v_smfmac_f32_16x16x64_bf16 v[20:23],v[92:95],a[112:119],v100
v_smfmac_f32_16x16x64_bf16 v[24:27],v[92:95],a[192:199],v100
v_smfmac_f32_16x16x64_bf16 v[28:31],v[92:95],v[144:151],v100
v_smfmac_f32_16x16x64_bf16 v[32:35],v[92:95],v[224:231],v100
v_smfmac_f32_16x16x64_bf16 v[36:39],v[92:95],v[112:119],v100
ds_read_b128 v[112:115],v13 offset:18432
ds_read_b128 v[116:119],v13 offset:19456
ds_read_b128 v[92:95],v8 offset:7168
s_waitcnt lgkmcnt(6)
v_smfmac_f32_16x16x64_bf16 v[16:19],v[96:99],a[40:47],v100
v_smfmac_f32_16x16x64_bf16 v[20:23],v[96:99],a[120:127],v100
v_smfmac_f32_16x16x64_bf16 v[24:27],v[96:99],a[200:207],v100
v_smfmac_f32_16x16x64_bf16 v[28:31],v[96:99],v[152:159],v100
v_smfmac_f32_16x16x64_bf16 v[32:35],v[96:99],v[232:239],v100
v_smfmac_f32_16x16x64_bf16 v[36:39],v[96:99],v[120:127],v100
ds_read_b128 v[120:123],v13 offset:0
ds_read_b128 v[124:127],v13 offset:1024
ds_read_b128 v[96:99],v8 offset:8192
s_waitcnt lgkmcnt(6)
v_smfmac_f32_16x16x64_bf16 v[16:19],v[88:91],a[48:55],v100
v_smfmac_f32_16x16x64_bf16 v[20:23],v[88:91],a[128:135],v100
v_smfmac_f32_16x16x64_bf16 v[24:27],v[88:91],a[208:215],v100
v_smfmac_f32_16x16x64_bf16 v[28:31],v[88:91],v[160:167],v100
v_smfmac_f32_16x16x64_bf16 v[32:35],v[88:91],v[240:247],v100
v_smfmac_f32_16x16x64_bf16 v[36:39],v[88:91],v[104:111],v100
ds_read_b128 v[104:107],v13 offset:20480
ds_read_b128 v[108:111],v13 offset:21504
ds_read_b128 v[88:91],v8 offset:9216
s_waitcnt lgkmcnt(6)
v_smfmac_f32_16x16x64_bf16 v[16:19],v[92:95],a[56:63],v100
v_smfmac_f32_16x16x64_bf16 v[20:23],v[92:95],a[136:143],v100
v_smfmac_f32_16x16x64_bf16 v[24:27],v[92:95],a[216:223],v100
v_smfmac_f32_16x16x64_bf16 v[28:31],v[92:95],v[168:175],v100
v_smfmac_f32_16x16x64_bf16 v[32:35],v[92:95],v[248:255],v100
v_smfmac_f32_16x16x64_bf16 v[36:39],v[92:95],v[112:119],v100
ds_read_b128 v[112:115],v13 offset:2048
ds_read_b128 v[116:119],v13 offset:3072
s_waitcnt lgkmcnt(3)
v_smfmac_f32_16x16x64_bf16 v[16:19],v[96:99],a[64:71],v100
v_smfmac_f32_16x16x64_bf16 v[20:23],v[96:99],a[144:151],v100
v_smfmac_f32_16x16x64_bf16 v[24:27],v[96:99],a[224:231],v100
v_smfmac_f32_16x16x64_bf16 v[28:31],v[96:99],v[176:183],v100
v_smfmac_f32_16x16x64_bf16 v[32:35],v[96:99],v[120:127],v100
ds_read_b128 v[120:123],v13 offset:22528
ds_read_b128 v[124:127],v13 offset:23552
v_smfmac_f32_16x16x64_bf16 v[36:39],v[96:99],v[104:111],v100
s_waitcnt lgkmcnt(0)
v_smfmac_f32_16x16x64_bf16 v[16:19],v[88:91],a[72:79],v100
v_smfmac_f32_16x16x64_bf16 v[20:23],v[88:91],a[152:159],v100
v_smfmac_f32_16x16x64_bf16 v[24:27],v[88:91],a[232:239],v100
v_smfmac_f32_16x16x64_bf16 v[28:31],v[88:91],v[184:191],v100
v_smfmac_f32_16x16x64_bf16 v[32:35],v[88:91],v[112:119],v100
v_smfmac_f32_16x16x64_bf16 v[36:39],v[88:91],v[120:127],v100
s_waitcnt vmcnt(0)
s_nop 6
s_nop 1
v_add_f32 v16,v16,v18
v_add_f32 v17,v17,v19
v_add_f32 v28,v28,v30
v_add_f32 v29,v29,v31
v_add_f32 v20,v20,v22
v_add_f32 v21,v21,v23
v_add_f32 v32,v32,v34
v_add_f32 v33,v33,v35
v_add_f32 v24,v24,v26
v_add_f32 v25,v25,v27
v_add_f32 v36,v36,v38
v_add_f32 v37,v37,v39
cv v16,v16,v17
cv v28,v28,v29
cv v20,v20,v21
cv v32,v32,v33
cv v24,v24,v25
cv v36,v36,v37
ds_write_b32 v101,v16 offset:0
ds_write_b32 v101,v28 offset:768
ds_write_b32 v101,v20 offset:256
ds_write_b32 v101,v32 offset:1024
ds_write_b32 v101,v24 offset:512
ds_write_b32 v101,v36 offset:1280
tr v[16:17],v102,0
tr v[28:29],v102,768
tr v[20:21],v102,256
tr v[32:33],v102,1024
tr v[24:25],v102,512
tr v[36:37],v102,1280
s_waitcnt lgkmcnt(0)
v_mfma_f32_16x16x16_bf16 v[88:91],v[28:29],v[16:17],0
v_mfma_f32_16x16x16_bf16 v[92:95],v[40:41],v[16:17],0
v_mfma_f32_16x16x16_bf16 v[96:99],v[46:47],v[16:17],0
v_mfma_f32_16x16x16_bf16 v[88:91],v[32:33],v[20:21],v[88:91]
v_mfma_f32_16x16x16_bf16 v[92:95],v[42:43],v[20:21],v[92:95]
v_mfma_f32_16x16x16_bf16 v[96:99],v[48:49],v[20:21],v[96:99]
v_mfma_f32_16x16x16_bf16 v[88:91],v[36:37],v[24:25],v[88:91]
v_mfma_f32_16x16x16_bf16 v[92:95],v[44:45],v[24:25],v[92:95]
v_mfma_f32_16x16x16_bf16 v[96:99],v[50:51],v[24:25],v[96:99]
s_mov_b32 exec_lo,0x00ff00ff
s_mov_b32 exec_hi,0x00ff00ff
s_nop 7
s_nop 1
ds_write_b128 v12,v[92:95] offset:256
ds_write_b128 v12,v[96:99] offset:768
s_mov_b32 exec_hi,0
ds_write_b128 v12,v[88:91]
s_mov_b64 exec,-1
s_waitcnt lgkmcnt(0)
s_barrier
s_cmp_lg_u32 s20,0
s_cbranch_scc1 chA_rest
ds_read_b128 v[52:55],v14 offset:0
ds_read_b128 v[56:59],v14 offset:16
ds_read_b128 v[60:63],v14 offset:1280
ds_read_b128 v[64:67],v14 offset:1296
ds_read_b128 v[68:71],v14 offset:2560
ds_read_b128 v[72:75],v14 offset:2576
ds_read_b128 v[76:79],v14 offset:3840
ds_read_b128 v[80:83],v14 offset:3856
v_cmp_gt_u32 vcc,40,v1
v_mov_b32 v88,0xff800000
s_waitcnt lgkmcnt(4)
v_add_f32 v52,v52,v60
v_add_f32 v53,v53,v61
v_add_f32 v54,v54,v62
v_add_f32 v55,v55,v63
v_add_f32 v56,v56,v64
v_add_f32 v57,v57,v65
v_add_f32 v58,v58,v66
v_add_f32 v59,v59,v67
s_waitcnt lgkmcnt(0)
v_add_f32 v68,v68,v76
v_add_f32 v69,v69,v77
v_add_f32 v70,v70,v78
v_add_f32 v71,v71,v79
v_add_f32 v72,v72,v80
v_add_f32 v73,v73,v81
v_add_f32 v74,v74,v82
v_add_f32 v75,v75,v83
v_add_f32 v52,v52,v68
v_add_f32 v53,v53,v69
v_add_f32 v54,v54,v70
v_add_f32 v55,v55,v71
v_add_f32 v56,v56,v72
v_add_f32 v57,v57,v73
v_add_f32 v58,v58,v74
v_add_f32 v59,v59,v75
v_max3_f32 v89,v52,v53,v54
v_max3_f32 v90,v55,v56,v57
v_max3_f32 v89,v89,v58,v59
v_max_f32 v89,v89,v90
v_cndmask_b32 v89,v88,v89,vcc
s_nop 1
v_max_f32_dpp v89,v89,v89 row_ror:8 row_mask:0xf bank_mask:0xf
v_mov_b32 v90,v89
s_nop 1
v_permlane16_swap_b32 v89,v90
s_nop 1
v_max_f32 v89,v89,v90
v_mov_b32 v90,v89
s_nop 1
v_permlane32_swap_b32 v89,v90
s_nop 1
v_max_f32 v89,v89,v90
v_mul_f32 v89,0x3dd53b95,v89
v_mov_b32 v91,0x3dd53b95
v_fma_f32 v52,v52,v91,-v89
v_fma_f32 v53,v53,v91,-v89
v_fma_f32 v54,v54,v91,-v89
v_fma_f32 v55,v55,v91,-v89
v_fma_f32 v56,v56,v91,-v89
v_fma_f32 v57,v57,v91,-v89
v_fma_f32 v58,v58,v91,-v89
v_fma_f32 v59,v59,v91,-v89
v_exp_f32 v52,v52
v_exp_f32 v53,v53
v_exp_f32 v54,v54
v_exp_f32 v55,v55
v_exp_f32 v56,v56
v_exp_f32 v57,v57
v_exp_f32 v58,v58
v_exp_f32 v59,v59
v_mov_b32 v88,0
v_add_f32 v89,v52,v53
v_add_f32 v90,v54,v55
v_add_f32 v92,v56,v57
v_add_f32 v93,v58,v59
v_add_f32 v89,v89,v90
v_add_f32 v92,v92,v93
v_add_f32 v89,v89,v92
v_cndmask_b32 v89,v88,v89,vcc
s_nop 1
v_add_f32_dpp v89,v89,v89 row_ror:8 row_mask:0xf bank_mask:0xf
v_mov_b32 v90,v89
s_nop 1
v_permlane16_swap_b32 v89,v90
s_nop 1
v_add_f32 v89,v89,v90
v_mov_b32 v90,v89
s_nop 1
v_permlane32_swap_b32 v89,v90
s_nop 1
v_add_f32 v89,v89,v90
v_rcp_f32 v89,v89
s_nop 0
v_mul_f32 v52,v52,v89
v_mul_f32 v53,v53,v89
v_mul_f32 v54,v54,v89
v_mul_f32 v55,v55,v89
v_mul_f32 v56,v56,v89
v_mul_f32 v57,v57,v89
v_mul_f32 v58,v58,v89
v_mul_f32 v59,v59,v89
cv v60,v52,v53
cv v61,v54,v55
cv v62,v56,v57
cv v63,v58,v59
s_add_u32 s23,s42,s43
s_mov_b32 exec_hi,0xff
buffer_store_dwordx4 v[60:63],v11,s[48:51],s23 offen sc1
s_mov_b64 exec,-1
chA_rest:
s_mov_b32 exec_lo,0x00ff00ff
s_mov_b32 exec_hi,0x00ff00ff
buffer_store_dwordx2 v[28:29],v10,s[56:59],s62 offen offset:0 sc1
buffer_store_dwordx2 v[32:33],v10,s[56:59],s62 offen offset:128 sc1
buffer_store_dwordx2 v[36:37],v10,s[56:59],s62 offen offset:256 sc1
s_mov_b64 exec,-1
s_add_u32 s61,s61,393216
s_add_u32 s62,s62,98304
s_cmp_lg_u32 s40,3
s_cbranch_scc1 chA_fk1_ok
s_lshl_b32 s22,s2,2
s_add_u32 s22,s22,53376
s_mov_b32 s60,0
chA_fk1:
buffer_load_dword v15,off,s[92:95],s22 sc1
s_waitcnt vmcnt(0)
v_cmp_ne_u32 vcc,-1,v15
s_nop 1
s_cmp_eq_u64 vcc,exec
s_cbranch_scc1 chA_fk1_ok
s_sleep 8
s_add_u32 s60,s60,1
s_cmp_gt_u32 s60,400000
s_cbranch_scc1 chain_end
s_branch chA_fk1
chA_fk1_ok:
s_add_u32 s22,s40,1
s_and_b32 s23,s22,7
s_cmp_lg_u32 s23,0
s_cbranch_scc1 chA_fk_ok
s_cmp_ge_u32 s22,64
s_cbranch_scc1 chA_fk_ok
s_lshl_b32 s22,s22,4
s_lshl_b32 s23,s2,2
s_add_u32 s22,s22,s23
s_add_u32 s22,s22,33792
s_mov_b32 s60,0
chA_fk:
buffer_load_dword v15,off,s[92:95],s22 sc1
s_waitcnt vmcnt(0)
v_cmp_ne_u32 vcc,-1,v15
s_nop 1
s_cmp_eq_u64 vcc,exec
s_cbranch_scc1 chA_fk_ok
s_sleep 8
s_add_u32 s60,s60,1
s_cmp_gt_u32 s60,400000
s_cbranch_scc1 chain_end
s_branch chA_fk
chA_fk_ok:
s_add_u32 s23,s61,0
buffer_load_dwordx2 v[40:41],v9,s[52:55],s23 offen
s_add_u32 s23,s61,128
buffer_load_dwordx2 v[42:43],v9,s[52:55],s23 offen
s_add_u32 s23,s61,256
buffer_load_dwordx2 v[44:45],v9,s[52:55],s23 offen
s_add_u32 s23,s61,196608
buffer_load_dwordx2 v[46:47],v9,s[52:55],s23 offen
s_add_u32 s23,s61,196736
buffer_load_dwordx2 v[48:49],v9,s[52:55],s23 offen
s_add_u32 s23,s61,196864
buffer_load_dwordx2 v[50:51],v9,s[52:55],s23 offen
s_add_u32 s40,s40,1
s_add_u32 s41,s41,10240
s_add_u32 s42,s42,20480
s_cmp_ge_u32 s40,64
s_cbranch_scc1 chA_end
s_cmp_lg_u32 s20,0
s_cbranch_scc1 chA_slp
s_sleep 23
s_branch chA_loop
chA_slp:
s_sleep 28
s_branch chA_loop
chA_end:
s_waitcnt vmcnt(0)
s_barrier
s_cmp_lg_u32 s20,0
s_cbranch_scc1 chain_fin
v_mov_b32 v60,0
v_mov_b32 v61,0
v_mov_b32 v62,0
v_mov_b32 v63,0
s_add_u32 s23,s42,s43
s_mov_b32 exec_hi,0xff
buffer_store_dwordx4 v[60:63],v11,s[48:51],s23 offen sc1
s_mov_b64 exec,-1
s_branch chain_fin
s_branch chain_end
chain_R:
s_sub_u32 s24,s2,32
s_mul_i32 s26,s24,327680
s_mul_i32 s27,s20,81920
s_add_u32 s26,s26,s27
s_add_u32 s26,s26,83886080
s_add_u32 s32,s12,s26
s_addc_u32 s33,s13,0
s_mov_b32 s34,0x14000
s_mov_b32 s35,0x00020000
s_mul_i32 s26,s20,5120
s_lshl_b32 s27,s24,3
s_add_u32 s26,s26,s27
s_lshl_b32 s27,s26,6
s_add_u32 s27,s27,117440512
s_sub_u32 s28,201326592,s27
s_add_u32 s36,s12,s27
s_addc_u32 s37,s13,0
s_mov_b32 s38,s28
s_mov_b32 s39,0x00020000
s_lshl_b32 s27,s26,4
s_add_u32 s27,s27,218103808
s_sub_u32 s28,239075328,s27
s_add_u32 s52,s12,s27
s_addc_u32 s53,s13,0
s_mov_b32 s54,s28
s_mov_b32 s55,0x00020000
v_lshlrev_b32 v9,4,v1
v_lshlrev_b32 v30,2,v1
v_lshlrev_b32 v31,2,v1
v_add_u32 v31,256,v31
s_mov_b32 s22,49152
s_mov_b32 s60,0
chR_vo0:
buffer_load_dword v15,v30,s[92:95],s22 offen sc1
s_waitcnt vmcnt(0)
v_cmp_ne_u32 vcc,-1,v15
s_nop 1
s_cmp_eq_u64 vcc,exec
s_cbranch_scc1 chR_vo0_ok
s_sleep 8
s_add_u32 s60,s60,1
s_cmp_gt_u32 s60,400000
s_cbranch_scc1 chain_end
s_branch chR_vo0
chR_vo0_ok:
s_mov_b32 s60,0
chR_vo1:
buffer_load_dword v15,v31,s[92:95],s22 offen sc1
s_waitcnt vmcnt(0)
v_cmp_ne_u32 vcc,-1,v15
s_nop 1
s_cmp_eq_u64 vcc,exec
s_cbranch_scc1 chR_vo1_ok
s_sleep 8
s_add_u32 s60,s60,1
s_cmp_gt_u32 s60,400000
s_cbranch_scc1 chain_end
s_branch chR_vo1
chR_vo1_ok:
s_mov_b32 s23,0
buffer_load_dwordx4 a[0:3],v9,s[32:35],s23 offen
s_mov_b32 s23,1024
buffer_load_dwordx4 a[4:7],v9,s[32:35],s23 offen
s_mov_b32 s23,2048
buffer_load_dwordx4 a[8:11],v9,s[32:35],s23 offen
s_mov_b32 s23,3072
buffer_load_dwordx4 a[12:15],v9,s[32:35],s23 offen
s_mov_b32 s23,4096
buffer_load_dwordx4 a[16:19],v9,s[32:35],s23 offen
s_mov_b32 s23,5120
buffer_load_dwordx4 a[20:23],v9,s[32:35],s23 offen
s_mov_b32 s23,6144
buffer_load_dwordx4 a[24:27],v9,s[32:35],s23 offen
s_mov_b32 s23,7168
buffer_load_dwordx4 a[28:31],v9,s[32:35],s23 offen
s_mov_b32 s23,8192
buffer_load_dwordx4 a[32:35],v9,s[32:35],s23 offen
s_mov_b32 s23,9216
buffer_load_dwordx4 a[36:39],v9,s[32:35],s23 offen
s_mov_b32 s23,10240
buffer_load_dwordx4 a[40:43],v9,s[32:35],s23 offen
s_mov_b32 s23,11264
buffer_load_dwordx4 a[44:47],v9,s[32:35],s23 offen
s_mov_b32 s23,12288
buffer_load_dwordx4 a[48:51],v9,s[32:35],s23 offen
s_mov_b32 s23,13312
buffer_load_dwordx4 a[52:55],v9,s[32:35],s23 offen
s_mov_b32 s23,14336
buffer_load_dwordx4 a[56:59],v9,s[32:35],s23 offen
s_mov_b32 s23,15360
buffer_load_dwordx4 a[60:63],v9,s[32:35],s23 offen
s_mov_b32 s23,16384
buffer_load_dwordx4 a[64:67],v9,s[32:35],s23 offen
s_mov_b32 s23,17408
buffer_load_dwordx4 a[68:71],v9,s[32:35],s23 offen
s_mov_b32 s23,18432
buffer_load_dwordx4 a[72:75],v9,s[32:35],s23 offen
s_mov_b32 s23,19456
buffer_load_dwordx4 a[76:79],v9,s[32:35],s23 offen
s_mov_b32 s23,20480
buffer_load_dwordx4 a[80:83],v9,s[32:35],s23 offen
s_mov_b32 s23,21504
buffer_load_dwordx4 a[84:87],v9,s[32:35],s23 offen
s_mov_b32 s23,22528
buffer_load_dwordx4 a[88:91],v9,s[32:35],s23 offen
s_mov_b32 s23,23552
buffer_load_dwordx4 a[92:95],v9,s[32:35],s23 offen
s_mov_b32 s23,24576
buffer_load_dwordx4 a[96:99],v9,s[32:35],s23 offen
s_mov_b32 s23,25600
buffer_load_dwordx4 a[100:103],v9,s[32:35],s23 offen
s_mov_b32 s23,26624
buffer_load_dwordx4 a[104:107],v9,s[32:35],s23 offen
s_mov_b32 s23,27648
buffer_load_dwordx4 a[108:111],v9,s[32:35],s23 offen
s_mov_b32 s23,28672
buffer_load_dwordx4 a[112:115],v9,s[32:35],s23 offen
s_mov_b32 s23,29696
buffer_load_dwordx4 a[116:119],v9,s[32:35],s23 offen
s_mov_b32 s23,30720
buffer_load_dwordx4 a[120:123],v9,s[32:35],s23 offen
s_mov_b32 s23,31744
buffer_load_dwordx4 a[124:127],v9,s[32:35],s23 offen
s_mov_b32 s23,32768
buffer_load_dwordx4 a[128:131],v9,s[32:35],s23 offen
s_mov_b32 s23,33792
buffer_load_dwordx4 a[132:135],v9,s[32:35],s23 offen
s_mov_b32 s23,34816
buffer_load_dwordx4 a[136:139],v9,s[32:35],s23 offen
s_mov_b32 s23,35840
buffer_load_dwordx4 a[140:143],v9,s[32:35],s23 offen
s_mov_b32 s23,36864
buffer_load_dwordx4 a[144:147],v9,s[32:35],s23 offen
s_mov_b32 s23,37888
buffer_load_dwordx4 a[148:151],v9,s[32:35],s23 offen
s_mov_b32 s23,38912
buffer_load_dwordx4 a[152:155],v9,s[32:35],s23 offen
s_mov_b32 s23,39936
buffer_load_dwordx4 a[156:159],v9,s[32:35],s23 offen
s_mov_b32 s23,40960
buffer_load_dwordx4 a[160:163],v9,s[32:35],s23 offen
s_mov_b32 s23,41984
buffer_load_dwordx4 a[164:167],v9,s[32:35],s23 offen
s_mov_b32 s23,43008
buffer_load_dwordx4 a[168:171],v9,s[32:35],s23 offen
s_mov_b32 s23,44032
buffer_load_dwordx4 a[172:175],v9,s[32:35],s23 offen
s_mov_b32 s23,45056
buffer_load_dwordx4 a[176:179],v9,s[32:35],s23 offen
s_mov_b32 s23,46080
buffer_load_dwordx4 a[180:183],v9,s[32:35],s23 offen
s_mov_b32 s23,47104
buffer_load_dwordx4 a[184:187],v9,s[32:35],s23 offen
s_mov_b32 s23,48128
buffer_load_dwordx4 a[188:191],v9,s[32:35],s23 offen
s_mov_b32 s23,49152
buffer_load_dwordx4 a[192:195],v9,s[32:35],s23 offen
s_mov_b32 s23,50176
buffer_load_dwordx4 a[196:199],v9,s[32:35],s23 offen
s_mov_b32 s23,51200
buffer_load_dwordx4 a[200:203],v9,s[32:35],s23 offen
s_mov_b32 s23,52224
buffer_load_dwordx4 a[204:207],v9,s[32:35],s23 offen
s_mov_b32 s23,53248
buffer_load_dwordx4 a[208:211],v9,s[32:35],s23 offen
s_mov_b32 s23,54272
buffer_load_dwordx4 a[212:215],v9,s[32:35],s23 offen
s_mov_b32 s23,55296
buffer_load_dwordx4 a[216:219],v9,s[32:35],s23 offen
s_mov_b32 s23,56320
buffer_load_dwordx4 a[220:223],v9,s[32:35],s23 offen
s_mov_b32 s23,57344
buffer_load_dwordx4 a[224:227],v9,s[32:35],s23 offen
s_mov_b32 s23,58368
buffer_load_dwordx4 a[228:231],v9,s[32:35],s23 offen
s_mov_b32 s23,59392
buffer_load_dwordx4 a[232:235],v9,s[32:35],s23 offen
s_mov_b32 s23,60416
buffer_load_dwordx4 a[236:239],v9,s[32:35],s23 offen
s_mov_b32 s23,61440
buffer_load_dwordx4 a[240:243],v9,s[32:35],s23 offen
s_mov_b32 s23,62464
buffer_load_dwordx4 a[244:247],v9,s[32:35],s23 offen
s_mov_b32 s23,63488
buffer_load_dwordx4 a[248:251],v9,s[32:35],s23 offen
s_mov_b32 s23,64512
buffer_load_dwordx4 a[252:255],v9,s[32:35],s23 offen
s_mov_b32 s23,65536
buffer_load_dwordx4 v[192:195],v9,s[32:35],s23 offen
s_mov_b32 s23,66560
buffer_load_dwordx4 v[196:199],v9,s[32:35],s23 offen
s_mov_b32 s23,67584
buffer_load_dwordx4 v[200:203],v9,s[32:35],s23 offen
s_mov_b32 s23,68608
buffer_load_dwordx4 v[204:207],v9,s[32:35],s23 offen
s_mov_b32 s23,69632
buffer_load_dwordx4 v[208:211],v9,s[32:35],s23 offen
s_mov_b32 s23,70656
buffer_load_dwordx4 v[212:215],v9,s[32:35],s23 offen
s_mov_b32 s23,71680
buffer_load_dwordx4 v[216:219],v9,s[32:35],s23 offen
s_mov_b32 s23,72704
buffer_load_dwordx4 v[220:223],v9,s[32:35],s23 offen
s_mov_b32 s23,73728
buffer_load_dwordx4 v[224:227],v9,s[32:35],s23 offen
s_mov_b32 s23,74752
buffer_load_dwordx4 v[228:231],v9,s[32:35],s23 offen
s_mov_b32 s23,75776
buffer_load_dwordx4 v[232:235],v9,s[32:35],s23 offen
s_mov_b32 s23,76800
buffer_load_dwordx4 v[236:239],v9,s[32:35],s23 offen
s_mov_b32 s23,77824
buffer_load_dwordx4 v[240:243],v9,s[32:35],s23 offen
s_mov_b32 s23,78848
buffer_load_dwordx4 v[244:247],v9,s[32:35],s23 offen
s_mov_b32 s23,79872
buffer_load_dwordx4 v[248:251],v9,s[32:35],s23 offen
s_mov_b32 s23,80896
buffer_load_dwordx4 v[252:255],v9,s[32:35],s23 offen
v_and_b32 v10,7,v3
v_lshrrev_b32 v14,3,v3
v_lshl_add_u32 v14,v14,2,v2
s_lshl_b32 s22,s20,10
s_add_u32 s22,s22,16384
v_add_u32 v11,0,v14
v_mul_u32_u24 v12,52,v11
v_lshrrev_b32 v12,8,v12
v_mul_u32_u24 v13,5,v12
v_sub_u32 v13,v11,v13
v_max_u32 v13,1,v13
v_subrev_u32 v13,1,v13
v_mul_u32_u24 v16,40960,v12
v_lshl_add_u32 v16,v13,4,v16
v_lshl_add_u32 v16,v10,6,v16
v_lshlrev_b32 v184,7,v12
v_lshl_add_u32 v184,v10,4,v184
v_add_u32 v184,s22,v184
v_add_u32 v11,8,v14
v_mul_u32_u24 v12,52,v11
v_lshrrev_b32 v12,8,v12
v_mul_u32_u24 v13,5,v12
v_sub_u32 v13,v11,v13
v_max_u32 v13,1,v13
v_subrev_u32 v13,1,v13
v_mul_u32_u24 v17,40960,v12
v_lshl_add_u32 v17,v13,4,v17
v_lshl_add_u32 v17,v10,6,v17
v_lshlrev_b32 v185,7,v12
v_lshl_add_u32 v185,v10,4,v185
v_add_u32 v185,s22,v185
v_add_u32 v11,16,v14
v_mul_u32_u24 v12,52,v11
v_lshrrev_b32 v12,8,v12
v_mul_u32_u24 v13,5,v12
v_sub_u32 v13,v11,v13
v_max_u32 v13,1,v13
v_subrev_u32 v13,1,v13
v_mul_u32_u24 v18,40960,v12
v_lshl_add_u32 v18,v13,4,v18
v_lshl_add_u32 v18,v10,6,v18
v_lshlrev_b32 v186,7,v12
v_lshl_add_u32 v186,v10,4,v186
v_add_u32 v186,s22,v186
v_add_u32 v11,24,v14
v_mul_u32_u24 v12,52,v11
v_lshrrev_b32 v12,8,v12
v_mul_u32_u24 v13,5,v12
v_sub_u32 v13,v11,v13
v_max_u32 v13,1,v13
v_subrev_u32 v13,1,v13
v_mul_u32_u24 v19,40960,v12
v_lshl_add_u32 v19,v13,4,v19
v_lshl_add_u32 v19,v10,6,v19
v_lshlrev_b32 v187,7,v12
v_lshl_add_u32 v187,v10,4,v187
v_add_u32 v187,s22,v187
v_add_u32 v11,32,v14
v_mul_u32_u24 v12,52,v11
v_lshrrev_b32 v12,8,v12
v_mul_u32_u24 v13,5,v12
v_sub_u32 v13,v11,v13
v_max_u32 v13,1,v13
v_subrev_u32 v13,1,v13
v_mul_u32_u24 v20,40960,v12
v_lshl_add_u32 v20,v13,4,v20
v_lshl_add_u32 v20,v10,6,v20
v_lshlrev_b32 v188,7,v12
v_lshl_add_u32 v188,v10,4,v188
v_add_u32 v188,s22,v188
s_mul_i32 s23,s20,5120
v_lshlrev_b32 v21,7,v14
v_lshl_add_u32 v21,v10,4,v21
v_add_u32 v21,s23,v21
v_lshlrev_b32 v22,4,v3
v_lshl_add_u32 v22,v2,3,v22
v_add_u32 v22,s22,v22
v_lshlrev_b32 v24,4,v1
v_add_u32 v24,s22,v24
v_lshrrev_b32 v25,3,v1
v_mul_u32_u24 v25,10240,v25
v_and_b32 v11,7,v1
v_lshl_add_u32 v25,v11,4,v25
v_lshlrev_b32 v27,4,v1
v_add_u32 v27,24576,v27
s_lshl_b32 s22,s20,10
v_add_u32 v26,s22,v27
s_lshl_b32 s22,s24,7
v_lshlrev_b32 v28,4,v3
v_lshl_add_u32 v28,v2,3,v28
v_add_u32 v28,s22,v28
s_mov_b32 s61,0
s_mov_b32 s62,0
v_and_b32 v30,31,v1
v_lshlrev_b32 v30,2,v30
s_mov_b32 s22,32768
s_mov_b32 s60,0
chR_fu0:
buffer_load_dword v15,v30,s[92:95],s22 offen sc1
s_waitcnt vmcnt(0)
v_cmp_ne_u32 vcc,-1,v15
s_nop 1
s_cmp_eq_u64 vcc,exec
s_cbranch_scc1 chR_fu0_ok
s_sleep 8
s_add_u32 s60,s60,1
s_cmp_gt_u32 s60,400000
s_cbranch_scc1 chain_end
s_branch chR_fu0
chR_fu0_ok:
buffer_load_dwordx4 v[100:103],v16,s[36:39],s61 offen
buffer_load_dwordx4 v[104:107],v17,s[36:39],s61 offen
buffer_load_dwordx4 v[108:111],v18,s[36:39],s61 offen
buffer_load_dwordx4 v[112:115],v19,s[36:39],s61 offen
buffer_load_dwordx4 v[116:119],v20,s[36:39],s61 offen
chR_loop:
s_mov_b32 s60,0
buffer_load_dwordx4 v[32:35],v5,s[44:47],s41 offen sc1
buffer_load_dwordx4 v[36:39],v6,s[44:47],s41 offen sc1
buffer_load_dwordx4 v[40:43],v7,s[44:47],s41 offen sc1
chR_lp:
s_waitcnt vmcnt(0)
v_max3_u32 v15,v32,v33,v34
v_max3_u32 v15,v15,v35,v36
v_max3_u32 v15,v15,v37,v38
v_max3_u32 v15,v15,v39,v40
v_max3_u32 v15,v15,v41,v42
v_max_u32 v15,v15,v43
v_cmp_ne_u32 vcc,-1,v15
s_nop 1
s_cmp_eq_u64 vcc,exec
s_cbranch_scc1 chR_ok0
buffer_load_dwordx4 v[32:35],v5,s[44:47],s41 offen sc1
buffer_load_dwordx4 v[36:39],v6,s[44:47],s41 offen sc1
buffer_load_dwordx4 v[40:43],v7,s[44:47],s41 offen sc1
s_add_u32 s60,s60,1
s_cmp_gt_u32 s60,400000
s_cbranch_scc1 chain_end
s_branch chR_lp
chR_ok0:
ds_write_b128 v5,v[32:35]
ds_write_b128 v6,v[36:39]
ds_write_b128 v7,v[40:43]
chR_done:
s_waitcnt lgkmcnt(0)
s_barrier
ds_read_b128 v[84:87],v8 offset:0
ds_read_b128 v[88:91],v8 offset:512
ds_read_b128 v[92:95],v8 offset:1024
ds_read_b128 v[96:99],v8 offset:1536
s_waitcnt lgkmcnt(3)
mf v[68:71],v[84:87],a[0:3],0
mf v[72:75],v[84:87],a[80:83],0
mf v[76:79],v[84:87],a[160:163],0
mf v[80:83],v[84:87],a[240:243],0
ds_read_b128 v[84:87],v8 offset:2048
s_waitcnt lgkmcnt(3)
mf v[68:71],v[88:91],a[4:7],v[68:71]
mf v[72:75],v[88:91],a[84:87],v[72:75]
mf v[76:79],v[88:91],a[164:167],v[76:79]
mf v[80:83],v[88:91],a[244:247],v[80:83]
ds_read_b128 v[88:91],v8 offset:2560
s_waitcnt lgkmcnt(3)
mf v[68:71],v[92:95],a[8:11],v[68:71]
mf v[72:75],v[92:95],a[88:91],v[72:75]
mf v[76:79],v[92:95],a[168:171],v[76:79]
mf v[80:83],v[92:95],a[248:251],v[80:83]
ds_read_b128 v[92:95],v8 offset:3072
s_waitcnt lgkmcnt(3)
mf v[68:71],v[96:99],a[12:15],v[68:71]
mf v[72:75],v[96:99],a[92:95],v[72:75]
mf v[76:79],v[96:99],a[172:175],v[76:79]
mf v[80:83],v[96:99],a[252:255],v[80:83]
ds_read_b128 v[96:99],v8 offset:3584
s_waitcnt lgkmcnt(3)
mf v[68:71],v[84:87],a[16:19],v[68:71]
mf v[72:75],v[84:87],a[96:99],v[72:75]
mf v[76:79],v[84:87],a[176:179],v[76:79]
mf v[80:83],v[84:87],v[192:195],v[80:83]
ds_read_b128 v[84:87],v8 offset:4096
s_waitcnt lgkmcnt(3)
mf v[68:71],v[88:91],a[20:23],v[68:71]
mf v[72:75],v[88:91],a[100:103],v[72:75]
mf v[76:79],v[88:91],a[180:183],v[76:79]
mf v[80:83],v[88:91],v[196:199],v[80:83]
ds_read_b128 v[88:91],v8 offset:4608
s_waitcnt lgkmcnt(3)
mf v[68:71],v[92:95],a[24:27],v[68:71]
mf v[72:75],v[92:95],a[104:107],v[72:75]
mf v[76:79],v[92:95],a[184:187],v[76:79]
mf v[80:83],v[92:95],v[200:203],v[80:83]
ds_read_b128 v[92:95],v8 offset:5120
s_waitcnt lgkmcnt(3)
mf v[68:71],v[96:99],a[28:31],v[68:71]
mf v[72:75],v[96:99],a[108:111],v[72:75]
mf v[76:79],v[96:99],a[188:191],v[76:79]
mf v[80:83],v[96:99],v[204:207],v[80:83]
ds_read_b128 v[96:99],v8 offset:5632
s_waitcnt lgkmcnt(3)
mf v[68:71],v[84:87],a[32:35],v[68:71]
mf v[72:75],v[84:87],a[112:115],v[72:75]
mf v[76:79],v[84:87],a[192:195],v[76:79]
mf v[80:83],v[84:87],v[208:211],v[80:83]
ds_read_b128 v[84:87],v8 offset:6144
s_waitcnt lgkmcnt(3)
mf v[68:71],v[88:91],a[36:39],v[68:71]
mf v[72:75],v[88:91],a[116:119],v[72:75]
mf v[76:79],v[88:91],a[196:199],v[76:79]
mf v[80:83],v[88:91],v[212:215],v[80:83]
ds_read_b128 v[88:91],v8 offset:6656
s_waitcnt lgkmcnt(3)
mf v[68:71],v[92:95],a[40:43],v[68:71]
mf v[72:75],v[92:95],a[120:123],v[72:75]
mf v[76:79],v[92:95],a[200:203],v[76:79]
mf v[80:83],v[92:95],v[216:219],v[80:83]
ds_read_b128 v[92:95],v8 offset:7168
s_waitcnt lgkmcnt(3)
mf v[68:71],v[96:99],a[44:47],v[68:71]
mf v[72:75],v[96:99],a[124:127],v[72:75]
mf v[76:79],v[96:99],a[204:207],v[76:79]
mf v[80:83],v[96:99],v[220:223],v[80:83]
ds_read_b128 v[96:99],v8 offset:7680
s_waitcnt lgkmcnt(3)
mf v[68:71],v[84:87],a[48:51],v[68:71]
mf v[72:75],v[84:87],a[128:131],v[72:75]
mf v[76:79],v[84:87],a[208:211],v[76:79]
mf v[80:83],v[84:87],v[224:227],v[80:83]
ds_read_b128 v[84:87],v8 offset:8192
s_waitcnt lgkmcnt(3)
mf v[68:71],v[88:91],a[52:55],v[68:71]
mf v[72:75],v[88:91],a[132:135],v[72:75]
mf v[76:79],v[88:91],a[212:215],v[76:79]
mf v[80:83],v[88:91],v[228:231],v[80:83]
ds_read_b128 v[88:91],v8 offset:8704
s_waitcnt lgkmcnt(3)
mf v[68:71],v[92:95],a[56:59],v[68:71]
mf v[72:75],v[92:95],a[136:139],v[72:75]
mf v[76:79],v[92:95],a[216:219],v[76:79]
mf v[80:83],v[92:95],v[232:235],v[80:83]
ds_read_b128 v[92:95],v8 offset:9216
s_waitcnt lgkmcnt(3)
mf v[68:71],v[96:99],a[60:63],v[68:71]
mf v[72:75],v[96:99],a[140:143],v[72:75]
mf v[76:79],v[96:99],a[220:223],v[76:79]
mf v[80:83],v[96:99],v[236:239],v[80:83]
ds_read_b128 v[96:99],v8 offset:9728
s_waitcnt lgkmcnt(3)
mf v[68:71],v[84:87],a[64:67],v[68:71]
mf v[72:75],v[84:87],a[144:147],v[72:75]
mf v[76:79],v[84:87],a[224:227],v[76:79]
mf v[80:83],v[84:87],v[240:243],v[80:83]
s_waitcnt lgkmcnt(2)
mf v[68:71],v[88:91],a[68:71],v[68:71]
mf v[72:75],v[88:91],a[148:151],v[72:75]
mf v[76:79],v[88:91],a[228:231],v[76:79]
mf v[80:83],v[88:91],v[244:247],v[80:83]
s_waitcnt lgkmcnt(1)
mf v[68:71],v[92:95],a[72:75],v[68:71]
mf v[72:75],v[92:95],a[152:155],v[72:75]
mf v[76:79],v[92:95],a[232:235],v[76:79]
mf v[80:83],v[92:95],v[248:251],v[80:83]
s_waitcnt lgkmcnt(0)
mf v[68:71],v[96:99],a[76:79],v[68:71]
mf v[72:75],v[96:99],a[156:159],v[72:75]
mf v[76:79],v[96:99],a[236:239],v[76:79]
mf v[80:83],v[96:99],v[252:255],v[80:83]
s_nop 7
s_nop 1
cv v68,v68,v69
cv v69,v70,v71
cv v72,v72,v73
cv v73,v74,v75
cv v76,v76,v77
cv v77,v78,v79
cv v80,v80,v81
cv v81,v82,v83
s_mov_b32 exec_hi,0
ds_write_b64 v22,v[68:69] offset:0
ds_write_b64 v22,v[72:73] offset:256
ds_write_b64 v22,v[76:77] offset:512
ds_write_b64 v22,v[80:81] offset:768
s_mov_b64 exec,-1
s_waitcnt vmcnt(0) lgkmcnt(0)
s_mov_b32 exec_lo,0xff0000ff
s_mov_b32 exec_hi,0x0
ds_read_b128 v[100:103],v184
s_mov_b32 exec_lo,0x0
s_mov_b32 exec_hi,0xff0000ff
ds_read_b128 v[104:107],v185
s_mov_b32 exec_lo,0xff00
s_mov_b32 exec_hi,0x0
ds_read_b128 v[108:111],v186
s_mov_b32 exec_lo,0xff0000
s_mov_b32 exec_hi,0xff00
ds_read_b128 v[112:115],v187
s_mov_b32 exec_lo,0x0
s_mov_b32 exec_hi,0xff0000
ds_read_b128 v[116:119],v188
s_mov_b64 exec,-1
ds_read_b128 v[84:87],v24
s_waitcnt lgkmcnt(0)
buffer_store_dwordx4 v[84:87],v25,s[52:55],s62 offen sc1
v_add_u32 v29,4096,v21
s_sleep 31
s_mov_b32 s60,0
buffer_load_dwordx4 v[120:123],v21,s[48:51],s42 offen offset:0 sc1
buffer_load_dwordx4 v[124:127],v21,s[48:51],s42 offen offset:1024 sc1
buffer_load_dwordx4 v[128:131],v21,s[48:51],s42 offen offset:2048 sc1
buffer_load_dwordx4 v[132:135],v21,s[48:51],s42 offen offset:3072 sc1
buffer_load_dwordx4 v[136:139],v29,s[48:51],s42 offen sc1
chRp_lp:
s_waitcnt vmcnt(0)
v_max3_u32 v15,v120,v121,v122
v_max3_u32 v15,v15,v123,v124
v_max3_u32 v15,v15,v125,v126
v_max3_u32 v15,v15,v127,v128
v_max3_u32 v15,v15,v129,v130
v_max3_u32 v15,v15,v131,v132
v_max3_u32 v15,v15,v133,v134
v_max3_u32 v15,v15,v135,v136
v_max3_u32 v15,v15,v137,v138
v_max_u32 v15,v15,v139
v_cmp_ne_u32 vcc,-1,v15
s_nop 1
s_cmp_eq_u64 vcc,exec
s_cbranch_scc1 chRp_ok0
buffer_load_dwordx4 v[120:123],v21,s[48:51],s42 offen offset:0 sc1
buffer_load_dwordx4 v[124:127],v21,s[48:51],s42 offen offset:1024 sc1
buffer_load_dwordx4 v[128:131],v21,s[48:51],s42 offen offset:2048 sc1
buffer_load_dwordx4 v[132:135],v21,s[48:51],s42 offen offset:3072 sc1
buffer_load_dwordx4 v[136:139],v29,s[48:51],s42 offen sc1
s_add_u32 s60,s60,1
s_cmp_gt_u32 s60,400000
s_cbranch_scc1 chain_end
s_branch chRp_lp
chRp_ok0:
mf v[68:71],v[100:103],v[120:123],0
mf v[72:75],v[104:107],v[124:127],0
mf v[68:71],v[108:111],v[128:131],v[68:71]
mf v[72:75],v[112:115],v[132:135],v[72:75]
mf v[68:71],v[116:119],v[136:139],v[68:71]
chRp_done:
s_nop 7
s_nop 1
v_add_f32 v68,v68,v72
v_add_f32 v69,v69,v73
v_add_f32 v70,v70,v74
v_add_f32 v71,v71,v75
ds_write_b128 v26,v[68:71]
s_waitcnt lgkmcnt(0)
s_barrier
s_cmp_lg_u32 s20,0
s_cbranch_scc1 chR_next
ds_read_b128 v[68:71],v27 offset:0
ds_read_b128 v[72:75],v27 offset:640
ds_read_b128 v[76:79],v27 offset:1024
ds_read_b128 v[80:83],v27 offset:1664
ds_read_b128 v[84:87],v27 offset:2048
ds_read_b128 v[88:91],v27 offset:2688
ds_read_b128 v[92:95],v27 offset:3072
ds_read_b128 v[96:99],v27 offset:3712
s_waitcnt lgkmcnt(0)
v_add_f32 v68,v68,v84
v_add_f32 v69,v69,v85
v_add_f32 v70,v70,v86
v_add_f32 v71,v71,v87
v_add_f32 v72,v72,v88
v_add_f32 v73,v73,v89
v_add_f32 v74,v74,v90
v_add_f32 v75,v75,v91
v_add_f32 v76,v76,v92
v_add_f32 v77,v77,v93
v_add_f32 v78,v78,v94
v_add_f32 v79,v79,v95
v_add_f32 v80,v80,v96
v_add_f32 v81,v81,v97
v_add_f32 v82,v82,v98
v_add_f32 v83,v83,v99
v_add_f32 v68,v68,v76
v_add_f32 v69,v69,v77
v_add_f32 v70,v70,v78
v_add_f32 v71,v71,v79
v_add_f32 v72,v72,v80
v_add_f32 v73,v73,v81
v_add_f32 v74,v74,v82
v_add_f32 v75,v75,v83
v_add_f32 v68,v68,v72
v_add_f32 v69,v69,v73
v_add_f32 v70,v70,v74
v_add_f32 v71,v71,v75
cv v68,v68,v69
cv v69,v70,v71
v_min_u32 v68,0xfffffffe,v68
v_min_u32 v69,0xfffffffe,v69
s_add_u32 s23,s41,10240
s_mov_b32 exec_lo,0x00ff00ff
s_mov_b32 exec_hi,0
buffer_store_dwordx2 v[68:69],v28,s[44:47],s23 offen sc1
s_mov_b64 exec,-1
chR_next:
s_add_u32 s40,s40,1
s_add_u32 s41,s41,10240
s_add_u32 s42,s42,20480
s_add_u32 s61,s61,1310720
s_add_u32 s62,s62,327680
s_cmp_ge_u32 s40,64
s_cbranch_scc1 chR_end
s_cmp_lg_u32 s40,4
s_cbranch_scc1 chR_fu1_ok
s_mov_b32 s22,53248
s_mov_b32 s60,0
chR_fu1:
buffer_load_dword v15,v30,s[92:95],s22 offen sc1
s_waitcnt vmcnt(0)
v_cmp_ne_u32 vcc,-1,v15
s_nop 1
s_cmp_eq_u64 vcc,exec
s_cbranch_scc1 chR_fu1_ok
s_sleep 8
s_add_u32 s60,s60,1
s_cmp_gt_u32 s60,400000
s_cbranch_scc1 chain_end
s_branch chR_fu1
chR_fu1_ok:
s_and_b32 s23,s40,7
s_cmp_lg_u32 s23,0
s_cbranch_scc1 chR_fu_ok
s_lshl_b32 s22,s40,4
s_add_u32 s22,s22,32768
s_mov_b32 s60,0
chR_fu:
buffer_load_dword v15,v30,s[92:95],s22 offen sc1
s_waitcnt vmcnt(0)
v_cmp_ne_u32 vcc,-1,v15
s_nop 1
s_cmp_eq_u64 vcc,exec
s_cbranch_scc1 chR_fu_ok
s_sleep 8
s_add_u32 s60,s60,1
s_cmp_gt_u32 s60,400000
s_cbranch_scc1 chain_end
s_branch chR_fu
chR_fu_ok:
buffer_load_dwordx4 v[100:103],v16,s[36:39],s61 offen
buffer_load_dwordx4 v[104:107],v17,s[36:39],s61 offen
buffer_load_dwordx4 v[108:111],v18,s[36:39],s61 offen
buffer_load_dwordx4 v[112:115],v19,s[36:39],s61 offen
buffer_load_dwordx4 v[116:119],v20,s[36:39],s61 offen
s_sleep 12
s_branch chR_loop
chR_end:
chain_fin:
s_branch task_next
chain_end:
s_branch mega_exit
t2_kernel_entry:
s_load_dwordx4 s[4:7],s[0:1],16
s_load_dwordx4 s[8:11],s[0:1],32
s_load_dwordx2 s[12:13],s[0:1],128
v_and_b32 v1,63,v0
v_lshrrev_b32 v2,4,v1
v_and_b32 v3,15,v0
v_lshrrev_b32 v4,6,v0
s_nop 0
v_readfirstlane_b32 s20,v4
s_nop 3
s_lshl_b32 s21,s20,10
v_bfe_u32 v5,v1,2,2
v_lshl_add_u32 v6,v2,3,v5
v_lshlrev_b32 v6,7,v6
v_and_b32 v7,3,v1
v_lshl_add_u32 v6,v7,3,v6
v_lshrrev_b32 v5,1,v5
v_and_b32 v7,1,v2
v_xor_b32 v11,0,v7
v_lshl_or_b32 v11,v11,1,v5
v_xor_b32 v8,0,v11
v_lshl_add_u32 v8,v8,5,v6
v_xor_b32 v9,1,v11
v_lshl_add_u32 v9,v9,5,v6
v_xor_b32 v10,2,v11
v_lshl_add_u32 v10,v10,5,v6
v_xor_b32 v11,3,v11
v_lshl_add_u32 v11,v11,5,v6
v_xor_b32 v15,1,v7
v_lshl_or_b32 v15,v15,1,v5
v_xor_b32 v12,0,v15
v_lshl_add_u32 v12,v12,5,v6
v_add_u32 v12,512,v12
v_xor_b32 v13,1,v15
v_lshl_add_u32 v13,v13,5,v6
v_add_u32 v13,512,v13
v_xor_b32 v14,2,v15
v_lshl_add_u32 v14,v14,5,v6
v_add_u32 v14,512,v14
v_xor_b32 v15,3,v15
v_lshl_add_u32 v15,v15,5,v6
v_add_u32 v15,512,v15
v_bfe_u32 v5,v1,2,2
v_lshl_add_u32 v6,v2,2,v5
v_lshlrev_b32 v6,7,v6
v_and_b32 v7,3,v1
v_lshl_add_u32 v6,v7,3,v6
v_lshrrev_b32 v5,1,v5
v_lshrrev_b32 v7,1,v2
v_xor_b32 v7,v7,v2
v_and_b32 v7,1,v7
v_lshl_or_b32 v19,v7,1,v5
v_xor_b32 v16,0,v19
v_lshl_add_u32 v16,v16,5,v6
v_xor_b32 v17,1,v19
v_lshl_add_u32 v17,v17,5,v6
v_xor_b32 v18,2,v19
v_lshl_add_u32 v18,v18,5,v6
v_xor_b32 v19,3,v19
v_lshl_add_u32 v19,v19,5,v6
s_and_b32 s24,s2,31
s_lshr_b32 s25,s2,5
s_waitcnt lgkmcnt(0)
s_mul_i32 s26,s24,384
s_sub_u32 s27,7864320,s26
s_lshl_b32 s29,s25,2
s_add_u32 s29,s29,s20
s_mul_i32 s30,s29,81920
s_add_u32 s30,s30,26214400
s_add_u32 s48,s12,s30
s_addc_u32 s49,s13,0
s_mov_b32 s50,0x14000
s_mov_b32 s51,0x00020000
v_lshrrev_b32 v244,3,v1
v_lshl_add_u32 v245,v4,3,v244
v_bfe_u32 v246,v245,1,1
v_lshrrev_b32 v5,2,v245
v_lshrrev_b32 v244,3,v245
v_xor_b32 v5,v5,v244
v_and_b32 v5,1,v5
v_lshl_or_b32 v246,v5,1,v246
v_bfe_u32 v244,v1,1,2
v_xor_b32 v246,v246,v244
v_and_b32 v244,1,v1
v_lshl_or_b32 v246,v246,1,v244
v_lshlrev_b32 v246,4,v246
s_mov_b32 s22,12288
v_mul_lo_u32 v5,s22,v245
v_add_u32 v5,v5,v246
v_lshrrev_b32 v244,3,v1
v_lshl_add_u32 v245,v4,3,v244
v_bfe_u32 v246,v245,1,1
v_lshrrev_b32 v6,2,v245
v_lshrrev_b32 v244,3,v245
v_xor_b32 v6,v6,v244
v_and_b32 v6,1,v6
v_lshl_or_b32 v246,v6,1,v246
v_bfe_u32 v244,v1,1,2
v_xor_b32 v246,v246,v244
v_and_b32 v244,1,v1
v_lshl_or_b32 v246,v246,1,v244
v_lshlrev_b32 v246,4,v246
s_mov_b32 s22,1280
v_mul_lo_u32 v6,s22,v245
v_add_u32 v6,v6,v246
v_lshrrev_b32 v244,2,v3
v_and_b32 v245,3,v3
v_lshl_add_u32 v244,v244,3,v245
v_lshlrev_b32 v245,4,v2
v_mul_u32_u24 v247,1280,v244
v_add_u32 v247,v247,v245
v_mul_u32_u24 v248,12288,v244
v_add_u32 v248,v248,v245
v_lshl_add_u32 v249,v3,6,v245
v_lshlrev_b32 v250,4,v1
s_add_u32 s40,s8,s26
s_addc_u32 s41,s9,0
s_mov_b32 s42,s27
s_mov_b32 s43,0x00020000
s_mul_i32 s28,s24,245760
s_add_u32 s44,s10,s28
s_addc_u32 s45,s11,0
s_mov_b32 s46,0x3c000
s_mov_b32 s47,0x00020000
s_lshl_b32 s30,s29,6
s_add_u32 s30,s30,s24
s_mul_i32 s30,s30,40960
s_add_u32 s30,s30,117440512
s_add_u32 s60,s12,s30
s_addc_u32 s61,s13,0
s_mov_b32 s62,0x14a000
s_mov_b32 s63,0x00020000
s_mov_b32 s23,0
buffer_load_dwordx4 a[0:3],v250,s[48:51],s23 offen
s_mov_b32 s23,1024
buffer_load_dwordx4 a[4:7],v250,s[48:51],s23 offen
s_mov_b32 s23,2048
buffer_load_dwordx4 a[8:11],v250,s[48:51],s23 offen
s_mov_b32 s23,3072
buffer_load_dwordx4 a[12:15],v250,s[48:51],s23 offen
s_mov_b32 s23,4096
buffer_load_dwordx4 a[16:19],v250,s[48:51],s23 offen
s_mov_b32 s23,5120
buffer_load_dwordx4 a[20:23],v250,s[48:51],s23 offen
s_mov_b32 s23,6144
buffer_load_dwordx4 a[24:27],v250,s[48:51],s23 offen
s_mov_b32 s23,7168
buffer_load_dwordx4 a[28:31],v250,s[48:51],s23 offen
s_mov_b32 s23,8192
buffer_load_dwordx4 a[32:35],v250,s[48:51],s23 offen
s_mov_b32 s23,9216
buffer_load_dwordx4 a[36:39],v250,s[48:51],s23 offen
s_mov_b32 s23,10240
buffer_load_dwordx4 a[40:43],v250,s[48:51],s23 offen
s_mov_b32 s23,11264
buffer_load_dwordx4 a[44:47],v250,s[48:51],s23 offen
s_mov_b32 s23,12288
buffer_load_dwordx4 a[48:51],v250,s[48:51],s23 offen
s_mov_b32 s23,13312
buffer_load_dwordx4 a[52:55],v250,s[48:51],s23 offen
s_mov_b32 s23,14336
buffer_load_dwordx4 a[56:59],v250,s[48:51],s23 offen
s_mov_b32 s23,15360
buffer_load_dwordx4 a[60:63],v250,s[48:51],s23 offen
s_mov_b32 s23,16384
buffer_load_dwordx4 a[64:67],v250,s[48:51],s23 offen
s_mov_b32 s23,17408
buffer_load_dwordx4 a[68:71],v250,s[48:51],s23 offen
s_mov_b32 s23,18432
buffer_load_dwordx4 a[72:75],v250,s[48:51],s23 offen
s_mov_b32 s23,19456
buffer_load_dwordx4 a[76:79],v250,s[48:51],s23 offen
s_mov_b32 s23,20480
buffer_load_dwordx4 a[80:83],v250,s[48:51],s23 offen
s_mov_b32 s23,21504
buffer_load_dwordx4 a[84:87],v250,s[48:51],s23 offen
s_mov_b32 s23,22528
buffer_load_dwordx4 a[88:91],v250,s[48:51],s23 offen
s_mov_b32 s23,23552
buffer_load_dwordx4 a[92:95],v250,s[48:51],s23 offen
s_mov_b32 s23,24576
buffer_load_dwordx4 a[96:99],v250,s[48:51],s23 offen
s_mov_b32 s23,25600
buffer_load_dwordx4 a[100:103],v250,s[48:51],s23 offen
s_mov_b32 s23,26624
buffer_load_dwordx4 a[104:107],v250,s[48:51],s23 offen
s_mov_b32 s23,27648
buffer_load_dwordx4 a[108:111],v250,s[48:51],s23 offen
s_mov_b32 s23,28672
buffer_load_dwordx4 a[112:115],v250,s[48:51],s23 offen
s_mov_b32 s23,29696
buffer_load_dwordx4 a[116:119],v250,s[48:51],s23 offen
s_mov_b32 s23,30720
buffer_load_dwordx4 a[120:123],v250,s[48:51],s23 offen
s_mov_b32 s23,31744
buffer_load_dwordx4 a[124:127],v250,s[48:51],s23 offen
s_mov_b32 s23,32768
buffer_load_dwordx4 a[128:131],v250,s[48:51],s23 offen
s_mov_b32 s23,33792
buffer_load_dwordx4 a[132:135],v250,s[48:51],s23 offen
s_mov_b32 s23,34816
buffer_load_dwordx4 a[136:139],v250,s[48:51],s23 offen
s_mov_b32 s23,35840
buffer_load_dwordx4 a[140:143],v250,s[48:51],s23 offen
s_mov_b32 s23,36864
buffer_load_dwordx4 a[144:147],v250,s[48:51],s23 offen
s_mov_b32 s23,37888
buffer_load_dwordx4 a[148:151],v250,s[48:51],s23 offen
s_mov_b32 s23,38912
buffer_load_dwordx4 a[152:155],v250,s[48:51],s23 offen
s_mov_b32 s23,39936
buffer_load_dwordx4 a[156:159],v250,s[48:51],s23 offen
s_mov_b32 s23,40960
buffer_load_dwordx4 a[160:163],v250,s[48:51],s23 offen
s_mov_b32 s23,41984
buffer_load_dwordx4 a[164:167],v250,s[48:51],s23 offen
s_mov_b32 s23,43008
buffer_load_dwordx4 a[168:171],v250,s[48:51],s23 offen
s_mov_b32 s23,44032
buffer_load_dwordx4 a[172:175],v250,s[48:51],s23 offen
s_mov_b32 s23,45056
buffer_load_dwordx4 a[176:179],v250,s[48:51],s23 offen
s_mov_b32 s23,46080
buffer_load_dwordx4 a[180:183],v250,s[48:51],s23 offen
s_mov_b32 s23,47104
buffer_load_dwordx4 a[184:187],v250,s[48:51],s23 offen
s_mov_b32 s23,48128
buffer_load_dwordx4 a[188:191],v250,s[48:51],s23 offen
s_mov_b32 s23,49152
buffer_load_dwordx4 a[192:195],v250,s[48:51],s23 offen
s_mov_b32 s23,50176
buffer_load_dwordx4 a[196:199],v250,s[48:51],s23 offen
s_mov_b32 s23,51200
buffer_load_dwordx4 a[200:203],v250,s[48:51],s23 offen
s_mov_b32 s23,52224
buffer_load_dwordx4 a[204:207],v250,s[48:51],s23 offen
s_mov_b32 s23,53248
buffer_load_dwordx4 a[208:211],v250,s[48:51],s23 offen
s_mov_b32 s23,54272
buffer_load_dwordx4 a[212:215],v250,s[48:51],s23 offen
s_mov_b32 s23,55296
buffer_load_dwordx4 a[216:219],v250,s[48:51],s23 offen
s_mov_b32 s23,56320
buffer_load_dwordx4 a[220:223],v250,s[48:51],s23 offen
s_mov_b32 s23,57344
buffer_load_dwordx4 a[224:227],v250,s[48:51],s23 offen
s_mov_b32 s23,58368
buffer_load_dwordx4 a[228:231],v250,s[48:51],s23 offen
s_mov_b32 s23,59392
buffer_load_dwordx4 a[232:235],v250,s[48:51],s23 offen
s_mov_b32 s23,60416
buffer_load_dwordx4 a[236:239],v250,s[48:51],s23 offen
s_mov_b32 s23,61440
buffer_load_dwordx4 a[240:243],v250,s[48:51],s23 offen
s_mov_b32 s23,62464
buffer_load_dwordx4 a[244:247],v250,s[48:51],s23 offen
s_mov_b32 s23,63488
buffer_load_dwordx4 a[248:251],v250,s[48:51],s23 offen
s_mov_b32 s23,64512
buffer_load_dwordx4 a[252:255],v250,s[48:51],s23 offen
s_mov_b32 s23,65536
buffer_load_dwordx4 v[116:119],v250,s[48:51],s23 offen
s_mov_b32 s23,66560
buffer_load_dwordx4 v[120:123],v250,s[48:51],s23 offen
s_mov_b32 s23,67584
buffer_load_dwordx4 v[124:127],v250,s[48:51],s23 offen
s_mov_b32 s23,68608
buffer_load_dwordx4 v[128:131],v250,s[48:51],s23 offen
s_mov_b32 s23,69632
buffer_load_dwordx4 v[132:135],v250,s[48:51],s23 offen
s_mov_b32 s23,70656
buffer_load_dwordx4 v[136:139],v250,s[48:51],s23 offen
s_mov_b32 s23,71680
buffer_load_dwordx4 v[140:143],v250,s[48:51],s23 offen
s_mov_b32 s23,72704
buffer_load_dwordx4 v[144:147],v250,s[48:51],s23 offen
s_mov_b32 s23,73728
buffer_load_dwordx4 v[148:151],v250,s[48:51],s23 offen
s_mov_b32 s23,74752
buffer_load_dwordx4 v[152:155],v250,s[48:51],s23 offen
s_mov_b32 s23,75776
buffer_load_dwordx4 v[156:159],v250,s[48:51],s23 offen
s_mov_b32 s23,76800
buffer_load_dwordx4 v[160:163],v250,s[48:51],s23 offen
s_mov_b32 s23,77824
buffer_load_dwordx4 v[164:167],v250,s[48:51],s23 offen
s_mov_b32 s23,78848
buffer_load_dwordx4 v[168:171],v250,s[48:51],s23 offen
s_mov_b32 s23,79872
buffer_load_dwordx4 v[172:175],v250,s[48:51],s23 offen
s_mov_b32 s23,80896
buffer_load_dwordx4 v[176:179],v250,s[48:51],s23 offen
s_add_u32 m0,s21,0
s_mov_b32 s23,0
buffer_load_dwordx4 v5,s[40:43],s23 offen lds
s_add_u32 m0,s21,4096
s_mov_b32 s23,393216
buffer_load_dwordx4 v5,s[40:43],s23 offen lds
s_add_u32 m0,s21,8192
s_mov_b32 s23,786432
buffer_load_dwordx4 v5,s[40:43],s23 offen lds
s_add_u32 m0,s21,12288
s_mov_b32 s23,1179648
buffer_load_dwordx4 v5,s[40:43],s23 offen lds
s_add_u32 m0,s21,16384
s_mov_b32 s23,1572864
buffer_load_dwordx4 v5,s[40:43],s23 offen lds
s_add_u32 m0,s21,20480
s_mov_b32 s23,1966080
buffer_load_dwordx4 v5,s[40:43],s23 offen lds
s_add_u32 m0,s21,24576
s_mov_b32 s23,2359296
buffer_load_dwordx4 v5,s[40:43],s23 offen lds
s_add_u32 m0,s21,28672
s_mov_b32 s23,2752512
buffer_load_dwordx4 v5,s[40:43],s23 offen lds
s_add_u32 m0,s21,32768
s_mov_b32 s23,3145728
buffer_load_dwordx4 v5,s[40:43],s23 offen lds
s_add_u32 m0,s21,36864
s_mov_b32 s23,3538944
buffer_load_dwordx4 v5,s[40:43],s23 offen lds
s_add_u32 m0,s21,40960
s_mov_b32 s23,3932160
buffer_load_dwordx4 v5,s[40:43],s23 offen lds
s_add_u32 m0,s21,45056
s_mov_b32 s23,4325376
buffer_load_dwordx4 v5,s[40:43],s23 offen lds
s_add_u32 m0,s21,49152
s_mov_b32 s23,4718592
buffer_load_dwordx4 v5,s[40:43],s23 offen lds
s_add_u32 m0,s21,53248
s_mov_b32 s23,5111808
buffer_load_dwordx4 v5,s[40:43],s23 offen lds
s_add_u32 m0,s21,57344
s_mov_b32 s23,5505024
buffer_load_dwordx4 v5,s[40:43],s23 offen lds
s_add_u32 m0,s21,61440
s_mov_b32 s23,5898240
buffer_load_dwordx4 v5,s[40:43],s23 offen lds
s_add_u32 m0,s21,65536
s_mov_b32 s23,6291456
buffer_load_dwordx4 v5,s[40:43],s23 offen lds
s_add_u32 m0,s21,69632
s_mov_b32 s23,6684672
buffer_load_dwordx4 v5,s[40:43],s23 offen lds
s_add_u32 m0,s21,73728
s_mov_b32 s23,7077888
buffer_load_dwordx4 v5,s[40:43],s23 offen lds
s_add_u32 m0,s21,77824
s_mov_b32 s23,7471104
buffer_load_dwordx4 v5,s[40:43],s23 offen lds
s_add_u32 m0,s21,81920
s_mov_b32 s23,128
buffer_load_dwordx4 v5,s[40:43],s23 offen lds
s_add_u32 m0,s21,86016
s_mov_b32 s23,393344
buffer_load_dwordx4 v5,s[40:43],s23 offen lds
s_add_u32 m0,s21,90112
s_mov_b32 s23,786560
buffer_load_dwordx4 v5,s[40:43],s23 offen lds
s_add_u32 m0,s21,94208
s_mov_b32 s23,1179776
buffer_load_dwordx4 v5,s[40:43],s23 offen lds
s_add_u32 m0,s21,98304
s_mov_b32 s23,1572992
buffer_load_dwordx4 v5,s[40:43],s23 offen lds
s_add_u32 m0,s21,102400
s_mov_b32 s23,1966208
buffer_load_dwordx4 v5,s[40:43],s23 offen lds
s_add_u32 m0,s21,106496
s_mov_b32 s23,2359424
buffer_load_dwordx4 v5,s[40:43],s23 offen lds
s_add_u32 m0,s21,110592
s_mov_b32 s23,2752640
buffer_load_dwordx4 v5,s[40:43],s23 offen lds
s_add_u32 m0,s21,114688
s_mov_b32 s23,3145856
buffer_load_dwordx4 v5,s[40:43],s23 offen lds
s_add_u32 m0,s21,118784
s_mov_b32 s23,3539072
buffer_load_dwordx4 v5,s[40:43],s23 offen lds
s_add_u32 m0,s21,122880
s_mov_b32 s23,3932288
buffer_load_dwordx4 v5,s[40:43],s23 offen lds
s_add_u32 m0,s21,126976
s_mov_b32 s23,4325504
buffer_load_dwordx4 v5,s[40:43],s23 offen lds
s_add_u32 m0,s21,131072
s_mov_b32 s23,4718720
buffer_load_dwordx4 v5,s[40:43],s23 offen lds
s_add_u32 m0,s21,135168
s_mov_b32 s23,5111936
buffer_load_dwordx4 v5,s[40:43],s23 offen lds
s_add_u32 m0,s21,139264
s_mov_b32 s23,5505152
buffer_load_dwordx4 v5,s[40:43],s23 offen lds
s_add_u32 m0,s21,143360
s_mov_b32 s23,5898368
buffer_load_dwordx4 v5,s[40:43],s23 offen lds
s_add_u32 m0,s21,147456
s_mov_b32 s23,6291584
buffer_load_dwordx4 v5,s[40:43],s23 offen lds
s_add_u32 m0,s21,151552
s_mov_b32 s23,6684800
buffer_load_dwordx4 v5,s[40:43],s23 offen lds
s_add_u32 m0,s21,155648
s_mov_b32 s23,7078016
buffer_load_dwordx4 v5,s[40:43],s23 offen lds
s_add_u32 m0,s21,159744
s_mov_b32 s23,7471232
buffer_load_dwordx4 v5,s[40:43],s23 offen lds
s_waitcnt vmcnt(30)
s_barrier
tr v[20:21],v8,0
tr v[22:23],v12,0
tr v[24:25],v9,0
tr v[26:27],v13,0
tr v[28:29],v10,0
tr v[30:31],v14,0
tr v[32:33],v11,0
tr v[34:35],v15,0
s_waitcnt lgkmcnt(0)
tr v[36:37],v8,4096
tr v[38:39],v12,4096
tr v[40:41],v9,4096
tr v[42:43],v13,4096
tr v[44:45],v10,4096
tr v[46:47],v14,4096
tr v[48:49],v11,4096
tr v[50:51],v15,4096
mf v[52:55],v[20:23],a[0:3],0
mf v[68:71],v[20:23],a[80:83],0
mf v[84:87],v[20:23],a[160:163],0
mf v[100:103],v[20:23],a[240:243],0
mf v[56:59],v[24:27],a[0:3],0
mf v[72:75],v[24:27],a[80:83],0
mf v[88:91],v[24:27],a[160:163],0
mf v[104:107],v[24:27],a[240:243],0
mf v[60:63],v[28:31],a[0:3],0
mf v[76:79],v[28:31],a[80:83],0
mf v[92:95],v[28:31],a[160:163],0
mf v[108:111],v[28:31],a[240:243],0
mf v[64:67],v[32:35],a[0:3],0
mf v[80:83],v[32:35],a[80:83],0
mf v[96:99],v[32:35],a[160:163],0
mf v[112:115],v[32:35],a[240:243],0
s_waitcnt lgkmcnt(0)
tr v[20:21],v8,8192
tr v[22:23],v12,8192
tr v[24:25],v9,8192
tr v[26:27],v13,8192
tr v[28:29],v10,8192
tr v[30:31],v14,8192
tr v[32:33],v11,8192
tr v[34:35],v15,8192
mf v[52:55],v[36:39],a[4:7],v[52:55]
mf v[68:71],v[36:39],a[84:87],v[68:71]
mf v[84:87],v[36:39],a[164:167],v[84:87]
mf v[100:103],v[36:39],a[244:247],v[100:103]
mf v[56:59],v[40:43],a[4:7],v[56:59]
mf v[72:75],v[40:43],a[84:87],v[72:75]
mf v[88:91],v[40:43],a[164:167],v[88:91]
mf v[104:107],v[40:43],a[244:247],v[104:107]
mf v[60:63],v[44:47],a[4:7],v[60:63]
mf v[76:79],v[44:47],a[84:87],v[76:79]
mf v[92:95],v[44:47],a[164:167],v[92:95]
mf v[108:111],v[44:47],a[244:247],v[108:111]
mf v[64:67],v[48:51],a[4:7],v[64:67]
mf v[80:83],v[48:51],a[84:87],v[80:83]
mf v[96:99],v[48:51],a[164:167],v[96:99]
mf v[112:115],v[48:51],a[244:247],v[112:115]
s_waitcnt lgkmcnt(0)
tr v[36:37],v8,12288
tr v[38:39],v12,12288
tr v[40:41],v9,12288
tr v[42:43],v13,12288
tr v[44:45],v10,12288
tr v[46:47],v14,12288
tr v[48:49],v11,12288
tr v[50:51],v15,12288
mf v[52:55],v[20:23],a[8:11],v[52:55]
mf v[68:71],v[20:23],a[88:91],v[68:71]
mf v[84:87],v[20:23],a[168:171],v[84:87]
mf v[100:103],v[20:23],a[248:251],v[100:103]
mf v[56:59],v[24:27],a[8:11],v[56:59]
mf v[72:75],v[24:27],a[88:91],v[72:75]
mf v[88:91],v[24:27],a[168:171],v[88:91]
mf v[104:107],v[24:27],a[248:251],v[104:107]
mf v[60:63],v[28:31],a[8:11],v[60:63]
mf v[76:79],v[28:31],a[88:91],v[76:79]
mf v[92:95],v[28:31],a[168:171],v[92:95]
mf v[108:111],v[28:31],a[248:251],v[108:111]
mf v[64:67],v[32:35],a[8:11],v[64:67]
mf v[80:83],v[32:35],a[88:91],v[80:83]
mf v[96:99],v[32:35],a[168:171],v[96:99]
mf v[112:115],v[32:35],a[248:251],v[112:115]
s_waitcnt lgkmcnt(0)
tr v[20:21],v8,16384
tr v[22:23],v12,16384
tr v[24:25],v9,16384
tr v[26:27],v13,16384
tr v[28:29],v10,16384
tr v[30:31],v14,16384
tr v[32:33],v11,16384
tr v[34:35],v15,16384
mf v[52:55],v[36:39],a[12:15],v[52:55]
mf v[68:71],v[36:39],a[92:95],v[68:71]
mf v[84:87],v[36:39],a[172:175],v[84:87]
mf v[100:103],v[36:39],a[252:255],v[100:103]
mf v[56:59],v[40:43],a[12:15],v[56:59]
mf v[72:75],v[40:43],a[92:95],v[72:75]
mf v[88:91],v[40:43],a[172:175],v[88:91]
mf v[104:107],v[40:43],a[252:255],v[104:107]
mf v[60:63],v[44:47],a[12:15],v[60:63]
mf v[76:79],v[44:47],a[92:95],v[76:79]
mf v[92:95],v[44:47],a[172:175],v[92:95]
mf v[108:111],v[44:47],a[252:255],v[108:111]
mf v[64:67],v[48:51],a[12:15],v[64:67]
mf v[80:83],v[48:51],a[92:95],v[80:83]
mf v[96:99],v[48:51],a[172:175],v[96:99]
mf v[112:115],v[48:51],a[252:255],v[112:115]
s_waitcnt lgkmcnt(0)
tr v[36:37],v8,20480
tr v[38:39],v12,20480
tr v[40:41],v9,20480
tr v[42:43],v13,20480
tr v[44:45],v10,20480
tr v[46:47],v14,20480
tr v[48:49],v11,20480
tr v[50:51],v15,20480
mf v[52:55],v[20:23],a[16:19],v[52:55]
mf v[68:71],v[20:23],a[96:99],v[68:71]
mf v[84:87],v[20:23],a[176:179],v[84:87]
mf v[100:103],v[20:23],v[116:119],v[100:103]
mf v[56:59],v[24:27],a[16:19],v[56:59]
mf v[72:75],v[24:27],a[96:99],v[72:75]
mf v[88:91],v[24:27],a[176:179],v[88:91]
mf v[104:107],v[24:27],v[116:119],v[104:107]
mf v[60:63],v[28:31],a[16:19],v[60:63]
mf v[76:79],v[28:31],a[96:99],v[76:79]
mf v[92:95],v[28:31],a[176:179],v[92:95]
mf v[108:111],v[28:31],v[116:119],v[108:111]
mf v[64:67],v[32:35],a[16:19],v[64:67]
mf v[80:83],v[32:35],a[96:99],v[80:83]
mf v[96:99],v[32:35],a[176:179],v[96:99]
mf v[112:115],v[32:35],v[116:119],v[112:115]
s_waitcnt lgkmcnt(0)
tr v[20:21],v8,24576
tr v[22:23],v12,24576
tr v[24:25],v9,24576
tr v[26:27],v13,24576
tr v[28:29],v10,24576
tr v[30:31],v14,24576
tr v[32:33],v11,24576
tr v[34:35],v15,24576
mf v[52:55],v[36:39],a[20:23],v[52:55]
mf v[68:71],v[36:39],a[100:103],v[68:71]
mf v[84:87],v[36:39],a[180:183],v[84:87]
mf v[100:103],v[36:39],v[120:123],v[100:103]
mf v[56:59],v[40:43],a[20:23],v[56:59]
mf v[72:75],v[40:43],a[100:103],v[72:75]
mf v[88:91],v[40:43],a[180:183],v[88:91]
mf v[104:107],v[40:43],v[120:123],v[104:107]
mf v[60:63],v[44:47],a[20:23],v[60:63]
mf v[76:79],v[44:47],a[100:103],v[76:79]
mf v[92:95],v[44:47],a[180:183],v[92:95]
mf v[108:111],v[44:47],v[120:123],v[108:111]
mf v[64:67],v[48:51],a[20:23],v[64:67]
mf v[80:83],v[48:51],a[100:103],v[80:83]
mf v[96:99],v[48:51],a[180:183],v[96:99]
mf v[112:115],v[48:51],v[120:123],v[112:115]
s_waitcnt lgkmcnt(0)
tr v[36:37],v8,28672
tr v[38:39],v12,28672
tr v[40:41],v9,28672
tr v[42:43],v13,28672
tr v[44:45],v10,28672
tr v[46:47],v14,28672
tr v[48:49],v11,28672
tr v[50:51],v15,28672
mf v[52:55],v[20:23],a[24:27],v[52:55]
mf v[68:71],v[20:23],a[104:107],v[68:71]
mf v[84:87],v[20:23],a[184:187],v[84:87]
mf v[100:103],v[20:23],v[124:127],v[100:103]
mf v[56:59],v[24:27],a[24:27],v[56:59]
mf v[72:75],v[24:27],a[104:107],v[72:75]
mf v[88:91],v[24:27],a[184:187],v[88:91]
mf v[104:107],v[24:27],v[124:127],v[104:107]
mf v[60:63],v[28:31],a[24:27],v[60:63]
mf v[76:79],v[28:31],a[104:107],v[76:79]
mf v[92:95],v[28:31],a[184:187],v[92:95]
mf v[108:111],v[28:31],v[124:127],v[108:111]
mf v[64:67],v[32:35],a[24:27],v[64:67]
mf v[80:83],v[32:35],a[104:107],v[80:83]
mf v[96:99],v[32:35],a[184:187],v[96:99]
mf v[112:115],v[32:35],v[124:127],v[112:115]
s_waitcnt lgkmcnt(0)
tr v[20:21],v8,32768
tr v[22:23],v12,32768
tr v[24:25],v9,32768
tr v[26:27],v13,32768
tr v[28:29],v10,32768
tr v[30:31],v14,32768
tr v[32:33],v11,32768
tr v[34:35],v15,32768
mf v[52:55],v[36:39],a[28:31],v[52:55]
mf v[68:71],v[36:39],a[108:111],v[68:71]
mf v[84:87],v[36:39],a[188:191],v[84:87]
mf v[100:103],v[36:39],v[128:131],v[100:103]
mf v[56:59],v[40:43],a[28:31],v[56:59]
mf v[72:75],v[40:43],a[108:111],v[72:75]
mf v[88:91],v[40:43],a[188:191],v[88:91]
mf v[104:107],v[40:43],v[128:131],v[104:107]
mf v[60:63],v[44:47],a[28:31],v[60:63]
mf v[76:79],v[44:47],a[108:111],v[76:79]
mf v[92:95],v[44:47],a[188:191],v[92:95]
mf v[108:111],v[44:47],v[128:131],v[108:111]
mf v[64:67],v[48:51],a[28:31],v[64:67]
mf v[80:83],v[48:51],a[108:111],v[80:83]
mf v[96:99],v[48:51],a[188:191],v[96:99]
mf v[112:115],v[48:51],v[128:131],v[112:115]
s_waitcnt lgkmcnt(0)
tr v[36:37],v8,36864
tr v[38:39],v12,36864
tr v[40:41],v9,36864
tr v[42:43],v13,36864
tr v[44:45],v10,36864
tr v[46:47],v14,36864
tr v[48:49],v11,36864
tr v[50:51],v15,36864
mf v[52:55],v[20:23],a[32:35],v[52:55]
mf v[68:71],v[20:23],a[112:115],v[68:71]
mf v[84:87],v[20:23],a[192:195],v[84:87]
mf v[100:103],v[20:23],v[132:135],v[100:103]
mf v[56:59],v[24:27],a[32:35],v[56:59]
mf v[72:75],v[24:27],a[112:115],v[72:75]
mf v[88:91],v[24:27],a[192:195],v[88:91]
mf v[104:107],v[24:27],v[132:135],v[104:107]
mf v[60:63],v[28:31],a[32:35],v[60:63]
mf v[76:79],v[28:31],a[112:115],v[76:79]
mf v[92:95],v[28:31],a[192:195],v[92:95]
mf v[108:111],v[28:31],v[132:135],v[108:111]
mf v[64:67],v[32:35],a[32:35],v[64:67]
mf v[80:83],v[32:35],a[112:115],v[80:83]
mf v[96:99],v[32:35],a[192:195],v[96:99]
mf v[112:115],v[32:35],v[132:135],v[112:115]
s_waitcnt lgkmcnt(0)
s_waitcnt vmcnt(20)
s_barrier
s_add_u32 m0,s21,0
s_mov_b32 s23,256
buffer_load_dwordx4 v5,s[40:43],s23 offen lds
s_add_u32 m0,s21,4096
s_mov_b32 s23,393472
buffer_load_dwordx4 v5,s[40:43],s23 offen lds
s_add_u32 m0,s21,8192
s_mov_b32 s23,786688
buffer_load_dwordx4 v5,s[40:43],s23 offen lds
s_add_u32 m0,s21,12288
s_mov_b32 s23,1179904
buffer_load_dwordx4 v5,s[40:43],s23 offen lds
s_add_u32 m0,s21,16384
s_mov_b32 s23,1573120
buffer_load_dwordx4 v5,s[40:43],s23 offen lds
s_add_u32 m0,s21,20480
s_mov_b32 s23,1966336
buffer_load_dwordx4 v5,s[40:43],s23 offen lds
s_add_u32 m0,s21,24576
s_mov_b32 s23,2359552
buffer_load_dwordx4 v5,s[40:43],s23 offen lds
s_add_u32 m0,s21,28672
s_mov_b32 s23,2752768
buffer_load_dwordx4 v5,s[40:43],s23 offen lds
s_add_u32 m0,s21,32768
s_mov_b32 s23,3145984
buffer_load_dwordx4 v5,s[40:43],s23 offen lds
s_add_u32 m0,s21,36864
s_mov_b32 s23,3539200
buffer_load_dwordx4 v5,s[40:43],s23 offen lds
v_add_u32 v8,40960,v8
v_add_u32 v9,40960,v9
v_add_u32 v10,40960,v10
v_add_u32 v11,40960,v11
v_add_u32 v12,40960,v12
v_add_u32 v13,40960,v13
v_add_u32 v14,40960,v14
v_add_u32 v15,40960,v15
tr v[20:21],v8,0
tr v[22:23],v12,0
tr v[24:25],v9,0
tr v[26:27],v13,0
tr v[28:29],v10,0
tr v[30:31],v14,0
tr v[32:33],v11,0
tr v[34:35],v15,0
mf v[52:55],v[36:39],a[36:39],v[52:55]
mf v[68:71],v[36:39],a[116:119],v[68:71]
mf v[84:87],v[36:39],a[196:199],v[84:87]
mf v[100:103],v[36:39],v[136:139],v[100:103]
mf v[56:59],v[40:43],a[36:39],v[56:59]
mf v[72:75],v[40:43],a[116:119],v[72:75]
mf v[88:91],v[40:43],a[196:199],v[88:91]
mf v[104:107],v[40:43],v[136:139],v[104:107]
mf v[60:63],v[44:47],a[36:39],v[60:63]
mf v[76:79],v[44:47],a[116:119],v[76:79]
mf v[92:95],v[44:47],a[196:199],v[92:95]
mf v[108:111],v[44:47],v[136:139],v[108:111]
mf v[64:67],v[48:51],a[36:39],v[64:67]
mf v[80:83],v[48:51],a[116:119],v[80:83]
mf v[96:99],v[48:51],a[196:199],v[96:99]
mf v[112:115],v[48:51],v[136:139],v[112:115]
s_waitcnt lgkmcnt(0)
tr v[36:37],v8,4096
tr v[38:39],v12,4096
tr v[40:41],v9,4096
tr v[42:43],v13,4096
tr v[44:45],v10,4096
tr v[46:47],v14,4096
tr v[48:49],v11,4096
tr v[50:51],v15,4096
mf v[52:55],v[20:23],a[40:43],v[52:55]
mf v[68:71],v[20:23],a[120:123],v[68:71]
mf v[84:87],v[20:23],a[200:203],v[84:87]
mf v[100:103],v[20:23],v[140:143],v[100:103]
mf v[56:59],v[24:27],a[40:43],v[56:59]
mf v[72:75],v[24:27],a[120:123],v[72:75]
mf v[88:91],v[24:27],a[200:203],v[88:91]
mf v[104:107],v[24:27],v[140:143],v[104:107]
mf v[60:63],v[28:31],a[40:43],v[60:63]
mf v[76:79],v[28:31],a[120:123],v[76:79]
mf v[92:95],v[28:31],a[200:203],v[92:95]
mf v[108:111],v[28:31],v[140:143],v[108:111]
mf v[64:67],v[32:35],a[40:43],v[64:67]
mf v[80:83],v[32:35],a[120:123],v[80:83]
mf v[96:99],v[32:35],a[200:203],v[96:99]
mf v[112:115],v[32:35],v[140:143],v[112:115]
s_waitcnt lgkmcnt(0)
tr v[20:21],v8,8192
tr v[22:23],v12,8192
tr v[24:25],v9,8192
tr v[26:27],v13,8192
tr v[28:29],v10,8192
tr v[30:31],v14,8192
tr v[32:33],v11,8192
tr v[34:35],v15,8192
mf v[52:55],v[36:39],a[44:47],v[52:55]
mf v[68:71],v[36:39],a[124:127],v[68:71]
mf v[84:87],v[36:39],a[204:207],v[84:87]
mf v[100:103],v[36:39],v[144:147],v[100:103]
mf v[56:59],v[40:43],a[44:47],v[56:59]
mf v[72:75],v[40:43],a[124:127],v[72:75]
mf v[88:91],v[40:43],a[204:207],v[88:91]
mf v[104:107],v[40:43],v[144:147],v[104:107]
mf v[60:63],v[44:47],a[44:47],v[60:63]
mf v[76:79],v[44:47],a[124:127],v[76:79]
mf v[92:95],v[44:47],a[204:207],v[92:95]
mf v[108:111],v[44:47],v[144:147],v[108:111]
mf v[64:67],v[48:51],a[44:47],v[64:67]
mf v[80:83],v[48:51],a[124:127],v[80:83]
mf v[96:99],v[48:51],a[204:207],v[96:99]
mf v[112:115],v[48:51],v[144:147],v[112:115]
s_waitcnt lgkmcnt(0)
tr v[36:37],v8,12288
tr v[38:39],v12,12288
tr v[40:41],v9,12288
tr v[42:43],v13,12288
tr v[44:45],v10,12288
tr v[46:47],v14,12288
tr v[48:49],v11,12288
tr v[50:51],v15,12288
mf v[52:55],v[20:23],a[48:51],v[52:55]
mf v[68:71],v[20:23],a[128:131],v[68:71]
mf v[84:87],v[20:23],a[208:211],v[84:87]
mf v[100:103],v[20:23],v[148:151],v[100:103]
mf v[56:59],v[24:27],a[48:51],v[56:59]
mf v[72:75],v[24:27],a[128:131],v[72:75]
mf v[88:91],v[24:27],a[208:211],v[88:91]
mf v[104:107],v[24:27],v[148:151],v[104:107]
mf v[60:63],v[28:31],a[48:51],v[60:63]
mf v[76:79],v[28:31],a[128:131],v[76:79]
mf v[92:95],v[28:31],a[208:211],v[92:95]
mf v[108:111],v[28:31],v[148:151],v[108:111]
mf v[64:67],v[32:35],a[48:51],v[64:67]
mf v[80:83],v[32:35],a[128:131],v[80:83]
mf v[96:99],v[32:35],a[208:211],v[96:99]
mf v[112:115],v[32:35],v[148:151],v[112:115]
s_waitcnt lgkmcnt(0)
tr v[20:21],v8,16384
tr v[22:23],v12,16384
tr v[24:25],v9,16384
tr v[26:27],v13,16384
tr v[28:29],v10,16384
tr v[30:31],v14,16384
tr v[32:33],v11,16384
tr v[34:35],v15,16384
mf v[52:55],v[36:39],a[52:55],v[52:55]
mf v[68:71],v[36:39],a[132:135],v[68:71]
mf v[84:87],v[36:39],a[212:215],v[84:87]
mf v[100:103],v[36:39],v[152:155],v[100:103]
mf v[56:59],v[40:43],a[52:55],v[56:59]
mf v[72:75],v[40:43],a[132:135],v[72:75]
mf v[88:91],v[40:43],a[212:215],v[88:91]
mf v[104:107],v[40:43],v[152:155],v[104:107]
mf v[60:63],v[44:47],a[52:55],v[60:63]
mf v[76:79],v[44:47],a[132:135],v[76:79]
mf v[92:95],v[44:47],a[212:215],v[92:95]
mf v[108:111],v[44:47],v[152:155],v[108:111]
mf v[64:67],v[48:51],a[52:55],v[64:67]
mf v[80:83],v[48:51],a[132:135],v[80:83]
mf v[96:99],v[48:51],a[212:215],v[96:99]
mf v[112:115],v[48:51],v[152:155],v[112:115]
s_waitcnt lgkmcnt(0)
tr v[36:37],v8,20480
tr v[38:39],v12,20480
tr v[40:41],v9,20480
tr v[42:43],v13,20480
tr v[44:45],v10,20480
tr v[46:47],v14,20480
tr v[48:49],v11,20480
tr v[50:51],v15,20480
mf v[52:55],v[20:23],a[56:59],v[52:55]
mf v[68:71],v[20:23],a[136:139],v[68:71]
mf v[84:87],v[20:23],a[216:219],v[84:87]
mf v[100:103],v[20:23],v[156:159],v[100:103]
mf v[56:59],v[24:27],a[56:59],v[56:59]
mf v[72:75],v[24:27],a[136:139],v[72:75]
mf v[88:91],v[24:27],a[216:219],v[88:91]
mf v[104:107],v[24:27],v[156:159],v[104:107]
mf v[60:63],v[28:31],a[56:59],v[60:63]
mf v[76:79],v[28:31],a[136:139],v[76:79]
mf v[92:95],v[28:31],a[216:219],v[92:95]
mf v[108:111],v[28:31],v[156:159],v[108:111]
mf v[64:67],v[32:35],a[56:59],v[64:67]
mf v[80:83],v[32:35],a[136:139],v[80:83]
mf v[96:99],v[32:35],a[216:219],v[96:99]
mf v[112:115],v[32:35],v[156:159],v[112:115]
s_waitcnt lgkmcnt(0)
tr v[20:21],v8,24576
tr v[22:23],v12,24576
tr v[24:25],v9,24576
tr v[26:27],v13,24576
tr v[28:29],v10,24576
tr v[30:31],v14,24576
tr v[32:33],v11,24576
tr v[34:35],v15,24576
mf v[52:55],v[36:39],a[60:63],v[52:55]
mf v[68:71],v[36:39],a[140:143],v[68:71]
mf v[84:87],v[36:39],a[220:223],v[84:87]
mf v[100:103],v[36:39],v[160:163],v[100:103]
mf v[56:59],v[40:43],a[60:63],v[56:59]
mf v[72:75],v[40:43],a[140:143],v[72:75]
mf v[88:91],v[40:43],a[220:223],v[88:91]
mf v[104:107],v[40:43],v[160:163],v[104:107]
mf v[60:63],v[44:47],a[60:63],v[60:63]
mf v[76:79],v[44:47],a[140:143],v[76:79]
mf v[92:95],v[44:47],a[220:223],v[92:95]
mf v[108:111],v[44:47],v[160:163],v[108:111]
mf v[64:67],v[48:51],a[60:63],v[64:67]
mf v[80:83],v[48:51],a[140:143],v[80:83]
mf v[96:99],v[48:51],a[220:223],v[96:99]
mf v[112:115],v[48:51],v[160:163],v[112:115]
s_waitcnt lgkmcnt(0)
tr v[36:37],v8,28672
tr v[38:39],v12,28672
tr v[40:41],v9,28672
tr v[42:43],v13,28672
tr v[44:45],v10,28672
tr v[46:47],v14,28672
tr v[48:49],v11,28672
tr v[50:51],v15,28672
mf v[52:55],v[20:23],a[64:67],v[52:55]
mf v[68:71],v[20:23],a[144:147],v[68:71]
mf v[84:87],v[20:23],a[224:227],v[84:87]
mf v[100:103],v[20:23],v[164:167],v[100:103]
mf v[56:59],v[24:27],a[64:67],v[56:59]
mf v[72:75],v[24:27],a[144:147],v[72:75]
mf v[88:91],v[24:27],a[224:227],v[88:91]
mf v[104:107],v[24:27],v[164:167],v[104:107]
mf v[60:63],v[28:31],a[64:67],v[60:63]
mf v[76:79],v[28:31],a[144:147],v[76:79]
mf v[92:95],v[28:31],a[224:227],v[92:95]
mf v[108:111],v[28:31],v[164:167],v[108:111]
mf v[64:67],v[32:35],a[64:67],v[64:67]
mf v[80:83],v[32:35],a[144:147],v[80:83]
mf v[96:99],v[32:35],a[224:227],v[96:99]
mf v[112:115],v[32:35],v[164:167],v[112:115]
s_waitcnt lgkmcnt(0)
tr v[20:21],v8,32768
tr v[22:23],v12,32768
tr v[24:25],v9,32768
tr v[26:27],v13,32768
tr v[28:29],v10,32768
tr v[30:31],v14,32768
tr v[32:33],v11,32768
tr v[34:35],v15,32768
mf v[52:55],v[36:39],a[68:71],v[52:55]
mf v[68:71],v[36:39],a[148:151],v[68:71]
mf v[84:87],v[36:39],a[228:231],v[84:87]
mf v[100:103],v[36:39],v[168:171],v[100:103]
mf v[56:59],v[40:43],a[68:71],v[56:59]
mf v[72:75],v[40:43],a[148:151],v[72:75]
mf v[88:91],v[40:43],a[228:231],v[88:91]
mf v[104:107],v[40:43],v[168:171],v[104:107]
mf v[60:63],v[44:47],a[68:71],v[60:63]
mf v[76:79],v[44:47],a[148:151],v[76:79]
mf v[92:95],v[44:47],a[228:231],v[92:95]
mf v[108:111],v[44:47],v[168:171],v[108:111]
mf v[64:67],v[48:51],a[68:71],v[64:67]
mf v[80:83],v[48:51],a[148:151],v[80:83]
mf v[96:99],v[48:51],a[228:231],v[96:99]
mf v[112:115],v[48:51],v[168:171],v[112:115]
s_waitcnt lgkmcnt(0)
tr v[36:37],v8,36864
tr v[38:39],v12,36864
tr v[40:41],v9,36864
tr v[42:43],v13,36864
tr v[44:45],v10,36864
tr v[46:47],v14,36864
tr v[48:49],v11,36864
tr v[50:51],v15,36864
mf v[52:55],v[20:23],a[72:75],v[52:55]
mf v[68:71],v[20:23],a[152:155],v[68:71]
mf v[84:87],v[20:23],a[232:235],v[84:87]
mf v[100:103],v[20:23],v[172:175],v[100:103]
mf v[56:59],v[24:27],a[72:75],v[56:59]
mf v[72:75],v[24:27],a[152:155],v[72:75]
mf v[88:91],v[24:27],a[232:235],v[88:91]
mf v[104:107],v[24:27],v[172:175],v[104:107]
mf v[60:63],v[28:31],a[72:75],v[60:63]
mf v[76:79],v[28:31],a[152:155],v[76:79]
mf v[92:95],v[28:31],a[232:235],v[92:95]
mf v[108:111],v[28:31],v[172:175],v[108:111]
mf v[64:67],v[32:35],a[72:75],v[64:67]
mf v[80:83],v[32:35],a[152:155],v[80:83]
mf v[96:99],v[32:35],a[232:235],v[96:99]
mf v[112:115],v[32:35],v[172:175],v[112:115]
s_waitcnt lgkmcnt(0)
s_waitcnt vmcnt(20)
s_barrier
s_add_u32 m0,s21,40960
s_mov_b32 s23,3932416
buffer_load_dwordx4 v5,s[40:43],s23 offen lds
s_add_u32 m0,s21,45056
s_mov_b32 s23,4325632
buffer_load_dwordx4 v5,s[40:43],s23 offen lds
s_add_u32 m0,s21,49152
s_mov_b32 s23,4718848
buffer_load_dwordx4 v5,s[40:43],s23 offen lds
s_add_u32 m0,s21,53248
s_mov_b32 s23,5112064
buffer_load_dwordx4 v5,s[40:43],s23 offen lds
s_add_u32 m0,s21,57344
s_mov_b32 s23,5505280
buffer_load_dwordx4 v5,s[40:43],s23 offen lds
s_add_u32 m0,s21,61440
s_mov_b32 s23,5898496
buffer_load_dwordx4 v5,s[40:43],s23 offen lds
s_add_u32 m0,s21,65536
s_mov_b32 s23,6291712
buffer_load_dwordx4 v5,s[40:43],s23 offen lds
s_add_u32 m0,s21,69632
s_mov_b32 s23,6684928
buffer_load_dwordx4 v5,s[40:43],s23 offen lds
s_add_u32 m0,s21,73728
s_mov_b32 s23,7078144
buffer_load_dwordx4 v5,s[40:43],s23 offen lds
s_add_u32 m0,s21,77824
s_mov_b32 s23,7471360
buffer_load_dwordx4 v5,s[40:43],s23 offen lds
v_add_u32 v8,40960,v8
v_add_u32 v9,40960,v9
v_add_u32 v10,40960,v10
v_add_u32 v11,40960,v11
v_add_u32 v12,40960,v12
v_add_u32 v13,40960,v13
v_add_u32 v14,40960,v14
v_add_u32 v15,40960,v15
tr v[20:21],v8,0
tr v[22:23],v12,0
tr v[24:25],v9,0
tr v[26:27],v13,0
tr v[28:29],v10,0
tr v[30:31],v14,0
tr v[32:33],v11,0
tr v[34:35],v15,0
mf v[52:55],v[36:39],a[76:79],v[52:55]
mf v[68:71],v[36:39],a[156:159],v[68:71]
mf v[84:87],v[36:39],a[236:239],v[84:87]
mf v[100:103],v[36:39],v[176:179],v[100:103]
mf v[56:59],v[40:43],a[76:79],v[56:59]
mf v[72:75],v[40:43],a[156:159],v[72:75]
mf v[88:91],v[40:43],a[236:239],v[88:91]
mf v[104:107],v[40:43],v[176:179],v[104:107]
mf v[60:63],v[44:47],a[76:79],v[60:63]
mf v[76:79],v[44:47],a[156:159],v[76:79]
mf v[92:95],v[44:47],a[236:239],v[92:95]
mf v[108:111],v[44:47],v[176:179],v[108:111]
mf v[64:67],v[48:51],a[76:79],v[64:67]
mf v[80:83],v[48:51],a[156:159],v[80:83]
mf v[96:99],v[48:51],a[236:239],v[96:99]
mf v[112:115],v[48:51],v[176:179],v[112:115]
s_nop 7
s_nop 1
cv v180,v52,v53
cv v181,v54,v55
cv v182,v56,v57
cv v183,v58,v59
cv v184,v60,v61
cv v185,v62,v63
cv v186,v64,v65
cv v187,v66,v67
cv v188,v68,v69
cv v189,v70,v71
cv v190,v72,v73
cv v191,v74,v75
cv v192,v76,v77
cv v193,v78,v79
cv v194,v80,v81
cv v195,v82,v83
cv v196,v84,v85
cv v197,v86,v87
cv v198,v88,v89
cv v199,v90,v91
cv v200,v92,v93
cv v201,v94,v95
cv v202,v96,v97
cv v203,v98,v99
cv v204,v100,v101
cv v205,v102,v103
cv v206,v104,v105
cv v207,v106,v107
cv v208,v108,v109
cv v209,v110,v111
cv v210,v112,v113
cv v211,v114,v115
s_nop 1
s_waitcnt lgkmcnt(0)
tr v[36:37],v8,4096
tr v[38:39],v12,4096
tr v[40:41],v9,4096
tr v[42:43],v13,4096
tr v[44:45],v10,4096
tr v[46:47],v14,4096
tr v[48:49],v11,4096
tr v[50:51],v15,4096
mf v[52:55],v[20:23],a[0:3],0
mf v[68:71],v[20:23],a[80:83],0
mf v[84:87],v[20:23],a[160:163],0
mf v[100:103],v[20:23],a[240:243],0
mf v[56:59],v[24:27],a[0:3],0
mf v[72:75],v[24:27],a[80:83],0
mf v[88:91],v[24:27],a[160:163],0
mf v[104:107],v[24:27],a[240:243],0
mf v[60:63],v[28:31],a[0:3],0
mf v[76:79],v[28:31],a[80:83],0
mf v[92:95],v[28:31],a[160:163],0
mf v[108:111],v[28:31],a[240:243],0
mf v[64:67],v[32:35],a[0:3],0
mf v[80:83],v[32:35],a[80:83],0
mf v[96:99],v[32:35],a[160:163],0
mf v[112:115],v[32:35],a[240:243],0
s_waitcnt lgkmcnt(0)
tr v[20:21],v8,8192
tr v[22:23],v12,8192
tr v[24:25],v9,8192
tr v[26:27],v13,8192
tr v[28:29],v10,8192
tr v[30:31],v14,8192
tr v[32:33],v11,8192
tr v[34:35],v15,8192
mf v[52:55],v[36:39],a[4:7],v[52:55]
mf v[68:71],v[36:39],a[84:87],v[68:71]
mf v[84:87],v[36:39],a[164:167],v[84:87]
mf v[100:103],v[36:39],a[244:247],v[100:103]
mf v[56:59],v[40:43],a[4:7],v[56:59]
mf v[72:75],v[40:43],a[84:87],v[72:75]
mf v[88:91],v[40:43],a[164:167],v[88:91]
mf v[104:107],v[40:43],a[244:247],v[104:107]
mf v[60:63],v[44:47],a[4:7],v[60:63]
mf v[76:79],v[44:47],a[84:87],v[76:79]
mf v[92:95],v[44:47],a[164:167],v[92:95]
mf v[108:111],v[44:47],a[244:247],v[108:111]
mf v[64:67],v[48:51],a[4:7],v[64:67]
mf v[80:83],v[48:51],a[84:87],v[80:83]
mf v[96:99],v[48:51],a[164:167],v[96:99]
mf v[112:115],v[48:51],a[244:247],v[112:115]
s_waitcnt lgkmcnt(0)
tr v[36:37],v8,12288
tr v[38:39],v12,12288
tr v[40:41],v9,12288
tr v[42:43],v13,12288
tr v[44:45],v10,12288
tr v[46:47],v14,12288
tr v[48:49],v11,12288
tr v[50:51],v15,12288
mf v[52:55],v[20:23],a[8:11],v[52:55]
mf v[68:71],v[20:23],a[88:91],v[68:71]
mf v[84:87],v[20:23],a[168:171],v[84:87]
mf v[100:103],v[20:23],a[248:251],v[100:103]
mf v[56:59],v[24:27],a[8:11],v[56:59]
mf v[72:75],v[24:27],a[88:91],v[72:75]
mf v[88:91],v[24:27],a[168:171],v[88:91]
mf v[104:107],v[24:27],a[248:251],v[104:107]
mf v[60:63],v[28:31],a[8:11],v[60:63]
mf v[76:79],v[28:31],a[88:91],v[76:79]
mf v[92:95],v[28:31],a[168:171],v[92:95]
mf v[108:111],v[28:31],a[248:251],v[108:111]
mf v[64:67],v[32:35],a[8:11],v[64:67]
mf v[80:83],v[32:35],a[88:91],v[80:83]
mf v[96:99],v[32:35],a[168:171],v[96:99]
mf v[112:115],v[32:35],a[248:251],v[112:115]
s_waitcnt lgkmcnt(0)
tr v[20:21],v8,16384
tr v[22:23],v12,16384
tr v[24:25],v9,16384
tr v[26:27],v13,16384
tr v[28:29],v10,16384
tr v[30:31],v14,16384
tr v[32:33],v11,16384
tr v[34:35],v15,16384
mf v[52:55],v[36:39],a[12:15],v[52:55]
mf v[68:71],v[36:39],a[92:95],v[68:71]
mf v[84:87],v[36:39],a[172:175],v[84:87]
mf v[100:103],v[36:39],a[252:255],v[100:103]
mf v[56:59],v[40:43],a[12:15],v[56:59]
mf v[72:75],v[40:43],a[92:95],v[72:75]
mf v[88:91],v[40:43],a[172:175],v[88:91]
mf v[104:107],v[40:43],a[252:255],v[104:107]
mf v[60:63],v[44:47],a[12:15],v[60:63]
mf v[76:79],v[44:47],a[92:95],v[76:79]
mf v[92:95],v[44:47],a[172:175],v[92:95]
mf v[108:111],v[44:47],a[252:255],v[108:111]
mf v[64:67],v[48:51],a[12:15],v[64:67]
mf v[80:83],v[48:51],a[92:95],v[80:83]
mf v[96:99],v[48:51],a[172:175],v[96:99]
mf v[112:115],v[48:51],a[252:255],v[112:115]
s_waitcnt lgkmcnt(0)
tr v[36:37],v8,20480
tr v[38:39],v12,20480
tr v[40:41],v9,20480
tr v[42:43],v13,20480
tr v[44:45],v10,20480
tr v[46:47],v14,20480
tr v[48:49],v11,20480
tr v[50:51],v15,20480
mf v[52:55],v[20:23],a[16:19],v[52:55]
mf v[68:71],v[20:23],a[96:99],v[68:71]
mf v[84:87],v[20:23],a[176:179],v[84:87]
mf v[100:103],v[20:23],v[116:119],v[100:103]
mf v[56:59],v[24:27],a[16:19],v[56:59]
mf v[72:75],v[24:27],a[96:99],v[72:75]
mf v[88:91],v[24:27],a[176:179],v[88:91]
mf v[104:107],v[24:27],v[116:119],v[104:107]
mf v[60:63],v[28:31],a[16:19],v[60:63]
mf v[76:79],v[28:31],a[96:99],v[76:79]
mf v[92:95],v[28:31],a[176:179],v[92:95]
mf v[108:111],v[28:31],v[116:119],v[108:111]
mf v[64:67],v[32:35],a[16:19],v[64:67]
mf v[80:83],v[32:35],a[96:99],v[80:83]
mf v[96:99],v[32:35],a[176:179],v[96:99]
mf v[112:115],v[32:35],v[116:119],v[112:115]
s_waitcnt lgkmcnt(0)
tr v[20:21],v8,24576
tr v[22:23],v12,24576
tr v[24:25],v9,24576
tr v[26:27],v13,24576
tr v[28:29],v10,24576
tr v[30:31],v14,24576
tr v[32:33],v11,24576
tr v[34:35],v15,24576
mf v[52:55],v[36:39],a[20:23],v[52:55]
mf v[68:71],v[36:39],a[100:103],v[68:71]
mf v[84:87],v[36:39],a[180:183],v[84:87]
mf v[100:103],v[36:39],v[120:123],v[100:103]
mf v[56:59],v[40:43],a[20:23],v[56:59]
mf v[72:75],v[40:43],a[100:103],v[72:75]
mf v[88:91],v[40:43],a[180:183],v[88:91]
mf v[104:107],v[40:43],v[120:123],v[104:107]
mf v[60:63],v[44:47],a[20:23],v[60:63]
mf v[76:79],v[44:47],a[100:103],v[76:79]
mf v[92:95],v[44:47],a[180:183],v[92:95]
mf v[108:111],v[44:47],v[120:123],v[108:111]
mf v[64:67],v[48:51],a[20:23],v[64:67]
mf v[80:83],v[48:51],a[100:103],v[80:83]
mf v[96:99],v[48:51],a[180:183],v[96:99]
mf v[112:115],v[48:51],v[120:123],v[112:115]
s_waitcnt lgkmcnt(0)
tr v[36:37],v8,28672
tr v[38:39],v12,28672
tr v[40:41],v9,28672
tr v[42:43],v13,28672
tr v[44:45],v10,28672
tr v[46:47],v14,28672
tr v[48:49],v11,28672
tr v[50:51],v15,28672
mf v[52:55],v[20:23],a[24:27],v[52:55]
mf v[68:71],v[20:23],a[104:107],v[68:71]
mf v[84:87],v[20:23],a[184:187],v[84:87]
mf v[100:103],v[20:23],v[124:127],v[100:103]
mf v[56:59],v[24:27],a[24:27],v[56:59]
mf v[72:75],v[24:27],a[104:107],v[72:75]
mf v[88:91],v[24:27],a[184:187],v[88:91]
mf v[104:107],v[24:27],v[124:127],v[104:107]
mf v[60:63],v[28:31],a[24:27],v[60:63]
mf v[76:79],v[28:31],a[104:107],v[76:79]
mf v[92:95],v[28:31],a[184:187],v[92:95]
mf v[108:111],v[28:31],v[124:127],v[108:111]
mf v[64:67],v[32:35],a[24:27],v[64:67]
mf v[80:83],v[32:35],a[104:107],v[80:83]
mf v[96:99],v[32:35],a[184:187],v[96:99]
mf v[112:115],v[32:35],v[124:127],v[112:115]
s_waitcnt lgkmcnt(0)
tr v[20:21],v8,32768
tr v[22:23],v12,32768
tr v[24:25],v9,32768
tr v[26:27],v13,32768
tr v[28:29],v10,32768
tr v[30:31],v14,32768
tr v[32:33],v11,32768
tr v[34:35],v15,32768
mf v[52:55],v[36:39],a[28:31],v[52:55]
mf v[68:71],v[36:39],a[108:111],v[68:71]
mf v[84:87],v[36:39],a[188:191],v[84:87]
mf v[100:103],v[36:39],v[128:131],v[100:103]
mf v[56:59],v[40:43],a[28:31],v[56:59]
mf v[72:75],v[40:43],a[108:111],v[72:75]
mf v[88:91],v[40:43],a[188:191],v[88:91]
mf v[104:107],v[40:43],v[128:131],v[104:107]
mf v[60:63],v[44:47],a[28:31],v[60:63]
mf v[76:79],v[44:47],a[108:111],v[76:79]
mf v[92:95],v[44:47],a[188:191],v[92:95]
mf v[108:111],v[44:47],v[128:131],v[108:111]
mf v[64:67],v[48:51],a[28:31],v[64:67]
mf v[80:83],v[48:51],a[108:111],v[80:83]
mf v[96:99],v[48:51],a[188:191],v[96:99]
mf v[112:115],v[48:51],v[128:131],v[112:115]
s_waitcnt lgkmcnt(0)
tr v[36:37],v8,36864
tr v[38:39],v12,36864
tr v[40:41],v9,36864
tr v[42:43],v13,36864
tr v[44:45],v10,36864
tr v[46:47],v14,36864
tr v[48:49],v11,36864
tr v[50:51],v15,36864
mf v[52:55],v[20:23],a[32:35],v[52:55]
mf v[68:71],v[20:23],a[112:115],v[68:71]
mf v[84:87],v[20:23],a[192:195],v[84:87]
mf v[100:103],v[20:23],v[132:135],v[100:103]
mf v[56:59],v[24:27],a[32:35],v[56:59]
mf v[72:75],v[24:27],a[112:115],v[72:75]
mf v[88:91],v[24:27],a[192:195],v[88:91]
mf v[104:107],v[24:27],v[132:135],v[104:107]
mf v[60:63],v[28:31],a[32:35],v[60:63]
mf v[76:79],v[28:31],a[112:115],v[76:79]
mf v[92:95],v[28:31],a[192:195],v[92:95]
mf v[108:111],v[28:31],v[132:135],v[108:111]
mf v[64:67],v[32:35],a[32:35],v[64:67]
mf v[80:83],v[32:35],a[112:115],v[80:83]
mf v[96:99],v[32:35],a[192:195],v[96:99]
mf v[112:115],v[32:35],v[132:135],v[112:115]
s_waitcnt lgkmcnt(0)
s_waitcnt vmcnt(20)
s_barrier
s_add_u32 m0,s21,81920
s_mov_b32 s23,0
buffer_load_dwordx4 v6,s[44:47],s23 offen lds
s_add_u32 m0,s21,86016
s_mov_b32 s23,40960
buffer_load_dwordx4 v6,s[44:47],s23 offen lds
s_add_u32 m0,s21,90112
s_mov_b32 s23,81920
buffer_load_dwordx4 v6,s[44:47],s23 offen lds
s_add_u32 m0,s21,94208
s_mov_b32 s23,122880
buffer_load_dwordx4 v6,s[44:47],s23 offen lds
s_add_u32 m0,s21,98304
s_mov_b32 s23,163840
buffer_load_dwordx4 v6,s[44:47],s23 offen lds
s_add_u32 m0,s21,102400
s_mov_b32 s23,204800
buffer_load_dwordx4 v6,s[44:47],s23 offen lds
v_add_u32 v8,40960,v8
v_add_u32 v9,40960,v9
v_add_u32 v10,40960,v10
v_add_u32 v11,40960,v11
v_add_u32 v12,40960,v12
v_add_u32 v13,40960,v13
v_add_u32 v14,40960,v14
v_add_u32 v15,40960,v15
tr v[20:21],v8,0
tr v[22:23],v12,0
tr v[24:25],v9,0
tr v[26:27],v13,0
tr v[28:29],v10,0
tr v[30:31],v14,0
tr v[32:33],v11,0
tr v[34:35],v15,0
mf v[52:55],v[36:39],a[36:39],v[52:55]
mf v[68:71],v[36:39],a[116:119],v[68:71]
mf v[84:87],v[36:39],a[196:199],v[84:87]
mf v[100:103],v[36:39],v[136:139],v[100:103]
mf v[56:59],v[40:43],a[36:39],v[56:59]
mf v[72:75],v[40:43],a[116:119],v[72:75]
mf v[88:91],v[40:43],a[196:199],v[88:91]
mf v[104:107],v[40:43],v[136:139],v[104:107]
mf v[60:63],v[44:47],a[36:39],v[60:63]
mf v[76:79],v[44:47],a[116:119],v[76:79]
mf v[92:95],v[44:47],a[196:199],v[92:95]
mf v[108:111],v[44:47],v[136:139],v[108:111]
mf v[64:67],v[48:51],a[36:39],v[64:67]
mf v[80:83],v[48:51],a[116:119],v[80:83]
mf v[96:99],v[48:51],a[196:199],v[96:99]
mf v[112:115],v[48:51],v[136:139],v[112:115]
s_waitcnt lgkmcnt(0)
tr v[36:37],v8,4096
tr v[38:39],v12,4096
tr v[40:41],v9,4096
tr v[42:43],v13,4096
tr v[44:45],v10,4096
tr v[46:47],v14,4096
tr v[48:49],v11,4096
tr v[50:51],v15,4096
mf v[52:55],v[20:23],a[40:43],v[52:55]
mf v[68:71],v[20:23],a[120:123],v[68:71]
mf v[84:87],v[20:23],a[200:203],v[84:87]
mf v[100:103],v[20:23],v[140:143],v[100:103]
mf v[56:59],v[24:27],a[40:43],v[56:59]
mf v[72:75],v[24:27],a[120:123],v[72:75]
mf v[88:91],v[24:27],a[200:203],v[88:91]
mf v[104:107],v[24:27],v[140:143],v[104:107]
mf v[60:63],v[28:31],a[40:43],v[60:63]
mf v[76:79],v[28:31],a[120:123],v[76:79]
mf v[92:95],v[28:31],a[200:203],v[92:95]
mf v[108:111],v[28:31],v[140:143],v[108:111]
mf v[64:67],v[32:35],a[40:43],v[64:67]
mf v[80:83],v[32:35],a[120:123],v[80:83]
mf v[96:99],v[32:35],a[200:203],v[96:99]
mf v[112:115],v[32:35],v[140:143],v[112:115]
s_waitcnt lgkmcnt(0)
tr v[20:21],v8,8192
tr v[22:23],v12,8192
tr v[24:25],v9,8192
tr v[26:27],v13,8192
tr v[28:29],v10,8192
tr v[30:31],v14,8192
tr v[32:33],v11,8192
tr v[34:35],v15,8192
mf v[52:55],v[36:39],a[44:47],v[52:55]
mf v[68:71],v[36:39],a[124:127],v[68:71]
mf v[84:87],v[36:39],a[204:207],v[84:87]
mf v[100:103],v[36:39],v[144:147],v[100:103]
mf v[56:59],v[40:43],a[44:47],v[56:59]
mf v[72:75],v[40:43],a[124:127],v[72:75]
mf v[88:91],v[40:43],a[204:207],v[88:91]
mf v[104:107],v[40:43],v[144:147],v[104:107]
mf v[60:63],v[44:47],a[44:47],v[60:63]
mf v[76:79],v[44:47],a[124:127],v[76:79]
mf v[92:95],v[44:47],a[204:207],v[92:95]
mf v[108:111],v[44:47],v[144:147],v[108:111]
mf v[64:67],v[48:51],a[44:47],v[64:67]
mf v[80:83],v[48:51],a[124:127],v[80:83]
mf v[96:99],v[48:51],a[204:207],v[96:99]
mf v[112:115],v[48:51],v[144:147],v[112:115]
s_waitcnt lgkmcnt(0)
tr v[36:37],v8,12288
tr v[38:39],v12,12288
tr v[40:41],v9,12288
tr v[42:43],v13,12288
tr v[44:45],v10,12288
tr v[46:47],v14,12288
tr v[48:49],v11,12288
tr v[50:51],v15,12288
mf v[52:55],v[20:23],a[48:51],v[52:55]
mf v[68:71],v[20:23],a[128:131],v[68:71]
mf v[84:87],v[20:23],a[208:211],v[84:87]
mf v[100:103],v[20:23],v[148:151],v[100:103]
mf v[56:59],v[24:27],a[48:51],v[56:59]
mf v[72:75],v[24:27],a[128:131],v[72:75]
mf v[88:91],v[24:27],a[208:211],v[88:91]
mf v[104:107],v[24:27],v[148:151],v[104:107]
mf v[60:63],v[28:31],a[48:51],v[60:63]
mf v[76:79],v[28:31],a[128:131],v[76:79]
mf v[92:95],v[28:31],a[208:211],v[92:95]
mf v[108:111],v[28:31],v[148:151],v[108:111]
mf v[64:67],v[32:35],a[48:51],v[64:67]
mf v[80:83],v[32:35],a[128:131],v[80:83]
mf v[96:99],v[32:35],a[208:211],v[96:99]
mf v[112:115],v[32:35],v[148:151],v[112:115]
s_waitcnt lgkmcnt(0)
tr v[20:21],v8,16384
tr v[22:23],v12,16384
tr v[24:25],v9,16384
tr v[26:27],v13,16384
tr v[28:29],v10,16384
tr v[30:31],v14,16384
tr v[32:33],v11,16384
tr v[34:35],v15,16384
mf v[52:55],v[36:39],a[52:55],v[52:55]
mf v[68:71],v[36:39],a[132:135],v[68:71]
mf v[84:87],v[36:39],a[212:215],v[84:87]
mf v[100:103],v[36:39],v[152:155],v[100:103]
mf v[56:59],v[40:43],a[52:55],v[56:59]
mf v[72:75],v[40:43],a[132:135],v[72:75]
mf v[88:91],v[40:43],a[212:215],v[88:91]
mf v[104:107],v[40:43],v[152:155],v[104:107]
mf v[60:63],v[44:47],a[52:55],v[60:63]
mf v[76:79],v[44:47],a[132:135],v[76:79]
mf v[92:95],v[44:47],a[212:215],v[92:95]
mf v[108:111],v[44:47],v[152:155],v[108:111]
mf v[64:67],v[48:51],a[52:55],v[64:67]
mf v[80:83],v[48:51],a[132:135],v[80:83]
mf v[96:99],v[48:51],a[212:215],v[96:99]
mf v[112:115],v[48:51],v[152:155],v[112:115]
s_waitcnt lgkmcnt(0)
tr v[36:37],v8,20480
tr v[38:39],v12,20480
tr v[40:41],v9,20480
tr v[42:43],v13,20480
tr v[44:45],v10,20480
tr v[46:47],v14,20480
tr v[48:49],v11,20480
tr v[50:51],v15,20480
mf v[52:55],v[20:23],a[56:59],v[52:55]
mf v[68:71],v[20:23],a[136:139],v[68:71]
mf v[84:87],v[20:23],a[216:219],v[84:87]
mf v[100:103],v[20:23],v[156:159],v[100:103]
mf v[56:59],v[24:27],a[56:59],v[56:59]
mf v[72:75],v[24:27],a[136:139],v[72:75]
mf v[88:91],v[24:27],a[216:219],v[88:91]
mf v[104:107],v[24:27],v[156:159],v[104:107]
mf v[60:63],v[28:31],a[56:59],v[60:63]
mf v[76:79],v[28:31],a[136:139],v[76:79]
mf v[92:95],v[28:31],a[216:219],v[92:95]
mf v[108:111],v[28:31],v[156:159],v[108:111]
mf v[64:67],v[32:35],a[56:59],v[64:67]
mf v[80:83],v[32:35],a[136:139],v[80:83]
mf v[96:99],v[32:35],a[216:219],v[96:99]
mf v[112:115],v[32:35],v[156:159],v[112:115]
s_waitcnt lgkmcnt(0)
tr v[20:21],v8,24576
tr v[22:23],v12,24576
tr v[24:25],v9,24576
tr v[26:27],v13,24576
tr v[28:29],v10,24576
tr v[30:31],v14,24576
tr v[32:33],v11,24576
tr v[34:35],v15,24576
mf v[52:55],v[36:39],a[60:63],v[52:55]
mf v[68:71],v[36:39],a[140:143],v[68:71]
mf v[84:87],v[36:39],a[220:223],v[84:87]
mf v[100:103],v[36:39],v[160:163],v[100:103]
mf v[56:59],v[40:43],a[60:63],v[56:59]
mf v[72:75],v[40:43],a[140:143],v[72:75]
mf v[88:91],v[40:43],a[220:223],v[88:91]
mf v[104:107],v[40:43],v[160:163],v[104:107]
mf v[60:63],v[44:47],a[60:63],v[60:63]
mf v[76:79],v[44:47],a[140:143],v[76:79]
mf v[92:95],v[44:47],a[220:223],v[92:95]
mf v[108:111],v[44:47],v[160:163],v[108:111]
mf v[64:67],v[48:51],a[60:63],v[64:67]
mf v[80:83],v[48:51],a[140:143],v[80:83]
mf v[96:99],v[48:51],a[220:223],v[96:99]
mf v[112:115],v[48:51],v[160:163],v[112:115]
s_waitcnt lgkmcnt(0)
tr v[36:37],v8,28672
tr v[38:39],v12,28672
tr v[40:41],v9,28672
tr v[42:43],v13,28672
tr v[44:45],v10,28672
tr v[46:47],v14,28672
tr v[48:49],v11,28672
tr v[50:51],v15,28672
mf v[52:55],v[20:23],a[64:67],v[52:55]
mf v[68:71],v[20:23],a[144:147],v[68:71]
mf v[84:87],v[20:23],a[224:227],v[84:87]
mf v[100:103],v[20:23],v[164:167],v[100:103]
mf v[56:59],v[24:27],a[64:67],v[56:59]
mf v[72:75],v[24:27],a[144:147],v[72:75]
mf v[88:91],v[24:27],a[224:227],v[88:91]
mf v[104:107],v[24:27],v[164:167],v[104:107]
mf v[60:63],v[28:31],a[64:67],v[60:63]
mf v[76:79],v[28:31],a[144:147],v[76:79]
mf v[92:95],v[28:31],a[224:227],v[92:95]
mf v[108:111],v[28:31],v[164:167],v[108:111]
mf v[64:67],v[32:35],a[64:67],v[64:67]
mf v[80:83],v[32:35],a[144:147],v[80:83]
mf v[96:99],v[32:35],a[224:227],v[96:99]
mf v[112:115],v[32:35],v[164:167],v[112:115]
s_waitcnt lgkmcnt(0)
tr v[20:21],v8,32768
tr v[22:23],v12,32768
tr v[24:25],v9,32768
tr v[26:27],v13,32768
tr v[28:29],v10,32768
tr v[30:31],v14,32768
tr v[32:33],v11,32768
tr v[34:35],v15,32768
mf v[52:55],v[36:39],a[68:71],v[52:55]
mf v[68:71],v[36:39],a[148:151],v[68:71]
mf v[84:87],v[36:39],a[228:231],v[84:87]
mf v[100:103],v[36:39],v[168:171],v[100:103]
mf v[56:59],v[40:43],a[68:71],v[56:59]
mf v[72:75],v[40:43],a[148:151],v[72:75]
mf v[88:91],v[40:43],a[228:231],v[88:91]
mf v[104:107],v[40:43],v[168:171],v[104:107]
mf v[60:63],v[44:47],a[68:71],v[60:63]
mf v[76:79],v[44:47],a[148:151],v[76:79]
mf v[92:95],v[44:47],a[228:231],v[92:95]
mf v[108:111],v[44:47],v[168:171],v[108:111]
mf v[64:67],v[48:51],a[68:71],v[64:67]
mf v[80:83],v[48:51],a[148:151],v[80:83]
mf v[96:99],v[48:51],a[228:231],v[96:99]
mf v[112:115],v[48:51],v[168:171],v[112:115]
s_waitcnt lgkmcnt(0)
tr v[36:37],v8,36864
tr v[38:39],v12,36864
tr v[40:41],v9,36864
tr v[42:43],v13,36864
tr v[44:45],v10,36864
tr v[46:47],v14,36864
tr v[48:49],v11,36864
tr v[50:51],v15,36864
mf v[52:55],v[20:23],a[72:75],v[52:55]
mf v[68:71],v[20:23],a[152:155],v[68:71]
mf v[84:87],v[20:23],a[232:235],v[84:87]
mf v[100:103],v[20:23],v[172:175],v[100:103]
mf v[56:59],v[24:27],a[72:75],v[56:59]
mf v[72:75],v[24:27],a[152:155],v[72:75]
mf v[88:91],v[24:27],a[232:235],v[88:91]
mf v[104:107],v[24:27],v[172:175],v[104:107]
mf v[60:63],v[28:31],a[72:75],v[60:63]
mf v[76:79],v[28:31],a[152:155],v[76:79]
mf v[92:95],v[28:31],a[232:235],v[92:95]
mf v[108:111],v[28:31],v[172:175],v[108:111]
mf v[64:67],v[32:35],a[72:75],v[64:67]
mf v[80:83],v[32:35],a[152:155],v[80:83]
mf v[96:99],v[32:35],a[232:235],v[96:99]
mf v[112:115],v[32:35],v[172:175],v[112:115]
s_waitcnt lgkmcnt(0)
s_waitcnt vmcnt(16)
s_barrier
s_add_u32 m0,s21,122880
s_mov_b32 s23,128
buffer_load_dwordx4 v6,s[44:47],s23 offen lds
s_add_u32 m0,s21,126976
s_mov_b32 s23,41088
buffer_load_dwordx4 v6,s[44:47],s23 offen lds
s_add_u32 m0,s21,131072
s_mov_b32 s23,82048
buffer_load_dwordx4 v6,s[44:47],s23 offen lds
s_add_u32 m0,s21,135168
s_mov_b32 s23,123008
buffer_load_dwordx4 v6,s[44:47],s23 offen lds
s_add_u32 m0,s21,139264
s_mov_b32 s23,163968
buffer_load_dwordx4 v6,s[44:47],s23 offen lds
s_add_u32 m0,s21,143360
s_mov_b32 s23,204928
buffer_load_dwordx4 v6,s[44:47],s23 offen lds
v_add_u32 v8,4294844416,v8
v_add_u32 v9,4294844416,v9
v_add_u32 v10,4294844416,v10
v_add_u32 v11,4294844416,v11
v_add_u32 v12,4294844416,v12
v_add_u32 v13,4294844416,v13
v_add_u32 v14,4294844416,v14
v_add_u32 v15,4294844416,v15
tr v[20:21],v8,0
tr v[22:23],v12,0
tr v[24:25],v9,0
tr v[26:27],v13,0
tr v[28:29],v10,0
tr v[30:31],v14,0
tr v[32:33],v11,0
tr v[34:35],v15,0
mf v[52:55],v[36:39],a[76:79],v[52:55]
mf v[68:71],v[36:39],a[156:159],v[68:71]
mf v[84:87],v[36:39],a[236:239],v[84:87]
mf v[100:103],v[36:39],v[176:179],v[100:103]
mf v[56:59],v[40:43],a[76:79],v[56:59]
mf v[72:75],v[40:43],a[156:159],v[72:75]
mf v[88:91],v[40:43],a[236:239],v[88:91]
mf v[104:107],v[40:43],v[176:179],v[104:107]
mf v[60:63],v[44:47],a[76:79],v[60:63]
mf v[76:79],v[44:47],a[156:159],v[76:79]
mf v[92:95],v[44:47],a[236:239],v[92:95]
mf v[108:111],v[44:47],v[176:179],v[108:111]
mf v[64:67],v[48:51],a[76:79],v[64:67]
mf v[80:83],v[48:51],a[156:159],v[80:83]
mf v[96:99],v[48:51],a[236:239],v[96:99]
mf v[112:115],v[48:51],v[176:179],v[112:115]
s_nop 7
s_nop 1
cv v212,v52,v53
cv v213,v54,v55
cv v214,v56,v57
cv v215,v58,v59
cv v216,v60,v61
cv v217,v62,v63
cv v218,v64,v65
cv v219,v66,v67
cv v220,v68,v69
cv v221,v70,v71
cv v222,v72,v73
cv v223,v74,v75
cv v224,v76,v77
cv v225,v78,v79
cv v226,v80,v81
cv v227,v82,v83
cv v228,v84,v85
cv v229,v86,v87
cv v230,v88,v89
cv v231,v90,v91
cv v232,v92,v93
cv v233,v94,v95
cv v234,v96,v97
cv v235,v98,v99
cv v236,v100,v101
cv v237,v102,v103
cv v238,v104,v105
cv v239,v106,v107
cv v240,v108,v109
cv v241,v110,v111
cv v242,v112,v113
cv v243,v114,v115
s_nop 1
s_waitcnt lgkmcnt(0)
tr v[36:37],v8,4096
tr v[38:39],v12,4096
tr v[40:41],v9,4096
tr v[42:43],v13,4096
tr v[44:45],v10,4096
tr v[46:47],v14,4096
tr v[48:49],v11,4096
tr v[50:51],v15,4096
mf v[52:55],v[20:23],a[0:3],0
mf v[68:71],v[20:23],a[80:83],0
mf v[84:87],v[20:23],a[160:163],0
mf v[100:103],v[20:23],a[240:243],0
mf v[56:59],v[24:27],a[0:3],0
mf v[72:75],v[24:27],a[80:83],0
mf v[88:91],v[24:27],a[160:163],0
mf v[104:107],v[24:27],a[240:243],0
mf v[60:63],v[28:31],a[0:3],0
mf v[76:79],v[28:31],a[80:83],0
mf v[92:95],v[28:31],a[160:163],0
mf v[108:111],v[28:31],a[240:243],0
mf v[64:67],v[32:35],a[0:3],0
mf v[80:83],v[32:35],a[80:83],0
mf v[96:99],v[32:35],a[160:163],0
mf v[112:115],v[32:35],a[240:243],0
s_waitcnt lgkmcnt(0)
tr v[20:21],v8,8192
tr v[22:23],v12,8192
tr v[24:25],v9,8192
tr v[26:27],v13,8192
tr v[28:29],v10,8192
tr v[30:31],v14,8192
tr v[32:33],v11,8192
tr v[34:35],v15,8192
mf v[52:55],v[36:39],a[4:7],v[52:55]
mf v[68:71],v[36:39],a[84:87],v[68:71]
mf v[84:87],v[36:39],a[164:167],v[84:87]
mf v[100:103],v[36:39],a[244:247],v[100:103]
mf v[56:59],v[40:43],a[4:7],v[56:59]
mf v[72:75],v[40:43],a[84:87],v[72:75]
mf v[88:91],v[40:43],a[164:167],v[88:91]
mf v[104:107],v[40:43],a[244:247],v[104:107]
mf v[60:63],v[44:47],a[4:7],v[60:63]
mf v[76:79],v[44:47],a[84:87],v[76:79]
mf v[92:95],v[44:47],a[164:167],v[92:95]
mf v[108:111],v[44:47],a[244:247],v[108:111]
mf v[64:67],v[48:51],a[4:7],v[64:67]
mf v[80:83],v[48:51],a[84:87],v[80:83]
mf v[96:99],v[48:51],a[164:167],v[96:99]
mf v[112:115],v[48:51],a[244:247],v[112:115]
s_waitcnt lgkmcnt(0)
tr v[36:37],v8,12288
tr v[38:39],v12,12288
tr v[40:41],v9,12288
tr v[42:43],v13,12288
tr v[44:45],v10,12288
tr v[46:47],v14,12288
tr v[48:49],v11,12288
tr v[50:51],v15,12288
mf v[52:55],v[20:23],a[8:11],v[52:55]
mf v[68:71],v[20:23],a[88:91],v[68:71]
mf v[84:87],v[20:23],a[168:171],v[84:87]
mf v[100:103],v[20:23],a[248:251],v[100:103]
mf v[56:59],v[24:27],a[8:11],v[56:59]
mf v[72:75],v[24:27],a[88:91],v[72:75]
mf v[88:91],v[24:27],a[168:171],v[88:91]
mf v[104:107],v[24:27],a[248:251],v[104:107]
mf v[60:63],v[28:31],a[8:11],v[60:63]
mf v[76:79],v[28:31],a[88:91],v[76:79]
mf v[92:95],v[28:31],a[168:171],v[92:95]
mf v[108:111],v[28:31],a[248:251],v[108:111]
mf v[64:67],v[32:35],a[8:11],v[64:67]
mf v[80:83],v[32:35],a[88:91],v[80:83]
mf v[96:99],v[32:35],a[168:171],v[96:99]
mf v[112:115],v[32:35],a[248:251],v[112:115]
s_waitcnt lgkmcnt(0)
tr v[20:21],v8,16384
tr v[22:23],v12,16384
tr v[24:25],v9,16384
tr v[26:27],v13,16384
tr v[28:29],v10,16384
tr v[30:31],v14,16384
tr v[32:33],v11,16384
tr v[34:35],v15,16384
mf v[52:55],v[36:39],a[12:15],v[52:55]
mf v[68:71],v[36:39],a[92:95],v[68:71]
mf v[84:87],v[36:39],a[172:175],v[84:87]
mf v[100:103],v[36:39],a[252:255],v[100:103]
mf v[56:59],v[40:43],a[12:15],v[56:59]
mf v[72:75],v[40:43],a[92:95],v[72:75]
mf v[88:91],v[40:43],a[172:175],v[88:91]
mf v[104:107],v[40:43],a[252:255],v[104:107]
mf v[60:63],v[44:47],a[12:15],v[60:63]
mf v[76:79],v[44:47],a[92:95],v[76:79]
mf v[92:95],v[44:47],a[172:175],v[92:95]
mf v[108:111],v[44:47],a[252:255],v[108:111]
mf v[64:67],v[48:51],a[12:15],v[64:67]
mf v[80:83],v[48:51],a[92:95],v[80:83]
mf v[96:99],v[48:51],a[172:175],v[96:99]
mf v[112:115],v[48:51],a[252:255],v[112:115]
s_waitcnt lgkmcnt(0)
tr v[36:37],v8,20480
tr v[38:39],v12,20480
tr v[40:41],v9,20480
tr v[42:43],v13,20480
tr v[44:45],v10,20480
tr v[46:47],v14,20480
tr v[48:49],v11,20480
tr v[50:51],v15,20480
mf v[52:55],v[20:23],a[16:19],v[52:55]
mf v[68:71],v[20:23],a[96:99],v[68:71]
mf v[84:87],v[20:23],a[176:179],v[84:87]
mf v[100:103],v[20:23],v[116:119],v[100:103]
mf v[56:59],v[24:27],a[16:19],v[56:59]
mf v[72:75],v[24:27],a[96:99],v[72:75]
mf v[88:91],v[24:27],a[176:179],v[88:91]
mf v[104:107],v[24:27],v[116:119],v[104:107]
mf v[60:63],v[28:31],a[16:19],v[60:63]
mf v[76:79],v[28:31],a[96:99],v[76:79]
mf v[92:95],v[28:31],a[176:179],v[92:95]
mf v[108:111],v[28:31],v[116:119],v[108:111]
mf v[64:67],v[32:35],a[16:19],v[64:67]
mf v[80:83],v[32:35],a[96:99],v[80:83]
mf v[96:99],v[32:35],a[176:179],v[96:99]
mf v[112:115],v[32:35],v[116:119],v[112:115]
s_waitcnt lgkmcnt(0)
tr v[20:21],v8,24576
tr v[22:23],v12,24576
tr v[24:25],v9,24576
tr v[26:27],v13,24576
tr v[28:29],v10,24576
tr v[30:31],v14,24576
tr v[32:33],v11,24576
tr v[34:35],v15,24576
mf v[52:55],v[36:39],a[20:23],v[52:55]
mf v[68:71],v[36:39],a[100:103],v[68:71]
mf v[84:87],v[36:39],a[180:183],v[84:87]
mf v[100:103],v[36:39],v[120:123],v[100:103]
mf v[56:59],v[40:43],a[20:23],v[56:59]
mf v[72:75],v[40:43],a[100:103],v[72:75]
mf v[88:91],v[40:43],a[180:183],v[88:91]
mf v[104:107],v[40:43],v[120:123],v[104:107]
mf v[60:63],v[44:47],a[20:23],v[60:63]
mf v[76:79],v[44:47],a[100:103],v[76:79]
mf v[92:95],v[44:47],a[180:183],v[92:95]
mf v[108:111],v[44:47],v[120:123],v[108:111]
mf v[64:67],v[48:51],a[20:23],v[64:67]
mf v[80:83],v[48:51],a[100:103],v[80:83]
mf v[96:99],v[48:51],a[180:183],v[96:99]
mf v[112:115],v[48:51],v[120:123],v[112:115]
s_waitcnt lgkmcnt(0)
tr v[36:37],v8,28672
tr v[38:39],v12,28672
tr v[40:41],v9,28672
tr v[42:43],v13,28672
tr v[44:45],v10,28672
tr v[46:47],v14,28672
tr v[48:49],v11,28672
tr v[50:51],v15,28672
mf v[52:55],v[20:23],a[24:27],v[52:55]
mf v[68:71],v[20:23],a[104:107],v[68:71]
mf v[84:87],v[20:23],a[184:187],v[84:87]
mf v[100:103],v[20:23],v[124:127],v[100:103]
mf v[56:59],v[24:27],a[24:27],v[56:59]
mf v[72:75],v[24:27],a[104:107],v[72:75]
mf v[88:91],v[24:27],a[184:187],v[88:91]
mf v[104:107],v[24:27],v[124:127],v[104:107]
mf v[60:63],v[28:31],a[24:27],v[60:63]
mf v[76:79],v[28:31],a[104:107],v[76:79]
mf v[92:95],v[28:31],a[184:187],v[92:95]
mf v[108:111],v[28:31],v[124:127],v[108:111]
mf v[64:67],v[32:35],a[24:27],v[64:67]
mf v[80:83],v[32:35],a[104:107],v[80:83]
mf v[96:99],v[32:35],a[184:187],v[96:99]
mf v[112:115],v[32:35],v[124:127],v[112:115]
s_waitcnt lgkmcnt(0)
tr v[20:21],v8,32768
tr v[22:23],v12,32768
tr v[24:25],v9,32768
tr v[26:27],v13,32768
tr v[28:29],v10,32768
tr v[30:31],v14,32768
tr v[32:33],v11,32768
tr v[34:35],v15,32768
mf v[52:55],v[36:39],a[28:31],v[52:55]
mf v[68:71],v[36:39],a[108:111],v[68:71]
mf v[84:87],v[36:39],a[188:191],v[84:87]
mf v[100:103],v[36:39],v[128:131],v[100:103]
mf v[56:59],v[40:43],a[28:31],v[56:59]
mf v[72:75],v[40:43],a[108:111],v[72:75]
mf v[88:91],v[40:43],a[188:191],v[88:91]
mf v[104:107],v[40:43],v[128:131],v[104:107]
mf v[60:63],v[44:47],a[28:31],v[60:63]
mf v[76:79],v[44:47],a[108:111],v[76:79]
mf v[92:95],v[44:47],a[188:191],v[92:95]
mf v[108:111],v[44:47],v[128:131],v[108:111]
mf v[64:67],v[48:51],a[28:31],v[64:67]
mf v[80:83],v[48:51],a[108:111],v[80:83]
mf v[96:99],v[48:51],a[188:191],v[96:99]
mf v[112:115],v[48:51],v[128:131],v[112:115]
s_waitcnt lgkmcnt(0)
tr v[36:37],v8,36864
tr v[38:39],v12,36864
tr v[40:41],v9,36864
tr v[42:43],v13,36864
tr v[44:45],v10,36864
tr v[46:47],v14,36864
tr v[48:49],v11,36864
tr v[50:51],v15,36864
mf v[52:55],v[20:23],a[32:35],v[52:55]
mf v[68:71],v[20:23],a[112:115],v[68:71]
mf v[84:87],v[20:23],a[192:195],v[84:87]
mf v[100:103],v[20:23],v[132:135],v[100:103]
mf v[56:59],v[24:27],a[32:35],v[56:59]
mf v[72:75],v[24:27],a[112:115],v[72:75]
mf v[88:91],v[24:27],a[192:195],v[88:91]
mf v[104:107],v[24:27],v[132:135],v[104:107]
mf v[60:63],v[28:31],a[32:35],v[60:63]
mf v[76:79],v[28:31],a[112:115],v[76:79]
mf v[92:95],v[28:31],a[192:195],v[92:95]
mf v[108:111],v[28:31],v[132:135],v[108:111]
mf v[64:67],v[32:35],a[32:35],v[64:67]
mf v[80:83],v[32:35],a[112:115],v[80:83]
mf v[96:99],v[32:35],a[192:195],v[96:99]
mf v[112:115],v[32:35],v[132:135],v[112:115]
s_waitcnt lgkmcnt(0)
s_waitcnt vmcnt(12)
s_barrier
s_add_u32 m0,s21,0
s_mov_b32 s23,256
buffer_load_dwordx4 v6,s[44:47],s23 offen lds
s_add_u32 m0,s21,4096
s_mov_b32 s23,41216
buffer_load_dwordx4 v6,s[44:47],s23 offen lds
s_add_u32 m0,s21,8192
s_mov_b32 s23,82176
buffer_load_dwordx4 v6,s[44:47],s23 offen lds
s_add_u32 m0,s21,12288
s_mov_b32 s23,123136
buffer_load_dwordx4 v6,s[44:47],s23 offen lds
s_add_u32 m0,s21,16384
s_mov_b32 s23,164096
buffer_load_dwordx4 v6,s[44:47],s23 offen lds
s_add_u32 m0,s21,20480
s_mov_b32 s23,205056
buffer_load_dwordx4 v6,s[44:47],s23 offen lds
v_add_u32 v8,40960,v8
v_add_u32 v9,40960,v9
v_add_u32 v10,40960,v10
v_add_u32 v11,40960,v11
v_add_u32 v12,40960,v12
v_add_u32 v13,40960,v13
v_add_u32 v14,40960,v14
v_add_u32 v15,40960,v15
tr v[20:21],v8,0
tr v[22:23],v12,0
tr v[24:25],v9,0
tr v[26:27],v13,0
tr v[28:29],v10,0
tr v[30:31],v14,0
tr v[32:33],v11,0
tr v[34:35],v15,0
mf v[52:55],v[36:39],a[36:39],v[52:55]
mf v[68:71],v[36:39],a[116:119],v[68:71]
mf v[84:87],v[36:39],a[196:199],v[84:87]
mf v[100:103],v[36:39],v[136:139],v[100:103]
mf v[56:59],v[40:43],a[36:39],v[56:59]
mf v[72:75],v[40:43],a[116:119],v[72:75]
mf v[88:91],v[40:43],a[196:199],v[88:91]
mf v[104:107],v[40:43],v[136:139],v[104:107]
mf v[60:63],v[44:47],a[36:39],v[60:63]
mf v[76:79],v[44:47],a[116:119],v[76:79]
mf v[92:95],v[44:47],a[196:199],v[92:95]
mf v[108:111],v[44:47],v[136:139],v[108:111]
mf v[64:67],v[48:51],a[36:39],v[64:67]
mf v[80:83],v[48:51],a[116:119],v[80:83]
mf v[96:99],v[48:51],a[196:199],v[96:99]
mf v[112:115],v[48:51],v[136:139],v[112:115]
s_waitcnt lgkmcnt(0)
tr v[36:37],v8,4096
tr v[38:39],v12,4096
tr v[40:41],v9,4096
tr v[42:43],v13,4096
tr v[44:45],v10,4096
tr v[46:47],v14,4096
tr v[48:49],v11,4096
tr v[50:51],v15,4096
mf v[52:55],v[20:23],a[40:43],v[52:55]
mf v[68:71],v[20:23],a[120:123],v[68:71]
mf v[84:87],v[20:23],a[200:203],v[84:87]
mf v[100:103],v[20:23],v[140:143],v[100:103]
mf v[56:59],v[24:27],a[40:43],v[56:59]
mf v[72:75],v[24:27],a[120:123],v[72:75]
mf v[88:91],v[24:27],a[200:203],v[88:91]
mf v[104:107],v[24:27],v[140:143],v[104:107]
mf v[60:63],v[28:31],a[40:43],v[60:63]
mf v[76:79],v[28:31],a[120:123],v[76:79]
mf v[92:95],v[28:31],a[200:203],v[92:95]
mf v[108:111],v[28:31],v[140:143],v[108:111]
mf v[64:67],v[32:35],a[40:43],v[64:67]
mf v[80:83],v[32:35],a[120:123],v[80:83]
mf v[96:99],v[32:35],a[200:203],v[96:99]
mf v[112:115],v[32:35],v[140:143],v[112:115]
s_waitcnt lgkmcnt(0)
tr v[20:21],v8,8192
tr v[22:23],v12,8192
tr v[24:25],v9,8192
tr v[26:27],v13,8192
tr v[28:29],v10,8192
tr v[30:31],v14,8192
tr v[32:33],v11,8192
tr v[34:35],v15,8192
mf v[52:55],v[36:39],a[44:47],v[52:55]
mf v[68:71],v[36:39],a[124:127],v[68:71]
mf v[84:87],v[36:39],a[204:207],v[84:87]
mf v[100:103],v[36:39],v[144:147],v[100:103]
mf v[56:59],v[40:43],a[44:47],v[56:59]
mf v[72:75],v[40:43],a[124:127],v[72:75]
mf v[88:91],v[40:43],a[204:207],v[88:91]
mf v[104:107],v[40:43],v[144:147],v[104:107]
mf v[60:63],v[44:47],a[44:47],v[60:63]
mf v[76:79],v[44:47],a[124:127],v[76:79]
mf v[92:95],v[44:47],a[204:207],v[92:95]
mf v[108:111],v[44:47],v[144:147],v[108:111]
mf v[64:67],v[48:51],a[44:47],v[64:67]
mf v[80:83],v[48:51],a[124:127],v[80:83]
mf v[96:99],v[48:51],a[204:207],v[96:99]
mf v[112:115],v[48:51],v[144:147],v[112:115]
s_waitcnt lgkmcnt(0)
tr v[36:37],v8,12288
tr v[38:39],v12,12288
tr v[40:41],v9,12288
tr v[42:43],v13,12288
tr v[44:45],v10,12288
tr v[46:47],v14,12288
tr v[48:49],v11,12288
tr v[50:51],v15,12288
mf v[52:55],v[20:23],a[48:51],v[52:55]
mf v[68:71],v[20:23],a[128:131],v[68:71]
mf v[84:87],v[20:23],a[208:211],v[84:87]
mf v[100:103],v[20:23],v[148:151],v[100:103]
mf v[56:59],v[24:27],a[48:51],v[56:59]
mf v[72:75],v[24:27],a[128:131],v[72:75]
mf v[88:91],v[24:27],a[208:211],v[88:91]
mf v[104:107],v[24:27],v[148:151],v[104:107]
mf v[60:63],v[28:31],a[48:51],v[60:63]
mf v[76:79],v[28:31],a[128:131],v[76:79]
mf v[92:95],v[28:31],a[208:211],v[92:95]
mf v[108:111],v[28:31],v[148:151],v[108:111]
mf v[64:67],v[32:35],a[48:51],v[64:67]
mf v[80:83],v[32:35],a[128:131],v[80:83]
mf v[96:99],v[32:35],a[208:211],v[96:99]
mf v[112:115],v[32:35],v[148:151],v[112:115]
s_waitcnt lgkmcnt(0)
tr v[20:21],v8,16384
tr v[22:23],v12,16384
tr v[24:25],v9,16384
tr v[26:27],v13,16384
tr v[28:29],v10,16384
tr v[30:31],v14,16384
tr v[32:33],v11,16384
tr v[34:35],v15,16384
mf v[52:55],v[36:39],a[52:55],v[52:55]
mf v[68:71],v[36:39],a[132:135],v[68:71]
mf v[84:87],v[36:39],a[212:215],v[84:87]
mf v[100:103],v[36:39],v[152:155],v[100:103]
mf v[56:59],v[40:43],a[52:55],v[56:59]
mf v[72:75],v[40:43],a[132:135],v[72:75]
mf v[88:91],v[40:43],a[212:215],v[88:91]
mf v[104:107],v[40:43],v[152:155],v[104:107]
mf v[60:63],v[44:47],a[52:55],v[60:63]
mf v[76:79],v[44:47],a[132:135],v[76:79]
mf v[92:95],v[44:47],a[212:215],v[92:95]
mf v[108:111],v[44:47],v[152:155],v[108:111]
mf v[64:67],v[48:51],a[52:55],v[64:67]
mf v[80:83],v[48:51],a[132:135],v[80:83]
mf v[96:99],v[48:51],a[212:215],v[96:99]
mf v[112:115],v[48:51],v[152:155],v[112:115]
s_waitcnt lgkmcnt(0)
tr v[36:37],v8,20480
tr v[38:39],v12,20480
tr v[40:41],v9,20480
tr v[42:43],v13,20480
tr v[44:45],v10,20480
tr v[46:47],v14,20480
tr v[48:49],v11,20480
tr v[50:51],v15,20480
mf v[52:55],v[20:23],a[56:59],v[52:55]
mf v[68:71],v[20:23],a[136:139],v[68:71]
mf v[84:87],v[20:23],a[216:219],v[84:87]
mf v[100:103],v[20:23],v[156:159],v[100:103]
mf v[56:59],v[24:27],a[56:59],v[56:59]
mf v[72:75],v[24:27],a[136:139],v[72:75]
mf v[88:91],v[24:27],a[216:219],v[88:91]
mf v[104:107],v[24:27],v[156:159],v[104:107]
mf v[60:63],v[28:31],a[56:59],v[60:63]
mf v[76:79],v[28:31],a[136:139],v[76:79]
mf v[92:95],v[28:31],a[216:219],v[92:95]
mf v[108:111],v[28:31],v[156:159],v[108:111]
mf v[64:67],v[32:35],a[56:59],v[64:67]
mf v[80:83],v[32:35],a[136:139],v[80:83]
mf v[96:99],v[32:35],a[216:219],v[96:99]
mf v[112:115],v[32:35],v[156:159],v[112:115]
s_waitcnt lgkmcnt(0)
tr v[20:21],v8,24576
tr v[22:23],v12,24576
tr v[24:25],v9,24576
tr v[26:27],v13,24576
tr v[28:29],v10,24576
tr v[30:31],v14,24576
tr v[32:33],v11,24576
tr v[34:35],v15,24576
mf v[52:55],v[36:39],a[60:63],v[52:55]
mf v[68:71],v[36:39],a[140:143],v[68:71]
mf v[84:87],v[36:39],a[220:223],v[84:87]
mf v[100:103],v[36:39],v[160:163],v[100:103]
mf v[56:59],v[40:43],a[60:63],v[56:59]
mf v[72:75],v[40:43],a[140:143],v[72:75]
mf v[88:91],v[40:43],a[220:223],v[88:91]
mf v[104:107],v[40:43],v[160:163],v[104:107]
mf v[60:63],v[44:47],a[60:63],v[60:63]
mf v[76:79],v[44:47],a[140:143],v[76:79]
mf v[92:95],v[44:47],a[220:223],v[92:95]
mf v[108:111],v[44:47],v[160:163],v[108:111]
mf v[64:67],v[48:51],a[60:63],v[64:67]
mf v[80:83],v[48:51],a[140:143],v[80:83]
mf v[96:99],v[48:51],a[220:223],v[96:99]
mf v[112:115],v[48:51],v[160:163],v[112:115]
s_waitcnt lgkmcnt(0)
tr v[36:37],v8,28672
tr v[38:39],v12,28672
tr v[40:41],v9,28672
tr v[42:43],v13,28672
tr v[44:45],v10,28672
tr v[46:47],v14,28672
tr v[48:49],v11,28672
tr v[50:51],v15,28672
mf v[52:55],v[20:23],a[64:67],v[52:55]
mf v[68:71],v[20:23],a[144:147],v[68:71]
mf v[84:87],v[20:23],a[224:227],v[84:87]
mf v[100:103],v[20:23],v[164:167],v[100:103]
mf v[56:59],v[24:27],a[64:67],v[56:59]
mf v[72:75],v[24:27],a[144:147],v[72:75]
mf v[88:91],v[24:27],a[224:227],v[88:91]
mf v[104:107],v[24:27],v[164:167],v[104:107]
mf v[60:63],v[28:31],a[64:67],v[60:63]
mf v[76:79],v[28:31],a[144:147],v[76:79]
mf v[92:95],v[28:31],a[224:227],v[92:95]
mf v[108:111],v[28:31],v[164:167],v[108:111]
mf v[64:67],v[32:35],a[64:67],v[64:67]
mf v[80:83],v[32:35],a[144:147],v[80:83]
mf v[96:99],v[32:35],a[224:227],v[96:99]
mf v[112:115],v[32:35],v[164:167],v[112:115]
s_waitcnt lgkmcnt(0)
tr v[20:21],v8,32768
tr v[22:23],v12,32768
tr v[24:25],v9,32768
tr v[26:27],v13,32768
tr v[28:29],v10,32768
tr v[30:31],v14,32768
tr v[32:33],v11,32768
tr v[34:35],v15,32768
mf v[52:55],v[36:39],a[68:71],v[52:55]
mf v[68:71],v[36:39],a[148:151],v[68:71]
mf v[84:87],v[36:39],a[228:231],v[84:87]
mf v[100:103],v[36:39],v[168:171],v[100:103]
mf v[56:59],v[40:43],a[68:71],v[56:59]
mf v[72:75],v[40:43],a[148:151],v[72:75]
mf v[88:91],v[40:43],a[228:231],v[88:91]
mf v[104:107],v[40:43],v[168:171],v[104:107]
mf v[60:63],v[44:47],a[68:71],v[60:63]
mf v[76:79],v[44:47],a[148:151],v[76:79]
mf v[92:95],v[44:47],a[228:231],v[92:95]
mf v[108:111],v[44:47],v[168:171],v[108:111]
mf v[64:67],v[48:51],a[68:71],v[64:67]
mf v[80:83],v[48:51],a[148:151],v[80:83]
mf v[96:99],v[48:51],a[228:231],v[96:99]
mf v[112:115],v[48:51],v[168:171],v[112:115]
s_waitcnt lgkmcnt(0)
tr v[36:37],v8,36864
tr v[38:39],v12,36864
tr v[40:41],v9,36864
tr v[42:43],v13,36864
tr v[44:45],v10,36864
tr v[46:47],v14,36864
tr v[48:49],v11,36864
tr v[50:51],v15,36864
mf v[52:55],v[20:23],a[72:75],v[52:55]
mf v[68:71],v[20:23],a[152:155],v[68:71]
mf v[84:87],v[20:23],a[232:235],v[84:87]
mf v[100:103],v[20:23],v[172:175],v[100:103]
mf v[56:59],v[24:27],a[72:75],v[56:59]
mf v[72:75],v[24:27],a[152:155],v[72:75]
mf v[88:91],v[24:27],a[232:235],v[88:91]
mf v[104:107],v[24:27],v[172:175],v[104:107]
mf v[60:63],v[28:31],a[72:75],v[60:63]
mf v[76:79],v[28:31],a[152:155],v[76:79]
mf v[92:95],v[28:31],a[232:235],v[92:95]
mf v[108:111],v[28:31],v[172:175],v[108:111]
mf v[64:67],v[32:35],a[72:75],v[64:67]
mf v[80:83],v[32:35],a[152:155],v[80:83]
mf v[96:99],v[32:35],a[232:235],v[96:99]
mf v[112:115],v[32:35],v[172:175],v[112:115]
s_waitcnt lgkmcnt(0)
s_waitcnt vmcnt(12)
s_barrier
s_add_u32 m0,s21,40960
s_mov_b32 s23,384
buffer_load_dwordx4 v6,s[44:47],s23 offen lds
s_add_u32 m0,s21,45056
s_mov_b32 s23,41344
buffer_load_dwordx4 v6,s[44:47],s23 offen lds
s_add_u32 m0,s21,49152
s_mov_b32 s23,82304
buffer_load_dwordx4 v6,s[44:47],s23 offen lds
s_add_u32 m0,s21,53248
s_mov_b32 s23,123264
buffer_load_dwordx4 v6,s[44:47],s23 offen lds
s_add_u32 m0,s21,57344
s_mov_b32 s23,164224
buffer_load_dwordx4 v6,s[44:47],s23 offen lds
s_add_u32 m0,s21,61440
s_mov_b32 s23,205184
buffer_load_dwordx4 v6,s[44:47],s23 offen lds
v_add_u32 v16,81920,v16
v_add_u32 v17,81920,v17
v_add_u32 v18,81920,v18
v_add_u32 v19,81920,v19
tr v[20:21],v16,0
tr v[22:23],v16,2048
tr v[24:25],v17,0
tr v[26:27],v17,2048
tr v[28:29],v18,0
tr v[30:31],v18,2048
tr v[32:33],v19,0
tr v[34:35],v19,2048
mf v[52:55],v[36:39],a[76:79],v[52:55]
mf v[68:71],v[36:39],a[156:159],v[68:71]
mf v[84:87],v[36:39],a[236:239],v[84:87]
mf v[100:103],v[36:39],v[176:179],v[100:103]
mf v[56:59],v[40:43],a[76:79],v[56:59]
mf v[72:75],v[40:43],a[156:159],v[72:75]
mf v[88:91],v[40:43],a[236:239],v[88:91]
mf v[104:107],v[40:43],v[176:179],v[104:107]
mf v[60:63],v[44:47],a[76:79],v[60:63]
mf v[76:79],v[44:47],a[156:159],v[76:79]
mf v[92:95],v[44:47],a[236:239],v[92:95]
mf v[108:111],v[44:47],v[176:179],v[108:111]
mf v[64:67],v[48:51],a[76:79],v[64:67]
mf v[80:83],v[48:51],a[156:159],v[80:83]
mf v[96:99],v[48:51],a[236:239],v[96:99]
mf v[112:115],v[48:51],v[176:179],v[112:115]
s_nop 7
s_nop 1
cv v116,v52,v53
cv v117,v54,v55
cv v118,v56,v57
cv v119,v58,v59
cv v120,v60,v61
cv v121,v62,v63
cv v122,v64,v65
cv v123,v66,v67
cv v124,v68,v69
cv v125,v70,v71
cv v126,v72,v73
cv v127,v74,v75
cv v128,v76,v77
cv v129,v78,v79
cv v130,v80,v81
cv v131,v82,v83
cv v132,v84,v85
cv v133,v86,v87
cv v134,v88,v89
cv v135,v90,v91
cv v136,v92,v93
cv v137,v94,v95
cv v138,v96,v97
cv v139,v98,v99
cv v140,v100,v101
cv v141,v102,v103
cv v142,v104,v105
cv v143,v106,v107
cv v144,v108,v109
cv v145,v110,v111
cv v146,v112,v113
cv v147,v114,v115
s_nop 1
s_mov_b32 s64,5
s_mov_b32 s65,4294844416
s_add_u32 s66,s21,81920
s_mov_b32 s72,512
s_mov_b32 s73,0x7f000000
s_mov_b32 s74,0
t2_kernel_loop:
s_waitcnt lgkmcnt(0)
tr v[36:37],v16,4096
tr v[38:39],v16,6144
tr v[40:41],v17,4096
tr v[42:43],v17,6144
tr v[44:45],v18,4096
tr v[46:47],v18,6144
tr v[48:49],v19,4096
tr v[50:51],v19,6144
mf v[52:55],v[180:183],v[20:23],0
mf v[68:71],v[188:191],v[20:23],0
mf v[84:87],v[196:199],v[20:23],0
mf v[100:103],v[204:207],v[20:23],0
mf v[56:59],v[180:183],v[24:27],0
mf v[72:75],v[188:191],v[24:27],0
mf v[88:91],v[196:199],v[24:27],0
mf v[104:107],v[204:207],v[24:27],0
s_add_u32 s23,s73,0
buffer_store_dwordx4 v[148:151],v249,s[60:63],s23 offen sc1
s_add_u32 s23,s73,1024
buffer_store_dwordx4 v[152:155],v249,s[60:63],s23 offen sc1
mf v[60:63],v[180:183],v[28:31],0
mf v[76:79],v[188:191],v[28:31],0
mf v[92:95],v[196:199],v[28:31],0
mf v[108:111],v[204:207],v[28:31],0
mf v[64:67],v[180:183],v[32:35],0
mf v[80:83],v[188:191],v[32:35],0
mf v[96:99],v[196:199],v[32:35],0
mf v[112:115],v[204:207],v[32:35],0
s_waitcnt lgkmcnt(0)
tr v[20:21],v16,8192
tr v[22:23],v16,10240
tr v[24:25],v17,8192
tr v[26:27],v17,10240
tr v[28:29],v18,8192
tr v[30:31],v18,10240
tr v[32:33],v19,8192
tr v[34:35],v19,10240
mf v[52:55],v[184:187],v[36:39],v[52:55]
mf v[68:71],v[192:195],v[36:39],v[68:71]
mf v[84:87],v[200:203],v[36:39],v[84:87]
mf v[100:103],v[208:211],v[36:39],v[100:103]
mf v[56:59],v[184:187],v[40:43],v[56:59]
mf v[72:75],v[192:195],v[40:43],v[72:75]
mf v[88:91],v[200:203],v[40:43],v[88:91]
mf v[104:107],v[208:211],v[40:43],v[104:107]
s_add_u32 s23,s73,2048
buffer_store_dwordx4 v[156:159],v249,s[60:63],s23 offen sc1
s_add_u32 s23,s73,3072
buffer_store_dwordx4 v[160:163],v249,s[60:63],s23 offen sc1
mf v[60:63],v[184:187],v[44:47],v[60:63]
mf v[76:79],v[192:195],v[44:47],v[76:79]
mf v[92:95],v[200:203],v[44:47],v[92:95]
mf v[108:111],v[208:211],v[44:47],v[108:111]
mf v[64:67],v[184:187],v[48:51],v[64:67]
mf v[80:83],v[192:195],v[48:51],v[80:83]
mf v[96:99],v[200:203],v[48:51],v[96:99]
mf v[112:115],v[208:211],v[48:51],v[112:115]
s_waitcnt lgkmcnt(0)
tr v[36:37],v16,12288
tr v[38:39],v16,14336
tr v[40:41],v17,12288
tr v[42:43],v17,14336
tr v[44:45],v18,12288
tr v[46:47],v18,14336
tr v[48:49],v19,12288
tr v[50:51],v19,14336
mf v[52:55],v[212:215],v[20:23],v[52:55]
mf v[68:71],v[220:223],v[20:23],v[68:71]
mf v[84:87],v[228:231],v[20:23],v[84:87]
mf v[100:103],v[236:239],v[20:23],v[100:103]
mf v[56:59],v[212:215],v[24:27],v[56:59]
mf v[72:75],v[220:223],v[24:27],v[72:75]
mf v[88:91],v[228:231],v[24:27],v[88:91]
mf v[104:107],v[236:239],v[24:27],v[104:107]
s_add_u32 s23,s73,1310720
buffer_store_dwordx4 v[164:167],v249,s[60:63],s23 offen sc1
s_add_u32 s23,s73,1311744
buffer_store_dwordx4 v[168:171],v249,s[60:63],s23 offen sc1
mf v[60:63],v[212:215],v[28:31],v[60:63]
mf v[76:79],v[220:223],v[28:31],v[76:79]
mf v[92:95],v[228:231],v[28:31],v[92:95]
mf v[108:111],v[236:239],v[28:31],v[108:111]
mf v[64:67],v[212:215],v[32:35],v[64:67]
mf v[80:83],v[220:223],v[32:35],v[80:83]
mf v[96:99],v[228:231],v[32:35],v[96:99]
mf v[112:115],v[236:239],v[32:35],v[112:115]
s_waitcnt lgkmcnt(0)
tr v[20:21],v16,16384
tr v[22:23],v16,18432
tr v[24:25],v17,16384
tr v[26:27],v17,18432
tr v[28:29],v18,16384
tr v[30:31],v18,18432
tr v[32:33],v19,16384
tr v[34:35],v19,18432
mf v[52:55],v[216:219],v[36:39],v[52:55]
mf v[68:71],v[224:227],v[36:39],v[68:71]
mf v[84:87],v[232:235],v[36:39],v[84:87]
mf v[100:103],v[240:243],v[36:39],v[100:103]
mf v[56:59],v[216:219],v[40:43],v[56:59]
mf v[72:75],v[224:227],v[40:43],v[72:75]
mf v[88:91],v[232:235],v[40:43],v[88:91]
mf v[104:107],v[240:243],v[40:43],v[104:107]
s_add_u32 s23,s73,1312768
buffer_store_dwordx4 v[172:175],v249,s[60:63],s23 offen sc1
s_add_u32 s23,s73,1313792
buffer_store_dwordx4 v[176:179],v249,s[60:63],s23 offen sc1
mf v[60:63],v[216:219],v[44:47],v[60:63]
mf v[76:79],v[224:227],v[44:47],v[76:79]
mf v[92:95],v[232:235],v[44:47],v[92:95]
mf v[108:111],v[240:243],v[44:47],v[108:111]
mf v[64:67],v[216:219],v[48:51],v[64:67]
mf v[80:83],v[224:227],v[48:51],v[80:83]
mf v[96:99],v[232:235],v[48:51],v[96:99]
mf v[112:115],v[240:243],v[48:51],v[112:115]
s_waitcnt lgkmcnt(0)
tr v[36:37],v16,20480
tr v[38:39],v16,22528
tr v[40:41],v17,20480
tr v[42:43],v17,22528
tr v[44:45],v18,20480
tr v[46:47],v18,22528
tr v[48:49],v19,20480
tr v[50:51],v19,22528
mf v[52:55],v[116:119],v[20:23],v[52:55]
mf v[68:71],v[124:127],v[20:23],v[68:71]
mf v[84:87],v[132:135],v[20:23],v[84:87]
mf v[100:103],v[140:143],v[20:23],v[100:103]
mf v[56:59],v[116:119],v[24:27],v[56:59]
mf v[72:75],v[124:127],v[24:27],v[72:75]
mf v[88:91],v[132:135],v[24:27],v[88:91]
mf v[104:107],v[140:143],v[24:27],v[104:107]
mf v[60:63],v[116:119],v[28:31],v[60:63]
mf v[76:79],v[124:127],v[28:31],v[76:79]
mf v[92:95],v[132:135],v[28:31],v[92:95]
mf v[108:111],v[140:143],v[28:31],v[108:111]
mf v[64:67],v[116:119],v[32:35],v[64:67]
mf v[80:83],v[124:127],v[32:35],v[80:83]
mf v[96:99],v[132:135],v[32:35],v[96:99]
mf v[112:115],v[140:143],v[32:35],v[112:115]
s_waitcnt lgkmcnt(0)
s_waitcnt vmcnt(12)
s_barrier
s_min_u32 s22,s72,1024
s_add_u32 m0,s66,0
s_add_u32 s23,s22,0
buffer_load_dwordx4 v6,s[44:47],s23 offen lds
s_add_u32 m0,s66,4096
s_add_u32 s23,s22,40960
buffer_load_dwordx4 v6,s[44:47],s23 offen lds
s_add_u32 m0,s66,8192
s_add_u32 s23,s22,81920
buffer_load_dwordx4 v6,s[44:47],s23 offen lds
s_add_u32 m0,s66,12288
s_add_u32 s23,s22,122880
buffer_load_dwordx4 v6,s[44:47],s23 offen lds
s_add_u32 m0,s66,16384
s_add_u32 s23,s22,163840
buffer_load_dwordx4 v6,s[44:47],s23 offen lds
s_add_u32 m0,s66,20480
s_add_u32 s23,s22,204800
buffer_load_dwordx4 v6,s[44:47],s23 offen lds
v_add_u32 v16,40960,v16
v_add_u32 v17,40960,v17
v_add_u32 v18,40960,v18
v_add_u32 v19,40960,v19
tr v[20:21],v16,0
tr v[22:23],v16,2048
tr v[24:25],v17,0
tr v[26:27],v17,2048
tr v[28:29],v18,0
tr v[30:31],v18,2048
tr v[32:33],v19,0
tr v[34:35],v19,2048
mf v[52:55],v[120:123],v[36:39],v[52:55]
mf v[68:71],v[128:131],v[36:39],v[68:71]
mf v[84:87],v[136:139],v[36:39],v[84:87]
mf v[100:103],v[144:147],v[36:39],v[100:103]
mf v[56:59],v[120:123],v[40:43],v[56:59]
mf v[72:75],v[128:131],v[40:43],v[72:75]
mf v[88:91],v[136:139],v[40:43],v[88:91]
mf v[104:107],v[144:147],v[40:43],v[104:107]
mf v[60:63],v[120:123],v[44:47],v[60:63]
mf v[76:79],v[128:131],v[44:47],v[76:79]
mf v[92:95],v[136:139],v[44:47],v[92:95]
mf v[108:111],v[144:147],v[44:47],v[108:111]
mf v[64:67],v[120:123],v[48:51],v[64:67]
mf v[80:83],v[128:131],v[48:51],v[80:83]
mf v[96:99],v[136:139],v[48:51],v[96:99]
mf v[112:115],v[144:147],v[48:51],v[112:115]
s_nop 7
s_nop 1
cv v148,v52,v53
cv v149,v54,v55
cv v150,v68,v69
cv v151,v70,v71
cv v152,v56,v57
cv v153,v58,v59
cv v154,v72,v73
cv v155,v74,v75
cv v156,v60,v61
cv v157,v62,v63
cv v158,v76,v77
cv v159,v78,v79
cv v160,v64,v65
cv v161,v66,v67
cv v162,v80,v81
cv v163,v82,v83
cv v164,v84,v85
cv v165,v86,v87
cv v166,v100,v101
cv v167,v102,v103
cv v168,v88,v89
cv v169,v90,v91
cv v170,v104,v105
cv v171,v106,v107
cv v172,v92,v93
cv v173,v94,v95
cv v174,v108,v109
cv v175,v110,v111
cv v176,v96,v97
cv v177,v98,v99
cv v178,v112,v113
cv v179,v114,v115
s_mov_b32 s73,s74
s_add_u32 s74,s74,4096
s_waitcnt lgkmcnt(0)
tr v[36:37],v16,4096
tr v[38:39],v16,6144
tr v[40:41],v17,4096
tr v[42:43],v17,6144
tr v[44:45],v18,4096
tr v[46:47],v18,6144
tr v[48:49],v19,4096
tr v[50:51],v19,6144
mf v[52:55],v[180:183],v[20:23],0
mf v[68:71],v[188:191],v[20:23],0
mf v[84:87],v[196:199],v[20:23],0
mf v[100:103],v[204:207],v[20:23],0
mf v[56:59],v[180:183],v[24:27],0
mf v[72:75],v[188:191],v[24:27],0
mf v[88:91],v[196:199],v[24:27],0
mf v[104:107],v[204:207],v[24:27],0
s_add_u32 s23,s73,0
buffer_store_dwordx4 v[148:151],v249,s[60:63],s23 offen sc1
s_add_u32 s23,s73,1024
buffer_store_dwordx4 v[152:155],v249,s[60:63],s23 offen sc1
mf v[60:63],v[180:183],v[28:31],0
mf v[76:79],v[188:191],v[28:31],0
mf v[92:95],v[196:199],v[28:31],0
mf v[108:111],v[204:207],v[28:31],0
mf v[64:67],v[180:183],v[32:35],0
mf v[80:83],v[188:191],v[32:35],0
mf v[96:99],v[196:199],v[32:35],0
mf v[112:115],v[204:207],v[32:35],0
s_waitcnt lgkmcnt(0)
tr v[20:21],v16,8192
tr v[22:23],v16,10240
tr v[24:25],v17,8192
tr v[26:27],v17,10240
tr v[28:29],v18,8192
tr v[30:31],v18,10240
tr v[32:33],v19,8192
tr v[34:35],v19,10240
mf v[52:55],v[184:187],v[36:39],v[52:55]
mf v[68:71],v[192:195],v[36:39],v[68:71]
mf v[84:87],v[200:203],v[36:39],v[84:87]
mf v[100:103],v[208:211],v[36:39],v[100:103]
mf v[56:59],v[184:187],v[40:43],v[56:59]
mf v[72:75],v[192:195],v[40:43],v[72:75]
mf v[88:91],v[200:203],v[40:43],v[88:91]
mf v[104:107],v[208:211],v[40:43],v[104:107]
s_add_u32 s23,s73,2048
buffer_store_dwordx4 v[156:159],v249,s[60:63],s23 offen sc1
s_add_u32 s23,s73,3072
buffer_store_dwordx4 v[160:163],v249,s[60:63],s23 offen sc1
mf v[60:63],v[184:187],v[44:47],v[60:63]
mf v[76:79],v[192:195],v[44:47],v[76:79]
mf v[92:95],v[200:203],v[44:47],v[92:95]
mf v[108:111],v[208:211],v[44:47],v[108:111]
mf v[64:67],v[184:187],v[48:51],v[64:67]
mf v[80:83],v[192:195],v[48:51],v[80:83]
mf v[96:99],v[200:203],v[48:51],v[96:99]
mf v[112:115],v[208:211],v[48:51],v[112:115]
s_waitcnt lgkmcnt(0)
tr v[36:37],v16,12288
tr v[38:39],v16,14336
tr v[40:41],v17,12288
tr v[42:43],v17,14336
tr v[44:45],v18,12288
tr v[46:47],v18,14336
tr v[48:49],v19,12288
tr v[50:51],v19,14336
mf v[52:55],v[212:215],v[20:23],v[52:55]
mf v[68:71],v[220:223],v[20:23],v[68:71]
mf v[84:87],v[228:231],v[20:23],v[84:87]
mf v[100:103],v[236:239],v[20:23],v[100:103]
mf v[56:59],v[212:215],v[24:27],v[56:59]
mf v[72:75],v[220:223],v[24:27],v[72:75]
mf v[88:91],v[228:231],v[24:27],v[88:91]
mf v[104:107],v[236:239],v[24:27],v[104:107]
s_add_u32 s23,s73,1310720
buffer_store_dwordx4 v[164:167],v249,s[60:63],s23 offen sc1
s_add_u32 s23,s73,1311744
buffer_store_dwordx4 v[168:171],v249,s[60:63],s23 offen sc1
mf v[60:63],v[212:215],v[28:31],v[60:63]
mf v[76:79],v[220:223],v[28:31],v[76:79]
mf v[92:95],v[228:231],v[28:31],v[92:95]
mf v[108:111],v[236:239],v[28:31],v[108:111]
mf v[64:67],v[212:215],v[32:35],v[64:67]
mf v[80:83],v[220:223],v[32:35],v[80:83]
mf v[96:99],v[228:231],v[32:35],v[96:99]
mf v[112:115],v[236:239],v[32:35],v[112:115]
s_waitcnt lgkmcnt(0)
tr v[20:21],v16,16384
tr v[22:23],v16,18432
tr v[24:25],v17,16384
tr v[26:27],v17,18432
tr v[28:29],v18,16384
tr v[30:31],v18,18432
tr v[32:33],v19,16384
tr v[34:35],v19,18432
mf v[52:55],v[216:219],v[36:39],v[52:55]
mf v[68:71],v[224:227],v[36:39],v[68:71]
mf v[84:87],v[232:235],v[36:39],v[84:87]
mf v[100:103],v[240:243],v[36:39],v[100:103]
mf v[56:59],v[216:219],v[40:43],v[56:59]
mf v[72:75],v[224:227],v[40:43],v[72:75]
mf v[88:91],v[232:235],v[40:43],v[88:91]
mf v[104:107],v[240:243],v[40:43],v[104:107]
s_add_u32 s23,s73,1312768
buffer_store_dwordx4 v[172:175],v249,s[60:63],s23 offen sc1
s_add_u32 s23,s73,1313792
buffer_store_dwordx4 v[176:179],v249,s[60:63],s23 offen sc1
mf v[60:63],v[216:219],v[44:47],v[60:63]
mf v[76:79],v[224:227],v[44:47],v[76:79]
mf v[92:95],v[232:235],v[44:47],v[92:95]
mf v[108:111],v[240:243],v[44:47],v[108:111]
mf v[64:67],v[216:219],v[48:51],v[64:67]
mf v[80:83],v[224:227],v[48:51],v[80:83]
mf v[96:99],v[232:235],v[48:51],v[96:99]
mf v[112:115],v[240:243],v[48:51],v[112:115]
s_waitcnt lgkmcnt(0)
tr v[36:37],v16,20480
tr v[38:39],v16,22528
tr v[40:41],v17,20480
tr v[42:43],v17,22528
tr v[44:45],v18,20480
tr v[46:47],v18,22528
tr v[48:49],v19,20480
tr v[50:51],v19,22528
mf v[52:55],v[116:119],v[20:23],v[52:55]
mf v[68:71],v[124:127],v[20:23],v[68:71]
mf v[84:87],v[132:135],v[20:23],v[84:87]
mf v[100:103],v[140:143],v[20:23],v[100:103]
mf v[56:59],v[116:119],v[24:27],v[56:59]
mf v[72:75],v[124:127],v[24:27],v[72:75]
mf v[88:91],v[132:135],v[24:27],v[88:91]
mf v[104:107],v[140:143],v[24:27],v[104:107]
mf v[60:63],v[116:119],v[28:31],v[60:63]
mf v[76:79],v[124:127],v[28:31],v[76:79]
mf v[92:95],v[132:135],v[28:31],v[92:95]
mf v[108:111],v[140:143],v[28:31],v[108:111]
mf v[64:67],v[116:119],v[32:35],v[64:67]
mf v[80:83],v[124:127],v[32:35],v[80:83]
mf v[96:99],v[132:135],v[32:35],v[96:99]
mf v[112:115],v[140:143],v[32:35],v[112:115]
s_waitcnt lgkmcnt(0)
s_waitcnt vmcnt(12)
s_barrier
s_min_u32 s22,s72,1024
s_add_u32 m0,s66,40960
s_add_u32 s23,s22,128
buffer_load_dwordx4 v6,s[44:47],s23 offen lds
s_add_u32 m0,s66,45056
s_add_u32 s23,s22,41088
buffer_load_dwordx4 v6,s[44:47],s23 offen lds
s_add_u32 m0,s66,49152
s_add_u32 s23,s22,82048
buffer_load_dwordx4 v6,s[44:47],s23 offen lds
s_add_u32 m0,s66,53248
s_add_u32 s23,s22,123008
buffer_load_dwordx4 v6,s[44:47],s23 offen lds
s_add_u32 m0,s66,57344
s_add_u32 s23,s22,163968
buffer_load_dwordx4 v6,s[44:47],s23 offen lds
s_add_u32 m0,s66,61440
s_add_u32 s23,s22,204928
buffer_load_dwordx4 v6,s[44:47],s23 offen lds
s_add_u32 s72,s72,256
v_add_u32 v16,s65,v16
v_add_u32 v17,s65,v17
v_add_u32 v18,s65,v18
v_add_u32 v19,s65,v19
tr v[20:21],v16,0
tr v[22:23],v16,2048
tr v[24:25],v17,0
tr v[26:27],v17,2048
tr v[28:29],v18,0
tr v[30:31],v18,2048
tr v[32:33],v19,0
tr v[34:35],v19,2048
mf v[52:55],v[120:123],v[36:39],v[52:55]
mf v[68:71],v[128:131],v[36:39],v[68:71]
mf v[84:87],v[136:139],v[36:39],v[84:87]
mf v[100:103],v[144:147],v[36:39],v[100:103]
mf v[56:59],v[120:123],v[40:43],v[56:59]
mf v[72:75],v[128:131],v[40:43],v[72:75]
mf v[88:91],v[136:139],v[40:43],v[88:91]
mf v[104:107],v[144:147],v[40:43],v[104:107]
mf v[60:63],v[120:123],v[44:47],v[60:63]
mf v[76:79],v[128:131],v[44:47],v[76:79]
mf v[92:95],v[136:139],v[44:47],v[92:95]
mf v[108:111],v[144:147],v[44:47],v[108:111]
mf v[64:67],v[120:123],v[48:51],v[64:67]
mf v[80:83],v[128:131],v[48:51],v[80:83]
mf v[96:99],v[136:139],v[48:51],v[96:99]
mf v[112:115],v[144:147],v[48:51],v[112:115]
s_nop 7
s_nop 1
cv v148,v52,v53
cv v149,v54,v55
cv v150,v68,v69
cv v151,v70,v71
cv v152,v56,v57
cv v153,v58,v59
cv v154,v72,v73
cv v155,v74,v75
cv v156,v60,v61
cv v157,v62,v63
cv v158,v76,v77
cv v159,v78,v79
cv v160,v64,v65
cv v161,v66,v67
cv v162,v80,v81
cv v163,v82,v83
cv v164,v84,v85
cv v165,v86,v87
cv v166,v100,v101
cv v167,v102,v103
cv v168,v88,v89
cv v169,v90,v91
cv v170,v104,v105
cv v171,v106,v107
cv v172,v92,v93
cv v173,v94,v95
cv v174,v108,v109
cv v175,v110,v111
cv v176,v96,v97
cv v177,v98,v99
cv v178,v112,v113
cv v179,v114,v115
s_mov_b32 s73,s74
s_add_u32 s74,s74,4096
s_sub_u32 s65,4294885376,s65
s_xor_b32 s66,s66,81920
s_sub_u32 s64,s64,1
s_cmp_lg_u32 s64,0
s_cbranch_scc1 t2_kernel_loop
s_add_u32 s23,s73,0
buffer_store_dwordx4 v[148:151],v249,s[60:63],s23 offen sc1
s_add_u32 s23,s73,1024
buffer_store_dwordx4 v[152:155],v249,s[60:63],s23 offen sc1
s_add_u32 s23,s73,2048
buffer_store_dwordx4 v[156:159],v249,s[60:63],s23 offen sc1
s_add_u32 s23,s73,3072
buffer_store_dwordx4 v[160:163],v249,s[60:63],s23 offen sc1
s_add_u32 s23,s73,1310720
buffer_store_dwordx4 v[164:167],v249,s[60:63],s23 offen sc1
s_add_u32 s23,s73,1311744
buffer_store_dwordx4 v[168:171],v249,s[60:63],s23 offen sc1
s_add_u32 s23,s73,1312768
buffer_store_dwordx4 v[172:175],v249,s[60:63],s23 offen sc1
s_add_u32 s23,s73,1313792
buffer_store_dwordx4 v[176:179],v249,s[60:63],s23 offen sc1
s_branch task_done
t1_kernel_entry:
s_load_dwordx4 s[4:7],s[0:1],16
s_load_dwordx4 s[8:11],s[0:1],32
s_load_dwordx2 s[12:13],s[0:1],128
v_and_b32 v1,63,v0
v_lshrrev_b32 v2,4,v1
v_and_b32 v3,15,v0
v_lshrrev_b32 v4,6,v0
s_nop 0
v_readfirstlane_b32 s20,v4
s_nop 3
s_lshl_b32 s21,s20,10
v_bfe_u32 v5,v1,2,2
v_lshl_add_u32 v6,v2,3,v5
v_lshlrev_b32 v6,7,v6
v_and_b32 v7,3,v1
v_lshl_add_u32 v6,v7,3,v6
v_lshrrev_b32 v5,1,v5
v_and_b32 v7,1,v2
v_xor_b32 v11,0,v7
v_lshl_or_b32 v11,v11,1,v5
v_xor_b32 v8,0,v11
v_lshl_add_u32 v8,v8,5,v6
v_xor_b32 v9,1,v11
v_lshl_add_u32 v9,v9,5,v6
v_xor_b32 v10,2,v11
v_lshl_add_u32 v10,v10,5,v6
v_xor_b32 v11,3,v11
v_lshl_add_u32 v11,v11,5,v6
v_xor_b32 v15,1,v7
v_lshl_or_b32 v15,v15,1,v5
v_xor_b32 v12,0,v15
v_lshl_add_u32 v12,v12,5,v6
v_add_u32 v12,512,v12
v_xor_b32 v13,1,v15
v_lshl_add_u32 v13,v13,5,v6
v_add_u32 v13,512,v13
v_xor_b32 v14,2,v15
v_lshl_add_u32 v14,v14,5,v6
v_add_u32 v14,512,v14
v_xor_b32 v15,3,v15
v_lshl_add_u32 v15,v15,5,v6
v_add_u32 v15,512,v15
v_bfe_u32 v5,v1,2,2
v_lshl_add_u32 v6,v2,2,v5
v_lshlrev_b32 v6,7,v6
v_and_b32 v7,3,v1
v_lshl_add_u32 v6,v7,3,v6
v_lshrrev_b32 v5,1,v5
v_lshrrev_b32 v7,1,v2
v_xor_b32 v7,v7,v2
v_and_b32 v7,1,v7
v_lshl_or_b32 v19,v7,1,v5
v_xor_b32 v16,0,v19
v_lshl_add_u32 v16,v16,5,v6
v_xor_b32 v17,1,v19
v_lshl_add_u32 v17,v17,5,v6
v_xor_b32 v18,2,v19
v_lshl_add_u32 v18,v18,5,v6
v_xor_b32 v19,3,v19
v_lshl_add_u32 v19,v19,5,v6
s_and_b32 s24,s2,31
s_lshr_b32 s25,s2,5
s_waitcnt lgkmcnt(0)
s_mul_i32 s26,s24,384
s_sub_u32 s27,7864320,s26
s_lshl_b32 s29,s25,2
s_add_u32 s29,s29,s20
s_mul_i32 s30,s29,81920
s_add_u32 s30,s30,26214400
s_add_u32 s48,s12,s30
s_addc_u32 s49,s13,0
s_mov_b32 s50,0x14000
s_mov_b32 s51,0x00020000
v_lshrrev_b32 v244,3,v1
v_lshl_add_u32 v245,v4,3,v244
v_bfe_u32 v246,v245,1,1
v_lshrrev_b32 v5,2,v245
v_lshrrev_b32 v244,3,v245
v_xor_b32 v5,v5,v244
v_and_b32 v5,1,v5
v_lshl_or_b32 v246,v5,1,v246
v_bfe_u32 v244,v1,1,2
v_xor_b32 v246,v246,v244
v_and_b32 v244,1,v1
v_lshl_or_b32 v246,v246,1,v244
v_lshlrev_b32 v246,4,v246
s_mov_b32 s22,12288
v_mul_lo_u32 v5,s22,v245
v_add_u32 v5,v5,v246
v_lshrrev_b32 v244,3,v1
v_lshl_add_u32 v245,v4,3,v244
v_bfe_u32 v246,v245,1,1
v_lshrrev_b32 v6,2,v245
v_lshrrev_b32 v244,3,v245
v_xor_b32 v6,v6,v244
v_and_b32 v6,1,v6
v_lshl_or_b32 v246,v6,1,v246
v_bfe_u32 v244,v1,1,2
v_xor_b32 v246,v246,v244
v_and_b32 v244,1,v1
v_lshl_or_b32 v246,v246,1,v244
v_lshlrev_b32 v246,4,v246
s_mov_b32 s22,1280
v_mul_lo_u32 v6,s22,v245
v_add_u32 v6,v6,v246
v_lshrrev_b32 v244,2,v3
v_and_b32 v245,3,v3
v_lshl_add_u32 v244,v244,3,v245
v_lshlrev_b32 v245,4,v2
v_mul_u32_u24 v247,1280,v244
v_add_u32 v247,v247,v245
v_mul_u32_u24 v248,12288,v244
v_add_u32 v248,v248,v245
v_lshl_add_u32 v249,v3,6,v245
v_lshlrev_b32 v250,4,v1
s_add_u32 s32,s4,s26
s_addc_u32 s33,s5,0
s_mov_b32 s34,s27
s_mov_b32 s35,0x00020000
s_add_u32 s36,s6,s26
s_addc_u32 s37,s7,0
s_mov_b32 s38,s27
s_mov_b32 s39,0x00020000
s_mul_i32 s30,s29,786432
s_add_u32 s30,s30,s26
s_add_u32 s30,s30,33554432
s_add_u32 s52,s12,s30
s_addc_u32 s53,s13,0
s_mov_b32 s54,0x18c0000
s_mov_b32 s55,0x00020000
s_mov_b32 s23,0
buffer_load_dwordx4 a[0:3],v250,s[48:51],s23 offen
s_mov_b32 s23,1024
buffer_load_dwordx4 a[4:7],v250,s[48:51],s23 offen
s_mov_b32 s23,2048
buffer_load_dwordx4 a[8:11],v250,s[48:51],s23 offen
s_mov_b32 s23,3072
buffer_load_dwordx4 a[12:15],v250,s[48:51],s23 offen
s_mov_b32 s23,4096
buffer_load_dwordx4 a[16:19],v250,s[48:51],s23 offen
s_mov_b32 s23,5120
buffer_load_dwordx4 a[20:23],v250,s[48:51],s23 offen
s_mov_b32 s23,6144
buffer_load_dwordx4 a[24:27],v250,s[48:51],s23 offen
s_mov_b32 s23,7168
buffer_load_dwordx4 a[28:31],v250,s[48:51],s23 offen
s_mov_b32 s23,8192
buffer_load_dwordx4 a[32:35],v250,s[48:51],s23 offen
s_mov_b32 s23,9216
buffer_load_dwordx4 a[36:39],v250,s[48:51],s23 offen
s_mov_b32 s23,10240
buffer_load_dwordx4 a[40:43],v250,s[48:51],s23 offen
s_mov_b32 s23,11264
buffer_load_dwordx4 a[44:47],v250,s[48:51],s23 offen
s_mov_b32 s23,12288
buffer_load_dwordx4 a[48:51],v250,s[48:51],s23 offen
s_mov_b32 s23,13312
buffer_load_dwordx4 a[52:55],v250,s[48:51],s23 offen
s_mov_b32 s23,14336
buffer_load_dwordx4 a[56:59],v250,s[48:51],s23 offen
s_mov_b32 s23,15360
buffer_load_dwordx4 a[60:63],v250,s[48:51],s23 offen
s_mov_b32 s23,16384
buffer_load_dwordx4 a[64:67],v250,s[48:51],s23 offen
s_mov_b32 s23,17408
buffer_load_dwordx4 a[68:71],v250,s[48:51],s23 offen
s_mov_b32 s23,18432
buffer_load_dwordx4 a[72:75],v250,s[48:51],s23 offen
s_mov_b32 s23,19456
buffer_load_dwordx4 a[76:79],v250,s[48:51],s23 offen
s_mov_b32 s23,20480
buffer_load_dwordx4 a[80:83],v250,s[48:51],s23 offen
s_mov_b32 s23,21504
buffer_load_dwordx4 a[84:87],v250,s[48:51],s23 offen
s_mov_b32 s23,22528
buffer_load_dwordx4 a[88:91],v250,s[48:51],s23 offen
s_mov_b32 s23,23552
buffer_load_dwordx4 a[92:95],v250,s[48:51],s23 offen
s_mov_b32 s23,24576
buffer_load_dwordx4 a[96:99],v250,s[48:51],s23 offen
s_mov_b32 s23,25600
buffer_load_dwordx4 a[100:103],v250,s[48:51],s23 offen
s_mov_b32 s23,26624
buffer_load_dwordx4 a[104:107],v250,s[48:51],s23 offen
s_mov_b32 s23,27648
buffer_load_dwordx4 a[108:111],v250,s[48:51],s23 offen
s_mov_b32 s23,28672
buffer_load_dwordx4 a[112:115],v250,s[48:51],s23 offen
s_mov_b32 s23,29696
buffer_load_dwordx4 a[116:119],v250,s[48:51],s23 offen
s_mov_b32 s23,30720
buffer_load_dwordx4 a[120:123],v250,s[48:51],s23 offen
s_mov_b32 s23,31744
buffer_load_dwordx4 a[124:127],v250,s[48:51],s23 offen
s_mov_b32 s23,32768
buffer_load_dwordx4 a[128:131],v250,s[48:51],s23 offen
s_mov_b32 s23,33792
buffer_load_dwordx4 a[132:135],v250,s[48:51],s23 offen
s_mov_b32 s23,34816
buffer_load_dwordx4 a[136:139],v250,s[48:51],s23 offen
s_mov_b32 s23,35840
buffer_load_dwordx4 a[140:143],v250,s[48:51],s23 offen
s_mov_b32 s23,36864
buffer_load_dwordx4 a[144:147],v250,s[48:51],s23 offen
s_mov_b32 s23,37888
buffer_load_dwordx4 a[148:151],v250,s[48:51],s23 offen
s_mov_b32 s23,38912
buffer_load_dwordx4 a[152:155],v250,s[48:51],s23 offen
s_mov_b32 s23,39936
buffer_load_dwordx4 a[156:159],v250,s[48:51],s23 offen
s_mov_b32 s23,40960
buffer_load_dwordx4 a[160:163],v250,s[48:51],s23 offen
s_mov_b32 s23,41984
buffer_load_dwordx4 a[164:167],v250,s[48:51],s23 offen
s_mov_b32 s23,43008
buffer_load_dwordx4 a[168:171],v250,s[48:51],s23 offen
s_mov_b32 s23,44032
buffer_load_dwordx4 a[172:175],v250,s[48:51],s23 offen
s_mov_b32 s23,45056
buffer_load_dwordx4 a[176:179],v250,s[48:51],s23 offen
s_mov_b32 s23,46080
buffer_load_dwordx4 a[180:183],v250,s[48:51],s23 offen
s_mov_b32 s23,47104
buffer_load_dwordx4 a[184:187],v250,s[48:51],s23 offen
s_mov_b32 s23,48128
buffer_load_dwordx4 a[188:191],v250,s[48:51],s23 offen
s_mov_b32 s23,49152
buffer_load_dwordx4 a[192:195],v250,s[48:51],s23 offen
s_mov_b32 s23,50176
buffer_load_dwordx4 a[196:199],v250,s[48:51],s23 offen
s_mov_b32 s23,51200
buffer_load_dwordx4 a[200:203],v250,s[48:51],s23 offen
s_mov_b32 s23,52224
buffer_load_dwordx4 a[204:207],v250,s[48:51],s23 offen
s_mov_b32 s23,53248
buffer_load_dwordx4 a[208:211],v250,s[48:51],s23 offen
s_mov_b32 s23,54272
buffer_load_dwordx4 a[212:215],v250,s[48:51],s23 offen
s_mov_b32 s23,55296
buffer_load_dwordx4 a[216:219],v250,s[48:51],s23 offen
s_mov_b32 s23,56320
buffer_load_dwordx4 a[220:223],v250,s[48:51],s23 offen
s_mov_b32 s23,57344
buffer_load_dwordx4 a[224:227],v250,s[48:51],s23 offen
s_mov_b32 s23,58368
buffer_load_dwordx4 a[228:231],v250,s[48:51],s23 offen
s_mov_b32 s23,59392
buffer_load_dwordx4 a[232:235],v250,s[48:51],s23 offen
s_mov_b32 s23,60416
buffer_load_dwordx4 a[236:239],v250,s[48:51],s23 offen
s_mov_b32 s23,61440
buffer_load_dwordx4 a[240:243],v250,s[48:51],s23 offen
s_mov_b32 s23,62464
buffer_load_dwordx4 a[244:247],v250,s[48:51],s23 offen
s_mov_b32 s23,63488
buffer_load_dwordx4 a[248:251],v250,s[48:51],s23 offen
s_mov_b32 s23,64512
buffer_load_dwordx4 a[252:255],v250,s[48:51],s23 offen
s_mov_b32 s23,65536
buffer_load_dwordx4 v[116:119],v250,s[48:51],s23 offen
s_mov_b32 s23,66560
buffer_load_dwordx4 v[120:123],v250,s[48:51],s23 offen
s_mov_b32 s23,67584
buffer_load_dwordx4 v[124:127],v250,s[48:51],s23 offen
s_mov_b32 s23,68608
buffer_load_dwordx4 v[128:131],v250,s[48:51],s23 offen
s_mov_b32 s23,69632
buffer_load_dwordx4 v[132:135],v250,s[48:51],s23 offen
s_mov_b32 s23,70656
buffer_load_dwordx4 v[136:139],v250,s[48:51],s23 offen
s_mov_b32 s23,71680
buffer_load_dwordx4 v[140:143],v250,s[48:51],s23 offen
s_mov_b32 s23,72704
buffer_load_dwordx4 v[144:147],v250,s[48:51],s23 offen
s_mov_b32 s23,73728
buffer_load_dwordx4 v[148:151],v250,s[48:51],s23 offen
s_mov_b32 s23,74752
buffer_load_dwordx4 v[152:155],v250,s[48:51],s23 offen
s_mov_b32 s23,75776
buffer_load_dwordx4 v[156:159],v250,s[48:51],s23 offen
s_mov_b32 s23,76800
buffer_load_dwordx4 v[160:163],v250,s[48:51],s23 offen
s_mov_b32 s23,77824
buffer_load_dwordx4 v[164:167],v250,s[48:51],s23 offen
s_mov_b32 s23,78848
buffer_load_dwordx4 v[168:171],v250,s[48:51],s23 offen
s_mov_b32 s23,79872
buffer_load_dwordx4 v[172:175],v250,s[48:51],s23 offen
s_mov_b32 s23,80896
buffer_load_dwordx4 v[176:179],v250,s[48:51],s23 offen
s_add_u32 m0,s21,0
s_mov_b32 s23,0
buffer_load_dwordx4 v5,s[36:39],s23 offen lds
s_add_u32 m0,s21,4096
s_mov_b32 s23,393216
buffer_load_dwordx4 v5,s[36:39],s23 offen lds
s_add_u32 m0,s21,8192
s_mov_b32 s23,786432
buffer_load_dwordx4 v5,s[36:39],s23 offen lds
s_add_u32 m0,s21,12288
s_mov_b32 s23,1179648
buffer_load_dwordx4 v5,s[36:39],s23 offen lds
s_add_u32 m0,s21,16384
s_mov_b32 s23,1572864
buffer_load_dwordx4 v5,s[36:39],s23 offen lds
s_add_u32 m0,s21,20480
s_mov_b32 s23,1966080
buffer_load_dwordx4 v5,s[36:39],s23 offen lds
s_add_u32 m0,s21,24576
s_mov_b32 s23,2359296
buffer_load_dwordx4 v5,s[36:39],s23 offen lds
s_add_u32 m0,s21,28672
s_mov_b32 s23,2752512
buffer_load_dwordx4 v5,s[36:39],s23 offen lds
s_add_u32 m0,s21,32768
s_mov_b32 s23,3145728
buffer_load_dwordx4 v5,s[36:39],s23 offen lds
s_add_u32 m0,s21,36864
s_mov_b32 s23,3538944
buffer_load_dwordx4 v5,s[36:39],s23 offen lds
s_add_u32 m0,s21,40960
s_mov_b32 s23,3932160
buffer_load_dwordx4 v5,s[36:39],s23 offen lds
s_add_u32 m0,s21,45056
s_mov_b32 s23,4325376
buffer_load_dwordx4 v5,s[36:39],s23 offen lds
s_add_u32 m0,s21,49152
s_mov_b32 s23,4718592
buffer_load_dwordx4 v5,s[36:39],s23 offen lds
s_add_u32 m0,s21,53248
s_mov_b32 s23,5111808
buffer_load_dwordx4 v5,s[36:39],s23 offen lds
s_add_u32 m0,s21,57344
s_mov_b32 s23,5505024
buffer_load_dwordx4 v5,s[36:39],s23 offen lds
s_add_u32 m0,s21,61440
s_mov_b32 s23,5898240
buffer_load_dwordx4 v5,s[36:39],s23 offen lds
s_add_u32 m0,s21,65536
s_mov_b32 s23,6291456
buffer_load_dwordx4 v5,s[36:39],s23 offen lds
s_add_u32 m0,s21,69632
s_mov_b32 s23,6684672
buffer_load_dwordx4 v5,s[36:39],s23 offen lds
s_add_u32 m0,s21,73728
s_mov_b32 s23,7077888
buffer_load_dwordx4 v5,s[36:39],s23 offen lds
s_add_u32 m0,s21,77824
s_mov_b32 s23,7471104
buffer_load_dwordx4 v5,s[36:39],s23 offen lds
s_add_u32 m0,s21,81920
s_mov_b32 s23,128
buffer_load_dwordx4 v5,s[36:39],s23 offen lds
s_add_u32 m0,s21,86016
s_mov_b32 s23,393344
buffer_load_dwordx4 v5,s[36:39],s23 offen lds
s_add_u32 m0,s21,90112
s_mov_b32 s23,786560
buffer_load_dwordx4 v5,s[36:39],s23 offen lds
s_add_u32 m0,s21,94208
s_mov_b32 s23,1179776
buffer_load_dwordx4 v5,s[36:39],s23 offen lds
s_add_u32 m0,s21,98304
s_mov_b32 s23,1572992
buffer_load_dwordx4 v5,s[36:39],s23 offen lds
s_add_u32 m0,s21,102400
s_mov_b32 s23,1966208
buffer_load_dwordx4 v5,s[36:39],s23 offen lds
s_add_u32 m0,s21,106496
s_mov_b32 s23,2359424
buffer_load_dwordx4 v5,s[36:39],s23 offen lds
s_add_u32 m0,s21,110592
s_mov_b32 s23,2752640
buffer_load_dwordx4 v5,s[36:39],s23 offen lds
s_add_u32 m0,s21,114688
s_mov_b32 s23,3145856
buffer_load_dwordx4 v5,s[36:39],s23 offen lds
s_add_u32 m0,s21,118784
s_mov_b32 s23,3539072
buffer_load_dwordx4 v5,s[36:39],s23 offen lds
s_add_u32 m0,s21,122880
s_mov_b32 s23,3932288
buffer_load_dwordx4 v5,s[36:39],s23 offen lds
s_add_u32 m0,s21,126976
s_mov_b32 s23,4325504
buffer_load_dwordx4 v5,s[36:39],s23 offen lds
s_add_u32 m0,s21,131072
s_mov_b32 s23,4718720
buffer_load_dwordx4 v5,s[36:39],s23 offen lds
s_add_u32 m0,s21,135168
s_mov_b32 s23,5111936
buffer_load_dwordx4 v5,s[36:39],s23 offen lds
s_add_u32 m0,s21,139264
s_mov_b32 s23,5505152
buffer_load_dwordx4 v5,s[36:39],s23 offen lds
s_add_u32 m0,s21,143360
s_mov_b32 s23,5898368
buffer_load_dwordx4 v5,s[36:39],s23 offen lds
s_add_u32 m0,s21,147456
s_mov_b32 s23,6291584
buffer_load_dwordx4 v5,s[36:39],s23 offen lds
s_add_u32 m0,s21,151552
s_mov_b32 s23,6684800
buffer_load_dwordx4 v5,s[36:39],s23 offen lds
s_add_u32 m0,s21,155648
s_mov_b32 s23,7078016
buffer_load_dwordx4 v5,s[36:39],s23 offen lds
s_add_u32 m0,s21,159744
s_mov_b32 s23,7471232
buffer_load_dwordx4 v5,s[36:39],s23 offen lds
s_mov_b32 s64,6
s_mov_b32 s65,40960
s_mov_b32 s66,s21
s_mov_b32 s72,2
s_mov_b32 s73,0x7f000000
s_mov_b32 s74,0
s_waitcnt vmcnt(30)
s_barrier
tr v[20:21],v8,0
tr v[22:23],v12,0
tr v[24:25],v9,0
tr v[26:27],v13,0
tr v[28:29],v10,0
tr v[30:31],v14,0
tr v[32:33],v11,0
tr v[34:35],v15,0
t1_kernel_loop:
s_min_u32 s23,s72,5
s_cmp_lt_u32 s23,3
s_cselect_b32 s68,s36,s32
s_cselect_b32 s69,s37,s33
s_mov_b32 s70,s34
s_mov_b32 s71,0x00020000
s_cselect_b32 s22,0,3
s_sub_u32 s67,s23,s22
s_lshl_b32 s67,s67,7
s_add_u32 s72,s72,1
s_waitcnt lgkmcnt(0)
tr v[36:37],v8,4096
tr v[38:39],v12,4096
tr v[40:41],v9,4096
tr v[42:43],v13,4096
tr v[44:45],v10,4096
tr v[46:47],v14,4096
tr v[48:49],v11,4096
tr v[50:51],v15,4096
mf v[52:55],v[20:23],a[0:3],0
mf v[68:71],v[20:23],a[80:83],0
mf v[84:87],v[20:23],a[160:163],0
mf v[100:103],v[20:23],a[240:243],0
mf v[56:59],v[24:27],a[0:3],0
mf v[72:75],v[24:27],a[80:83],0
mf v[88:91],v[24:27],a[160:163],0
mf v[104:107],v[24:27],a[240:243],0
s_add_u32 s23,s73,0
buffer_store_dwordx4 v[180:183],v248,s[52:55],s23 offen sc1
mf v[60:63],v[28:31],a[0:3],0
mf v[76:79],v[28:31],a[80:83],0
mf v[92:95],v[28:31],a[160:163],0
mf v[108:111],v[28:31],a[240:243],0
mf v[64:67],v[32:35],a[0:3],0
mf v[80:83],v[32:35],a[80:83],0
mf v[96:99],v[32:35],a[160:163],0
mf v[112:115],v[32:35],a[240:243],0
s_waitcnt lgkmcnt(0)
tr v[20:21],v8,8192
tr v[22:23],v12,8192
tr v[24:25],v9,8192
tr v[26:27],v13,8192
tr v[28:29],v10,8192
tr v[30:31],v14,8192
tr v[32:33],v11,8192
tr v[34:35],v15,8192
mf v[52:55],v[36:39],a[4:7],v[52:55]
mf v[68:71],v[36:39],a[84:87],v[68:71]
mf v[84:87],v[36:39],a[164:167],v[84:87]
mf v[100:103],v[36:39],a[244:247],v[100:103]
mf v[56:59],v[40:43],a[4:7],v[56:59]
mf v[72:75],v[40:43],a[84:87],v[72:75]
mf v[88:91],v[40:43],a[164:167],v[88:91]
mf v[104:107],v[40:43],a[244:247],v[104:107]
s_add_u32 s23,s73,64
buffer_store_dwordx4 v[184:187],v248,s[52:55],s23 offen sc1
mf v[60:63],v[44:47],a[4:7],v[60:63]
mf v[76:79],v[44:47],a[84:87],v[76:79]
mf v[92:95],v[44:47],a[164:167],v[92:95]
mf v[108:111],v[44:47],a[244:247],v[108:111]
mf v[64:67],v[48:51],a[4:7],v[64:67]
mf v[80:83],v[48:51],a[84:87],v[80:83]
mf v[96:99],v[48:51],a[164:167],v[96:99]
mf v[112:115],v[48:51],a[244:247],v[112:115]
s_waitcnt lgkmcnt(0)
tr v[36:37],v8,12288
tr v[38:39],v12,12288
tr v[40:41],v9,12288
tr v[42:43],v13,12288
tr v[44:45],v10,12288
tr v[46:47],v14,12288
tr v[48:49],v11,12288
tr v[50:51],v15,12288
mf v[52:55],v[20:23],a[8:11],v[52:55]
mf v[68:71],v[20:23],a[88:91],v[68:71]
mf v[84:87],v[20:23],a[168:171],v[84:87]
mf v[100:103],v[20:23],a[248:251],v[100:103]
mf v[56:59],v[24:27],a[8:11],v[56:59]
mf v[72:75],v[24:27],a[88:91],v[72:75]
mf v[88:91],v[24:27],a[168:171],v[88:91]
mf v[104:107],v[24:27],a[248:251],v[104:107]
s_add_u32 s23,s73,49152
buffer_store_dwordx4 v[188:191],v248,s[52:55],s23 offen sc1
mf v[60:63],v[28:31],a[8:11],v[60:63]
mf v[76:79],v[28:31],a[88:91],v[76:79]
mf v[92:95],v[28:31],a[168:171],v[92:95]
mf v[108:111],v[28:31],a[248:251],v[108:111]
mf v[64:67],v[32:35],a[8:11],v[64:67]
mf v[80:83],v[32:35],a[88:91],v[80:83]
mf v[96:99],v[32:35],a[168:171],v[96:99]
mf v[112:115],v[32:35],a[248:251],v[112:115]
s_waitcnt lgkmcnt(0)
tr v[20:21],v8,16384
tr v[22:23],v12,16384
tr v[24:25],v9,16384
tr v[26:27],v13,16384
tr v[28:29],v10,16384
tr v[30:31],v14,16384
tr v[32:33],v11,16384
tr v[34:35],v15,16384
mf v[52:55],v[36:39],a[12:15],v[52:55]
mf v[68:71],v[36:39],a[92:95],v[68:71]
mf v[84:87],v[36:39],a[172:175],v[84:87]
mf v[100:103],v[36:39],a[252:255],v[100:103]
mf v[56:59],v[40:43],a[12:15],v[56:59]
mf v[72:75],v[40:43],a[92:95],v[72:75]
mf v[88:91],v[40:43],a[172:175],v[88:91]
mf v[104:107],v[40:43],a[252:255],v[104:107]
s_add_u32 s23,s73,49216
buffer_store_dwordx4 v[192:195],v248,s[52:55],s23 offen sc1
mf v[60:63],v[44:47],a[12:15],v[60:63]
mf v[76:79],v[44:47],a[92:95],v[76:79]
mf v[92:95],v[44:47],a[172:175],v[92:95]
mf v[108:111],v[44:47],a[252:255],v[108:111]
mf v[64:67],v[48:51],a[12:15],v[64:67]
mf v[80:83],v[48:51],a[92:95],v[80:83]
mf v[96:99],v[48:51],a[172:175],v[96:99]
mf v[112:115],v[48:51],a[252:255],v[112:115]
s_waitcnt lgkmcnt(0)
tr v[36:37],v8,20480
tr v[38:39],v12,20480
tr v[40:41],v9,20480
tr v[42:43],v13,20480
tr v[44:45],v10,20480
tr v[46:47],v14,20480
tr v[48:49],v11,20480
tr v[50:51],v15,20480
mf v[52:55],v[20:23],a[16:19],v[52:55]
mf v[68:71],v[20:23],a[96:99],v[68:71]
mf v[84:87],v[20:23],a[176:179],v[84:87]
mf v[100:103],v[20:23],v[116:119],v[100:103]
mf v[56:59],v[24:27],a[16:19],v[56:59]
mf v[72:75],v[24:27],a[96:99],v[72:75]
mf v[88:91],v[24:27],a[176:179],v[88:91]
mf v[104:107],v[24:27],v[116:119],v[104:107]
s_add_u32 s23,s73,393216
buffer_store_dwordx4 v[196:199],v248,s[52:55],s23 offen sc1
mf v[60:63],v[28:31],a[16:19],v[60:63]
mf v[76:79],v[28:31],a[96:99],v[76:79]
mf v[92:95],v[28:31],a[176:179],v[92:95]
mf v[108:111],v[28:31],v[116:119],v[108:111]
mf v[64:67],v[32:35],a[16:19],v[64:67]
mf v[80:83],v[32:35],a[96:99],v[80:83]
mf v[96:99],v[32:35],a[176:179],v[96:99]
mf v[112:115],v[32:35],v[116:119],v[112:115]
s_waitcnt lgkmcnt(0)
tr v[20:21],v8,24576
tr v[22:23],v12,24576
tr v[24:25],v9,24576
tr v[26:27],v13,24576
tr v[28:29],v10,24576
tr v[30:31],v14,24576
tr v[32:33],v11,24576
tr v[34:35],v15,24576
mf v[52:55],v[36:39],a[20:23],v[52:55]
mf v[68:71],v[36:39],a[100:103],v[68:71]
mf v[84:87],v[36:39],a[180:183],v[84:87]
mf v[100:103],v[36:39],v[120:123],v[100:103]
mf v[56:59],v[40:43],a[20:23],v[56:59]
mf v[72:75],v[40:43],a[100:103],v[72:75]
mf v[88:91],v[40:43],a[180:183],v[88:91]
mf v[104:107],v[40:43],v[120:123],v[104:107]
s_add_u32 s23,s73,393280
buffer_store_dwordx4 v[200:203],v248,s[52:55],s23 offen sc1
mf v[60:63],v[44:47],a[20:23],v[60:63]
mf v[76:79],v[44:47],a[100:103],v[76:79]
mf v[92:95],v[44:47],a[180:183],v[92:95]
mf v[108:111],v[44:47],v[120:123],v[108:111]
mf v[64:67],v[48:51],a[20:23],v[64:67]
mf v[80:83],v[48:51],a[100:103],v[80:83]
mf v[96:99],v[48:51],a[180:183],v[96:99]
mf v[112:115],v[48:51],v[120:123],v[112:115]
s_waitcnt lgkmcnt(0)
tr v[36:37],v8,28672
tr v[38:39],v12,28672
tr v[40:41],v9,28672
tr v[42:43],v13,28672
tr v[44:45],v10,28672
tr v[46:47],v14,28672
tr v[48:49],v11,28672
tr v[50:51],v15,28672
mf v[52:55],v[20:23],a[24:27],v[52:55]
mf v[68:71],v[20:23],a[104:107],v[68:71]
mf v[84:87],v[20:23],a[184:187],v[84:87]
mf v[100:103],v[20:23],v[124:127],v[100:103]
mf v[56:59],v[24:27],a[24:27],v[56:59]
mf v[72:75],v[24:27],a[104:107],v[72:75]
mf v[88:91],v[24:27],a[184:187],v[88:91]
mf v[104:107],v[24:27],v[124:127],v[104:107]
s_add_u32 s23,s73,442368
buffer_store_dwordx4 v[204:207],v248,s[52:55],s23 offen sc1
mf v[60:63],v[28:31],a[24:27],v[60:63]
mf v[76:79],v[28:31],a[104:107],v[76:79]
mf v[92:95],v[28:31],a[184:187],v[92:95]
mf v[108:111],v[28:31],v[124:127],v[108:111]
mf v[64:67],v[32:35],a[24:27],v[64:67]
mf v[80:83],v[32:35],a[104:107],v[80:83]
mf v[96:99],v[32:35],a[184:187],v[96:99]
mf v[112:115],v[32:35],v[124:127],v[112:115]
s_waitcnt lgkmcnt(0)
tr v[20:21],v8,32768
tr v[22:23],v12,32768
tr v[24:25],v9,32768
tr v[26:27],v13,32768
tr v[28:29],v10,32768
tr v[30:31],v14,32768
tr v[32:33],v11,32768
tr v[34:35],v15,32768
mf v[52:55],v[36:39],a[28:31],v[52:55]
mf v[68:71],v[36:39],a[108:111],v[68:71]
mf v[84:87],v[36:39],a[188:191],v[84:87]
mf v[100:103],v[36:39],v[128:131],v[100:103]
mf v[56:59],v[40:43],a[28:31],v[56:59]
mf v[72:75],v[40:43],a[108:111],v[72:75]
mf v[88:91],v[40:43],a[188:191],v[88:91]
mf v[104:107],v[40:43],v[128:131],v[104:107]
s_add_u32 s23,s73,442432
buffer_store_dwordx4 v[208:211],v248,s[52:55],s23 offen sc1
mf v[60:63],v[44:47],a[28:31],v[60:63]
mf v[76:79],v[44:47],a[108:111],v[76:79]
mf v[92:95],v[44:47],a[188:191],v[92:95]
mf v[108:111],v[44:47],v[128:131],v[108:111]
mf v[64:67],v[48:51],a[28:31],v[64:67]
mf v[80:83],v[48:51],a[108:111],v[80:83]
mf v[96:99],v[48:51],a[188:191],v[96:99]
mf v[112:115],v[48:51],v[128:131],v[112:115]
s_waitcnt lgkmcnt(0)
tr v[36:37],v8,36864
tr v[38:39],v12,36864
tr v[40:41],v9,36864
tr v[42:43],v13,36864
tr v[44:45],v10,36864
tr v[46:47],v14,36864
tr v[48:49],v11,36864
tr v[50:51],v15,36864
mf v[52:55],v[20:23],a[32:35],v[52:55]
mf v[68:71],v[20:23],a[112:115],v[68:71]
mf v[84:87],v[20:23],a[192:195],v[84:87]
mf v[100:103],v[20:23],v[132:135],v[100:103]
mf v[56:59],v[24:27],a[32:35],v[56:59]
mf v[72:75],v[24:27],a[112:115],v[72:75]
mf v[88:91],v[24:27],a[192:195],v[88:91]
mf v[104:107],v[24:27],v[132:135],v[104:107]
mf v[60:63],v[28:31],a[32:35],v[60:63]
mf v[76:79],v[28:31],a[112:115],v[76:79]
mf v[92:95],v[28:31],a[192:195],v[92:95]
mf v[108:111],v[28:31],v[132:135],v[108:111]
mf v[64:67],v[32:35],a[32:35],v[64:67]
mf v[80:83],v[32:35],a[112:115],v[80:83]
mf v[96:99],v[32:35],a[192:195],v[96:99]
mf v[112:115],v[32:35],v[132:135],v[112:115]
s_waitcnt lgkmcnt(0)
s_waitcnt vmcnt(20)
s_barrier
s_add_u32 m0,s66,0
s_add_u32 s23,s67,0
buffer_load_dwordx4 v5,s[68:71],s23 offen lds
s_add_u32 m0,s66,4096
s_add_u32 s23,s67,393216
buffer_load_dwordx4 v5,s[68:71],s23 offen lds
s_add_u32 m0,s66,8192
s_add_u32 s23,s67,786432
buffer_load_dwordx4 v5,s[68:71],s23 offen lds
s_add_u32 m0,s66,12288
s_add_u32 s23,s67,1179648
buffer_load_dwordx4 v5,s[68:71],s23 offen lds
s_add_u32 m0,s66,16384
s_add_u32 s23,s67,1572864
buffer_load_dwordx4 v5,s[68:71],s23 offen lds
s_add_u32 m0,s66,20480
s_add_u32 s23,s67,1966080
buffer_load_dwordx4 v5,s[68:71],s23 offen lds
s_add_u32 m0,s66,24576
s_add_u32 s23,s67,2359296
buffer_load_dwordx4 v5,s[68:71],s23 offen lds
s_add_u32 m0,s66,28672
s_add_u32 s23,s67,2752512
buffer_load_dwordx4 v5,s[68:71],s23 offen lds
s_add_u32 m0,s66,32768
s_add_u32 s23,s67,3145728
buffer_load_dwordx4 v5,s[68:71],s23 offen lds
s_add_u32 m0,s66,36864
s_add_u32 s23,s67,3538944
buffer_load_dwordx4 v5,s[68:71],s23 offen lds
v_add_u32 v8,40960,v8
v_add_u32 v9,40960,v9
v_add_u32 v10,40960,v10
v_add_u32 v11,40960,v11
v_add_u32 v12,40960,v12
v_add_u32 v13,40960,v13
v_add_u32 v14,40960,v14
v_add_u32 v15,40960,v15
tr v[20:21],v8,0
tr v[22:23],v12,0
tr v[24:25],v9,0
tr v[26:27],v13,0
tr v[28:29],v10,0
tr v[30:31],v14,0
tr v[32:33],v11,0
tr v[34:35],v15,0
mf v[52:55],v[36:39],a[36:39],v[52:55]
mf v[68:71],v[36:39],a[116:119],v[68:71]
mf v[84:87],v[36:39],a[196:199],v[84:87]
mf v[100:103],v[36:39],v[136:139],v[100:103]
mf v[56:59],v[40:43],a[36:39],v[56:59]
mf v[72:75],v[40:43],a[116:119],v[72:75]
mf v[88:91],v[40:43],a[196:199],v[88:91]
mf v[104:107],v[40:43],v[136:139],v[104:107]
mf v[60:63],v[44:47],a[36:39],v[60:63]
mf v[76:79],v[44:47],a[116:119],v[76:79]
mf v[92:95],v[44:47],a[196:199],v[92:95]
mf v[108:111],v[44:47],v[136:139],v[108:111]
mf v[64:67],v[48:51],a[36:39],v[64:67]
mf v[80:83],v[48:51],a[116:119],v[80:83]
mf v[96:99],v[48:51],a[196:199],v[96:99]
mf v[112:115],v[48:51],v[136:139],v[112:115]
s_waitcnt lgkmcnt(0)
tr v[36:37],v8,4096
tr v[38:39],v12,4096
tr v[40:41],v9,4096
tr v[42:43],v13,4096
tr v[44:45],v10,4096
tr v[46:47],v14,4096
tr v[48:49],v11,4096
tr v[50:51],v15,4096
mf v[52:55],v[20:23],a[40:43],v[52:55]
mf v[68:71],v[20:23],a[120:123],v[68:71]
mf v[84:87],v[20:23],a[200:203],v[84:87]
mf v[100:103],v[20:23],v[140:143],v[100:103]
mf v[56:59],v[24:27],a[40:43],v[56:59]
mf v[72:75],v[24:27],a[120:123],v[72:75]
mf v[88:91],v[24:27],a[200:203],v[88:91]
mf v[104:107],v[24:27],v[140:143],v[104:107]
mf v[60:63],v[28:31],a[40:43],v[60:63]
mf v[76:79],v[28:31],a[120:123],v[76:79]
mf v[92:95],v[28:31],a[200:203],v[92:95]
mf v[108:111],v[28:31],v[140:143],v[108:111]
mf v[64:67],v[32:35],a[40:43],v[64:67]
mf v[80:83],v[32:35],a[120:123],v[80:83]
mf v[96:99],v[32:35],a[200:203],v[96:99]
mf v[112:115],v[32:35],v[140:143],v[112:115]
s_waitcnt lgkmcnt(0)
tr v[20:21],v8,8192
tr v[22:23],v12,8192
tr v[24:25],v9,8192
tr v[26:27],v13,8192
tr v[28:29],v10,8192
tr v[30:31],v14,8192
tr v[32:33],v11,8192
tr v[34:35],v15,8192
mf v[52:55],v[36:39],a[44:47],v[52:55]
mf v[68:71],v[36:39],a[124:127],v[68:71]
mf v[84:87],v[36:39],a[204:207],v[84:87]
mf v[100:103],v[36:39],v[144:147],v[100:103]
mf v[56:59],v[40:43],a[44:47],v[56:59]
mf v[72:75],v[40:43],a[124:127],v[72:75]
mf v[88:91],v[40:43],a[204:207],v[88:91]
mf v[104:107],v[40:43],v[144:147],v[104:107]
mf v[60:63],v[44:47],a[44:47],v[60:63]
mf v[76:79],v[44:47],a[124:127],v[76:79]
mf v[92:95],v[44:47],a[204:207],v[92:95]
mf v[108:111],v[44:47],v[144:147],v[108:111]
mf v[64:67],v[48:51],a[44:47],v[64:67]
mf v[80:83],v[48:51],a[124:127],v[80:83]
mf v[96:99],v[48:51],a[204:207],v[96:99]
mf v[112:115],v[48:51],v[144:147],v[112:115]
s_waitcnt lgkmcnt(0)
tr v[36:37],v8,12288
tr v[38:39],v12,12288
tr v[40:41],v9,12288
tr v[42:43],v13,12288
tr v[44:45],v10,12288
tr v[46:47],v14,12288
tr v[48:49],v11,12288
tr v[50:51],v15,12288
mf v[52:55],v[20:23],a[48:51],v[52:55]
mf v[68:71],v[20:23],a[128:131],v[68:71]
mf v[84:87],v[20:23],a[208:211],v[84:87]
mf v[100:103],v[20:23],v[148:151],v[100:103]
mf v[56:59],v[24:27],a[48:51],v[56:59]
mf v[72:75],v[24:27],a[128:131],v[72:75]
mf v[88:91],v[24:27],a[208:211],v[88:91]
mf v[104:107],v[24:27],v[148:151],v[104:107]
mf v[60:63],v[28:31],a[48:51],v[60:63]
mf v[76:79],v[28:31],a[128:131],v[76:79]
mf v[92:95],v[28:31],a[208:211],v[92:95]
mf v[108:111],v[28:31],v[148:151],v[108:111]
mf v[64:67],v[32:35],a[48:51],v[64:67]
mf v[80:83],v[32:35],a[128:131],v[80:83]
mf v[96:99],v[32:35],a[208:211],v[96:99]
mf v[112:115],v[32:35],v[148:151],v[112:115]
s_waitcnt lgkmcnt(0)
tr v[20:21],v8,16384
tr v[22:23],v12,16384
tr v[24:25],v9,16384
tr v[26:27],v13,16384
tr v[28:29],v10,16384
tr v[30:31],v14,16384
tr v[32:33],v11,16384
tr v[34:35],v15,16384
mf v[52:55],v[36:39],a[52:55],v[52:55]
mf v[68:71],v[36:39],a[132:135],v[68:71]
mf v[84:87],v[36:39],a[212:215],v[84:87]
mf v[100:103],v[36:39],v[152:155],v[100:103]
mf v[56:59],v[40:43],a[52:55],v[56:59]
mf v[72:75],v[40:43],a[132:135],v[72:75]
mf v[88:91],v[40:43],a[212:215],v[88:91]
mf v[104:107],v[40:43],v[152:155],v[104:107]
mf v[60:63],v[44:47],a[52:55],v[60:63]
mf v[76:79],v[44:47],a[132:135],v[76:79]
mf v[92:95],v[44:47],a[212:215],v[92:95]
mf v[108:111],v[44:47],v[152:155],v[108:111]
mf v[64:67],v[48:51],a[52:55],v[64:67]
mf v[80:83],v[48:51],a[132:135],v[80:83]
mf v[96:99],v[48:51],a[212:215],v[96:99]
mf v[112:115],v[48:51],v[152:155],v[112:115]
s_waitcnt lgkmcnt(0)
tr v[36:37],v8,20480
tr v[38:39],v12,20480
tr v[40:41],v9,20480
tr v[42:43],v13,20480
tr v[44:45],v10,20480
tr v[46:47],v14,20480
tr v[48:49],v11,20480
tr v[50:51],v15,20480
mf v[52:55],v[20:23],a[56:59],v[52:55]
mf v[68:71],v[20:23],a[136:139],v[68:71]
mf v[84:87],v[20:23],a[216:219],v[84:87]
mf v[100:103],v[20:23],v[156:159],v[100:103]
mf v[56:59],v[24:27],a[56:59],v[56:59]
mf v[72:75],v[24:27],a[136:139],v[72:75]
mf v[88:91],v[24:27],a[216:219],v[88:91]
mf v[104:107],v[24:27],v[156:159],v[104:107]
mf v[60:63],v[28:31],a[56:59],v[60:63]
mf v[76:79],v[28:31],a[136:139],v[76:79]
mf v[92:95],v[28:31],a[216:219],v[92:95]
mf v[108:111],v[28:31],v[156:159],v[108:111]
mf v[64:67],v[32:35],a[56:59],v[64:67]
mf v[80:83],v[32:35],a[136:139],v[80:83]
mf v[96:99],v[32:35],a[216:219],v[96:99]
mf v[112:115],v[32:35],v[156:159],v[112:115]
s_waitcnt lgkmcnt(0)
tr v[20:21],v8,24576
tr v[22:23],v12,24576
tr v[24:25],v9,24576
tr v[26:27],v13,24576
tr v[28:29],v10,24576
tr v[30:31],v14,24576
tr v[32:33],v11,24576
tr v[34:35],v15,24576
mf v[52:55],v[36:39],a[60:63],v[52:55]
mf v[68:71],v[36:39],a[140:143],v[68:71]
mf v[84:87],v[36:39],a[220:223],v[84:87]
mf v[100:103],v[36:39],v[160:163],v[100:103]
mf v[56:59],v[40:43],a[60:63],v[56:59]
mf v[72:75],v[40:43],a[140:143],v[72:75]
mf v[88:91],v[40:43],a[220:223],v[88:91]
mf v[104:107],v[40:43],v[160:163],v[104:107]
mf v[60:63],v[44:47],a[60:63],v[60:63]
mf v[76:79],v[44:47],a[140:143],v[76:79]
mf v[92:95],v[44:47],a[220:223],v[92:95]
mf v[108:111],v[44:47],v[160:163],v[108:111]
mf v[64:67],v[48:51],a[60:63],v[64:67]
mf v[80:83],v[48:51],a[140:143],v[80:83]
mf v[96:99],v[48:51],a[220:223],v[96:99]
mf v[112:115],v[48:51],v[160:163],v[112:115]
s_waitcnt lgkmcnt(0)
tr v[36:37],v8,28672
tr v[38:39],v12,28672
tr v[40:41],v9,28672
tr v[42:43],v13,28672
tr v[44:45],v10,28672
tr v[46:47],v14,28672
tr v[48:49],v11,28672
tr v[50:51],v15,28672
mf v[52:55],v[20:23],a[64:67],v[52:55]
mf v[68:71],v[20:23],a[144:147],v[68:71]
mf v[84:87],v[20:23],a[224:227],v[84:87]
mf v[100:103],v[20:23],v[164:167],v[100:103]
mf v[56:59],v[24:27],a[64:67],v[56:59]
mf v[72:75],v[24:27],a[144:147],v[72:75]
mf v[88:91],v[24:27],a[224:227],v[88:91]
mf v[104:107],v[24:27],v[164:167],v[104:107]
mf v[60:63],v[28:31],a[64:67],v[60:63]
mf v[76:79],v[28:31],a[144:147],v[76:79]
mf v[92:95],v[28:31],a[224:227],v[92:95]
mf v[108:111],v[28:31],v[164:167],v[108:111]
mf v[64:67],v[32:35],a[64:67],v[64:67]
mf v[80:83],v[32:35],a[144:147],v[80:83]
mf v[96:99],v[32:35],a[224:227],v[96:99]
mf v[112:115],v[32:35],v[164:167],v[112:115]
s_waitcnt lgkmcnt(0)
tr v[20:21],v8,32768
tr v[22:23],v12,32768
tr v[24:25],v9,32768
tr v[26:27],v13,32768
tr v[28:29],v10,32768
tr v[30:31],v14,32768
tr v[32:33],v11,32768
tr v[34:35],v15,32768
mf v[52:55],v[36:39],a[68:71],v[52:55]
mf v[68:71],v[36:39],a[148:151],v[68:71]
mf v[84:87],v[36:39],a[228:231],v[84:87]
mf v[100:103],v[36:39],v[168:171],v[100:103]
mf v[56:59],v[40:43],a[68:71],v[56:59]
mf v[72:75],v[40:43],a[148:151],v[72:75]
mf v[88:91],v[40:43],a[228:231],v[88:91]
mf v[104:107],v[40:43],v[168:171],v[104:107]
mf v[60:63],v[44:47],a[68:71],v[60:63]
mf v[76:79],v[44:47],a[148:151],v[76:79]
mf v[92:95],v[44:47],a[228:231],v[92:95]
mf v[108:111],v[44:47],v[168:171],v[108:111]
mf v[64:67],v[48:51],a[68:71],v[64:67]
mf v[80:83],v[48:51],a[148:151],v[80:83]
mf v[96:99],v[48:51],a[228:231],v[96:99]
mf v[112:115],v[48:51],v[168:171],v[112:115]
s_waitcnt lgkmcnt(0)
tr v[36:37],v8,36864
tr v[38:39],v12,36864
tr v[40:41],v9,36864
tr v[42:43],v13,36864
tr v[44:45],v10,36864
tr v[46:47],v14,36864
tr v[48:49],v11,36864
tr v[50:51],v15,36864
mf v[52:55],v[20:23],a[72:75],v[52:55]
mf v[68:71],v[20:23],a[152:155],v[68:71]
mf v[84:87],v[20:23],a[232:235],v[84:87]
mf v[100:103],v[20:23],v[172:175],v[100:103]
mf v[56:59],v[24:27],a[72:75],v[56:59]
mf v[72:75],v[24:27],a[152:155],v[72:75]
mf v[88:91],v[24:27],a[232:235],v[88:91]
mf v[104:107],v[24:27],v[172:175],v[104:107]
mf v[60:63],v[28:31],a[72:75],v[60:63]
mf v[76:79],v[28:31],a[152:155],v[76:79]
mf v[92:95],v[28:31],a[232:235],v[92:95]
mf v[108:111],v[28:31],v[172:175],v[108:111]
mf v[64:67],v[32:35],a[72:75],v[64:67]
mf v[80:83],v[32:35],a[152:155],v[80:83]
mf v[96:99],v[32:35],a[232:235],v[96:99]
mf v[112:115],v[32:35],v[172:175],v[112:115]
s_waitcnt lgkmcnt(0)
s_cmp_lg_u32 s74,3
s_cbranch_scc1 t1_kernel_nosig0
s_waitcnt vmcnt(10)
t1_kernel_nosig0:
s_waitcnt vmcnt(20)
s_barrier
s_cmp_lg_u32 s74,3
s_cbranch_scc1 t1_kernel_nosig1
v_mov_b32 v251,0
s_mov_b64 exec,1
buffer_store_dword v251,off,s[92:95],s99 sc1
s_mov_b64 exec,-1
t1_kernel_nosig1:
s_add_u32 m0,s66,40960
s_add_u32 s23,s67,3932160
buffer_load_dwordx4 v5,s[68:71],s23 offen lds
s_add_u32 m0,s66,45056
s_add_u32 s23,s67,4325376
buffer_load_dwordx4 v5,s[68:71],s23 offen lds
s_add_u32 m0,s66,49152
s_add_u32 s23,s67,4718592
buffer_load_dwordx4 v5,s[68:71],s23 offen lds
s_add_u32 m0,s66,53248
s_add_u32 s23,s67,5111808
buffer_load_dwordx4 v5,s[68:71],s23 offen lds
s_add_u32 m0,s66,57344
s_add_u32 s23,s67,5505024
buffer_load_dwordx4 v5,s[68:71],s23 offen lds
s_add_u32 m0,s66,61440
s_add_u32 s23,s67,5898240
buffer_load_dwordx4 v5,s[68:71],s23 offen lds
s_add_u32 m0,s66,65536
s_add_u32 s23,s67,6291456
buffer_load_dwordx4 v5,s[68:71],s23 offen lds
s_add_u32 m0,s66,69632
s_add_u32 s23,s67,6684672
buffer_load_dwordx4 v5,s[68:71],s23 offen lds
s_add_u32 m0,s66,73728
s_add_u32 s23,s67,7077888
buffer_load_dwordx4 v5,s[68:71],s23 offen lds
s_add_u32 m0,s66,77824
s_add_u32 s23,s67,7471104
buffer_load_dwordx4 v5,s[68:71],s23 offen lds
v_add_u32 v8,s65,v8
v_add_u32 v9,s65,v9
v_add_u32 v10,s65,v10
v_add_u32 v11,s65,v11
v_add_u32 v12,s65,v12
v_add_u32 v13,s65,v13
v_add_u32 v14,s65,v14
v_add_u32 v15,s65,v15
tr v[20:21],v8,0
tr v[22:23],v12,0
tr v[24:25],v9,0
tr v[26:27],v13,0
tr v[28:29],v10,0
tr v[30:31],v14,0
tr v[32:33],v11,0
tr v[34:35],v15,0
mf v[52:55],v[36:39],a[76:79],v[52:55]
mf v[68:71],v[36:39],a[156:159],v[68:71]
mf v[84:87],v[36:39],a[236:239],v[84:87]
mf v[100:103],v[36:39],v[176:179],v[100:103]
mf v[56:59],v[40:43],a[76:79],v[56:59]
mf v[72:75],v[40:43],a[156:159],v[72:75]
mf v[88:91],v[40:43],a[236:239],v[88:91]
mf v[104:107],v[40:43],v[176:179],v[104:107]
mf v[60:63],v[44:47],a[76:79],v[60:63]
mf v[76:79],v[44:47],a[156:159],v[76:79]
mf v[92:95],v[44:47],a[236:239],v[92:95]
mf v[108:111],v[44:47],v[176:179],v[108:111]
mf v[64:67],v[48:51],a[76:79],v[64:67]
mf v[80:83],v[48:51],a[156:159],v[80:83]
mf v[96:99],v[48:51],a[236:239],v[96:99]
mf v[112:115],v[48:51],v[176:179],v[112:115]
s_nop 7
s_nop 1
cv v180,v52,v53
cv v181,v54,v55
cv v182,v56,v57
cv v183,v58,v59
cv v184,v60,v61
cv v185,v62,v63
cv v186,v64,v65
cv v187,v66,v67
cv v188,v68,v69
cv v189,v70,v71
cv v190,v72,v73
cv v191,v74,v75
cv v192,v76,v77
cv v193,v78,v79
cv v194,v80,v81
cv v195,v82,v83
cv v196,v84,v85
cv v197,v86,v87
cv v198,v88,v89
cv v199,v90,v91
cv v200,v92,v93
cv v201,v94,v95
cv v202,v96,v97
cv v203,v98,v99
cv v204,v100,v101
cv v205,v102,v103
cv v206,v104,v105
cv v207,v106,v107
cv v208,v108,v109
cv v209,v110,v111
cv v210,v112,v113
cv v211,v114,v115
s_cmp_lt_u32 s74,3
s_cselect_b32 s73,25165824,0
s_cselect_b32 s22,0,3
s_sub_u32 s22,s74,s22
s_lshl_b32 s22,s22,7
s_add_u32 s73,s73,s22
s_add_u32 s74,s74,1
s_sub_u32 s65,4294885376,s65
s_xor_b32 s66,s66,81920
s_sub_u32 s64,s64,1
s_cmp_lg_u32 s64,0
s_cbranch_scc1 t1_kernel_loop
s_add_u32 s23,s73,0
buffer_store_dwordx4 v[180:183],v248,s[52:55],s23 offen sc1
s_add_u32 s23,s73,64
buffer_store_dwordx4 v[184:187],v248,s[52:55],s23 offen sc1
s_add_u32 s23,s73,49152
buffer_store_dwordx4 v[188:191],v248,s[52:55],s23 offen sc1
s_add_u32 s23,s73,49216
buffer_store_dwordx4 v[192:195],v248,s[52:55],s23 offen sc1
s_add_u32 s23,s73,393216
buffer_store_dwordx4 v[196:199],v248,s[52:55],s23 offen sc1
s_add_u32 s23,s73,393280
buffer_store_dwordx4 v[200:203],v248,s[52:55],s23 offen sc1
s_add_u32 s23,s73,442368
buffer_store_dwordx4 v[204:207],v248,s[52:55],s23 offen sc1
s_add_u32 s23,s73,442432
buffer_store_dwordx4 v[208:211],v248,s[52:55],s23 offen sc1
s_branch task_done
t2h_kernel_entry:
s_load_dwordx4 s[4:7],s[0:1],16
s_load_dwordx4 s[8:11],s[0:1],32
s_load_dwordx2 s[12:13],s[0:1],128
v_and_b32 v1,63,v0
v_lshrrev_b32 v2,4,v1
v_and_b32 v3,15,v0
v_lshrrev_b32 v4,6,v0
s_nop 0
v_readfirstlane_b32 s20,v4
s_nop 3
s_lshl_b32 s21,s20,10
v_bfe_u32 v5,v1,2,2
v_lshl_add_u32 v6,v2,3,v5
v_lshlrev_b32 v6,7,v6
v_and_b32 v7,3,v1
v_lshl_add_u32 v6,v7,3,v6
v_lshrrev_b32 v5,1,v5
v_and_b32 v7,1,v2
v_xor_b32 v11,0,v7
v_lshl_or_b32 v11,v11,1,v5
v_xor_b32 v8,0,v11
v_lshl_add_u32 v8,v8,5,v6
v_xor_b32 v9,1,v11
v_lshl_add_u32 v9,v9,5,v6
v_xor_b32 v10,2,v11
v_lshl_add_u32 v10,v10,5,v6
v_xor_b32 v11,3,v11
v_lshl_add_u32 v11,v11,5,v6
v_xor_b32 v15,1,v7
v_lshl_or_b32 v15,v15,1,v5
v_xor_b32 v12,0,v15
v_lshl_add_u32 v12,v12,5,v6
v_add_u32 v12,512,v12
v_xor_b32 v13,1,v15
v_lshl_add_u32 v13,v13,5,v6
v_add_u32 v13,512,v13
v_xor_b32 v14,2,v15
v_lshl_add_u32 v14,v14,5,v6
v_add_u32 v14,512,v14
v_xor_b32 v15,3,v15
v_lshl_add_u32 v15,v15,5,v6
v_add_u32 v15,512,v15
v_bfe_u32 v5,v1,2,2
v_lshl_add_u32 v6,v2,2,v5
v_lshlrev_b32 v6,7,v6
v_and_b32 v7,3,v1
v_lshl_add_u32 v6,v7,3,v6
v_lshrrev_b32 v5,1,v5
v_lshrrev_b32 v7,1,v2
v_xor_b32 v7,v7,v2
v_and_b32 v7,1,v7
v_lshl_or_b32 v19,v7,1,v5
v_xor_b32 v16,0,v19
v_lshl_add_u32 v16,v16,5,v6
v_xor_b32 v17,1,v19
v_lshl_add_u32 v17,v17,5,v6
v_xor_b32 v18,2,v19
v_lshl_add_u32 v18,v18,5,v6
v_xor_b32 v19,3,v19
v_lshl_add_u32 v19,v19,5,v6
s_and_b32 s24,s2,31
s_lshr_b32 s25,s2,5
s_waitcnt lgkmcnt(0)
s_mul_i32 s26,s24,384
s_sub_u32 s27,7864320,s26
s_lshl_b32 s29,s25,2
s_add_u32 s29,s29,s20
s_mul_i32 s30,s29,40960
s_add_u32 s30,s30,26214400
s_add_u32 s48,s12,s30
s_addc_u32 s49,s13,0
s_mov_b32 s50,0xa000
s_mov_b32 s51,0x00020000
v_lshrrev_b32 v244,3,v1
v_lshl_add_u32 v245,v4,3,v244
v_bfe_u32 v246,v245,1,1
v_lshrrev_b32 v5,2,v245
v_lshrrev_b32 v244,3,v245
v_xor_b32 v5,v5,v244
v_and_b32 v5,1,v5
v_lshl_or_b32 v246,v5,1,v246
v_bfe_u32 v244,v1,1,2
v_xor_b32 v246,v246,v244
v_and_b32 v244,1,v1
v_lshl_or_b32 v246,v246,1,v244
v_lshlrev_b32 v246,4,v246
s_mov_b32 s22,12288
v_mul_lo_u32 v5,s22,v245
v_add_u32 v5,v5,v246
v_lshrrev_b32 v244,3,v1
v_lshl_add_u32 v245,v4,3,v244
v_bfe_u32 v246,v245,1,1
v_lshrrev_b32 v6,2,v245
v_lshrrev_b32 v244,3,v245
v_xor_b32 v6,v6,v244
v_and_b32 v6,1,v6
v_lshl_or_b32 v246,v6,1,v246
v_bfe_u32 v244,v1,1,2
v_xor_b32 v246,v246,v244
v_and_b32 v244,1,v1
v_lshl_or_b32 v246,v246,1,v244
v_lshlrev_b32 v246,4,v246
s_mov_b32 s22,1280
v_mul_lo_u32 v6,s22,v245
v_add_u32 v6,v6,v246
v_lshrrev_b32 v244,2,v3
v_and_b32 v245,3,v3
v_lshl_add_u32 v244,v244,3,v245
v_lshlrev_b32 v245,4,v2
v_mul_u32_u24 v247,1280,v244
v_add_u32 v247,v247,v245
v_mul_u32_u24 v248,12288,v244
v_add_u32 v248,v248,v245
v_lshl_add_u32 v249,v3,6,v245
v_lshlrev_b32 v250,4,v1
s_add_u32 s40,s8,s26
s_addc_u32 s41,s9,0
s_mov_b32 s42,s27
s_mov_b32 s43,0x00020000
s_mul_i32 s28,s24,245760
s_add_u32 s44,s10,s28
s_addc_u32 s45,s11,0
s_mov_b32 s46,0x3c000
s_mov_b32 s47,0x00020000
s_lshl_b32 s30,s29,5
s_add_u32 s30,s30,s24
s_mul_i32 s30,s30,40960
s_add_u32 s30,s30,117440512
s_add_u32 s60,s12,s30
s_addc_u32 s61,s13,0
s_mov_b32 s62,0xa000
s_mov_b32 s63,0x00020000
s_mov_b32 s23,0
buffer_load_dwordx4 a[0:3],v250,s[48:51],s23 offen
s_mov_b32 s23,1024
buffer_load_dwordx4 a[4:7],v250,s[48:51],s23 offen
s_mov_b32 s23,2048
buffer_load_dwordx4 a[8:11],v250,s[48:51],s23 offen
s_mov_b32 s23,3072
buffer_load_dwordx4 a[12:15],v250,s[48:51],s23 offen
s_mov_b32 s23,4096
buffer_load_dwordx4 a[16:19],v250,s[48:51],s23 offen
s_mov_b32 s23,5120
buffer_load_dwordx4 a[20:23],v250,s[48:51],s23 offen
s_mov_b32 s23,6144
buffer_load_dwordx4 a[24:27],v250,s[48:51],s23 offen
s_mov_b32 s23,7168
buffer_load_dwordx4 a[28:31],v250,s[48:51],s23 offen
s_mov_b32 s23,8192
buffer_load_dwordx4 a[32:35],v250,s[48:51],s23 offen
s_mov_b32 s23,9216
buffer_load_dwordx4 a[36:39],v250,s[48:51],s23 offen
s_mov_b32 s23,10240
buffer_load_dwordx4 a[40:43],v250,s[48:51],s23 offen
s_mov_b32 s23,11264
buffer_load_dwordx4 a[44:47],v250,s[48:51],s23 offen
s_mov_b32 s23,12288
buffer_load_dwordx4 a[48:51],v250,s[48:51],s23 offen
s_mov_b32 s23,13312
buffer_load_dwordx4 a[52:55],v250,s[48:51],s23 offen
s_mov_b32 s23,14336
buffer_load_dwordx4 a[56:59],v250,s[48:51],s23 offen
s_mov_b32 s23,15360
buffer_load_dwordx4 a[60:63],v250,s[48:51],s23 offen
s_mov_b32 s23,16384
buffer_load_dwordx4 a[64:67],v250,s[48:51],s23 offen
s_mov_b32 s23,17408
buffer_load_dwordx4 a[68:71],v250,s[48:51],s23 offen
s_mov_b32 s23,18432
buffer_load_dwordx4 a[72:75],v250,s[48:51],s23 offen
s_mov_b32 s23,19456
buffer_load_dwordx4 a[76:79],v250,s[48:51],s23 offen
s_mov_b32 s23,20480
buffer_load_dwordx4 a[80:83],v250,s[48:51],s23 offen
s_mov_b32 s23,21504
buffer_load_dwordx4 a[84:87],v250,s[48:51],s23 offen
s_mov_b32 s23,22528
buffer_load_dwordx4 a[88:91],v250,s[48:51],s23 offen
s_mov_b32 s23,23552
buffer_load_dwordx4 a[92:95],v250,s[48:51],s23 offen
s_mov_b32 s23,24576
buffer_load_dwordx4 a[96:99],v250,s[48:51],s23 offen
s_mov_b32 s23,25600
buffer_load_dwordx4 a[100:103],v250,s[48:51],s23 offen
s_mov_b32 s23,26624
buffer_load_dwordx4 a[104:107],v250,s[48:51],s23 offen
s_mov_b32 s23,27648
buffer_load_dwordx4 a[108:111],v250,s[48:51],s23 offen
s_mov_b32 s23,28672
buffer_load_dwordx4 a[112:115],v250,s[48:51],s23 offen
s_mov_b32 s23,29696
buffer_load_dwordx4 a[116:119],v250,s[48:51],s23 offen
s_mov_b32 s23,30720
buffer_load_dwordx4 a[120:123],v250,s[48:51],s23 offen
s_mov_b32 s23,31744
buffer_load_dwordx4 a[124:127],v250,s[48:51],s23 offen
s_mov_b32 s23,32768
buffer_load_dwordx4 a[128:131],v250,s[48:51],s23 offen
s_mov_b32 s23,33792
buffer_load_dwordx4 a[132:135],v250,s[48:51],s23 offen
s_mov_b32 s23,34816
buffer_load_dwordx4 a[136:139],v250,s[48:51],s23 offen
s_mov_b32 s23,35840
buffer_load_dwordx4 a[140:143],v250,s[48:51],s23 offen
s_mov_b32 s23,36864
buffer_load_dwordx4 a[144:147],v250,s[48:51],s23 offen
s_mov_b32 s23,37888
buffer_load_dwordx4 a[148:151],v250,s[48:51],s23 offen
s_mov_b32 s23,38912
buffer_load_dwordx4 a[152:155],v250,s[48:51],s23 offen
s_mov_b32 s23,39936
buffer_load_dwordx4 a[156:159],v250,s[48:51],s23 offen
s_add_u32 m0,s21,0
s_mov_b32 s23,0
buffer_load_dwordx4 v5,s[40:43],s23 offen lds
s_add_u32 m0,s21,4096
s_mov_b32 s23,393216
buffer_load_dwordx4 v5,s[40:43],s23 offen lds
s_add_u32 m0,s21,8192
s_mov_b32 s23,786432
buffer_load_dwordx4 v5,s[40:43],s23 offen lds
s_add_u32 m0,s21,12288
s_mov_b32 s23,1179648
buffer_load_dwordx4 v5,s[40:43],s23 offen lds
s_add_u32 m0,s21,16384
s_mov_b32 s23,1572864
buffer_load_dwordx4 v5,s[40:43],s23 offen lds
s_add_u32 m0,s21,20480
s_mov_b32 s23,1966080
buffer_load_dwordx4 v5,s[40:43],s23 offen lds
s_add_u32 m0,s21,24576
s_mov_b32 s23,2359296
buffer_load_dwordx4 v5,s[40:43],s23 offen lds
s_add_u32 m0,s21,28672
s_mov_b32 s23,2752512
buffer_load_dwordx4 v5,s[40:43],s23 offen lds
s_add_u32 m0,s21,32768
s_mov_b32 s23,3145728
buffer_load_dwordx4 v5,s[40:43],s23 offen lds
s_add_u32 m0,s21,36864
s_mov_b32 s23,3538944
buffer_load_dwordx4 v5,s[40:43],s23 offen lds
s_add_u32 m0,s21,40960
s_mov_b32 s23,3932160
buffer_load_dwordx4 v5,s[40:43],s23 offen lds
s_add_u32 m0,s21,45056
s_mov_b32 s23,4325376
buffer_load_dwordx4 v5,s[40:43],s23 offen lds
s_add_u32 m0,s21,49152
s_mov_b32 s23,4718592
buffer_load_dwordx4 v5,s[40:43],s23 offen lds
s_add_u32 m0,s21,53248
s_mov_b32 s23,5111808
buffer_load_dwordx4 v5,s[40:43],s23 offen lds
s_add_u32 m0,s21,57344
s_mov_b32 s23,5505024
buffer_load_dwordx4 v5,s[40:43],s23 offen lds
s_add_u32 m0,s21,61440
s_mov_b32 s23,5898240
buffer_load_dwordx4 v5,s[40:43],s23 offen lds
s_add_u32 m0,s21,65536
s_mov_b32 s23,6291456
buffer_load_dwordx4 v5,s[40:43],s23 offen lds
s_add_u32 m0,s21,69632
s_mov_b32 s23,6684672
buffer_load_dwordx4 v5,s[40:43],s23 offen lds
s_add_u32 m0,s21,73728
s_mov_b32 s23,7077888
buffer_load_dwordx4 v5,s[40:43],s23 offen lds
s_add_u32 m0,s21,77824
s_mov_b32 s23,7471104
buffer_load_dwordx4 v5,s[40:43],s23 offen lds
s_add_u32 m0,s21,81920
s_mov_b32 s23,128
buffer_load_dwordx4 v5,s[40:43],s23 offen lds
s_add_u32 m0,s21,86016
s_mov_b32 s23,393344
buffer_load_dwordx4 v5,s[40:43],s23 offen lds
s_add_u32 m0,s21,90112
s_mov_b32 s23,786560
buffer_load_dwordx4 v5,s[40:43],s23 offen lds
s_add_u32 m0,s21,94208
s_mov_b32 s23,1179776
buffer_load_dwordx4 v5,s[40:43],s23 offen lds
s_add_u32 m0,s21,98304
s_mov_b32 s23,1572992
buffer_load_dwordx4 v5,s[40:43],s23 offen lds
s_add_u32 m0,s21,102400
s_mov_b32 s23,1966208
buffer_load_dwordx4 v5,s[40:43],s23 offen lds
s_add_u32 m0,s21,106496
s_mov_b32 s23,2359424
buffer_load_dwordx4 v5,s[40:43],s23 offen lds
s_add_u32 m0,s21,110592
s_mov_b32 s23,2752640
buffer_load_dwordx4 v5,s[40:43],s23 offen lds
s_add_u32 m0,s21,114688
s_mov_b32 s23,3145856
buffer_load_dwordx4 v5,s[40:43],s23 offen lds
s_add_u32 m0,s21,118784
s_mov_b32 s23,3539072
buffer_load_dwordx4 v5,s[40:43],s23 offen lds
s_add_u32 m0,s21,122880
s_mov_b32 s23,3932288
buffer_load_dwordx4 v5,s[40:43],s23 offen lds
s_add_u32 m0,s21,126976
s_mov_b32 s23,4325504
buffer_load_dwordx4 v5,s[40:43],s23 offen lds
s_add_u32 m0,s21,131072
s_mov_b32 s23,4718720
buffer_load_dwordx4 v5,s[40:43],s23 offen lds
s_add_u32 m0,s21,135168
s_mov_b32 s23,5111936
buffer_load_dwordx4 v5,s[40:43],s23 offen lds
s_add_u32 m0,s21,139264
s_mov_b32 s23,5505152
buffer_load_dwordx4 v5,s[40:43],s23 offen lds
s_add_u32 m0,s21,143360
s_mov_b32 s23,5898368
buffer_load_dwordx4 v5,s[40:43],s23 offen lds
s_add_u32 m0,s21,147456
s_mov_b32 s23,6291584
buffer_load_dwordx4 v5,s[40:43],s23 offen lds
s_add_u32 m0,s21,151552
s_mov_b32 s23,6684800
buffer_load_dwordx4 v5,s[40:43],s23 offen lds
s_add_u32 m0,s21,155648
s_mov_b32 s23,7078016
buffer_load_dwordx4 v5,s[40:43],s23 offen lds
s_add_u32 m0,s21,159744
s_mov_b32 s23,7471232
buffer_load_dwordx4 v5,s[40:43],s23 offen lds
s_waitcnt vmcnt(30)
s_barrier
tr v[20:21],v8,0
tr v[22:23],v12,0
tr v[24:25],v9,0
tr v[26:27],v13,0
tr v[28:29],v10,0
tr v[30:31],v14,0
tr v[32:33],v11,0
tr v[34:35],v15,0
s_waitcnt lgkmcnt(0)
tr v[36:37],v8,4096
tr v[38:39],v12,4096
tr v[40:41],v9,4096
tr v[42:43],v13,4096
tr v[44:45],v10,4096
tr v[46:47],v14,4096
tr v[48:49],v11,4096
tr v[50:51],v15,4096
mf v[52:55],v[20:23],a[0:3],0
mf v[68:71],v[20:23],a[80:83],0
mf v[56:59],v[24:27],a[0:3],0
mf v[72:75],v[24:27],a[80:83],0
mf v[60:63],v[28:31],a[0:3],0
mf v[76:79],v[28:31],a[80:83],0
mf v[64:67],v[32:35],a[0:3],0
mf v[80:83],v[32:35],a[80:83],0
s_waitcnt lgkmcnt(0)
tr v[20:21],v8,8192
tr v[22:23],v12,8192
tr v[24:25],v9,8192
tr v[26:27],v13,8192
tr v[28:29],v10,8192
tr v[30:31],v14,8192
tr v[32:33],v11,8192
tr v[34:35],v15,8192
mf v[52:55],v[36:39],a[4:7],v[52:55]
mf v[68:71],v[36:39],a[84:87],v[68:71]
mf v[56:59],v[40:43],a[4:7],v[56:59]
mf v[72:75],v[40:43],a[84:87],v[72:75]
mf v[60:63],v[44:47],a[4:7],v[60:63]
mf v[76:79],v[44:47],a[84:87],v[76:79]
mf v[64:67],v[48:51],a[4:7],v[64:67]
mf v[80:83],v[48:51],a[84:87],v[80:83]
s_waitcnt lgkmcnt(0)
tr v[36:37],v8,12288
tr v[38:39],v12,12288
tr v[40:41],v9,12288
tr v[42:43],v13,12288
tr v[44:45],v10,12288
tr v[46:47],v14,12288
tr v[48:49],v11,12288
tr v[50:51],v15,12288
mf v[52:55],v[20:23],a[8:11],v[52:55]
mf v[68:71],v[20:23],a[88:91],v[68:71]
mf v[56:59],v[24:27],a[8:11],v[56:59]
mf v[72:75],v[24:27],a[88:91],v[72:75]
mf v[60:63],v[28:31],a[8:11],v[60:63]
mf v[76:79],v[28:31],a[88:91],v[76:79]
mf v[64:67],v[32:35],a[8:11],v[64:67]
mf v[80:83],v[32:35],a[88:91],v[80:83]
s_waitcnt lgkmcnt(0)
tr v[20:21],v8,16384
tr v[22:23],v12,16384
tr v[24:25],v9,16384
tr v[26:27],v13,16384
tr v[28:29],v10,16384
tr v[30:31],v14,16384
tr v[32:33],v11,16384
tr v[34:35],v15,16384
mf v[52:55],v[36:39],a[12:15],v[52:55]
mf v[68:71],v[36:39],a[92:95],v[68:71]
mf v[56:59],v[40:43],a[12:15],v[56:59]
mf v[72:75],v[40:43],a[92:95],v[72:75]
mf v[60:63],v[44:47],a[12:15],v[60:63]
mf v[76:79],v[44:47],a[92:95],v[76:79]
mf v[64:67],v[48:51],a[12:15],v[64:67]
mf v[80:83],v[48:51],a[92:95],v[80:83]
s_waitcnt lgkmcnt(0)
tr v[36:37],v8,20480
tr v[38:39],v12,20480
tr v[40:41],v9,20480
tr v[42:43],v13,20480
tr v[44:45],v10,20480
tr v[46:47],v14,20480
tr v[48:49],v11,20480
tr v[50:51],v15,20480
mf v[52:55],v[20:23],a[16:19],v[52:55]
mf v[68:71],v[20:23],a[96:99],v[68:71]
mf v[56:59],v[24:27],a[16:19],v[56:59]
mf v[72:75],v[24:27],a[96:99],v[72:75]
mf v[60:63],v[28:31],a[16:19],v[60:63]
mf v[76:79],v[28:31],a[96:99],v[76:79]
mf v[64:67],v[32:35],a[16:19],v[64:67]
mf v[80:83],v[32:35],a[96:99],v[80:83]
s_waitcnt lgkmcnt(0)
tr v[20:21],v8,24576
tr v[22:23],v12,24576
tr v[24:25],v9,24576
tr v[26:27],v13,24576
tr v[28:29],v10,24576
tr v[30:31],v14,24576
tr v[32:33],v11,24576
tr v[34:35],v15,24576
mf v[52:55],v[36:39],a[20:23],v[52:55]
mf v[68:71],v[36:39],a[100:103],v[68:71]
mf v[56:59],v[40:43],a[20:23],v[56:59]
mf v[72:75],v[40:43],a[100:103],v[72:75]
mf v[60:63],v[44:47],a[20:23],v[60:63]
mf v[76:79],v[44:47],a[100:103],v[76:79]
mf v[64:67],v[48:51],a[20:23],v[64:67]
mf v[80:83],v[48:51],a[100:103],v[80:83]
s_waitcnt lgkmcnt(0)
tr v[36:37],v8,28672
tr v[38:39],v12,28672
tr v[40:41],v9,28672
tr v[42:43],v13,28672
tr v[44:45],v10,28672
tr v[46:47],v14,28672
tr v[48:49],v11,28672
tr v[50:51],v15,28672
mf v[52:55],v[20:23],a[24:27],v[52:55]
mf v[68:71],v[20:23],a[104:107],v[68:71]
mf v[56:59],v[24:27],a[24:27],v[56:59]
mf v[72:75],v[24:27],a[104:107],v[72:75]
mf v[60:63],v[28:31],a[24:27],v[60:63]
mf v[76:79],v[28:31],a[104:107],v[76:79]
mf v[64:67],v[32:35],a[24:27],v[64:67]
mf v[80:83],v[32:35],a[104:107],v[80:83]
s_waitcnt lgkmcnt(0)
tr v[20:21],v8,32768
tr v[22:23],v12,32768
tr v[24:25],v9,32768
tr v[26:27],v13,32768
tr v[28:29],v10,32768
tr v[30:31],v14,32768
tr v[32:33],v11,32768
tr v[34:35],v15,32768
mf v[52:55],v[36:39],a[28:31],v[52:55]
mf v[68:71],v[36:39],a[108:111],v[68:71]
mf v[56:59],v[40:43],a[28:31],v[56:59]
mf v[72:75],v[40:43],a[108:111],v[72:75]
mf v[60:63],v[44:47],a[28:31],v[60:63]
mf v[76:79],v[44:47],a[108:111],v[76:79]
mf v[64:67],v[48:51],a[28:31],v[64:67]
mf v[80:83],v[48:51],a[108:111],v[80:83]
s_waitcnt lgkmcnt(0)
tr v[36:37],v8,36864
tr v[38:39],v12,36864
tr v[40:41],v9,36864
tr v[42:43],v13,36864
tr v[44:45],v10,36864
tr v[46:47],v14,36864
tr v[48:49],v11,36864
tr v[50:51],v15,36864
mf v[52:55],v[20:23],a[32:35],v[52:55]
mf v[68:71],v[20:23],a[112:115],v[68:71]
mf v[56:59],v[24:27],a[32:35],v[56:59]
mf v[72:75],v[24:27],a[112:115],v[72:75]
mf v[60:63],v[28:31],a[32:35],v[60:63]
mf v[76:79],v[28:31],a[112:115],v[76:79]
mf v[64:67],v[32:35],a[32:35],v[64:67]
mf v[80:83],v[32:35],a[112:115],v[80:83]
s_waitcnt lgkmcnt(0)
s_waitcnt vmcnt(20)
s_barrier
s_add_u32 m0,s21,0
s_mov_b32 s23,256
buffer_load_dwordx4 v5,s[40:43],s23 offen lds
s_add_u32 m0,s21,4096
s_mov_b32 s23,393472
buffer_load_dwordx4 v5,s[40:43],s23 offen lds
s_add_u32 m0,s21,8192
s_mov_b32 s23,786688
buffer_load_dwordx4 v5,s[40:43],s23 offen lds
s_add_u32 m0,s21,12288
s_mov_b32 s23,1179904
buffer_load_dwordx4 v5,s[40:43],s23 offen lds
s_add_u32 m0,s21,16384
s_mov_b32 s23,1573120
buffer_load_dwordx4 v5,s[40:43],s23 offen lds
s_add_u32 m0,s21,20480
s_mov_b32 s23,1966336
buffer_load_dwordx4 v5,s[40:43],s23 offen lds
s_add_u32 m0,s21,24576
s_mov_b32 s23,2359552
buffer_load_dwordx4 v5,s[40:43],s23 offen lds
s_add_u32 m0,s21,28672
s_mov_b32 s23,2752768
buffer_load_dwordx4 v5,s[40:43],s23 offen lds
s_add_u32 m0,s21,32768
s_mov_b32 s23,3145984
buffer_load_dwordx4 v5,s[40:43],s23 offen lds
s_add_u32 m0,s21,36864
s_mov_b32 s23,3539200
buffer_load_dwordx4 v5,s[40:43],s23 offen lds
v_add_u32 v8,40960,v8
v_add_u32 v9,40960,v9
v_add_u32 v10,40960,v10
v_add_u32 v11,40960,v11
v_add_u32 v12,40960,v12
v_add_u32 v13,40960,v13
v_add_u32 v14,40960,v14
v_add_u32 v15,40960,v15
tr v[20:21],v8,0
tr v[22:23],v12,0
tr v[24:25],v9,0
tr v[26:27],v13,0
tr v[28:29],v10,0
tr v[30:31],v14,0
tr v[32:33],v11,0
tr v[34:35],v15,0
mf v[52:55],v[36:39],a[36:39],v[52:55]
mf v[68:71],v[36:39],a[116:119],v[68:71]
mf v[56:59],v[40:43],a[36:39],v[56:59]
mf v[72:75],v[40:43],a[116:119],v[72:75]
mf v[60:63],v[44:47],a[36:39],v[60:63]
mf v[76:79],v[44:47],a[116:119],v[76:79]
mf v[64:67],v[48:51],a[36:39],v[64:67]
mf v[80:83],v[48:51],a[116:119],v[80:83]
s_waitcnt lgkmcnt(0)
tr v[36:37],v8,4096
tr v[38:39],v12,4096
tr v[40:41],v9,4096
tr v[42:43],v13,4096
tr v[44:45],v10,4096
tr v[46:47],v14,4096
tr v[48:49],v11,4096
tr v[50:51],v15,4096
mf v[52:55],v[20:23],a[40:43],v[52:55]
mf v[68:71],v[20:23],a[120:123],v[68:71]
mf v[56:59],v[24:27],a[40:43],v[56:59]
mf v[72:75],v[24:27],a[120:123],v[72:75]
mf v[60:63],v[28:31],a[40:43],v[60:63]
mf v[76:79],v[28:31],a[120:123],v[76:79]
mf v[64:67],v[32:35],a[40:43],v[64:67]
mf v[80:83],v[32:35],a[120:123],v[80:83]
s_waitcnt lgkmcnt(0)
tr v[20:21],v8,8192
tr v[22:23],v12,8192
tr v[24:25],v9,8192
tr v[26:27],v13,8192
tr v[28:29],v10,8192
tr v[30:31],v14,8192
tr v[32:33],v11,8192
tr v[34:35],v15,8192
mf v[52:55],v[36:39],a[44:47],v[52:55]
mf v[68:71],v[36:39],a[124:127],v[68:71]
mf v[56:59],v[40:43],a[44:47],v[56:59]
mf v[72:75],v[40:43],a[124:127],v[72:75]
mf v[60:63],v[44:47],a[44:47],v[60:63]
mf v[76:79],v[44:47],a[124:127],v[76:79]
mf v[64:67],v[48:51],a[44:47],v[64:67]
mf v[80:83],v[48:51],a[124:127],v[80:83]
s_waitcnt lgkmcnt(0)
tr v[36:37],v8,12288
tr v[38:39],v12,12288
tr v[40:41],v9,12288
tr v[42:43],v13,12288
tr v[44:45],v10,12288
tr v[46:47],v14,12288
tr v[48:49],v11,12288
tr v[50:51],v15,12288
mf v[52:55],v[20:23],a[48:51],v[52:55]
mf v[68:71],v[20:23],a[128:131],v[68:71]
mf v[56:59],v[24:27],a[48:51],v[56:59]
mf v[72:75],v[24:27],a[128:131],v[72:75]
mf v[60:63],v[28:31],a[48:51],v[60:63]
mf v[76:79],v[28:31],a[128:131],v[76:79]
mf v[64:67],v[32:35],a[48:51],v[64:67]
mf v[80:83],v[32:35],a[128:131],v[80:83]
s_waitcnt lgkmcnt(0)
tr v[20:21],v8,16384
tr v[22:23],v12,16384
tr v[24:25],v9,16384
tr v[26:27],v13,16384
tr v[28:29],v10,16384
tr v[30:31],v14,16384
tr v[32:33],v11,16384
tr v[34:35],v15,16384
mf v[52:55],v[36:39],a[52:55],v[52:55]
mf v[68:71],v[36:39],a[132:135],v[68:71]
mf v[56:59],v[40:43],a[52:55],v[56:59]
mf v[72:75],v[40:43],a[132:135],v[72:75]
mf v[60:63],v[44:47],a[52:55],v[60:63]
mf v[76:79],v[44:47],a[132:135],v[76:79]
mf v[64:67],v[48:51],a[52:55],v[64:67]
mf v[80:83],v[48:51],a[132:135],v[80:83]
s_waitcnt lgkmcnt(0)
tr v[36:37],v8,20480
tr v[38:39],v12,20480
tr v[40:41],v9,20480
tr v[42:43],v13,20480
tr v[44:45],v10,20480
tr v[46:47],v14,20480
tr v[48:49],v11,20480
tr v[50:51],v15,20480
mf v[52:55],v[20:23],a[56:59],v[52:55]
mf v[68:71],v[20:23],a[136:139],v[68:71]
mf v[56:59],v[24:27],a[56:59],v[56:59]
mf v[72:75],v[24:27],a[136:139],v[72:75]
mf v[60:63],v[28:31],a[56:59],v[60:63]
mf v[76:79],v[28:31],a[136:139],v[76:79]
mf v[64:67],v[32:35],a[56:59],v[64:67]
mf v[80:83],v[32:35],a[136:139],v[80:83]
s_waitcnt lgkmcnt(0)
tr v[20:21],v8,24576
tr v[22:23],v12,24576
tr v[24:25],v9,24576
tr v[26:27],v13,24576
tr v[28:29],v10,24576
tr v[30:31],v14,24576
tr v[32:33],v11,24576
tr v[34:35],v15,24576
mf v[52:55],v[36:39],a[60:63],v[52:55]
mf v[68:71],v[36:39],a[140:143],v[68:71]
mf v[56:59],v[40:43],a[60:63],v[56:59]
mf v[72:75],v[40:43],a[140:143],v[72:75]
mf v[60:63],v[44:47],a[60:63],v[60:63]
mf v[76:79],v[44:47],a[140:143],v[76:79]
mf v[64:67],v[48:51],a[60:63],v[64:67]
mf v[80:83],v[48:51],a[140:143],v[80:83]
s_waitcnt lgkmcnt(0)
tr v[36:37],v8,28672
tr v[38:39],v12,28672
tr v[40:41],v9,28672
tr v[42:43],v13,28672
tr v[44:45],v10,28672
tr v[46:47],v14,28672
tr v[48:49],v11,28672
tr v[50:51],v15,28672
mf v[52:55],v[20:23],a[64:67],v[52:55]
mf v[68:71],v[20:23],a[144:147],v[68:71]
mf v[56:59],v[24:27],a[64:67],v[56:59]
mf v[72:75],v[24:27],a[144:147],v[72:75]
mf v[60:63],v[28:31],a[64:67],v[60:63]
mf v[76:79],v[28:31],a[144:147],v[76:79]
mf v[64:67],v[32:35],a[64:67],v[64:67]
mf v[80:83],v[32:35],a[144:147],v[80:83]
s_waitcnt lgkmcnt(0)
tr v[20:21],v8,32768
tr v[22:23],v12,32768
tr v[24:25],v9,32768
tr v[26:27],v13,32768
tr v[28:29],v10,32768
tr v[30:31],v14,32768
tr v[32:33],v11,32768
tr v[34:35],v15,32768
mf v[52:55],v[36:39],a[68:71],v[52:55]
mf v[68:71],v[36:39],a[148:151],v[68:71]
mf v[56:59],v[40:43],a[68:71],v[56:59]
mf v[72:75],v[40:43],a[148:151],v[72:75]
mf v[60:63],v[44:47],a[68:71],v[60:63]
mf v[76:79],v[44:47],a[148:151],v[76:79]
mf v[64:67],v[48:51],a[68:71],v[64:67]
mf v[80:83],v[48:51],a[148:151],v[80:83]
s_waitcnt lgkmcnt(0)
tr v[36:37],v8,36864
tr v[38:39],v12,36864
tr v[40:41],v9,36864
tr v[42:43],v13,36864
tr v[44:45],v10,36864
tr v[46:47],v14,36864
tr v[48:49],v11,36864
tr v[50:51],v15,36864
mf v[52:55],v[20:23],a[72:75],v[52:55]
mf v[68:71],v[20:23],a[152:155],v[68:71]
mf v[56:59],v[24:27],a[72:75],v[56:59]
mf v[72:75],v[24:27],a[152:155],v[72:75]
mf v[60:63],v[28:31],a[72:75],v[60:63]
mf v[76:79],v[28:31],a[152:155],v[76:79]
mf v[64:67],v[32:35],a[72:75],v[64:67]
mf v[80:83],v[32:35],a[152:155],v[80:83]
s_waitcnt lgkmcnt(0)
s_waitcnt vmcnt(20)
s_barrier
s_add_u32 m0,s21,40960
s_mov_b32 s23,3932416
buffer_load_dwordx4 v5,s[40:43],s23 offen lds
s_add_u32 m0,s21,45056
s_mov_b32 s23,4325632
buffer_load_dwordx4 v5,s[40:43],s23 offen lds
s_add_u32 m0,s21,49152
s_mov_b32 s23,4718848
buffer_load_dwordx4 v5,s[40:43],s23 offen lds
s_add_u32 m0,s21,53248
s_mov_b32 s23,5112064
buffer_load_dwordx4 v5,s[40:43],s23 offen lds
s_add_u32 m0,s21,57344
s_mov_b32 s23,5505280
buffer_load_dwordx4 v5,s[40:43],s23 offen lds
s_add_u32 m0,s21,61440
s_mov_b32 s23,5898496
buffer_load_dwordx4 v5,s[40:43],s23 offen lds
s_add_u32 m0,s21,65536
s_mov_b32 s23,6291712
buffer_load_dwordx4 v5,s[40:43],s23 offen lds
s_add_u32 m0,s21,69632
s_mov_b32 s23,6684928
buffer_load_dwordx4 v5,s[40:43],s23 offen lds
s_add_u32 m0,s21,73728
s_mov_b32 s23,7078144
buffer_load_dwordx4 v5,s[40:43],s23 offen lds
s_add_u32 m0,s21,77824
s_mov_b32 s23,7471360
buffer_load_dwordx4 v5,s[40:43],s23 offen lds
v_add_u32 v8,40960,v8
v_add_u32 v9,40960,v9
v_add_u32 v10,40960,v10
v_add_u32 v11,40960,v11
v_add_u32 v12,40960,v12
v_add_u32 v13,40960,v13
v_add_u32 v14,40960,v14
v_add_u32 v15,40960,v15
tr v[20:21],v8,0
tr v[22:23],v12,0
tr v[24:25],v9,0
tr v[26:27],v13,0
tr v[28:29],v10,0
tr v[30:31],v14,0
tr v[32:33],v11,0
tr v[34:35],v15,0
mf v[52:55],v[36:39],a[76:79],v[52:55]
mf v[68:71],v[36:39],a[156:159],v[68:71]
mf v[56:59],v[40:43],a[76:79],v[56:59]
mf v[72:75],v[40:43],a[156:159],v[72:75]
mf v[60:63],v[44:47],a[76:79],v[60:63]
mf v[76:79],v[44:47],a[156:159],v[76:79]
mf v[64:67],v[48:51],a[76:79],v[64:67]
mf v[80:83],v[48:51],a[156:159],v[80:83]
s_nop 7
s_nop 1
cv v180,v52,v53
cv v181,v54,v55
cv v182,v56,v57
cv v183,v58,v59
cv v184,v60,v61
cv v185,v62,v63
cv v186,v64,v65
cv v187,v66,v67
cv v188,v68,v69
cv v189,v70,v71
cv v190,v72,v73
cv v191,v74,v75
cv v192,v76,v77
cv v193,v78,v79
cv v194,v80,v81
cv v195,v82,v83
s_nop 1
s_waitcnt lgkmcnt(0)
tr v[36:37],v8,4096
tr v[38:39],v12,4096
tr v[40:41],v9,4096
tr v[42:43],v13,4096
tr v[44:45],v10,4096
tr v[46:47],v14,4096
tr v[48:49],v11,4096
tr v[50:51],v15,4096
mf v[52:55],v[20:23],a[0:3],0
mf v[68:71],v[20:23],a[80:83],0
mf v[56:59],v[24:27],a[0:3],0
mf v[72:75],v[24:27],a[80:83],0
mf v[60:63],v[28:31],a[0:3],0
mf v[76:79],v[28:31],a[80:83],0
mf v[64:67],v[32:35],a[0:3],0
mf v[80:83],v[32:35],a[80:83],0
s_waitcnt lgkmcnt(0)
tr v[20:21],v8,8192
tr v[22:23],v12,8192
tr v[24:25],v9,8192
tr v[26:27],v13,8192
tr v[28:29],v10,8192
tr v[30:31],v14,8192
tr v[32:33],v11,8192
tr v[34:35],v15,8192
mf v[52:55],v[36:39],a[4:7],v[52:55]
mf v[68:71],v[36:39],a[84:87],v[68:71]
mf v[56:59],v[40:43],a[4:7],v[56:59]
mf v[72:75],v[40:43],a[84:87],v[72:75]
mf v[60:63],v[44:47],a[4:7],v[60:63]
mf v[76:79],v[44:47],a[84:87],v[76:79]
mf v[64:67],v[48:51],a[4:7],v[64:67]
mf v[80:83],v[48:51],a[84:87],v[80:83]
s_waitcnt lgkmcnt(0)
tr v[36:37],v8,12288
tr v[38:39],v12,12288
tr v[40:41],v9,12288
tr v[42:43],v13,12288
tr v[44:45],v10,12288
tr v[46:47],v14,12288
tr v[48:49],v11,12288
tr v[50:51],v15,12288
mf v[52:55],v[20:23],a[8:11],v[52:55]
mf v[68:71],v[20:23],a[88:91],v[68:71]
mf v[56:59],v[24:27],a[8:11],v[56:59]
mf v[72:75],v[24:27],a[88:91],v[72:75]
mf v[60:63],v[28:31],a[8:11],v[60:63]
mf v[76:79],v[28:31],a[88:91],v[76:79]
mf v[64:67],v[32:35],a[8:11],v[64:67]
mf v[80:83],v[32:35],a[88:91],v[80:83]
s_waitcnt lgkmcnt(0)
tr v[20:21],v8,16384
tr v[22:23],v12,16384
tr v[24:25],v9,16384
tr v[26:27],v13,16384
tr v[28:29],v10,16384
tr v[30:31],v14,16384
tr v[32:33],v11,16384
tr v[34:35],v15,16384
mf v[52:55],v[36:39],a[12:15],v[52:55]
mf v[68:71],v[36:39],a[92:95],v[68:71]
mf v[56:59],v[40:43],a[12:15],v[56:59]
mf v[72:75],v[40:43],a[92:95],v[72:75]
mf v[60:63],v[44:47],a[12:15],v[60:63]
mf v[76:79],v[44:47],a[92:95],v[76:79]
mf v[64:67],v[48:51],a[12:15],v[64:67]
mf v[80:83],v[48:51],a[92:95],v[80:83]
s_waitcnt lgkmcnt(0)
tr v[36:37],v8,20480
tr v[38:39],v12,20480
tr v[40:41],v9,20480
tr v[42:43],v13,20480
tr v[44:45],v10,20480
tr v[46:47],v14,20480
tr v[48:49],v11,20480
tr v[50:51],v15,20480
mf v[52:55],v[20:23],a[16:19],v[52:55]
mf v[68:71],v[20:23],a[96:99],v[68:71]
mf v[56:59],v[24:27],a[16:19],v[56:59]
mf v[72:75],v[24:27],a[96:99],v[72:75]
mf v[60:63],v[28:31],a[16:19],v[60:63]
mf v[76:79],v[28:31],a[96:99],v[76:79]
mf v[64:67],v[32:35],a[16:19],v[64:67]
mf v[80:83],v[32:35],a[96:99],v[80:83]
s_waitcnt lgkmcnt(0)
tr v[20:21],v8,24576
tr v[22:23],v12,24576
tr v[24:25],v9,24576
tr v[26:27],v13,24576
tr v[28:29],v10,24576
tr v[30:31],v14,24576
tr v[32:33],v11,24576
tr v[34:35],v15,24576
mf v[52:55],v[36:39],a[20:23],v[52:55]
mf v[68:71],v[36:39],a[100:103],v[68:71]
mf v[56:59],v[40:43],a[20:23],v[56:59]
mf v[72:75],v[40:43],a[100:103],v[72:75]
mf v[60:63],v[44:47],a[20:23],v[60:63]
mf v[76:79],v[44:47],a[100:103],v[76:79]
mf v[64:67],v[48:51],a[20:23],v[64:67]
mf v[80:83],v[48:51],a[100:103],v[80:83]
s_waitcnt lgkmcnt(0)
tr v[36:37],v8,28672
tr v[38:39],v12,28672
tr v[40:41],v9,28672
tr v[42:43],v13,28672
tr v[44:45],v10,28672
tr v[46:47],v14,28672
tr v[48:49],v11,28672
tr v[50:51],v15,28672
mf v[52:55],v[20:23],a[24:27],v[52:55]
mf v[68:71],v[20:23],a[104:107],v[68:71]
mf v[56:59],v[24:27],a[24:27],v[56:59]
mf v[72:75],v[24:27],a[104:107],v[72:75]
mf v[60:63],v[28:31],a[24:27],v[60:63]
mf v[76:79],v[28:31],a[104:107],v[76:79]
mf v[64:67],v[32:35],a[24:27],v[64:67]
mf v[80:83],v[32:35],a[104:107],v[80:83]
s_waitcnt lgkmcnt(0)
tr v[20:21],v8,32768
tr v[22:23],v12,32768
tr v[24:25],v9,32768
tr v[26:27],v13,32768
tr v[28:29],v10,32768
tr v[30:31],v14,32768
tr v[32:33],v11,32768
tr v[34:35],v15,32768
mf v[52:55],v[36:39],a[28:31],v[52:55]
mf v[68:71],v[36:39],a[108:111],v[68:71]
mf v[56:59],v[40:43],a[28:31],v[56:59]
mf v[72:75],v[40:43],a[108:111],v[72:75]
mf v[60:63],v[44:47],a[28:31],v[60:63]
mf v[76:79],v[44:47],a[108:111],v[76:79]
mf v[64:67],v[48:51],a[28:31],v[64:67]
mf v[80:83],v[48:51],a[108:111],v[80:83]
s_waitcnt lgkmcnt(0)
tr v[36:37],v8,36864
tr v[38:39],v12,36864
tr v[40:41],v9,36864
tr v[42:43],v13,36864
tr v[44:45],v10,36864
tr v[46:47],v14,36864
tr v[48:49],v11,36864
tr v[50:51],v15,36864
mf v[52:55],v[20:23],a[32:35],v[52:55]
mf v[68:71],v[20:23],a[112:115],v[68:71]
mf v[56:59],v[24:27],a[32:35],v[56:59]
mf v[72:75],v[24:27],a[112:115],v[72:75]
mf v[60:63],v[28:31],a[32:35],v[60:63]
mf v[76:79],v[28:31],a[112:115],v[76:79]
mf v[64:67],v[32:35],a[32:35],v[64:67]
mf v[80:83],v[32:35],a[112:115],v[80:83]
s_waitcnt lgkmcnt(0)
s_waitcnt vmcnt(20)
s_barrier
s_add_u32 m0,s21,81920
s_mov_b32 s23,0
buffer_load_dwordx4 v6,s[44:47],s23 offen lds
s_add_u32 m0,s21,86016
s_mov_b32 s23,40960
buffer_load_dwordx4 v6,s[44:47],s23 offen lds
s_add_u32 m0,s21,90112
s_mov_b32 s23,81920
buffer_load_dwordx4 v6,s[44:47],s23 offen lds
s_add_u32 m0,s21,94208
s_mov_b32 s23,122880
buffer_load_dwordx4 v6,s[44:47],s23 offen lds
s_add_u32 m0,s21,98304
s_mov_b32 s23,163840
buffer_load_dwordx4 v6,s[44:47],s23 offen lds
s_add_u32 m0,s21,102400
s_mov_b32 s23,204800
buffer_load_dwordx4 v6,s[44:47],s23 offen lds
v_add_u32 v8,40960,v8
v_add_u32 v9,40960,v9
v_add_u32 v10,40960,v10
v_add_u32 v11,40960,v11
v_add_u32 v12,40960,v12
v_add_u32 v13,40960,v13
v_add_u32 v14,40960,v14
v_add_u32 v15,40960,v15
tr v[20:21],v8,0
tr v[22:23],v12,0
tr v[24:25],v9,0
tr v[26:27],v13,0
tr v[28:29],v10,0
tr v[30:31],v14,0
tr v[32:33],v11,0
tr v[34:35],v15,0
mf v[52:55],v[36:39],a[36:39],v[52:55]
mf v[68:71],v[36:39],a[116:119],v[68:71]
mf v[56:59],v[40:43],a[36:39],v[56:59]
mf v[72:75],v[40:43],a[116:119],v[72:75]
mf v[60:63],v[44:47],a[36:39],v[60:63]
mf v[76:79],v[44:47],a[116:119],v[76:79]
mf v[64:67],v[48:51],a[36:39],v[64:67]
mf v[80:83],v[48:51],a[116:119],v[80:83]
s_waitcnt lgkmcnt(0)
tr v[36:37],v8,4096
tr v[38:39],v12,4096
tr v[40:41],v9,4096
tr v[42:43],v13,4096
tr v[44:45],v10,4096
tr v[46:47],v14,4096
tr v[48:49],v11,4096
tr v[50:51],v15,4096
mf v[52:55],v[20:23],a[40:43],v[52:55]
mf v[68:71],v[20:23],a[120:123],v[68:71]
mf v[56:59],v[24:27],a[40:43],v[56:59]
mf v[72:75],v[24:27],a[120:123],v[72:75]
mf v[60:63],v[28:31],a[40:43],v[60:63]
mf v[76:79],v[28:31],a[120:123],v[76:79]
mf v[64:67],v[32:35],a[40:43],v[64:67]
mf v[80:83],v[32:35],a[120:123],v[80:83]
s_waitcnt lgkmcnt(0)
tr v[20:21],v8,8192
tr v[22:23],v12,8192
tr v[24:25],v9,8192
tr v[26:27],v13,8192
tr v[28:29],v10,8192
tr v[30:31],v14,8192
tr v[32:33],v11,8192
tr v[34:35],v15,8192
mf v[52:55],v[36:39],a[44:47],v[52:55]
mf v[68:71],v[36:39],a[124:127],v[68:71]
mf v[56:59],v[40:43],a[44:47],v[56:59]
mf v[72:75],v[40:43],a[124:127],v[72:75]
mf v[60:63],v[44:47],a[44:47],v[60:63]
mf v[76:79],v[44:47],a[124:127],v[76:79]
mf v[64:67],v[48:51],a[44:47],v[64:67]
mf v[80:83],v[48:51],a[124:127],v[80:83]
s_waitcnt lgkmcnt(0)
tr v[36:37],v8,12288
tr v[38:39],v12,12288
tr v[40:41],v9,12288
tr v[42:43],v13,12288
tr v[44:45],v10,12288
tr v[46:47],v14,12288
tr v[48:49],v11,12288
tr v[50:51],v15,12288
mf v[52:55],v[20:23],a[48:51],v[52:55]
mf v[68:71],v[20:23],a[128:131],v[68:71]
mf v[56:59],v[24:27],a[48:51],v[56:59]
mf v[72:75],v[24:27],a[128:131],v[72:75]
mf v[60:63],v[28:31],a[48:51],v[60:63]
mf v[76:79],v[28:31],a[128:131],v[76:79]
mf v[64:67],v[32:35],a[48:51],v[64:67]
mf v[80:83],v[32:35],a[128:131],v[80:83]
s_waitcnt lgkmcnt(0)
tr v[20:21],v8,16384
tr v[22:23],v12,16384
tr v[24:25],v9,16384
tr v[26:27],v13,16384
tr v[28:29],v10,16384
tr v[30:31],v14,16384
tr v[32:33],v11,16384
tr v[34:35],v15,16384
mf v[52:55],v[36:39],a[52:55],v[52:55]
mf v[68:71],v[36:39],a[132:135],v[68:71]
mf v[56:59],v[40:43],a[52:55],v[56:59]
mf v[72:75],v[40:43],a[132:135],v[72:75]
mf v[60:63],v[44:47],a[52:55],v[60:63]
mf v[76:79],v[44:47],a[132:135],v[76:79]
mf v[64:67],v[48:51],a[52:55],v[64:67]
mf v[80:83],v[48:51],a[132:135],v[80:83]
s_waitcnt lgkmcnt(0)
tr v[36:37],v8,20480
tr v[38:39],v12,20480
tr v[40:41],v9,20480
tr v[42:43],v13,20480
tr v[44:45],v10,20480
tr v[46:47],v14,20480
tr v[48:49],v11,20480
tr v[50:51],v15,20480
mf v[52:55],v[20:23],a[56:59],v[52:55]
mf v[68:71],v[20:23],a[136:139],v[68:71]
mf v[56:59],v[24:27],a[56:59],v[56:59]
mf v[72:75],v[24:27],a[136:139],v[72:75]
mf v[60:63],v[28:31],a[56:59],v[60:63]
mf v[76:79],v[28:31],a[136:139],v[76:79]
mf v[64:67],v[32:35],a[56:59],v[64:67]
mf v[80:83],v[32:35],a[136:139],v[80:83]
s_waitcnt lgkmcnt(0)
tr v[20:21],v8,24576
tr v[22:23],v12,24576
tr v[24:25],v9,24576
tr v[26:27],v13,24576
tr v[28:29],v10,24576
tr v[30:31],v14,24576
tr v[32:33],v11,24576
tr v[34:35],v15,24576
mf v[52:55],v[36:39],a[60:63],v[52:55]
mf v[68:71],v[36:39],a[140:143],v[68:71]
mf v[56:59],v[40:43],a[60:63],v[56:59]
mf v[72:75],v[40:43],a[140:143],v[72:75]
mf v[60:63],v[44:47],a[60:63],v[60:63]
mf v[76:79],v[44:47],a[140:143],v[76:79]
mf v[64:67],v[48:51],a[60:63],v[64:67]
mf v[80:83],v[48:51],a[140:143],v[80:83]
s_waitcnt lgkmcnt(0)
tr v[36:37],v8,28672
tr v[38:39],v12,28672
tr v[40:41],v9,28672
tr v[42:43],v13,28672
tr v[44:45],v10,28672
tr v[46:47],v14,28672
tr v[48:49],v11,28672
tr v[50:51],v15,28672
mf v[52:55],v[20:23],a[64:67],v[52:55]
mf v[68:71],v[20:23],a[144:147],v[68:71]
mf v[56:59],v[24:27],a[64:67],v[56:59]
mf v[72:75],v[24:27],a[144:147],v[72:75]
mf v[60:63],v[28:31],a[64:67],v[60:63]
mf v[76:79],v[28:31],a[144:147],v[76:79]
mf v[64:67],v[32:35],a[64:67],v[64:67]
mf v[80:83],v[32:35],a[144:147],v[80:83]
s_waitcnt lgkmcnt(0)
tr v[20:21],v8,32768
tr v[22:23],v12,32768
tr v[24:25],v9,32768
tr v[26:27],v13,32768
tr v[28:29],v10,32768
tr v[30:31],v14,32768
tr v[32:33],v11,32768
tr v[34:35],v15,32768
mf v[52:55],v[36:39],a[68:71],v[52:55]
mf v[68:71],v[36:39],a[148:151],v[68:71]
mf v[56:59],v[40:43],a[68:71],v[56:59]
mf v[72:75],v[40:43],a[148:151],v[72:75]
mf v[60:63],v[44:47],a[68:71],v[60:63]
mf v[76:79],v[44:47],a[148:151],v[76:79]
mf v[64:67],v[48:51],a[68:71],v[64:67]
mf v[80:83],v[48:51],a[148:151],v[80:83]
s_waitcnt lgkmcnt(0)
tr v[36:37],v8,36864
tr v[38:39],v12,36864
tr v[40:41],v9,36864
tr v[42:43],v13,36864
tr v[44:45],v10,36864
tr v[46:47],v14,36864
tr v[48:49],v11,36864
tr v[50:51],v15,36864
mf v[52:55],v[20:23],a[72:75],v[52:55]
mf v[68:71],v[20:23],a[152:155],v[68:71]
mf v[56:59],v[24:27],a[72:75],v[56:59]
mf v[72:75],v[24:27],a[152:155],v[72:75]
mf v[60:63],v[28:31],a[72:75],v[60:63]
mf v[76:79],v[28:31],a[152:155],v[76:79]
mf v[64:67],v[32:35],a[72:75],v[64:67]
mf v[80:83],v[32:35],a[152:155],v[80:83]
s_waitcnt lgkmcnt(0)
s_waitcnt vmcnt(16)
s_barrier
s_add_u32 m0,s21,122880
s_mov_b32 s23,128
buffer_load_dwordx4 v6,s[44:47],s23 offen lds
s_add_u32 m0,s21,126976
s_mov_b32 s23,41088
buffer_load_dwordx4 v6,s[44:47],s23 offen lds
s_add_u32 m0,s21,131072
s_mov_b32 s23,82048
buffer_load_dwordx4 v6,s[44:47],s23 offen lds
s_add_u32 m0,s21,135168
s_mov_b32 s23,123008
buffer_load_dwordx4 v6,s[44:47],s23 offen lds
s_add_u32 m0,s21,139264
s_mov_b32 s23,163968
buffer_load_dwordx4 v6,s[44:47],s23 offen lds
s_add_u32 m0,s21,143360
s_mov_b32 s23,204928
buffer_load_dwordx4 v6,s[44:47],s23 offen lds
v_add_u32 v8,4294844416,v8
v_add_u32 v9,4294844416,v9
v_add_u32 v10,4294844416,v10
v_add_u32 v11,4294844416,v11
v_add_u32 v12,4294844416,v12
v_add_u32 v13,4294844416,v13
v_add_u32 v14,4294844416,v14
v_add_u32 v15,4294844416,v15
tr v[20:21],v8,0
tr v[22:23],v12,0
tr v[24:25],v9,0
tr v[26:27],v13,0
tr v[28:29],v10,0
tr v[30:31],v14,0
tr v[32:33],v11,0
tr v[34:35],v15,0
mf v[52:55],v[36:39],a[76:79],v[52:55]
mf v[68:71],v[36:39],a[156:159],v[68:71]
mf v[56:59],v[40:43],a[76:79],v[56:59]
mf v[72:75],v[40:43],a[156:159],v[72:75]
mf v[60:63],v[44:47],a[76:79],v[60:63]
mf v[76:79],v[44:47],a[156:159],v[76:79]
mf v[64:67],v[48:51],a[76:79],v[64:67]
mf v[80:83],v[48:51],a[156:159],v[80:83]
s_nop 7
s_nop 1
cv v212,v52,v53
cv v213,v54,v55
cv v214,v56,v57
cv v215,v58,v59
cv v216,v60,v61
cv v217,v62,v63
cv v218,v64,v65
cv v219,v66,v67
cv v220,v68,v69
cv v221,v70,v71
cv v222,v72,v73
cv v223,v74,v75
cv v224,v76,v77
cv v225,v78,v79
cv v226,v80,v81
cv v227,v82,v83
s_nop 1
s_waitcnt lgkmcnt(0)
tr v[36:37],v8,4096
tr v[38:39],v12,4096
tr v[40:41],v9,4096
tr v[42:43],v13,4096
tr v[44:45],v10,4096
tr v[46:47],v14,4096
tr v[48:49],v11,4096
tr v[50:51],v15,4096
mf v[52:55],v[20:23],a[0:3],0
mf v[68:71],v[20:23],a[80:83],0
mf v[56:59],v[24:27],a[0:3],0
mf v[72:75],v[24:27],a[80:83],0
mf v[60:63],v[28:31],a[0:3],0
mf v[76:79],v[28:31],a[80:83],0
mf v[64:67],v[32:35],a[0:3],0
mf v[80:83],v[32:35],a[80:83],0
s_waitcnt lgkmcnt(0)
tr v[20:21],v8,8192
tr v[22:23],v12,8192
tr v[24:25],v9,8192
tr v[26:27],v13,8192
tr v[28:29],v10,8192
tr v[30:31],v14,8192
tr v[32:33],v11,8192
tr v[34:35],v15,8192
mf v[52:55],v[36:39],a[4:7],v[52:55]
mf v[68:71],v[36:39],a[84:87],v[68:71]
mf v[56:59],v[40:43],a[4:7],v[56:59]
mf v[72:75],v[40:43],a[84:87],v[72:75]
mf v[60:63],v[44:47],a[4:7],v[60:63]
mf v[76:79],v[44:47],a[84:87],v[76:79]
mf v[64:67],v[48:51],a[4:7],v[64:67]
mf v[80:83],v[48:51],a[84:87],v[80:83]
s_waitcnt lgkmcnt(0)
tr v[36:37],v8,12288
tr v[38:39],v12,12288
tr v[40:41],v9,12288
tr v[42:43],v13,12288
tr v[44:45],v10,12288
tr v[46:47],v14,12288
tr v[48:49],v11,12288
tr v[50:51],v15,12288
mf v[52:55],v[20:23],a[8:11],v[52:55]
mf v[68:71],v[20:23],a[88:91],v[68:71]
mf v[56:59],v[24:27],a[8:11],v[56:59]
mf v[72:75],v[24:27],a[88:91],v[72:75]
mf v[60:63],v[28:31],a[8:11],v[60:63]
mf v[76:79],v[28:31],a[88:91],v[76:79]
mf v[64:67],v[32:35],a[8:11],v[64:67]
mf v[80:83],v[32:35],a[88:91],v[80:83]
s_waitcnt lgkmcnt(0)
tr v[20:21],v8,16384
tr v[22:23],v12,16384
tr v[24:25],v9,16384
tr v[26:27],v13,16384
tr v[28:29],v10,16384
tr v[30:31],v14,16384
tr v[32:33],v11,16384
tr v[34:35],v15,16384
mf v[52:55],v[36:39],a[12:15],v[52:55]
mf v[68:71],v[36:39],a[92:95],v[68:71]
mf v[56:59],v[40:43],a[12:15],v[56:59]
mf v[72:75],v[40:43],a[92:95],v[72:75]
mf v[60:63],v[44:47],a[12:15],v[60:63]
mf v[76:79],v[44:47],a[92:95],v[76:79]
mf v[64:67],v[48:51],a[12:15],v[64:67]
mf v[80:83],v[48:51],a[92:95],v[80:83]
s_waitcnt lgkmcnt(0)
tr v[36:37],v8,20480
tr v[38:39],v12,20480
tr v[40:41],v9,20480
tr v[42:43],v13,20480
tr v[44:45],v10,20480
tr v[46:47],v14,20480
tr v[48:49],v11,20480
tr v[50:51],v15,20480
mf v[52:55],v[20:23],a[16:19],v[52:55]
mf v[68:71],v[20:23],a[96:99],v[68:71]
mf v[56:59],v[24:27],a[16:19],v[56:59]
mf v[72:75],v[24:27],a[96:99],v[72:75]
mf v[60:63],v[28:31],a[16:19],v[60:63]
mf v[76:79],v[28:31],a[96:99],v[76:79]
mf v[64:67],v[32:35],a[16:19],v[64:67]
mf v[80:83],v[32:35],a[96:99],v[80:83]
s_waitcnt lgkmcnt(0)
tr v[20:21],v8,24576
tr v[22:23],v12,24576
tr v[24:25],v9,24576
tr v[26:27],v13,24576
tr v[28:29],v10,24576
tr v[30:31],v14,24576
tr v[32:33],v11,24576
tr v[34:35],v15,24576
mf v[52:55],v[36:39],a[20:23],v[52:55]
mf v[68:71],v[36:39],a[100:103],v[68:71]
mf v[56:59],v[40:43],a[20:23],v[56:59]
mf v[72:75],v[40:43],a[100:103],v[72:75]
mf v[60:63],v[44:47],a[20:23],v[60:63]
mf v[76:79],v[44:47],a[100:103],v[76:79]
mf v[64:67],v[48:51],a[20:23],v[64:67]
mf v[80:83],v[48:51],a[100:103],v[80:83]
s_waitcnt lgkmcnt(0)
tr v[36:37],v8,28672
tr v[38:39],v12,28672
tr v[40:41],v9,28672
tr v[42:43],v13,28672
tr v[44:45],v10,28672
tr v[46:47],v14,28672
tr v[48:49],v11,28672
tr v[50:51],v15,28672
mf v[52:55],v[20:23],a[24:27],v[52:55]
mf v[68:71],v[20:23],a[104:107],v[68:71]
mf v[56:59],v[24:27],a[24:27],v[56:59]
mf v[72:75],v[24:27],a[104:107],v[72:75]
mf v[60:63],v[28:31],a[24:27],v[60:63]
mf v[76:79],v[28:31],a[104:107],v[76:79]
mf v[64:67],v[32:35],a[24:27],v[64:67]
mf v[80:83],v[32:35],a[104:107],v[80:83]
s_waitcnt lgkmcnt(0)
tr v[20:21],v8,32768
tr v[22:23],v12,32768
tr v[24:25],v9,32768
tr v[26:27],v13,32768
tr v[28:29],v10,32768
tr v[30:31],v14,32768
tr v[32:33],v11,32768
tr v[34:35],v15,32768
mf v[52:55],v[36:39],a[28:31],v[52:55]
mf v[68:71],v[36:39],a[108:111],v[68:71]
mf v[56:59],v[40:43],a[28:31],v[56:59]
mf v[72:75],v[40:43],a[108:111],v[72:75]
mf v[60:63],v[44:47],a[28:31],v[60:63]
mf v[76:79],v[44:47],a[108:111],v[76:79]
mf v[64:67],v[48:51],a[28:31],v[64:67]
mf v[80:83],v[48:51],a[108:111],v[80:83]
s_waitcnt lgkmcnt(0)
tr v[36:37],v8,36864
tr v[38:39],v12,36864
tr v[40:41],v9,36864
tr v[42:43],v13,36864
tr v[44:45],v10,36864
tr v[46:47],v14,36864
tr v[48:49],v11,36864
tr v[50:51],v15,36864
mf v[52:55],v[20:23],a[32:35],v[52:55]
mf v[68:71],v[20:23],a[112:115],v[68:71]
mf v[56:59],v[24:27],a[32:35],v[56:59]
mf v[72:75],v[24:27],a[112:115],v[72:75]
mf v[60:63],v[28:31],a[32:35],v[60:63]
mf v[76:79],v[28:31],a[112:115],v[76:79]
mf v[64:67],v[32:35],a[32:35],v[64:67]
mf v[80:83],v[32:35],a[112:115],v[80:83]
s_waitcnt lgkmcnt(0)
s_waitcnt vmcnt(12)
s_barrier
s_add_u32 m0,s21,0
s_mov_b32 s23,256
buffer_load_dwordx4 v6,s[44:47],s23 offen lds
s_add_u32 m0,s21,4096
s_mov_b32 s23,41216
buffer_load_dwordx4 v6,s[44:47],s23 offen lds
s_add_u32 m0,s21,8192
s_mov_b32 s23,82176
buffer_load_dwordx4 v6,s[44:47],s23 offen lds
s_add_u32 m0,s21,12288
s_mov_b32 s23,123136
buffer_load_dwordx4 v6,s[44:47],s23 offen lds
s_add_u32 m0,s21,16384
s_mov_b32 s23,164096
buffer_load_dwordx4 v6,s[44:47],s23 offen lds
s_add_u32 m0,s21,20480
s_mov_b32 s23,205056
buffer_load_dwordx4 v6,s[44:47],s23 offen lds
v_add_u32 v8,40960,v8
v_add_u32 v9,40960,v9
v_add_u32 v10,40960,v10
v_add_u32 v11,40960,v11
v_add_u32 v12,40960,v12
v_add_u32 v13,40960,v13
v_add_u32 v14,40960,v14
v_add_u32 v15,40960,v15
tr v[20:21],v8,0
tr v[22:23],v12,0
tr v[24:25],v9,0
tr v[26:27],v13,0
tr v[28:29],v10,0
tr v[30:31],v14,0
tr v[32:33],v11,0
tr v[34:35],v15,0
mf v[52:55],v[36:39],a[36:39],v[52:55]
mf v[68:71],v[36:39],a[116:119],v[68:71]
mf v[56:59],v[40:43],a[36:39],v[56:59]
mf v[72:75],v[40:43],a[116:119],v[72:75]
mf v[60:63],v[44:47],a[36:39],v[60:63]
mf v[76:79],v[44:47],a[116:119],v[76:79]
mf v[64:67],v[48:51],a[36:39],v[64:67]
mf v[80:83],v[48:51],a[116:119],v[80:83]
s_waitcnt lgkmcnt(0)
tr v[36:37],v8,4096
tr v[38:39],v12,4096
tr v[40:41],v9,4096
tr v[42:43],v13,4096
tr v[44:45],v10,4096
tr v[46:47],v14,4096
tr v[48:49],v11,4096
tr v[50:51],v15,4096
mf v[52:55],v[20:23],a[40:43],v[52:55]
mf v[68:71],v[20:23],a[120:123],v[68:71]
mf v[56:59],v[24:27],a[40:43],v[56:59]
mf v[72:75],v[24:27],a[120:123],v[72:75]
mf v[60:63],v[28:31],a[40:43],v[60:63]
mf v[76:79],v[28:31],a[120:123],v[76:79]
mf v[64:67],v[32:35],a[40:43],v[64:67]
mf v[80:83],v[32:35],a[120:123],v[80:83]
s_waitcnt lgkmcnt(0)
tr v[20:21],v8,8192
tr v[22:23],v12,8192
tr v[24:25],v9,8192
tr v[26:27],v13,8192
tr v[28:29],v10,8192
tr v[30:31],v14,8192
tr v[32:33],v11,8192
tr v[34:35],v15,8192
mf v[52:55],v[36:39],a[44:47],v[52:55]
mf v[68:71],v[36:39],a[124:127],v[68:71]
mf v[56:59],v[40:43],a[44:47],v[56:59]
mf v[72:75],v[40:43],a[124:127],v[72:75]
mf v[60:63],v[44:47],a[44:47],v[60:63]
mf v[76:79],v[44:47],a[124:127],v[76:79]
mf v[64:67],v[48:51],a[44:47],v[64:67]
mf v[80:83],v[48:51],a[124:127],v[80:83]
s_waitcnt lgkmcnt(0)
tr v[36:37],v8,12288
tr v[38:39],v12,12288
tr v[40:41],v9,12288
tr v[42:43],v13,12288
tr v[44:45],v10,12288
tr v[46:47],v14,12288
tr v[48:49],v11,12288
tr v[50:51],v15,12288
mf v[52:55],v[20:23],a[48:51],v[52:55]
mf v[68:71],v[20:23],a[128:131],v[68:71]
mf v[56:59],v[24:27],a[48:51],v[56:59]
mf v[72:75],v[24:27],a[128:131],v[72:75]
mf v[60:63],v[28:31],a[48:51],v[60:63]
mf v[76:79],v[28:31],a[128:131],v[76:79]
mf v[64:67],v[32:35],a[48:51],v[64:67]
mf v[80:83],v[32:35],a[128:131],v[80:83]
s_waitcnt lgkmcnt(0)
tr v[20:21],v8,16384
tr v[22:23],v12,16384
tr v[24:25],v9,16384
tr v[26:27],v13,16384
tr v[28:29],v10,16384
tr v[30:31],v14,16384
tr v[32:33],v11,16384
tr v[34:35],v15,16384
mf v[52:55],v[36:39],a[52:55],v[52:55]
mf v[68:71],v[36:39],a[132:135],v[68:71]
mf v[56:59],v[40:43],a[52:55],v[56:59]
mf v[72:75],v[40:43],a[132:135],v[72:75]
mf v[60:63],v[44:47],a[52:55],v[60:63]
mf v[76:79],v[44:47],a[132:135],v[76:79]
mf v[64:67],v[48:51],a[52:55],v[64:67]
mf v[80:83],v[48:51],a[132:135],v[80:83]
s_waitcnt lgkmcnt(0)
tr v[36:37],v8,20480
tr v[38:39],v12,20480
tr v[40:41],v9,20480
tr v[42:43],v13,20480
tr v[44:45],v10,20480
tr v[46:47],v14,20480
tr v[48:49],v11,20480
tr v[50:51],v15,20480
mf v[52:55],v[20:23],a[56:59],v[52:55]
mf v[68:71],v[20:23],a[136:139],v[68:71]
mf v[56:59],v[24:27],a[56:59],v[56:59]
mf v[72:75],v[24:27],a[136:139],v[72:75]
mf v[60:63],v[28:31],a[56:59],v[60:63]
mf v[76:79],v[28:31],a[136:139],v[76:79]
mf v[64:67],v[32:35],a[56:59],v[64:67]
mf v[80:83],v[32:35],a[136:139],v[80:83]
s_waitcnt lgkmcnt(0)
tr v[20:21],v8,24576
tr v[22:23],v12,24576
tr v[24:25],v9,24576
tr v[26:27],v13,24576
tr v[28:29],v10,24576
tr v[30:31],v14,24576
tr v[32:33],v11,24576
tr v[34:35],v15,24576
mf v[52:55],v[36:39],a[60:63],v[52:55]
mf v[68:71],v[36:39],a[140:143],v[68:71]
mf v[56:59],v[40:43],a[60:63],v[56:59]
mf v[72:75],v[40:43],a[140:143],v[72:75]
mf v[60:63],v[44:47],a[60:63],v[60:63]
mf v[76:79],v[44:47],a[140:143],v[76:79]
mf v[64:67],v[48:51],a[60:63],v[64:67]
mf v[80:83],v[48:51],a[140:143],v[80:83]
s_waitcnt lgkmcnt(0)
tr v[36:37],v8,28672
tr v[38:39],v12,28672
tr v[40:41],v9,28672
tr v[42:43],v13,28672
tr v[44:45],v10,28672
tr v[46:47],v14,28672
tr v[48:49],v11,28672
tr v[50:51],v15,28672
mf v[52:55],v[20:23],a[64:67],v[52:55]
mf v[68:71],v[20:23],a[144:147],v[68:71]
mf v[56:59],v[24:27],a[64:67],v[56:59]
mf v[72:75],v[24:27],a[144:147],v[72:75]
mf v[60:63],v[28:31],a[64:67],v[60:63]
mf v[76:79],v[28:31],a[144:147],v[76:79]
mf v[64:67],v[32:35],a[64:67],v[64:67]
mf v[80:83],v[32:35],a[144:147],v[80:83]
s_waitcnt lgkmcnt(0)
tr v[20:21],v8,32768
tr v[22:23],v12,32768
tr v[24:25],v9,32768
tr v[26:27],v13,32768
tr v[28:29],v10,32768
tr v[30:31],v14,32768
tr v[32:33],v11,32768
tr v[34:35],v15,32768
mf v[52:55],v[36:39],a[68:71],v[52:55]
mf v[68:71],v[36:39],a[148:151],v[68:71]
mf v[56:59],v[40:43],a[68:71],v[56:59]
mf v[72:75],v[40:43],a[148:151],v[72:75]
mf v[60:63],v[44:47],a[68:71],v[60:63]
mf v[76:79],v[44:47],a[148:151],v[76:79]
mf v[64:67],v[48:51],a[68:71],v[64:67]
mf v[80:83],v[48:51],a[148:151],v[80:83]
s_waitcnt lgkmcnt(0)
tr v[36:37],v8,36864
tr v[38:39],v12,36864
tr v[40:41],v9,36864
tr v[42:43],v13,36864
tr v[44:45],v10,36864
tr v[46:47],v14,36864
tr v[48:49],v11,36864
tr v[50:51],v15,36864
mf v[52:55],v[20:23],a[72:75],v[52:55]
mf v[68:71],v[20:23],a[152:155],v[68:71]
mf v[56:59],v[24:27],a[72:75],v[56:59]
mf v[72:75],v[24:27],a[152:155],v[72:75]
mf v[60:63],v[28:31],a[72:75],v[60:63]
mf v[76:79],v[28:31],a[152:155],v[76:79]
mf v[64:67],v[32:35],a[72:75],v[64:67]
mf v[80:83],v[32:35],a[152:155],v[80:83]
s_waitcnt lgkmcnt(0)
s_waitcnt vmcnt(12)
s_barrier
s_add_u32 m0,s21,40960
s_mov_b32 s23,384
buffer_load_dwordx4 v6,s[44:47],s23 offen lds
s_add_u32 m0,s21,45056
s_mov_b32 s23,41344
buffer_load_dwordx4 v6,s[44:47],s23 offen lds
s_add_u32 m0,s21,49152
s_mov_b32 s23,82304
buffer_load_dwordx4 v6,s[44:47],s23 offen lds
s_add_u32 m0,s21,53248
s_mov_b32 s23,123264
buffer_load_dwordx4 v6,s[44:47],s23 offen lds
s_add_u32 m0,s21,57344
s_mov_b32 s23,164224
buffer_load_dwordx4 v6,s[44:47],s23 offen lds
s_add_u32 m0,s21,61440
s_mov_b32 s23,205184
buffer_load_dwordx4 v6,s[44:47],s23 offen lds
v_add_u32 v16,81920,v16
v_add_u32 v17,81920,v17
v_add_u32 v18,81920,v18
v_add_u32 v19,81920,v19
tr v[20:21],v16,0
tr v[22:23],v16,2048
tr v[24:25],v17,0
tr v[26:27],v17,2048
tr v[28:29],v18,0
tr v[30:31],v18,2048
tr v[32:33],v19,0
tr v[34:35],v19,2048
mf v[52:55],v[36:39],a[76:79],v[52:55]
mf v[68:71],v[36:39],a[156:159],v[68:71]
mf v[56:59],v[40:43],a[76:79],v[56:59]
mf v[72:75],v[40:43],a[156:159],v[72:75]
mf v[60:63],v[44:47],a[76:79],v[60:63]
mf v[76:79],v[44:47],a[156:159],v[76:79]
mf v[64:67],v[48:51],a[76:79],v[64:67]
mf v[80:83],v[48:51],a[156:159],v[80:83]
s_nop 7
s_nop 1
cv v116,v52,v53
cv v117,v54,v55
cv v118,v56,v57
cv v119,v58,v59
cv v120,v60,v61
cv v121,v62,v63
cv v122,v64,v65
cv v123,v66,v67
cv v124,v68,v69
cv v125,v70,v71
cv v126,v72,v73
cv v127,v74,v75
cv v128,v76,v77
cv v129,v78,v79
cv v130,v80,v81
cv v131,v82,v83
s_nop 1
s_mov_b32 s64,5
s_mov_b32 s65,4294844416
s_add_u32 s66,s21,81920
s_mov_b32 s72,512
s_mov_b32 s73,0x7f000000
s_mov_b32 s74,0
t2h_kernel_loop:
s_waitcnt lgkmcnt(0)
tr v[36:37],v16,4096
tr v[38:39],v16,6144
tr v[40:41],v17,4096
tr v[42:43],v17,6144
tr v[44:45],v18,4096
tr v[46:47],v18,6144
tr v[48:49],v19,4096
tr v[50:51],v19,6144
mf v[52:55],v[180:183],v[20:23],0
mf v[68:71],v[188:191],v[20:23],0
mf v[56:59],v[180:183],v[24:27],0
mf v[72:75],v[188:191],v[24:27],0
s_add_u32 s23,s73,0
buffer_store_dwordx4 v[148:151],v249,s[60:63],s23 offen sc1
mf v[60:63],v[180:183],v[28:31],0
mf v[76:79],v[188:191],v[28:31],0
mf v[64:67],v[180:183],v[32:35],0
mf v[80:83],v[188:191],v[32:35],0
s_waitcnt lgkmcnt(0)
tr v[20:21],v16,8192
tr v[22:23],v16,10240
tr v[24:25],v17,8192
tr v[26:27],v17,10240
tr v[28:29],v18,8192
tr v[30:31],v18,10240
tr v[32:33],v19,8192
tr v[34:35],v19,10240
mf v[52:55],v[184:187],v[36:39],v[52:55]
mf v[68:71],v[192:195],v[36:39],v[68:71]
mf v[56:59],v[184:187],v[40:43],v[56:59]
mf v[72:75],v[192:195],v[40:43],v[72:75]
s_add_u32 s23,s73,1024
buffer_store_dwordx4 v[152:155],v249,s[60:63],s23 offen sc1
mf v[60:63],v[184:187],v[44:47],v[60:63]
mf v[76:79],v[192:195],v[44:47],v[76:79]
mf v[64:67],v[184:187],v[48:51],v[64:67]
mf v[80:83],v[192:195],v[48:51],v[80:83]
s_waitcnt lgkmcnt(0)
tr v[36:37],v16,12288
tr v[38:39],v16,14336
tr v[40:41],v17,12288
tr v[42:43],v17,14336
tr v[44:45],v18,12288
tr v[46:47],v18,14336
tr v[48:49],v19,12288
tr v[50:51],v19,14336
mf v[52:55],v[212:215],v[20:23],v[52:55]
mf v[68:71],v[220:223],v[20:23],v[68:71]
mf v[56:59],v[212:215],v[24:27],v[56:59]
mf v[72:75],v[220:223],v[24:27],v[72:75]
s_add_u32 s23,s73,2048
buffer_store_dwordx4 v[156:159],v249,s[60:63],s23 offen sc1
mf v[60:63],v[212:215],v[28:31],v[60:63]
mf v[76:79],v[220:223],v[28:31],v[76:79]
mf v[64:67],v[212:215],v[32:35],v[64:67]
mf v[80:83],v[220:223],v[32:35],v[80:83]
s_waitcnt lgkmcnt(0)
tr v[20:21],v16,16384
tr v[22:23],v16,18432
tr v[24:25],v17,16384
tr v[26:27],v17,18432
tr v[28:29],v18,16384
tr v[30:31],v18,18432
tr v[32:33],v19,16384
tr v[34:35],v19,18432
mf v[52:55],v[216:219],v[36:39],v[52:55]
mf v[68:71],v[224:227],v[36:39],v[68:71]
mf v[56:59],v[216:219],v[40:43],v[56:59]
mf v[72:75],v[224:227],v[40:43],v[72:75]
s_add_u32 s23,s73,3072
buffer_store_dwordx4 v[160:163],v249,s[60:63],s23 offen sc1
mf v[60:63],v[216:219],v[44:47],v[60:63]
mf v[76:79],v[224:227],v[44:47],v[76:79]
mf v[64:67],v[216:219],v[48:51],v[64:67]
mf v[80:83],v[224:227],v[48:51],v[80:83]
s_waitcnt lgkmcnt(0)
tr v[36:37],v16,20480
tr v[38:39],v16,22528
tr v[40:41],v17,20480
tr v[42:43],v17,22528
tr v[44:45],v18,20480
tr v[46:47],v18,22528
tr v[48:49],v19,20480
tr v[50:51],v19,22528
mf v[52:55],v[116:119],v[20:23],v[52:55]
mf v[68:71],v[124:127],v[20:23],v[68:71]
mf v[56:59],v[116:119],v[24:27],v[56:59]
mf v[72:75],v[124:127],v[24:27],v[72:75]
mf v[60:63],v[116:119],v[28:31],v[60:63]
mf v[76:79],v[124:127],v[28:31],v[76:79]
mf v[64:67],v[116:119],v[32:35],v[64:67]
mf v[80:83],v[124:127],v[32:35],v[80:83]
s_waitcnt lgkmcnt(0)
s_waitcnt vmcnt(12)
s_barrier
s_min_u32 s22,s72,1024
s_add_u32 m0,s66,0
s_add_u32 s23,s22,0
buffer_load_dwordx4 v6,s[44:47],s23 offen lds
s_add_u32 m0,s66,4096
s_add_u32 s23,s22,40960
buffer_load_dwordx4 v6,s[44:47],s23 offen lds
s_add_u32 m0,s66,8192
s_add_u32 s23,s22,81920
buffer_load_dwordx4 v6,s[44:47],s23 offen lds
s_add_u32 m0,s66,12288
s_add_u32 s23,s22,122880
buffer_load_dwordx4 v6,s[44:47],s23 offen lds
s_add_u32 m0,s66,16384
s_add_u32 s23,s22,163840
buffer_load_dwordx4 v6,s[44:47],s23 offen lds
s_add_u32 m0,s66,20480
s_add_u32 s23,s22,204800
buffer_load_dwordx4 v6,s[44:47],s23 offen lds
v_add_u32 v16,40960,v16
v_add_u32 v17,40960,v17
v_add_u32 v18,40960,v18
v_add_u32 v19,40960,v19
tr v[20:21],v16,0
tr v[22:23],v16,2048
tr v[24:25],v17,0
tr v[26:27],v17,2048
tr v[28:29],v18,0
tr v[30:31],v18,2048
tr v[32:33],v19,0
tr v[34:35],v19,2048
mf v[52:55],v[120:123],v[36:39],v[52:55]
mf v[68:71],v[128:131],v[36:39],v[68:71]
mf v[56:59],v[120:123],v[40:43],v[56:59]
mf v[72:75],v[128:131],v[40:43],v[72:75]
mf v[60:63],v[120:123],v[44:47],v[60:63]
mf v[76:79],v[128:131],v[44:47],v[76:79]
mf v[64:67],v[120:123],v[48:51],v[64:67]
mf v[80:83],v[128:131],v[48:51],v[80:83]
s_nop 7
s_nop 1
cv v148,v52,v53
cv v149,v54,v55
cv v150,v68,v69
cv v151,v70,v71
cv v152,v56,v57
cv v153,v58,v59
cv v154,v72,v73
cv v155,v74,v75
cv v156,v60,v61
cv v157,v62,v63
cv v158,v76,v77
cv v159,v78,v79
cv v160,v64,v65
cv v161,v66,v67
cv v162,v80,v81
cv v163,v82,v83
s_mov_b32 s73,s74
s_add_u32 s74,s74,4096
s_waitcnt lgkmcnt(0)
tr v[36:37],v16,4096
tr v[38:39],v16,6144
tr v[40:41],v17,4096
tr v[42:43],v17,6144
tr v[44:45],v18,4096
tr v[46:47],v18,6144
tr v[48:49],v19,4096
tr v[50:51],v19,6144
mf v[52:55],v[180:183],v[20:23],0
mf v[68:71],v[188:191],v[20:23],0
mf v[56:59],v[180:183],v[24:27],0
mf v[72:75],v[188:191],v[24:27],0
s_add_u32 s23,s73,0
buffer_store_dwordx4 v[148:151],v249,s[60:63],s23 offen sc1
mf v[60:63],v[180:183],v[28:31],0
mf v[76:79],v[188:191],v[28:31],0
mf v[64:67],v[180:183],v[32:35],0
mf v[80:83],v[188:191],v[32:35],0
s_waitcnt lgkmcnt(0)
tr v[20:21],v16,8192
tr v[22:23],v16,10240
tr v[24:25],v17,8192
tr v[26:27],v17,10240
tr v[28:29],v18,8192
tr v[30:31],v18,10240
tr v[32:33],v19,8192
tr v[34:35],v19,10240
mf v[52:55],v[184:187],v[36:39],v[52:55]
mf v[68:71],v[192:195],v[36:39],v[68:71]
mf v[56:59],v[184:187],v[40:43],v[56:59]
mf v[72:75],v[192:195],v[40:43],v[72:75]
s_add_u32 s23,s73,1024
buffer_store_dwordx4 v[152:155],v249,s[60:63],s23 offen sc1
mf v[60:63],v[184:187],v[44:47],v[60:63]
mf v[76:79],v[192:195],v[44:47],v[76:79]
mf v[64:67],v[184:187],v[48:51],v[64:67]
mf v[80:83],v[192:195],v[48:51],v[80:83]
s_waitcnt lgkmcnt(0)
tr v[36:37],v16,12288
tr v[38:39],v16,14336
tr v[40:41],v17,12288
tr v[42:43],v17,14336
tr v[44:45],v18,12288
tr v[46:47],v18,14336
tr v[48:49],v19,12288
tr v[50:51],v19,14336
mf v[52:55],v[212:215],v[20:23],v[52:55]
mf v[68:71],v[220:223],v[20:23],v[68:71]
mf v[56:59],v[212:215],v[24:27],v[56:59]
mf v[72:75],v[220:223],v[24:27],v[72:75]
s_add_u32 s23,s73,2048
buffer_store_dwordx4 v[156:159],v249,s[60:63],s23 offen sc1
mf v[60:63],v[212:215],v[28:31],v[60:63]
mf v[76:79],v[220:223],v[28:31],v[76:79]
mf v[64:67],v[212:215],v[32:35],v[64:67]
mf v[80:83],v[220:223],v[32:35],v[80:83]
s_waitcnt lgkmcnt(0)
tr v[20:21],v16,16384
tr v[22:23],v16,18432
tr v[24:25],v17,16384
tr v[26:27],v17,18432
tr v[28:29],v18,16384
tr v[30:31],v18,18432
tr v[32:33],v19,16384
tr v[34:35],v19,18432
mf v[52:55],v[216:219],v[36:39],v[52:55]
mf v[68:71],v[224:227],v[36:39],v[68:71]
mf v[56:59],v[216:219],v[40:43],v[56:59]
mf v[72:75],v[224:227],v[40:43],v[72:75]
s_add_u32 s23,s73,3072
buffer_store_dwordx4 v[160:163],v249,s[60:63],s23 offen sc1
mf v[60:63],v[216:219],v[44:47],v[60:63]
mf v[76:79],v[224:227],v[44:47],v[76:79]
mf v[64:67],v[216:219],v[48:51],v[64:67]
mf v[80:83],v[224:227],v[48:51],v[80:83]
s_waitcnt lgkmcnt(0)
tr v[36:37],v16,20480
tr v[38:39],v16,22528
tr v[40:41],v17,20480
tr v[42:43],v17,22528
tr v[44:45],v18,20480
tr v[46:47],v18,22528
tr v[48:49],v19,20480
tr v[50:51],v19,22528
mf v[52:55],v[116:119],v[20:23],v[52:55]
mf v[68:71],v[124:127],v[20:23],v[68:71]
mf v[56:59],v[116:119],v[24:27],v[56:59]
mf v[72:75],v[124:127],v[24:27],v[72:75]
mf v[60:63],v[116:119],v[28:31],v[60:63]
mf v[76:79],v[124:127],v[28:31],v[76:79]
mf v[64:67],v[116:119],v[32:35],v[64:67]
mf v[80:83],v[124:127],v[32:35],v[80:83]
s_waitcnt lgkmcnt(0)
s_waitcnt vmcnt(12)
s_barrier
s_min_u32 s22,s72,1024
s_add_u32 m0,s66,40960
s_add_u32 s23,s22,128
buffer_load_dwordx4 v6,s[44:47],s23 offen lds
s_add_u32 m0,s66,45056
s_add_u32 s23,s22,41088
buffer_load_dwordx4 v6,s[44:47],s23 offen lds
s_add_u32 m0,s66,49152
s_add_u32 s23,s22,82048
buffer_load_dwordx4 v6,s[44:47],s23 offen lds
s_add_u32 m0,s66,53248
s_add_u32 s23,s22,123008
buffer_load_dwordx4 v6,s[44:47],s23 offen lds
s_add_u32 m0,s66,57344
s_add_u32 s23,s22,163968
buffer_load_dwordx4 v6,s[44:47],s23 offen lds
s_add_u32 m0,s66,61440
s_add_u32 s23,s22,204928
buffer_load_dwordx4 v6,s[44:47],s23 offen lds
s_add_u32 s72,s72,256
v_add_u32 v16,s65,v16
v_add_u32 v17,s65,v17
v_add_u32 v18,s65,v18
v_add_u32 v19,s65,v19
tr v[20:21],v16,0
tr v[22:23],v16,2048
tr v[24:25],v17,0
tr v[26:27],v17,2048
tr v[28:29],v18,0
tr v[30:31],v18,2048
tr v[32:33],v19,0
tr v[34:35],v19,2048
mf v[52:55],v[120:123],v[36:39],v[52:55]
mf v[68:71],v[128:131],v[36:39],v[68:71]
mf v[56:59],v[120:123],v[40:43],v[56:59]
mf v[72:75],v[128:131],v[40:43],v[72:75]
mf v[60:63],v[120:123],v[44:47],v[60:63]
mf v[76:79],v[128:131],v[44:47],v[76:79]
mf v[64:67],v[120:123],v[48:51],v[64:67]
mf v[80:83],v[128:131],v[48:51],v[80:83]
s_nop 7
s_nop 1
cv v148,v52,v53
cv v149,v54,v55
cv v150,v68,v69
cv v151,v70,v71
cv v152,v56,v57
cv v153,v58,v59
cv v154,v72,v73
cv v155,v74,v75
cv v156,v60,v61
cv v157,v62,v63
cv v158,v76,v77
cv v159,v78,v79
cv v160,v64,v65
cv v161,v66,v67
cv v162,v80,v81
cv v163,v82,v83
s_mov_b32 s73,s74
s_add_u32 s74,s74,4096
s_sub_u32 s65,4294885376,s65
s_xor_b32 s66,s66,81920
s_sub_u32 s64,s64,1
s_cmp_lg_u32 s64,0
s_cbranch_scc1 t2h_kernel_loop
s_add_u32 s23,s73,0
buffer_store_dwordx4 v[148:151],v249,s[60:63],s23 offen sc1
s_add_u32 s23,s73,1024
buffer_store_dwordx4 v[152:155],v249,s[60:63],s23 offen sc1
s_add_u32 s23,s73,2048
buffer_store_dwordx4 v[156:159],v249,s[60:63],s23 offen sc1
s_add_u32 s23,s73,3072
buffer_store_dwordx4 v[160:163],v249,s[60:63],s23 offen sc1
s_branch task_done
t1h_kernel_entry:
s_load_dwordx4 s[4:7],s[0:1],16
s_load_dwordx4 s[8:11],s[0:1],32
s_load_dwordx2 s[12:13],s[0:1],128
v_and_b32 v1,63,v0
v_lshrrev_b32 v2,4,v1
v_and_b32 v3,15,v0
v_lshrrev_b32 v4,6,v0
s_nop 0
v_readfirstlane_b32 s20,v4
s_nop 3
s_lshl_b32 s21,s20,10
v_bfe_u32 v5,v1,2,2
v_lshl_add_u32 v6,v2,3,v5
v_lshlrev_b32 v6,7,v6
v_and_b32 v7,3,v1
v_lshl_add_u32 v6,v7,3,v6
v_lshrrev_b32 v5,1,v5
v_and_b32 v7,1,v2
v_xor_b32 v11,0,v7
v_lshl_or_b32 v11,v11,1,v5
v_xor_b32 v8,0,v11
v_lshl_add_u32 v8,v8,5,v6
v_xor_b32 v9,1,v11
v_lshl_add_u32 v9,v9,5,v6
v_xor_b32 v10,2,v11
v_lshl_add_u32 v10,v10,5,v6
v_xor_b32 v11,3,v11
v_lshl_add_u32 v11,v11,5,v6
v_xor_b32 v15,1,v7
v_lshl_or_b32 v15,v15,1,v5
v_xor_b32 v12,0,v15
v_lshl_add_u32 v12,v12,5,v6
v_add_u32 v12,512,v12
v_xor_b32 v13,1,v15
v_lshl_add_u32 v13,v13,5,v6
v_add_u32 v13,512,v13
v_xor_b32 v14,2,v15
v_lshl_add_u32 v14,v14,5,v6
v_add_u32 v14,512,v14
v_xor_b32 v15,3,v15
v_lshl_add_u32 v15,v15,5,v6
v_add_u32 v15,512,v15
v_bfe_u32 v5,v1,2,2
v_lshl_add_u32 v6,v2,2,v5
v_lshlrev_b32 v6,7,v6
v_and_b32 v7,3,v1
v_lshl_add_u32 v6,v7,3,v6
v_lshrrev_b32 v5,1,v5
v_lshrrev_b32 v7,1,v2
v_xor_b32 v7,v7,v2
v_and_b32 v7,1,v7
v_lshl_or_b32 v19,v7,1,v5
v_xor_b32 v16,0,v19
v_lshl_add_u32 v16,v16,5,v6
v_xor_b32 v17,1,v19
v_lshl_add_u32 v17,v17,5,v6
v_xor_b32 v18,2,v19
v_lshl_add_u32 v18,v18,5,v6
v_xor_b32 v19,3,v19
v_lshl_add_u32 v19,v19,5,v6
s_and_b32 s24,s2,31
s_lshr_b32 s25,s2,5
s_waitcnt lgkmcnt(0)
s_mul_i32 s26,s24,384
s_sub_u32 s27,7864320,s26
s_lshl_b32 s29,s25,2
s_add_u32 s29,s29,s20
s_mul_i32 s30,s29,40960
s_add_u32 s30,s30,26214400
s_add_u32 s48,s12,s30
s_addc_u32 s49,s13,0
s_mov_b32 s50,0xa000
s_mov_b32 s51,0x00020000
v_lshrrev_b32 v244,3,v1
v_lshl_add_u32 v245,v4,3,v244
v_bfe_u32 v246,v245,1,1
v_lshrrev_b32 v5,2,v245
v_lshrrev_b32 v244,3,v245
v_xor_b32 v5,v5,v244
v_and_b32 v5,1,v5
v_lshl_or_b32 v246,v5,1,v246
v_bfe_u32 v244,v1,1,2
v_xor_b32 v246,v246,v244
v_and_b32 v244,1,v1
v_lshl_or_b32 v246,v246,1,v244
v_lshlrev_b32 v246,4,v246
s_mov_b32 s22,12288
v_mul_lo_u32 v5,s22,v245
v_add_u32 v5,v5,v246
v_lshrrev_b32 v244,3,v1
v_lshl_add_u32 v245,v4,3,v244
v_bfe_u32 v246,v245,1,1
v_lshrrev_b32 v6,2,v245
v_lshrrev_b32 v244,3,v245
v_xor_b32 v6,v6,v244
v_and_b32 v6,1,v6
v_lshl_or_b32 v246,v6,1,v246
v_bfe_u32 v244,v1,1,2
v_xor_b32 v246,v246,v244
v_and_b32 v244,1,v1
v_lshl_or_b32 v246,v246,1,v244
v_lshlrev_b32 v246,4,v246
s_mov_b32 s22,1280
v_mul_lo_u32 v6,s22,v245
v_add_u32 v6,v6,v246
v_lshrrev_b32 v244,2,v3
v_and_b32 v245,3,v3
v_lshl_add_u32 v244,v244,3,v245
v_lshlrev_b32 v245,4,v2
v_mul_u32_u24 v247,1280,v244
v_add_u32 v247,v247,v245
v_mul_u32_u24 v248,12288,v244
v_add_u32 v248,v248,v245
v_lshl_add_u32 v249,v3,6,v245
v_lshlrev_b32 v250,4,v1
s_add_u32 s32,s4,s26
s_addc_u32 s33,s5,0
s_mov_b32 s34,s27
s_mov_b32 s35,0x00020000
s_add_u32 s36,s6,s26
s_addc_u32 s37,s7,0
s_mov_b32 s38,s27
s_mov_b32 s39,0x00020000
s_mul_i32 s30,s29,393216
s_add_u32 s30,s30,s26
s_add_u32 s30,s30,33554432
s_add_u32 s52,s12,s30
s_addc_u32 s53,s13,0
s_mov_b32 s54,0x1860000
s_mov_b32 s55,0x00020000
s_mov_b32 s23,0
buffer_load_dwordx4 a[0:3],v250,s[48:51],s23 offen
s_mov_b32 s23,1024
buffer_load_dwordx4 a[4:7],v250,s[48:51],s23 offen
s_mov_b32 s23,2048
buffer_load_dwordx4 a[8:11],v250,s[48:51],s23 offen
s_mov_b32 s23,3072
buffer_load_dwordx4 a[12:15],v250,s[48:51],s23 offen
s_mov_b32 s23,4096
buffer_load_dwordx4 a[16:19],v250,s[48:51],s23 offen
s_mov_b32 s23,5120
buffer_load_dwordx4 a[20:23],v250,s[48:51],s23 offen
s_mov_b32 s23,6144
buffer_load_dwordx4 a[24:27],v250,s[48:51],s23 offen
s_mov_b32 s23,7168
buffer_load_dwordx4 a[28:31],v250,s[48:51],s23 offen
s_mov_b32 s23,8192
buffer_load_dwordx4 a[32:35],v250,s[48:51],s23 offen
s_mov_b32 s23,9216
buffer_load_dwordx4 a[36:39],v250,s[48:51],s23 offen
s_mov_b32 s23,10240
buffer_load_dwordx4 a[40:43],v250,s[48:51],s23 offen
s_mov_b32 s23,11264
buffer_load_dwordx4 a[44:47],v250,s[48:51],s23 offen
s_mov_b32 s23,12288
buffer_load_dwordx4 a[48:51],v250,s[48:51],s23 offen
s_mov_b32 s23,13312
buffer_load_dwordx4 a[52:55],v250,s[48:51],s23 offen
s_mov_b32 s23,14336
buffer_load_dwordx4 a[56:59],v250,s[48:51],s23 offen
s_mov_b32 s23,15360
buffer_load_dwordx4 a[60:63],v250,s[48:51],s23 offen
s_mov_b32 s23,16384
buffer_load_dwordx4 a[64:67],v250,s[48:51],s23 offen
s_mov_b32 s23,17408
buffer_load_dwordx4 a[68:71],v250,s[48:51],s23 offen
s_mov_b32 s23,18432
buffer_load_dwordx4 a[72:75],v250,s[48:51],s23 offen
s_mov_b32 s23,19456
buffer_load_dwordx4 a[76:79],v250,s[48:51],s23 offen
s_mov_b32 s23,20480
buffer_load_dwordx4 a[80:83],v250,s[48:51],s23 offen
s_mov_b32 s23,21504
buffer_load_dwordx4 a[84:87],v250,s[48:51],s23 offen
s_mov_b32 s23,22528
buffer_load_dwordx4 a[88:91],v250,s[48:51],s23 offen
s_mov_b32 s23,23552
buffer_load_dwordx4 a[92:95],v250,s[48:51],s23 offen
s_mov_b32 s23,24576
buffer_load_dwordx4 a[96:99],v250,s[48:51],s23 offen
s_mov_b32 s23,25600
buffer_load_dwordx4 a[100:103],v250,s[48:51],s23 offen
s_mov_b32 s23,26624
buffer_load_dwordx4 a[104:107],v250,s[48:51],s23 offen
s_mov_b32 s23,27648
buffer_load_dwordx4 a[108:111],v250,s[48:51],s23 offen
s_mov_b32 s23,28672
buffer_load_dwordx4 a[112:115],v250,s[48:51],s23 offen
s_mov_b32 s23,29696
buffer_load_dwordx4 a[116:119],v250,s[48:51],s23 offen
s_mov_b32 s23,30720
buffer_load_dwordx4 a[120:123],v250,s[48:51],s23 offen
s_mov_b32 s23,31744
buffer_load_dwordx4 a[124:127],v250,s[48:51],s23 offen
s_mov_b32 s23,32768
buffer_load_dwordx4 a[128:131],v250,s[48:51],s23 offen
s_mov_b32 s23,33792
buffer_load_dwordx4 a[132:135],v250,s[48:51],s23 offen
s_mov_b32 s23,34816
buffer_load_dwordx4 a[136:139],v250,s[48:51],s23 offen
s_mov_b32 s23,35840
buffer_load_dwordx4 a[140:143],v250,s[48:51],s23 offen
s_mov_b32 s23,36864
buffer_load_dwordx4 a[144:147],v250,s[48:51],s23 offen
s_mov_b32 s23,37888
buffer_load_dwordx4 a[148:151],v250,s[48:51],s23 offen
s_mov_b32 s23,38912
buffer_load_dwordx4 a[152:155],v250,s[48:51],s23 offen
s_mov_b32 s23,39936
buffer_load_dwordx4 a[156:159],v250,s[48:51],s23 offen
s_add_u32 m0,s21,0
s_mov_b32 s23,0
buffer_load_dwordx4 v5,s[36:39],s23 offen lds
s_add_u32 m0,s21,4096
s_mov_b32 s23,393216
buffer_load_dwordx4 v5,s[36:39],s23 offen lds
s_add_u32 m0,s21,8192
s_mov_b32 s23,786432
buffer_load_dwordx4 v5,s[36:39],s23 offen lds
s_add_u32 m0,s21,12288
s_mov_b32 s23,1179648
buffer_load_dwordx4 v5,s[36:39],s23 offen lds
s_add_u32 m0,s21,16384
s_mov_b32 s23,1572864
buffer_load_dwordx4 v5,s[36:39],s23 offen lds
s_add_u32 m0,s21,20480
s_mov_b32 s23,1966080
buffer_load_dwordx4 v5,s[36:39],s23 offen lds
s_add_u32 m0,s21,24576
s_mov_b32 s23,2359296
buffer_load_dwordx4 v5,s[36:39],s23 offen lds
s_add_u32 m0,s21,28672
s_mov_b32 s23,2752512
buffer_load_dwordx4 v5,s[36:39],s23 offen lds
s_add_u32 m0,s21,32768
s_mov_b32 s23,3145728
buffer_load_dwordx4 v5,s[36:39],s23 offen lds
s_add_u32 m0,s21,36864
s_mov_b32 s23,3538944
buffer_load_dwordx4 v5,s[36:39],s23 offen lds
s_add_u32 m0,s21,40960
s_mov_b32 s23,3932160
buffer_load_dwordx4 v5,s[36:39],s23 offen lds
s_add_u32 m0,s21,45056
s_mov_b32 s23,4325376
buffer_load_dwordx4 v5,s[36:39],s23 offen lds
s_add_u32 m0,s21,49152
s_mov_b32 s23,4718592
buffer_load_dwordx4 v5,s[36:39],s23 offen lds
s_add_u32 m0,s21,53248
s_mov_b32 s23,5111808
buffer_load_dwordx4 v5,s[36:39],s23 offen lds
s_add_u32 m0,s21,57344
s_mov_b32 s23,5505024
buffer_load_dwordx4 v5,s[36:39],s23 offen lds
s_add_u32 m0,s21,61440
s_mov_b32 s23,5898240
buffer_load_dwordx4 v5,s[36:39],s23 offen lds
s_add_u32 m0,s21,65536
s_mov_b32 s23,6291456
buffer_load_dwordx4 v5,s[36:39],s23 offen lds
s_add_u32 m0,s21,69632
s_mov_b32 s23,6684672
buffer_load_dwordx4 v5,s[36:39],s23 offen lds
s_add_u32 m0,s21,73728
s_mov_b32 s23,7077888
buffer_load_dwordx4 v5,s[36:39],s23 offen lds
s_add_u32 m0,s21,77824
s_mov_b32 s23,7471104
buffer_load_dwordx4 v5,s[36:39],s23 offen lds
s_add_u32 m0,s21,81920
s_mov_b32 s23,128
buffer_load_dwordx4 v5,s[36:39],s23 offen lds
s_add_u32 m0,s21,86016
s_mov_b32 s23,393344
buffer_load_dwordx4 v5,s[36:39],s23 offen lds
s_add_u32 m0,s21,90112
s_mov_b32 s23,786560
buffer_load_dwordx4 v5,s[36:39],s23 offen lds
s_add_u32 m0,s21,94208
s_mov_b32 s23,1179776
buffer_load_dwordx4 v5,s[36:39],s23 offen lds
s_add_u32 m0,s21,98304
s_mov_b32 s23,1572992
buffer_load_dwordx4 v5,s[36:39],s23 offen lds
s_add_u32 m0,s21,102400
s_mov_b32 s23,1966208
buffer_load_dwordx4 v5,s[36:39],s23 offen lds
s_add_u32 m0,s21,106496
s_mov_b32 s23,2359424
buffer_load_dwordx4 v5,s[36:39],s23 offen lds
s_add_u32 m0,s21,110592
s_mov_b32 s23,2752640
buffer_load_dwordx4 v5,s[36:39],s23 offen lds
s_add_u32 m0,s21,114688
s_mov_b32 s23,3145856
buffer_load_dwordx4 v5,s[36:39],s23 offen lds
s_add_u32 m0,s21,118784
s_mov_b32 s23,3539072
buffer_load_dwordx4 v5,s[36:39],s23 offen lds
s_add_u32 m0,s21,122880
s_mov_b32 s23,3932288
buffer_load_dwordx4 v5,s[36:39],s23 offen lds
s_add_u32 m0,s21,126976
s_mov_b32 s23,4325504
buffer_load_dwordx4 v5,s[36:39],s23 offen lds
s_add_u32 m0,s21,131072
s_mov_b32 s23,4718720
buffer_load_dwordx4 v5,s[36:39],s23 offen lds
s_add_u32 m0,s21,135168
s_mov_b32 s23,5111936
buffer_load_dwordx4 v5,s[36:39],s23 offen lds
s_add_u32 m0,s21,139264
s_mov_b32 s23,5505152
buffer_load_dwordx4 v5,s[36:39],s23 offen lds
s_add_u32 m0,s21,143360
s_mov_b32 s23,5898368
buffer_load_dwordx4 v5,s[36:39],s23 offen lds
s_add_u32 m0,s21,147456
s_mov_b32 s23,6291584
buffer_load_dwordx4 v5,s[36:39],s23 offen lds
s_add_u32 m0,s21,151552
s_mov_b32 s23,6684800
buffer_load_dwordx4 v5,s[36:39],s23 offen lds
s_add_u32 m0,s21,155648
s_mov_b32 s23,7078016
buffer_load_dwordx4 v5,s[36:39],s23 offen lds
s_add_u32 m0,s21,159744
s_mov_b32 s23,7471232
buffer_load_dwordx4 v5,s[36:39],s23 offen lds
s_mov_b32 s64,6
s_mov_b32 s65,40960
s_mov_b32 s66,s21
s_mov_b32 s72,2
s_mov_b32 s73,0x7f000000
s_mov_b32 s74,0
s_waitcnt vmcnt(30)
s_barrier
tr v[20:21],v8,0
tr v[22:23],v12,0
tr v[24:25],v9,0
tr v[26:27],v13,0
tr v[28:29],v10,0
tr v[30:31],v14,0
tr v[32:33],v11,0
tr v[34:35],v15,0
t1h_kernel_loop:
s_min_u32 s23,s72,5
s_cmp_lt_u32 s23,3
s_cselect_b32 s68,s36,s32
s_cselect_b32 s69,s37,s33
s_mov_b32 s70,s34
s_mov_b32 s71,0x00020000
s_cselect_b32 s22,0,3
s_sub_u32 s67,s23,s22
s_lshl_b32 s67,s67,7
s_add_u32 s72,s72,1
s_waitcnt lgkmcnt(0)
tr v[36:37],v8,4096
tr v[38:39],v12,4096
tr v[40:41],v9,4096
tr v[42:43],v13,4096
tr v[44:45],v10,4096
tr v[46:47],v14,4096
tr v[48:49],v11,4096
tr v[50:51],v15,4096
mf v[52:55],v[20:23],a[0:3],0
mf v[68:71],v[20:23],a[80:83],0
mf v[56:59],v[24:27],a[0:3],0
mf v[72:75],v[24:27],a[80:83],0
s_add_u32 s23,s73,0
buffer_store_dwordx4 v[180:183],v248,s[52:55],s23 offen sc1
mf v[60:63],v[28:31],a[0:3],0
mf v[76:79],v[28:31],a[80:83],0
mf v[64:67],v[32:35],a[0:3],0
mf v[80:83],v[32:35],a[80:83],0
s_waitcnt lgkmcnt(0)
tr v[20:21],v8,8192
tr v[22:23],v12,8192
tr v[24:25],v9,8192
tr v[26:27],v13,8192
tr v[28:29],v10,8192
tr v[30:31],v14,8192
tr v[32:33],v11,8192
tr v[34:35],v15,8192
mf v[52:55],v[36:39],a[4:7],v[52:55]
mf v[68:71],v[36:39],a[84:87],v[68:71]
mf v[56:59],v[40:43],a[4:7],v[56:59]
mf v[72:75],v[40:43],a[84:87],v[72:75]
s_add_u32 s23,s73,64
buffer_store_dwordx4 v[184:187],v248,s[52:55],s23 offen sc1
mf v[60:63],v[44:47],a[4:7],v[60:63]
mf v[76:79],v[44:47],a[84:87],v[76:79]
mf v[64:67],v[48:51],a[4:7],v[64:67]
mf v[80:83],v[48:51],a[84:87],v[80:83]
s_waitcnt lgkmcnt(0)
tr v[36:37],v8,12288
tr v[38:39],v12,12288
tr v[40:41],v9,12288
tr v[42:43],v13,12288
tr v[44:45],v10,12288
tr v[46:47],v14,12288
tr v[48:49],v11,12288
tr v[50:51],v15,12288
mf v[52:55],v[20:23],a[8:11],v[52:55]
mf v[68:71],v[20:23],a[88:91],v[68:71]
mf v[56:59],v[24:27],a[8:11],v[56:59]
mf v[72:75],v[24:27],a[88:91],v[72:75]
s_add_u32 s23,s73,49152
buffer_store_dwordx4 v[188:191],v248,s[52:55],s23 offen sc1
mf v[60:63],v[28:31],a[8:11],v[60:63]
mf v[76:79],v[28:31],a[88:91],v[76:79]
mf v[64:67],v[32:35],a[8:11],v[64:67]
mf v[80:83],v[32:35],a[88:91],v[80:83]
s_waitcnt lgkmcnt(0)
tr v[20:21],v8,16384
tr v[22:23],v12,16384
tr v[24:25],v9,16384
tr v[26:27],v13,16384
tr v[28:29],v10,16384
tr v[30:31],v14,16384
tr v[32:33],v11,16384
tr v[34:35],v15,16384
mf v[52:55],v[36:39],a[12:15],v[52:55]
mf v[68:71],v[36:39],a[92:95],v[68:71]
mf v[56:59],v[40:43],a[12:15],v[56:59]
mf v[72:75],v[40:43],a[92:95],v[72:75]
s_add_u32 s23,s73,49216
buffer_store_dwordx4 v[192:195],v248,s[52:55],s23 offen sc1
mf v[60:63],v[44:47],a[12:15],v[60:63]
mf v[76:79],v[44:47],a[92:95],v[76:79]
mf v[64:67],v[48:51],a[12:15],v[64:67]
mf v[80:83],v[48:51],a[92:95],v[80:83]
s_waitcnt lgkmcnt(0)
tr v[36:37],v8,20480
tr v[38:39],v12,20480
tr v[40:41],v9,20480
tr v[42:43],v13,20480
tr v[44:45],v10,20480
tr v[46:47],v14,20480
tr v[48:49],v11,20480
tr v[50:51],v15,20480
mf v[52:55],v[20:23],a[16:19],v[52:55]
mf v[68:71],v[20:23],a[96:99],v[68:71]
mf v[56:59],v[24:27],a[16:19],v[56:59]
mf v[72:75],v[24:27],a[96:99],v[72:75]
mf v[60:63],v[28:31],a[16:19],v[60:63]
mf v[76:79],v[28:31],a[96:99],v[76:79]
mf v[64:67],v[32:35],a[16:19],v[64:67]
mf v[80:83],v[32:35],a[96:99],v[80:83]
s_waitcnt lgkmcnt(0)
tr v[20:21],v8,24576
tr v[22:23],v12,24576
tr v[24:25],v9,24576
tr v[26:27],v13,24576
tr v[28:29],v10,24576
tr v[30:31],v14,24576
tr v[32:33],v11,24576
tr v[34:35],v15,24576
mf v[52:55],v[36:39],a[20:23],v[52:55]
mf v[68:71],v[36:39],a[100:103],v[68:71]
mf v[56:59],v[40:43],a[20:23],v[56:59]
mf v[72:75],v[40:43],a[100:103],v[72:75]
mf v[60:63],v[44:47],a[20:23],v[60:63]
mf v[76:79],v[44:47],a[100:103],v[76:79]
mf v[64:67],v[48:51],a[20:23],v[64:67]
mf v[80:83],v[48:51],a[100:103],v[80:83]
s_waitcnt lgkmcnt(0)
tr v[36:37],v8,28672
tr v[38:39],v12,28672
tr v[40:41],v9,28672
tr v[42:43],v13,28672
tr v[44:45],v10,28672
tr v[46:47],v14,28672
tr v[48:49],v11,28672
tr v[50:51],v15,28672
mf v[52:55],v[20:23],a[24:27],v[52:55]
mf v[68:71],v[20:23],a[104:107],v[68:71]
mf v[56:59],v[24:27],a[24:27],v[56:59]
mf v[72:75],v[24:27],a[104:107],v[72:75]
mf v[60:63],v[28:31],a[24:27],v[60:63]
mf v[76:79],v[28:31],a[104:107],v[76:79]
mf v[64:67],v[32:35],a[24:27],v[64:67]
mf v[80:83],v[32:35],a[104:107],v[80:83]
s_waitcnt lgkmcnt(0)
tr v[20:21],v8,32768
tr v[22:23],v12,32768
tr v[24:25],v9,32768
tr v[26:27],v13,32768
tr v[28:29],v10,32768
tr v[30:31],v14,32768
tr v[32:33],v11,32768
tr v[34:35],v15,32768
mf v[52:55],v[36:39],a[28:31],v[52:55]
mf v[68:71],v[36:39],a[108:111],v[68:71]
mf v[56:59],v[40:43],a[28:31],v[56:59]
mf v[72:75],v[40:43],a[108:111],v[72:75]
mf v[60:63],v[44:47],a[28:31],v[60:63]
mf v[76:79],v[44:47],a[108:111],v[76:79]
mf v[64:67],v[48:51],a[28:31],v[64:67]
mf v[80:83],v[48:51],a[108:111],v[80:83]
s_waitcnt lgkmcnt(0)
tr v[36:37],v8,36864
tr v[38:39],v12,36864
tr v[40:41],v9,36864
tr v[42:43],v13,36864
tr v[44:45],v10,36864
tr v[46:47],v14,36864
tr v[48:49],v11,36864
tr v[50:51],v15,36864
mf v[52:55],v[20:23],a[32:35],v[52:55]
mf v[68:71],v[20:23],a[112:115],v[68:71]
mf v[56:59],v[24:27],a[32:35],v[56:59]
mf v[72:75],v[24:27],a[112:115],v[72:75]
mf v[60:63],v[28:31],a[32:35],v[60:63]
mf v[76:79],v[28:31],a[112:115],v[76:79]
mf v[64:67],v[32:35],a[32:35],v[64:67]
mf v[80:83],v[32:35],a[112:115],v[80:83]
s_waitcnt lgkmcnt(0)
s_waitcnt vmcnt(20)
s_barrier
s_add_u32 m0,s66,0
s_add_u32 s23,s67,0
buffer_load_dwordx4 v5,s[68:71],s23 offen lds
s_add_u32 m0,s66,4096
s_add_u32 s23,s67,393216
buffer_load_dwordx4 v5,s[68:71],s23 offen lds
s_add_u32 m0,s66,8192
s_add_u32 s23,s67,786432
buffer_load_dwordx4 v5,s[68:71],s23 offen lds
s_add_u32 m0,s66,12288
s_add_u32 s23,s67,1179648
buffer_load_dwordx4 v5,s[68:71],s23 offen lds
s_add_u32 m0,s66,16384
s_add_u32 s23,s67,1572864
buffer_load_dwordx4 v5,s[68:71],s23 offen lds
s_add_u32 m0,s66,20480
s_add_u32 s23,s67,1966080
buffer_load_dwordx4 v5,s[68:71],s23 offen lds
s_add_u32 m0,s66,24576
s_add_u32 s23,s67,2359296
buffer_load_dwordx4 v5,s[68:71],s23 offen lds
s_add_u32 m0,s66,28672
s_add_u32 s23,s67,2752512
buffer_load_dwordx4 v5,s[68:71],s23 offen lds
s_add_u32 m0,s66,32768
s_add_u32 s23,s67,3145728
buffer_load_dwordx4 v5,s[68:71],s23 offen lds
s_add_u32 m0,s66,36864
s_add_u32 s23,s67,3538944
buffer_load_dwordx4 v5,s[68:71],s23 offen lds
v_add_u32 v8,40960,v8
v_add_u32 v9,40960,v9
v_add_u32 v10,40960,v10
v_add_u32 v11,40960,v11
v_add_u32 v12,40960,v12
v_add_u32 v13,40960,v13
v_add_u32 v14,40960,v14
v_add_u32 v15,40960,v15
tr v[20:21],v8,0
tr v[22:23],v12,0
tr v[24:25],v9,0
tr v[26:27],v13,0
tr v[28:29],v10,0
tr v[30:31],v14,0
tr v[32:33],v11,0
tr v[34:35],v15,0
mf v[52:55],v[36:39],a[36:39],v[52:55]
mf v[68:71],v[36:39],a[116:119],v[68:71]
mf v[56:59],v[40:43],a[36:39],v[56:59]
mf v[72:75],v[40:43],a[116:119],v[72:75]
mf v[60:63],v[44:47],a[36:39],v[60:63]
mf v[76:79],v[44:47],a[116:119],v[76:79]
mf v[64:67],v[48:51],a[36:39],v[64:67]
mf v[80:83],v[48:51],a[116:119],v[80:83]
s_waitcnt lgkmcnt(0)
tr v[36:37],v8,4096
tr v[38:39],v12,4096
tr v[40:41],v9,4096
tr v[42:43],v13,4096
tr v[44:45],v10,4096
tr v[46:47],v14,4096
tr v[48:49],v11,4096
tr v[50:51],v15,4096
mf v[52:55],v[20:23],a[40:43],v[52:55]
mf v[68:71],v[20:23],a[120:123],v[68:71]
mf v[56:59],v[24:27],a[40:43],v[56:59]
mf v[72:75],v[24:27],a[120:123],v[72:75]
mf v[60:63],v[28:31],a[40:43],v[60:63]
mf v[76:79],v[28:31],a[120:123],v[76:79]
mf v[64:67],v[32:35],a[40:43],v[64:67]
mf v[80:83],v[32:35],a[120:123],v[80:83]
s_waitcnt lgkmcnt(0)
tr v[20:21],v8,8192
tr v[22:23],v12,8192
tr v[24:25],v9,8192
tr v[26:27],v13,8192
tr v[28:29],v10,8192
tr v[30:31],v14,8192
tr v[32:33],v11,8192
tr v[34:35],v15,8192
mf v[52:55],v[36:39],a[44:47],v[52:55]
mf v[68:71],v[36:39],a[124:127],v[68:71]
mf v[56:59],v[40:43],a[44:47],v[56:59]
mf v[72:75],v[40:43],a[124:127],v[72:75]
mf v[60:63],v[44:47],a[44:47],v[60:63]
mf v[76:79],v[44:47],a[124:127],v[76:79]
mf v[64:67],v[48:51],a[44:47],v[64:67]
mf v[80:83],v[48:51],a[124:127],v[80:83]
s_waitcnt lgkmcnt(0)
tr v[36:37],v8,12288
tr v[38:39],v12,12288
tr v[40:41],v9,12288
tr v[42:43],v13,12288
tr v[44:45],v10,12288
tr v[46:47],v14,12288
tr v[48:49],v11,12288
tr v[50:51],v15,12288
mf v[52:55],v[20:23],a[48:51],v[52:55]
mf v[68:71],v[20:23],a[128:131],v[68:71]
mf v[56:59],v[24:27],a[48:51],v[56:59]
mf v[72:75],v[24:27],a[128:131],v[72:75]
mf v[60:63],v[28:31],a[48:51],v[60:63]
mf v[76:79],v[28:31],a[128:131],v[76:79]
mf v[64:67],v[32:35],a[48:51],v[64:67]
mf v[80:83],v[32:35],a[128:131],v[80:83]
s_waitcnt lgkmcnt(0)
tr v[20:21],v8,16384
tr v[22:23],v12,16384
tr v[24:25],v9,16384
tr v[26:27],v13,16384
tr v[28:29],v10,16384
tr v[30:31],v14,16384
tr v[32:33],v11,16384
tr v[34:35],v15,16384
mf v[52:55],v[36:39],a[52:55],v[52:55]
mf v[68:71],v[36:39],a[132:135],v[68:71]
mf v[56:59],v[40:43],a[52:55],v[56:59]
mf v[72:75],v[40:43],a[132:135],v[72:75]
mf v[60:63],v[44:47],a[52:55],v[60:63]
mf v[76:79],v[44:47],a[132:135],v[76:79]
mf v[64:67],v[48:51],a[52:55],v[64:67]
mf v[80:83],v[48:51],a[132:135],v[80:83]
s_waitcnt lgkmcnt(0)
tr v[36:37],v8,20480
tr v[38:39],v12,20480
tr v[40:41],v9,20480
tr v[42:43],v13,20480
tr v[44:45],v10,20480
tr v[46:47],v14,20480
tr v[48:49],v11,20480
tr v[50:51],v15,20480
mf v[52:55],v[20:23],a[56:59],v[52:55]
mf v[68:71],v[20:23],a[136:139],v[68:71]
mf v[56:59],v[24:27],a[56:59],v[56:59]
mf v[72:75],v[24:27],a[136:139],v[72:75]
mf v[60:63],v[28:31],a[56:59],v[60:63]
mf v[76:79],v[28:31],a[136:139],v[76:79]
mf v[64:67],v[32:35],a[56:59],v[64:67]
mf v[80:83],v[32:35],a[136:139],v[80:83]
s_waitcnt lgkmcnt(0)
tr v[20:21],v8,24576
tr v[22:23],v12,24576
tr v[24:25],v9,24576
tr v[26:27],v13,24576
tr v[28:29],v10,24576
tr v[30:31],v14,24576
tr v[32:33],v11,24576
tr v[34:35],v15,24576
mf v[52:55],v[36:39],a[60:63],v[52:55]
mf v[68:71],v[36:39],a[140:143],v[68:71]
mf v[56:59],v[40:43],a[60:63],v[56:59]
mf v[72:75],v[40:43],a[140:143],v[72:75]
mf v[60:63],v[44:47],a[60:63],v[60:63]
mf v[76:79],v[44:47],a[140:143],v[76:79]
mf v[64:67],v[48:51],a[60:63],v[64:67]
mf v[80:83],v[48:51],a[140:143],v[80:83]
s_waitcnt lgkmcnt(0)
tr v[36:37],v8,28672
tr v[38:39],v12,28672
tr v[40:41],v9,28672
tr v[42:43],v13,28672
tr v[44:45],v10,28672
tr v[46:47],v14,28672
tr v[48:49],v11,28672
tr v[50:51],v15,28672
mf v[52:55],v[20:23],a[64:67],v[52:55]
mf v[68:71],v[20:23],a[144:147],v[68:71]
mf v[56:59],v[24:27],a[64:67],v[56:59]
mf v[72:75],v[24:27],a[144:147],v[72:75]
mf v[60:63],v[28:31],a[64:67],v[60:63]
mf v[76:79],v[28:31],a[144:147],v[76:79]
mf v[64:67],v[32:35],a[64:67],v[64:67]
mf v[80:83],v[32:35],a[144:147],v[80:83]
s_waitcnt lgkmcnt(0)
tr v[20:21],v8,32768
tr v[22:23],v12,32768
tr v[24:25],v9,32768
tr v[26:27],v13,32768
tr v[28:29],v10,32768
tr v[30:31],v14,32768
tr v[32:33],v11,32768
tr v[34:35],v15,32768
mf v[52:55],v[36:39],a[68:71],v[52:55]
mf v[68:71],v[36:39],a[148:151],v[68:71]
mf v[56:59],v[40:43],a[68:71],v[56:59]
mf v[72:75],v[40:43],a[148:151],v[72:75]
mf v[60:63],v[44:47],a[68:71],v[60:63]
mf v[76:79],v[44:47],a[148:151],v[76:79]
mf v[64:67],v[48:51],a[68:71],v[64:67]
mf v[80:83],v[48:51],a[148:151],v[80:83]
s_waitcnt lgkmcnt(0)
tr v[36:37],v8,36864
tr v[38:39],v12,36864
tr v[40:41],v9,36864
tr v[42:43],v13,36864
tr v[44:45],v10,36864
tr v[46:47],v14,36864
tr v[48:49],v11,36864
tr v[50:51],v15,36864
mf v[52:55],v[20:23],a[72:75],v[52:55]
mf v[68:71],v[20:23],a[152:155],v[68:71]
mf v[56:59],v[24:27],a[72:75],v[56:59]
mf v[72:75],v[24:27],a[152:155],v[72:75]
mf v[60:63],v[28:31],a[72:75],v[60:63]
mf v[76:79],v[28:31],a[152:155],v[76:79]
mf v[64:67],v[32:35],a[72:75],v[64:67]
mf v[80:83],v[32:35],a[152:155],v[80:83]
s_waitcnt lgkmcnt(0)
s_cmp_lg_u32 s74,3
s_cbranch_scc1 t1h_kernel_nosig0
s_waitcnt vmcnt(10)
t1h_kernel_nosig0:
s_waitcnt vmcnt(20)
s_barrier
s_cmp_lg_u32 s74,3
s_cbranch_scc1 t1h_kernel_nosig1
v_mov_b32 v251,0
s_mov_b64 exec,1
buffer_store_dword v251,off,s[92:95],s99 sc1
s_mov_b64 exec,-1
t1h_kernel_nosig1:
s_add_u32 m0,s66,40960
s_add_u32 s23,s67,3932160
buffer_load_dwordx4 v5,s[68:71],s23 offen lds
s_add_u32 m0,s66,45056
s_add_u32 s23,s67,4325376
buffer_load_dwordx4 v5,s[68:71],s23 offen lds
s_add_u32 m0,s66,49152
s_add_u32 s23,s67,4718592
buffer_load_dwordx4 v5,s[68:71],s23 offen lds
s_add_u32 m0,s66,53248
s_add_u32 s23,s67,5111808
buffer_load_dwordx4 v5,s[68:71],s23 offen lds
s_add_u32 m0,s66,57344
s_add_u32 s23,s67,5505024
buffer_load_dwordx4 v5,s[68:71],s23 offen lds
s_add_u32 m0,s66,61440
s_add_u32 s23,s67,5898240
buffer_load_dwordx4 v5,s[68:71],s23 offen lds
s_add_u32 m0,s66,65536
s_add_u32 s23,s67,6291456
buffer_load_dwordx4 v5,s[68:71],s23 offen lds
s_add_u32 m0,s66,69632
s_add_u32 s23,s67,6684672
buffer_load_dwordx4 v5,s[68:71],s23 offen lds
s_add_u32 m0,s66,73728
s_add_u32 s23,s67,7077888
buffer_load_dwordx4 v5,s[68:71],s23 offen lds
s_add_u32 m0,s66,77824
s_add_u32 s23,s67,7471104
buffer_load_dwordx4 v5,s[68:71],s23 offen lds
v_add_u32 v8,s65,v8
v_add_u32 v9,s65,v9
v_add_u32 v10,s65,v10
v_add_u32 v11,s65,v11
v_add_u32 v12,s65,v12
v_add_u32 v13,s65,v13
v_add_u32 v14,s65,v14
v_add_u32 v15,s65,v15
tr v[20:21],v8,0
tr v[22:23],v12,0
tr v[24:25],v9,0
tr v[26:27],v13,0
tr v[28:29],v10,0
tr v[30:31],v14,0
tr v[32:33],v11,0
tr v[34:35],v15,0
mf v[52:55],v[36:39],a[76:79],v[52:55]
mf v[68:71],v[36:39],a[156:159],v[68:71]
mf v[56:59],v[40:43],a[76:79],v[56:59]
mf v[72:75],v[40:43],a[156:159],v[72:75]
mf v[60:63],v[44:47],a[76:79],v[60:63]
mf v[76:79],v[44:47],a[156:159],v[76:79]
mf v[64:67],v[48:51],a[76:79],v[64:67]
mf v[80:83],v[48:51],a[156:159],v[80:83]
s_nop 7
s_nop 1
cv v180,v52,v53
cv v181,v54,v55
cv v182,v56,v57
cv v183,v58,v59
cv v184,v60,v61
cv v185,v62,v63
cv v186,v64,v65
cv v187,v66,v67
cv v188,v68,v69
cv v189,v70,v71
cv v190,v72,v73
cv v191,v74,v75
cv v192,v76,v77
cv v193,v78,v79
cv v194,v80,v81
cv v195,v82,v83
s_cmp_lt_u32 s74,3
s_cselect_b32 s73,25165824,0
s_cselect_b32 s22,0,3
s_sub_u32 s22,s74,s22
s_lshl_b32 s22,s22,7
s_add_u32 s73,s73,s22
s_add_u32 s74,s74,1
s_sub_u32 s65,4294885376,s65
s_xor_b32 s66,s66,81920
s_sub_u32 s64,s64,1
s_cmp_lg_u32 s64,0
s_cbranch_scc1 t1h_kernel_loop
s_add_u32 s23,s73,0
buffer_store_dwordx4 v[180:183],v248,s[52:55],s23 offen sc1
s_add_u32 s23,s73,64
buffer_store_dwordx4 v[184:187],v248,s[52:55],s23 offen sc1
s_add_u32 s23,s73,49152
buffer_store_dwordx4 v[188:191],v248,s[52:55],s23 offen sc1
s_add_u32 s23,s73,49216
buffer_store_dwordx4 v[192:195],v248,s[52:55],s23 offen sc1
s_branch task_done
pattn_kernel_entry:
s_load_dwordx2 s[12:13],s[0:1],128
v_and_b32 v1,63,v0
v_lshrrev_b32 v2,4,v1
v_and_b32 v3,15,v0
v_lshrrev_b32 v4,6,v0
s_nop 0
v_readfirstlane_b32 s20,v4
s_nop 3
s_lshl_b32 s21,s20,10
s_lshl_b32 s24,s2,2
s_add_u32 s24,s24,s20
s_and_b32 s25,s24,31
s_lshr_b32 s26,s24,5
s_waitcnt lgkmcnt(0)
s_mul_i32 s27,s26,393216
s_mul_i32 s28,s25,384
s_add_u32 s27,s27,s28
s_add_u32 s28,s27,33554432
s_add_u32 s32,s12,s28
s_addc_u32 s33,s13,0
s_mov_b32 s34,0x60000
s_mov_b32 s35,0x00020000
s_add_u32 s28,s27,58720256
s_add_u32 s36,s12,s28
s_addc_u32 s37,s13,0
s_mov_b32 s38,0x60000
s_mov_b32 s39,0x00020000
s_mul_i32 s28,s24,3072
s_add_u32 s28,s28,2621440
s_add_u32 s40,s12,s28
s_addc_u32 s41,s13,0
s_mov_b32 s42,0xc00
s_mov_b32 s43,0x00020000
s_mul_i32 s28,s26,81920
s_mul_i32 s29,s25,80
s_add_u32 s28,s28,s29
s_add_u32 s28,s28,14680064
s_add_u32 s44,s12,s28
s_addc_u32 s45,s13,0
s_mov_b32 s46,0x14000
s_mov_b32 s47,0x00020000
v_mul_u32_u24 v5,12288,v3
v_lshl_add_u32 v5,v2,4,v5
v_and_b32 v7,7,v3
v_mul_u32_u24 v6,384,v7
v_lshl_add_u32 v6,v2,4,v6
s_mov_b32 s23,0
buffer_load_dwordx4 v[16:19],v5,s[32:35],s23 offen
buffer_load_dwordx4 v[64:67],v5,s[36:39],s23 offen
s_mov_b32 s23,196608
buffer_load_dwordx4 v[40:43],v5,s[32:35],s23 offen
buffer_load_dwordx4 v[88:91],v5,s[36:39],s23 offen
s_mov_b32 s23,64
buffer_load_dwordx4 v[20:23],v5,s[32:35],s23 offen
buffer_load_dwordx4 v[68:71],v5,s[36:39],s23 offen
s_mov_b32 s23,196672
buffer_load_dwordx4 v[44:47],v5,s[32:35],s23 offen
buffer_load_dwordx4 v[92:95],v5,s[36:39],s23 offen
s_mov_b32 s23,128
buffer_load_dwordx4 v[24:27],v5,s[32:35],s23 offen
buffer_load_dwordx4 v[72:75],v5,s[36:39],s23 offen
s_mov_b32 s23,196736
buffer_load_dwordx4 v[48:51],v5,s[32:35],s23 offen
buffer_load_dwordx4 v[96:99],v5,s[36:39],s23 offen
s_mov_b32 s23,192
buffer_load_dwordx4 v[28:31],v5,s[32:35],s23 offen
buffer_load_dwordx4 v[76:79],v5,s[36:39],s23 offen
s_mov_b32 s23,196800
buffer_load_dwordx4 v[52:55],v5,s[32:35],s23 offen
buffer_load_dwordx4 v[100:103],v5,s[36:39],s23 offen
s_mov_b32 s23,256
buffer_load_dwordx4 v[32:35],v5,s[32:35],s23 offen
buffer_load_dwordx4 v[80:83],v5,s[36:39],s23 offen
s_mov_b32 s23,196864
buffer_load_dwordx4 v[56:59],v5,s[32:35],s23 offen
buffer_load_dwordx4 v[104:107],v5,s[36:39],s23 offen
s_mov_b32 s23,320
buffer_load_dwordx4 v[36:39],v5,s[32:35],s23 offen
buffer_load_dwordx4 v[84:87],v5,s[36:39],s23 offen
s_mov_b32 s23,196928
buffer_load_dwordx4 v[60:63],v5,s[32:35],s23 offen
buffer_load_dwordx4 v[108:111],v5,s[36:39],s23 offen
s_cmp_lg_u32 s100,0
s_cbranch_scc1 tpa_skip
v_and_b32 v200,63,v0
v_add_u32 v200,0,v200
v_min_u32 v200,3,v200
v_mul_u32_u24 v202,640,v200
s_mov_b32 s60,0
tpa:
buffer_load_dword v200,v202,s[88:91],s99 offen sc1
s_waitcnt vmcnt(0)
v_cmp_ne_u32 vcc,-1,v200
s_nop 1
s_cmp_eq_u64 vcc,exec
s_cbranch_scc1 tpa_ok
s_sleep 32
s_add_u32 s60,s60,1
s_cmp_gt_u32 s60,400000
s_cbranch_scc1 mega_exit
s_branch tpa
tpa_ok:
tpa_skip:
s_barrier
buffer_load_dwordx4 v[112:115],v6,s[40:43],0 offen offset:0
buffer_load_dwordx4 v[116:119],v6,s[40:43],0 offen offset:64
buffer_load_dwordx4 v[120:123],v6,s[40:43],0 offen offset:128
buffer_load_dwordx4 v[124:127],v6,s[40:43],0 offen offset:192
buffer_load_dwordx4 v[128:131],v6,s[40:43],0 offen offset:256
buffer_load_dwordx4 v[132:135],v6,s[40:43],0 offen offset:320
s_waitcnt vmcnt(0)
mf v[136:139],v[112:115],v[16:19],0
mf v[140:143],v[64:67],v[16:19],0
mf v[144:147],v[88:91],v[16:19],0
mf v[148:151],v[112:115],v[40:43],0
mf v[152:155],v[64:67],v[40:43],0
mf v[156:159],v[88:91],v[40:43],0
mf v[136:139],v[116:119],v[20:23],v[136:139]
mf v[140:143],v[68:71],v[20:23],v[140:143]
mf v[144:147],v[92:95],v[20:23],v[144:147]
mf v[148:151],v[116:119],v[44:47],v[148:151]
mf v[152:155],v[68:71],v[44:47],v[152:155]
mf v[156:159],v[92:95],v[44:47],v[156:159]
mf v[136:139],v[120:123],v[24:27],v[136:139]
mf v[140:143],v[72:75],v[24:27],v[140:143]
mf v[144:147],v[96:99],v[24:27],v[144:147]
mf v[148:151],v[120:123],v[48:51],v[148:151]
mf v[152:155],v[72:75],v[48:51],v[152:155]
mf v[156:159],v[96:99],v[48:51],v[156:159]
mf v[136:139],v[124:127],v[28:31],v[136:139]
mf v[140:143],v[76:79],v[28:31],v[140:143]
mf v[144:147],v[100:103],v[28:31],v[144:147]
mf v[148:151],v[124:127],v[52:55],v[148:151]
mf v[152:155],v[76:79],v[52:55],v[152:155]
mf v[156:159],v[100:103],v[52:55],v[156:159]
mf v[136:139],v[128:131],v[32:35],v[136:139]
mf v[140:143],v[80:83],v[32:35],v[140:143]
mf v[144:147],v[104:107],v[32:35],v[144:147]
mf v[148:151],v[128:131],v[56:59],v[148:151]
mf v[152:155],v[80:83],v[56:59],v[152:155]
mf v[156:159],v[104:107],v[56:59],v[156:159]
mf v[136:139],v[132:135],v[36:39],v[136:139]
mf v[140:143],v[84:87],v[36:39],v[140:143]
mf v[144:147],v[108:111],v[36:39],v[144:147]
mf v[148:151],v[132:135],v[60:63],v[148:151]
mf v[152:155],v[84:87],v[60:63],v[152:155]
mf v[156:159],v[108:111],v[60:63],v[156:159]
s_nop 7
s_nop 1
v_mov_b32 v8,0xff800000
v_lshlrev_b32 v9,2,v2
v_mul_u32_u24 v10,2560,v3
v_lshl_add_u32 v10,v2,3,v10
v_cmp_gt_u32 vcc,2,v2
s_nop 1
v_cndmask_b32 v136,v8,v136,vcc
v_cndmask_b32 v137,v8,v137,vcc
v_cndmask_b32 v138,v8,v138,vcc
v_cndmask_b32 v139,v8,v139,vcc
v_add_u32 v11,64,v9
v_add_u32 v12,64,v3
v_cmp_le_u32 vcc,v11,v12
s_nop 1
v_cndmask_b32 v140,v8,v140,vcc
v_add_u32 v11,65,v9
v_add_u32 v12,64,v3
v_cmp_le_u32 vcc,v11,v12
s_nop 1
v_cndmask_b32 v141,v8,v141,vcc
v_add_u32 v11,66,v9
v_add_u32 v12,64,v3
v_cmp_le_u32 vcc,v11,v12
s_nop 1
v_cndmask_b32 v142,v8,v142,vcc
v_add_u32 v11,67,v9
v_add_u32 v12,64,v3
v_cmp_le_u32 vcc,v11,v12
s_nop 1
v_cndmask_b32 v143,v8,v143,vcc
v_add_u32 v11,80,v9
v_add_u32 v12,64,v3
v_cmp_le_u32 vcc,v11,v12
s_nop 1
v_cndmask_b32 v144,v8,v144,vcc
v_add_u32 v11,81,v9
v_add_u32 v12,64,v3
v_cmp_le_u32 vcc,v11,v12
s_nop 1
v_cndmask_b32 v145,v8,v145,vcc
v_add_u32 v11,82,v9
v_add_u32 v12,64,v3
v_cmp_le_u32 vcc,v11,v12
s_nop 1
v_cndmask_b32 v146,v8,v146,vcc
v_add_u32 v11,83,v9
v_add_u32 v12,64,v3
v_cmp_le_u32 vcc,v11,v12
s_nop 1
v_cndmask_b32 v147,v8,v147,vcc
v_max3_f32 v13,v136,v137,v138
v_max3_f32 v13,v13,v139,v140
v_max3_f32 v13,v13,v141,v142
v_max3_f32 v13,v13,v143,v144
v_max3_f32 v13,v13,v145,v146
v_max_f32 v13,v13,v147
v_mov_b32 v14,v13
s_nop 1
v_permlane16_swap_b32 v13,v14
s_nop 1
v_max_f32 v13,v13,v14
v_mov_b32 v14,v13
s_nop 1
v_permlane32_swap_b32 v13,v14
s_nop 1
v_max_f32 v13,v13,v14
v_mul_f32 v13,0x3dd53b95,v13
v_mov_b32 v15,0x3dd53b95
v_fma_f32 v136,v136,v15,-v13
v_fma_f32 v137,v137,v15,-v13
v_fma_f32 v138,v138,v15,-v13
v_fma_f32 v139,v139,v15,-v13
v_fma_f32 v140,v140,v15,-v13
v_fma_f32 v141,v141,v15,-v13
v_fma_f32 v142,v142,v15,-v13
v_fma_f32 v143,v143,v15,-v13
v_fma_f32 v144,v144,v15,-v13
v_fma_f32 v145,v145,v15,-v13
v_fma_f32 v146,v146,v15,-v13
v_fma_f32 v147,v147,v15,-v13
v_exp_f32 v136,v136
v_exp_f32 v137,v137
v_exp_f32 v138,v138
v_exp_f32 v139,v139
v_exp_f32 v140,v140
v_exp_f32 v141,v141
v_exp_f32 v142,v142
v_exp_f32 v143,v143
v_exp_f32 v144,v144
v_exp_f32 v145,v145
v_exp_f32 v146,v146
v_exp_f32 v147,v147
s_nop 0
v_add_f32 v13,v136,v137
v_add_f32 v13,v13,v138
v_add_f32 v13,v13,v139
v_add_f32 v13,v13,v140
v_add_f32 v13,v13,v141
v_add_f32 v13,v13,v142
v_add_f32 v13,v13,v143
v_add_f32 v13,v13,v144
v_add_f32 v13,v13,v145
v_add_f32 v13,v13,v146
v_add_f32 v13,v13,v147
v_mov_b32 v14,v13
s_nop 1
v_permlane16_swap_b32 v13,v14
s_nop 1
v_add_f32 v13,v13,v14
v_mov_b32 v14,v13
s_nop 1
v_permlane32_swap_b32 v13,v14
s_nop 1
v_add_f32 v13,v13,v14
v_rcp_f32 v13,v13
s_nop 0
v_mul_f32 v136,v136,v13
v_mul_f32 v137,v137,v13
v_mul_f32 v138,v138,v13
v_mul_f32 v139,v139,v13
v_mul_f32 v140,v140,v13
v_mul_f32 v141,v141,v13
v_mul_f32 v142,v142,v13
v_mul_f32 v143,v143,v13
v_mul_f32 v144,v144,v13
v_mul_f32 v145,v145,v13
v_mul_f32 v146,v146,v13
v_mul_f32 v147,v147,v13
cv v136,v136,v137
cv v137,v138,v139
cv v138,v140,v141
cv v139,v142,v143
cv v140,v144,v145
cv v141,v146,v147
s_mov_b32 s23,0
buffer_store_dwordx2 v[138:139],v10,s[44:47],s23 offen offset:16 sc1
buffer_store_dwordx2 v[140:141],v10,s[44:47],s23 offen offset:48 sc1
s_mov_b32 exec_hi,0
buffer_store_dwordx2 v[136:137],v10,s[44:47],s23 offen sc1
s_mov_b64 exec,-1
v_cmp_gt_u32 vcc,2,v2
s_nop 1
v_cndmask_b32 v148,v8,v148,vcc
v_cndmask_b32 v149,v8,v149,vcc
v_cndmask_b32 v150,v8,v150,vcc
v_cndmask_b32 v151,v8,v151,vcc
v_add_u32 v11,48,v9
v_add_u32 v12,64,v3
v_cmp_le_u32 vcc,v11,v12
s_nop 1
v_cndmask_b32 v152,v8,v152,vcc
v_add_u32 v11,49,v9
v_add_u32 v12,64,v3
v_cmp_le_u32 vcc,v11,v12
s_nop 1
v_cndmask_b32 v153,v8,v153,vcc
v_add_u32 v11,50,v9
v_add_u32 v12,64,v3
v_cmp_le_u32 vcc,v11,v12
s_nop 1
v_cndmask_b32 v154,v8,v154,vcc
v_add_u32 v11,51,v9
v_add_u32 v12,64,v3
v_cmp_le_u32 vcc,v11,v12
s_nop 1
v_cndmask_b32 v155,v8,v155,vcc
v_add_u32 v11,64,v9
v_add_u32 v12,64,v3
v_cmp_le_u32 vcc,v11,v12
s_nop 1
v_cndmask_b32 v156,v8,v156,vcc
v_add_u32 v11,65,v9
v_add_u32 v12,64,v3
v_cmp_le_u32 vcc,v11,v12
s_nop 1
v_cndmask_b32 v157,v8,v157,vcc
v_add_u32 v11,66,v9
v_add_u32 v12,64,v3
v_cmp_le_u32 vcc,v11,v12
s_nop 1
v_cndmask_b32 v158,v8,v158,vcc
v_add_u32 v11,67,v9
v_add_u32 v12,64,v3
v_cmp_le_u32 vcc,v11,v12
s_nop 1
v_cndmask_b32 v159,v8,v159,vcc
v_max3_f32 v13,v148,v149,v150
v_max3_f32 v13,v13,v151,v152
v_max3_f32 v13,v13,v153,v154
v_max3_f32 v13,v13,v155,v156
v_max3_f32 v13,v13,v157,v158
v_max_f32 v13,v13,v159
v_mov_b32 v14,v13
s_nop 1
v_permlane16_swap_b32 v13,v14
s_nop 1
v_max_f32 v13,v13,v14
v_mov_b32 v14,v13
s_nop 1
v_permlane32_swap_b32 v13,v14
s_nop 1
v_max_f32 v13,v13,v14
v_mul_f32 v13,0x3dd53b95,v13
v_mov_b32 v15,0x3dd53b95
v_fma_f32 v148,v148,v15,-v13
v_fma_f32 v149,v149,v15,-v13
v_fma_f32 v150,v150,v15,-v13
v_fma_f32 v151,v151,v15,-v13
v_fma_f32 v152,v152,v15,-v13
v_fma_f32 v153,v153,v15,-v13
v_fma_f32 v154,v154,v15,-v13
v_fma_f32 v155,v155,v15,-v13
v_fma_f32 v156,v156,v15,-v13
v_fma_f32 v157,v157,v15,-v13
v_fma_f32 v158,v158,v15,-v13
v_fma_f32 v159,v159,v15,-v13
v_exp_f32 v148,v148
v_exp_f32 v149,v149
v_exp_f32 v150,v150
v_exp_f32 v151,v151
v_exp_f32 v152,v152
v_exp_f32 v153,v153
v_exp_f32 v154,v154
v_exp_f32 v155,v155
v_exp_f32 v156,v156
v_exp_f32 v157,v157
v_exp_f32 v158,v158
v_exp_f32 v159,v159
s_nop 0
v_add_f32 v13,v148,v149
v_add_f32 v13,v13,v150
v_add_f32 v13,v13,v151
v_add_f32 v13,v13,v152
v_add_f32 v13,v13,v153
v_add_f32 v13,v13,v154
v_add_f32 v13,v13,v155
v_add_f32 v13,v13,v156
v_add_f32 v13,v13,v157
v_add_f32 v13,v13,v158
v_add_f32 v13,v13,v159
v_mov_b32 v14,v13
s_nop 1
v_permlane16_swap_b32 v13,v14
s_nop 1
v_add_f32 v13,v13,v14
v_mov_b32 v14,v13
s_nop 1
v_permlane32_swap_b32 v13,v14
s_nop 1
v_add_f32 v13,v13,v14
v_rcp_f32 v13,v13
s_nop 0
v_mul_f32 v148,v148,v13
v_mul_f32 v149,v149,v13
v_mul_f32 v150,v150,v13
v_mul_f32 v151,v151,v13
v_mul_f32 v152,v152,v13
v_mul_f32 v153,v153,v13
v_mul_f32 v154,v154,v13
v_mul_f32 v155,v155,v13
v_mul_f32 v156,v156,v13
v_mul_f32 v157,v157,v13
v_mul_f32 v158,v158,v13
v_mul_f32 v159,v159,v13
cv v148,v148,v149
cv v149,v150,v151
cv v150,v152,v153
cv v151,v154,v155
cv v152,v156,v157
cv v153,v158,v159
s_mov_b32 s23,40960
buffer_store_dwordx2 v[150:151],v10,s[44:47],s23 offen offset:16 sc1
buffer_store_dwordx2 v[152:153],v10,s[44:47],s23 offen offset:48 sc1
s_mov_b32 exec_hi,0
buffer_store_dwordx2 v[148:149],v10,s[44:47],s23 offen sc1
s_mov_b64 exec,-1
s_branch task_done
pout_kernel_entry:
s_load_dwordx2 s[12:13],s[0:1],128
s_load_dwordx2 s[6:7],s[0:1],0
v_and_b32 v1,63,v0
v_lshrrev_b32 v2,4,v1
v_and_b32 v3,15,v0
v_lshrrev_b32 v4,6,v0
s_nop 0
v_readfirstlane_b32 s20,v4
s_nop 3
s_lshl_b32 s21,s20,10
s_lshr_b32 s26,s2,5
s_and_b32 s25,s2,31
s_lshr_b32 s62,s20,1
s_and_b32 s63,s20,1
s_waitcnt lgkmcnt(0)
s_mul_i32 s28,s26,81920
s_add_u32 s28,s28,14680064
s_add_u32 s32,s12,s28
s_addc_u32 s33,s13,0
s_mov_b32 s34,0x14000
s_mov_b32 s35,0x00020000
s_mov_b32 s36,s12
s_mov_b32 s37,s13
s_mov_b32 s38,0x10000000
s_mov_b32 s39,0x00020000
s_mul_i32 s28,s26,40960
s_lshl_b32 s29,s25,6
s_add_u32 s28,s28,s29
s_add_u32 s40,s6,s28
s_addc_u32 s41,s7,0
s_mov_b32 s42,0xa000
s_mov_b32 s43,0x00020000
s_mul_i32 s28,s26,81920
s_lshl_b32 s29,s25,7
s_add_u32 s28,s28,s29
s_add_u32 s28,s28,9437184
s_add_u32 s44,s12,s28
s_addc_u32 s45,s13,0
s_mov_b32 s46,0x14000
s_mov_b32 s47,0x00020000
s_add_u32 s28,s29,5120
s_add_u32 s48,s12,s28
s_addc_u32 s49,s13,0
s_mov_b32 s50,0x80
s_mov_b32 s51,0x00020000
v_mul_u32_u24 v5,2560,v3
v_lshl_add_u32 v5,v2,4,v5
s_mul_i32 s28,s26,20480
s_lshl_b32 s29,s25,5
s_add_u32 s28,s28,s29
v_add_u32 v14,s28,v3
s_lshl_b32 s30,s20,1
v_add_u32 v11,0,v2
v_mul_u32_u24 v12,52,v11
v_lshrrev_b32 v12,8,v12
v_mul_u32_u24 v13,5,v12
v_sub_u32 v13,v11,v13
v_mul_u32_u24 v12,640,v12
v_add_u32 v12,v12,v14
v_lshlrev_b32 v6,4,v12
v_add_u32 v6,218103808,v6
v_lshlrev_b32 v7,6,v12
v_lshl_add_u32 v7,v13,4,v7
v_add_u32 v7,117440496,v7
v_cmp_eq_u32 vcc,0,v13
v_mov_b32 v8,163840
v_mov_b32 v9,40960
v_cndmask_b32 v216,v7,v6,vcc
v_cndmask_b32 v222,v8,v9,vcc
v_mov_b32 v8,1024
v_mov_b32 v9,256
v_cndmask_b32 v228,v8,v9,vcc
v_mul_lo_u32 v8,s30,v222
v_add_u32 v216,v216,v8
v_add_u32 v11,4,v2
v_mul_u32_u24 v12,52,v11
v_lshrrev_b32 v12,8,v12
v_mul_u32_u24 v13,5,v12
v_sub_u32 v13,v11,v13
v_mul_u32_u24 v12,640,v12
v_add_u32 v12,v12,v14
v_lshlrev_b32 v6,4,v12
v_add_u32 v6,218103808,v6
v_lshlrev_b32 v7,6,v12
v_lshl_add_u32 v7,v13,4,v7
v_add_u32 v7,117440496,v7
v_cmp_eq_u32 vcc,0,v13
v_mov_b32 v8,163840
v_mov_b32 v9,40960
v_cndmask_b32 v217,v7,v6,vcc
v_cndmask_b32 v223,v8,v9,vcc
v_mov_b32 v8,1024
v_mov_b32 v9,256
v_cndmask_b32 v229,v8,v9,vcc
v_mul_lo_u32 v8,s30,v223
v_add_u32 v217,v217,v8
v_add_u32 v11,8,v2
v_mul_u32_u24 v12,52,v11
v_lshrrev_b32 v12,8,v12
v_mul_u32_u24 v13,5,v12
v_sub_u32 v13,v11,v13
v_mul_u32_u24 v12,640,v12
v_add_u32 v12,v12,v14
v_lshlrev_b32 v6,4,v12
v_add_u32 v6,218103808,v6
v_lshlrev_b32 v7,6,v12
v_lshl_add_u32 v7,v13,4,v7
v_add_u32 v7,117440496,v7
v_cmp_eq_u32 vcc,0,v13
v_mov_b32 v8,163840
v_mov_b32 v9,40960
v_cndmask_b32 v218,v7,v6,vcc
v_cndmask_b32 v224,v8,v9,vcc
v_mov_b32 v8,1024
v_mov_b32 v9,256
v_cndmask_b32 v230,v8,v9,vcc
v_mul_lo_u32 v8,s30,v224
v_add_u32 v218,v218,v8
v_add_u32 v11,12,v2
v_mul_u32_u24 v12,52,v11
v_lshrrev_b32 v12,8,v12
v_mul_u32_u24 v13,5,v12
v_sub_u32 v13,v11,v13
v_mul_u32_u24 v12,640,v12
v_add_u32 v12,v12,v14
v_lshlrev_b32 v6,4,v12
v_add_u32 v6,218103808,v6
v_lshlrev_b32 v7,6,v12
v_lshl_add_u32 v7,v13,4,v7
v_add_u32 v7,117440496,v7
v_cmp_eq_u32 vcc,0,v13
v_mov_b32 v8,163840
v_mov_b32 v9,40960
v_cndmask_b32 v219,v7,v6,vcc
v_cndmask_b32 v225,v8,v9,vcc
v_mov_b32 v8,1024
v_mov_b32 v9,256
v_cndmask_b32 v231,v8,v9,vcc
v_mul_lo_u32 v8,s30,v225
v_add_u32 v219,v219,v8
v_add_u32 v11,16,v2
v_mul_u32_u24 v12,52,v11
v_lshrrev_b32 v12,8,v12
v_mul_u32_u24 v13,5,v12
v_sub_u32 v13,v11,v13
v_mul_u32_u24 v12,640,v12
v_add_u32 v12,v12,v14
v_lshlrev_b32 v6,4,v12
v_add_u32 v6,218103808,v6
v_lshlrev_b32 v7,6,v12
v_lshl_add_u32 v7,v13,4,v7
v_add_u32 v7,117440496,v7
v_cmp_eq_u32 vcc,0,v13
v_mov_b32 v8,163840
v_mov_b32 v9,40960
v_cndmask_b32 v220,v7,v6,vcc
v_cndmask_b32 v226,v8,v9,vcc
v_mov_b32 v8,1024
v_mov_b32 v9,256
v_cndmask_b32 v232,v8,v9,vcc
v_mul_lo_u32 v8,s30,v226
v_add_u32 v220,v220,v8
s_mul_i32 s31,s20,640
buffer_load_dwordx4 a[8:11],v216,s[36:39],0 offen
v_add_u32 v6,v216,v228
buffer_load_dwordx4 a[12:15],v6,s[36:39],0 offen
v_add_u32 v216,v216,v222
buffer_load_dwordx4 a[24:27],v217,s[36:39],0 offen
v_add_u32 v6,v217,v229
buffer_load_dwordx4 a[28:31],v6,s[36:39],0 offen
v_add_u32 v217,v217,v223
buffer_load_dwordx4 a[40:43],v218,s[36:39],0 offen
v_add_u32 v6,v218,v230
buffer_load_dwordx4 a[44:47],v6,s[36:39],0 offen
v_add_u32 v218,v218,v224
buffer_load_dwordx4 a[56:59],v219,s[36:39],0 offen
v_add_u32 v6,v219,v231
buffer_load_dwordx4 a[60:63],v6,s[36:39],0 offen
v_add_u32 v219,v219,v225
buffer_load_dwordx4 a[72:75],v220,s[36:39],0 offen
v_add_u32 v6,v220,v232
buffer_load_dwordx4 a[76:79],v6,s[36:39],0 offen
v_add_u32 v220,v220,v226
buffer_load_dwordx4 a[88:91],v216,s[36:39],0 offen
v_add_u32 v6,v216,v228
buffer_load_dwordx4 a[92:95],v6,s[36:39],0 offen
buffer_load_dwordx4 a[104:107],v217,s[36:39],0 offen
v_add_u32 v6,v217,v229
buffer_load_dwordx4 a[108:111],v6,s[36:39],0 offen
buffer_load_dwordx4 a[120:123],v218,s[36:39],0 offen
v_add_u32 v6,v218,v230
buffer_load_dwordx4 a[124:127],v6,s[36:39],0 offen
buffer_load_dwordx4 a[136:139],v219,s[36:39],0 offen
v_add_u32 v6,v219,v231
buffer_load_dwordx4 a[140:143],v6,s[36:39],0 offen
buffer_load_dwordx4 a[152:155],v220,s[36:39],0 offen
v_add_u32 v6,v220,v232
buffer_load_dwordx4 a[156:159],v6,s[36:39],0 offen
v_mul_u32_u24 v12,1280,v3
v_lshl_add_u32 v12,v2,3,v12
v_lshlrev_b32 v13,4,v2
s_lshl_b32 s23,s63,6
buffer_load_dwordx4 v[32:35],v13,s[48:51],s23 offen
s_mul_i32 s23,s62,20480
s_lshl_b32 s22,s63,5
s_add_u32 s23,s23,s22
buffer_load_dwordx2 v[40:41],v12,s[40:43],s23 offen
s_cmp_lg_u32 s100,0
s_cbranch_scc1 tpo_skip
v_and_b32 v200,63,v0
v_add_u32 v200,0,v200
v_min_u32 v200,7,v200
v_lshlrev_b32 v202,2,v200
s_mov_b32 s60,0
tpo:
buffer_load_dword v200,v202,s[92:95],s99 offen sc1
s_waitcnt vmcnt(0)
v_cmp_ne_u32 vcc,-1,v200
s_nop 1
s_cmp_eq_u64 vcc,exec
s_cbranch_scc1 tpo_ok
s_sleep 32
s_add_u32 s60,s60,1
s_cmp_gt_u32 s60,400000
s_cbranch_scc1 mega_exit
s_branch tpo
tpo_ok:
tpo_skip:
s_barrier
s_add_u32 s23,s31,0
buffer_load_dwordx4 a[0:3],v5,s[32:35],s23 offen
s_add_u32 s23,s31,40960
buffer_load_dwordx4 a[4:7],v5,s[32:35],s23 offen
s_add_u32 s23,s31,64
buffer_load_dwordx4 a[16:19],v5,s[32:35],s23 offen
s_add_u32 s23,s31,41024
buffer_load_dwordx4 a[20:23],v5,s[32:35],s23 offen
s_add_u32 s23,s31,128
buffer_load_dwordx4 a[32:35],v5,s[32:35],s23 offen
s_add_u32 s23,s31,41088
buffer_load_dwordx4 a[36:39],v5,s[32:35],s23 offen
s_add_u32 s23,s31,192
buffer_load_dwordx4 a[48:51],v5,s[32:35],s23 offen
s_add_u32 s23,s31,41152
buffer_load_dwordx4 a[52:55],v5,s[32:35],s23 offen
s_add_u32 s23,s31,256
buffer_load_dwordx4 a[64:67],v5,s[32:35],s23 offen
s_add_u32 s23,s31,41216
buffer_load_dwordx4 a[68:71],v5,s[32:35],s23 offen
s_add_u32 s23,s31,320
buffer_load_dwordx4 a[80:83],v5,s[32:35],s23 offen
s_add_u32 s23,s31,41280
buffer_load_dwordx4 a[84:87],v5,s[32:35],s23 offen
s_add_u32 s23,s31,384
buffer_load_dwordx4 a[96:99],v5,s[32:35],s23 offen
s_add_u32 s23,s31,41344
buffer_load_dwordx4 a[100:103],v5,s[32:35],s23 offen
s_add_u32 s23,s31,448
buffer_load_dwordx4 a[112:115],v5,s[32:35],s23 offen
s_add_u32 s23,s31,41408
buffer_load_dwordx4 a[116:119],v5,s[32:35],s23 offen
s_add_u32 s23,s31,512
buffer_load_dwordx4 a[128:131],v5,s[32:35],s23 offen
s_add_u32 s23,s31,41472
buffer_load_dwordx4 a[132:135],v5,s[32:35],s23 offen
s_add_u32 s23,s31,576
buffer_load_dwordx4 a[144:147],v5,s[32:35],s23 offen
s_add_u32 s23,s31,41536
buffer_load_dwordx4 a[148:151],v5,s[32:35],s23 offen
s_waitcnt vmcnt(18)
mf v[16:19],a[8:11],a[0:3],0
mf v[20:23],a[12:15],a[0:3],0
mf v[24:27],a[8:11],a[4:7],0
mf v[28:31],a[12:15],a[4:7],0
s_waitcnt vmcnt(16)
mf v[16:19],a[24:27],a[16:19],v[16:19]
mf v[20:23],a[28:31],a[16:19],v[20:23]
mf v[24:27],a[24:27],a[20:23],v[24:27]
mf v[28:31],a[28:31],a[20:23],v[28:31]
s_waitcnt vmcnt(14)
mf v[16:19],a[40:43],a[32:35],v[16:19]
mf v[20:23],a[44:47],a[32:35],v[20:23]
mf v[24:27],a[40:43],a[36:39],v[24:27]
mf v[28:31],a[44:47],a[36:39],v[28:31]
s_waitcnt vmcnt(12)
mf v[16:19],a[56:59],a[48:51],v[16:19]
mf v[20:23],a[60:63],a[48:51],v[20:23]
mf v[24:27],a[56:59],a[52:55],v[24:27]
mf v[28:31],a[60:63],a[52:55],v[28:31]
s_waitcnt vmcnt(10)
mf v[16:19],a[72:75],a[64:67],v[16:19]
mf v[20:23],a[76:79],a[64:67],v[20:23]
mf v[24:27],a[72:75],a[68:71],v[24:27]
mf v[28:31],a[76:79],a[68:71],v[28:31]
s_waitcnt vmcnt(8)
mf v[16:19],a[88:91],a[80:83],v[16:19]
mf v[20:23],a[92:95],a[80:83],v[20:23]
mf v[24:27],a[88:91],a[84:87],v[24:27]
mf v[28:31],a[92:95],a[84:87],v[28:31]
s_waitcnt vmcnt(6)
mf v[16:19],a[104:107],a[96:99],v[16:19]
mf v[20:23],a[108:111],a[96:99],v[20:23]
mf v[24:27],a[104:107],a[100:103],v[24:27]
mf v[28:31],a[108:111],a[100:103],v[28:31]
s_waitcnt vmcnt(4)
mf v[16:19],a[120:123],a[112:115],v[16:19]
mf v[20:23],a[124:127],a[112:115],v[20:23]
mf v[24:27],a[120:123],a[116:119],v[24:27]
mf v[28:31],a[124:127],a[116:119],v[28:31]
s_waitcnt vmcnt(2)
mf v[16:19],a[136:139],a[128:131],v[16:19]
mf v[20:23],a[140:143],a[128:131],v[20:23]
mf v[24:27],a[136:139],a[132:135],v[24:27]
mf v[28:31],a[140:143],a[132:135],v[28:31]
s_waitcnt vmcnt(0)
mf v[16:19],a[152:155],a[144:147],v[16:19]
mf v[20:23],a[156:159],a[144:147],v[20:23]
mf v[24:27],a[152:155],a[148:151],v[24:27]
mf v[28:31],a[156:159],a[148:151],v[28:31]
s_nop 7
s_nop 1
v_lshlrev_b32 v6,4,v1
s_lshl_b32 s23,s20,12
v_add_u32 v7,s23,v6
ds_write_b128 v7,v[16:19] offset:0
ds_write_b128 v7,v[20:23] offset:1024
ds_write_b128 v7,v[24:27] offset:2048
ds_write_b128 v7,v[28:31] offset:3072
s_waitcnt lgkmcnt(0)
s_barrier
s_lshl_b32 s23,s20,10
v_add_u32 v7,s23,v6
ds_read_b128 v[80:83],v7 offset:0
ds_read_b128 v[84:87],v7 offset:4096
ds_read_b128 v[88:91],v7 offset:8192
ds_read_b128 v[92:95],v7 offset:12288
s_waitcnt vmcnt(0) lgkmcnt(0)
v_add_f32 v16,v80,v84
v_add_f32 v6,v88,v92
v_add_f32 v16,v16,v6
v_add_f32 v17,v81,v85
v_add_f32 v6,v89,v93
v_add_f32 v17,v17,v6
v_add_f32 v18,v82,v86
v_add_f32 v6,v90,v94
v_add_f32 v18,v18,v6
v_add_f32 v19,v83,v87
v_add_f32 v6,v91,v95
v_add_f32 v19,v19,v6
v_lshlrev_b32 v48,16,v40
v_and_b32 v49,0xffff0000,v40
v_fma_f32 v16,v16,v32,v48
v_fma_f32 v17,v17,v33,v49
v_lshlrev_b32 v48,16,v41
v_and_b32 v49,0xffff0000,v41
v_fma_f32 v18,v18,v34,v48
v_fma_f32 v19,v19,v35,v49
s_mul_i32 s23,s62,40960
s_lshl_b32 s22,s63,6
s_add_u32 s23,s23,s22
buffer_store_dwordx4 v[16:19],v5,s[44:47],s23 offen sc1
s_branch task_done
ln2_kernel_entry:
s_load_dwordx2 s[12:13],s[0:1],128
s_load_dwordx2 s[6:7],s[0:1],128
v_and_b32 v1,63,v0
v_lshlrev_b32 v3,2,v1
v_lshlrev_b32 v5,3,v1
s_waitcnt lgkmcnt(0)
s_add_u32 s32,s6,0x900000
s_addc_u32 s33,s7,0
s_mov_b32 s34,0x500000
s_mov_b32 s35,0x00020000
s_mov_b32 s36,s12
s_mov_b32 s37,s13
s_mov_b32 s38,0x2000000
s_mov_b32 s39,0x00020000
s_lshl_b32 s24,s2,5
s_lshl_b32 s25,s100,3
s_add_u32 s24,s24,s25
s_mul_i32 s26,s24,2560
s_add_u32 s23,s26,0
buffer_load_dwordx2 v[20:21],v5,s[32:35],s23 offen offset:0
buffer_load_dwordx2 v[22:23],v5,s[32:35],s23 offen offset:512
buffer_load_dwordx2 v[24:25],v5,s[32:35],s23 offen offset:1024
buffer_load_dwordx2 v[26:27],v5,s[32:35],s23 offen offset:1536
buffer_load_dwordx2 v[28:29],v5,s[32:35],s23 offen offset:2048
s_add_u32 s23,s26,2560
buffer_load_dwordx2 v[30:31],v5,s[32:35],s23 offen offset:0
buffer_load_dwordx2 v[32:33],v5,s[32:35],s23 offen offset:512
buffer_load_dwordx2 v[34:35],v5,s[32:35],s23 offen offset:1024
buffer_load_dwordx2 v[36:37],v5,s[32:35],s23 offen offset:1536
buffer_load_dwordx2 v[38:39],v5,s[32:35],s23 offen offset:2048
s_add_u32 s23,s26,5120
buffer_load_dwordx2 v[40:41],v5,s[32:35],s23 offen offset:0
buffer_load_dwordx2 v[42:43],v5,s[32:35],s23 offen offset:512
buffer_load_dwordx2 v[44:45],v5,s[32:35],s23 offen offset:1024
buffer_load_dwordx2 v[46:47],v5,s[32:35],s23 offen offset:1536
buffer_load_dwordx2 v[48:49],v5,s[32:35],s23 offen offset:2048
s_add_u32 s23,s26,7680
buffer_load_dwordx2 v[50:51],v5,s[32:35],s23 offen offset:0
buffer_load_dwordx2 v[52:53],v5,s[32:35],s23 offen offset:512
buffer_load_dwordx2 v[54:55],v5,s[32:35],s23 offen offset:1024
buffer_load_dwordx2 v[56:57],v5,s[32:35],s23 offen offset:1536
buffer_load_dwordx2 v[58:59],v5,s[32:35],s23 offen offset:2048
s_add_u32 s23,s26,10240
buffer_load_dwordx2 v[60:61],v5,s[32:35],s23 offen offset:0
buffer_load_dwordx2 v[62:63],v5,s[32:35],s23 offen offset:512
buffer_load_dwordx2 v[64:65],v5,s[32:35],s23 offen offset:1024
buffer_load_dwordx2 v[66:67],v5,s[32:35],s23 offen offset:1536
buffer_load_dwordx2 v[68:69],v5,s[32:35],s23 offen offset:2048
s_add_u32 s23,s26,12800
buffer_load_dwordx2 v[70:71],v5,s[32:35],s23 offen offset:0
buffer_load_dwordx2 v[72:73],v5,s[32:35],s23 offen offset:512
buffer_load_dwordx2 v[74:75],v5,s[32:35],s23 offen offset:1024
buffer_load_dwordx2 v[76:77],v5,s[32:35],s23 offen offset:1536
buffer_load_dwordx2 v[78:79],v5,s[32:35],s23 offen offset:2048
s_add_u32 s23,s26,15360
buffer_load_dwordx2 v[80:81],v5,s[32:35],s23 offen offset:0
buffer_load_dwordx2 v[82:83],v5,s[32:35],s23 offen offset:512
buffer_load_dwordx2 v[84:85],v5,s[32:35],s23 offen offset:1024
buffer_load_dwordx2 v[86:87],v5,s[32:35],s23 offen offset:1536
buffer_load_dwordx2 v[88:89],v5,s[32:35],s23 offen offset:2048
s_add_u32 s23,s26,17920
buffer_load_dwordx2 v[90:91],v5,s[32:35],s23 offen offset:0
buffer_load_dwordx2 v[92:93],v5,s[32:35],s23 offen offset:512
buffer_load_dwordx2 v[94:95],v5,s[32:35],s23 offen offset:1024
buffer_load_dwordx2 v[96:97],v5,s[32:35],s23 offen offset:1536
buffer_load_dwordx2 v[98:99],v5,s[32:35],s23 offen offset:2048
s_mov_b32 s14,10240
buffer_load_dwordx2 v[140:141],v5,s[36:39],s14 offen
s_mov_b32 s14,7680
buffer_load_dwordx2 v[150:151],v5,s[36:39],s14 offen
s_mov_b32 s14,10752
buffer_load_dwordx2 v[142:143],v5,s[36:39],s14 offen
s_mov_b32 s14,8192
buffer_load_dwordx2 v[152:153],v5,s[36:39],s14 offen
s_mov_b32 s14,11264
buffer_load_dwordx2 v[144:145],v5,s[36:39],s14 offen
s_mov_b32 s14,8704
buffer_load_dwordx2 v[154:155],v5,s[36:39],s14 offen
s_mov_b32 s14,11776
buffer_load_dwordx2 v[146:147],v5,s[36:39],s14 offen
s_mov_b32 s14,9216
buffer_load_dwordx2 v[156:157],v5,s[36:39],s14 offen
s_mov_b32 s14,12288
buffer_load_dwordx2 v[148:149],v5,s[36:39],s14 offen
s_mov_b32 s14,9728
buffer_load_dwordx2 v[158:159],v5,s[36:39],s14 offen
v_lshrrev_b32 v6,4,v1
v_lshlrev_b32 v4,10,v6
v_bfe_u32 v6,v1,2,2
v_lshl_add_u32 v4,v6,8,v4
v_and_b32 v6,3,v1
v_lshl_add_u32 v4,v6,2,v4
s_lshr_b32 s27,s2,1
s_mul_i32 s27,s27,81920
s_and_b32 s28,s2,1
s_mul_i32 s28,s28,40960
s_add_u32 s27,s27,s28
s_lshl_b32 s28,s100,6
v_add_u32 v4,s28,v4
s_add_u32 s27,s27,29360128
s_waitcnt vmcnt(0)
v_add_f32 v168,v20,v21
v_add_f32 v168,v168,v22
v_add_f32 v168,v168,v23
v_add_f32 v168,v168,v24
v_add_f32 v168,v168,v25
v_add_f32 v168,v168,v26
v_add_f32 v168,v168,v27
v_add_f32 v168,v168,v28
v_add_f32 v168,v168,v29
v_add_f32 v169,v30,v31
v_add_f32 v169,v169,v32
v_add_f32 v169,v169,v33
v_add_f32 v169,v169,v34
v_add_f32 v169,v169,v35
v_add_f32 v169,v169,v36
v_add_f32 v169,v169,v37
v_add_f32 v169,v169,v38
v_add_f32 v169,v169,v39
v_add_f32 v170,v40,v41
v_add_f32 v170,v170,v42
v_add_f32 v170,v170,v43
v_add_f32 v170,v170,v44
v_add_f32 v170,v170,v45
v_add_f32 v170,v170,v46
v_add_f32 v170,v170,v47
v_add_f32 v170,v170,v48
v_add_f32 v170,v170,v49
v_add_f32 v171,v50,v51
v_add_f32 v171,v171,v52
v_add_f32 v171,v171,v53
v_add_f32 v171,v171,v54
v_add_f32 v171,v171,v55
v_add_f32 v171,v171,v56
v_add_f32 v171,v171,v57
v_add_f32 v171,v171,v58
v_add_f32 v171,v171,v59
v_add_f32 v172,v60,v61
v_add_f32 v172,v172,v62
v_add_f32 v172,v172,v63
v_add_f32 v172,v172,v64
v_add_f32 v172,v172,v65
v_add_f32 v172,v172,v66
v_add_f32 v172,v172,v67
v_add_f32 v172,v172,v68
v_add_f32 v172,v172,v69
v_add_f32 v173,v70,v71
v_add_f32 v173,v173,v72
v_add_f32 v173,v173,v73
v_add_f32 v173,v173,v74
v_add_f32 v173,v173,v75
v_add_f32 v173,v173,v76
v_add_f32 v173,v173,v77
v_add_f32 v173,v173,v78
v_add_f32 v173,v173,v79
v_add_f32 v174,v80,v81
v_add_f32 v174,v174,v82
v_add_f32 v174,v174,v83
v_add_f32 v174,v174,v84
v_add_f32 v174,v174,v85
v_add_f32 v174,v174,v86
v_add_f32 v174,v174,v87
v_add_f32 v174,v174,v88
v_add_f32 v174,v174,v89
v_add_f32 v175,v90,v91
v_add_f32 v175,v175,v92
v_add_f32 v175,v175,v93
v_add_f32 v175,v175,v94
v_add_f32 v175,v175,v95
v_add_f32 v175,v175,v96
v_add_f32 v175,v175,v97
v_add_f32 v175,v175,v98
v_add_f32 v175,v175,v99
v_xor_b32 v184,4,v3
ds_bpermute_b32 v176,v184,v168
ds_bpermute_b32 v177,v184,v169
ds_bpermute_b32 v178,v184,v170
ds_bpermute_b32 v179,v184,v171
ds_bpermute_b32 v180,v184,v172
ds_bpermute_b32 v181,v184,v173
ds_bpermute_b32 v182,v184,v174
ds_bpermute_b32 v183,v184,v175
s_waitcnt lgkmcnt(0)
v_add_f32 v168,v168,v176
v_add_f32 v169,v169,v177
v_add_f32 v170,v170,v178
v_add_f32 v171,v171,v179
v_add_f32 v172,v172,v180
v_add_f32 v173,v173,v181
v_add_f32 v174,v174,v182
v_add_f32 v175,v175,v183
v_xor_b32 v184,8,v3
ds_bpermute_b32 v176,v184,v168
ds_bpermute_b32 v177,v184,v169
ds_bpermute_b32 v178,v184,v170
ds_bpermute_b32 v179,v184,v171
ds_bpermute_b32 v180,v184,v172
ds_bpermute_b32 v181,v184,v173
ds_bpermute_b32 v182,v184,v174
ds_bpermute_b32 v183,v184,v175
s_waitcnt lgkmcnt(0)
v_add_f32 v168,v168,v176
v_add_f32 v169,v169,v177
v_add_f32 v170,v170,v178
v_add_f32 v171,v171,v179
v_add_f32 v172,v172,v180
v_add_f32 v173,v173,v181
v_add_f32 v174,v174,v182
v_add_f32 v175,v175,v183
v_xor_b32 v184,16,v3
ds_bpermute_b32 v176,v184,v168
ds_bpermute_b32 v177,v184,v169
ds_bpermute_b32 v178,v184,v170
ds_bpermute_b32 v179,v184,v171
ds_bpermute_b32 v180,v184,v172
ds_bpermute_b32 v181,v184,v173
ds_bpermute_b32 v182,v184,v174
ds_bpermute_b32 v183,v184,v175
s_waitcnt lgkmcnt(0)
v_add_f32 v168,v168,v176
v_add_f32 v169,v169,v177
v_add_f32 v170,v170,v178
v_add_f32 v171,v171,v179
v_add_f32 v172,v172,v180
v_add_f32 v173,v173,v181
v_add_f32 v174,v174,v182
v_add_f32 v175,v175,v183
v_xor_b32 v184,32,v3
ds_bpermute_b32 v176,v184,v168
ds_bpermute_b32 v177,v184,v169
ds_bpermute_b32 v178,v184,v170
ds_bpermute_b32 v179,v184,v171
ds_bpermute_b32 v180,v184,v172
ds_bpermute_b32 v181,v184,v173
ds_bpermute_b32 v182,v184,v174
ds_bpermute_b32 v183,v184,v175
s_waitcnt lgkmcnt(0)
v_add_f32 v168,v168,v176
v_add_f32 v169,v169,v177
v_add_f32 v170,v170,v178
v_add_f32 v171,v171,v179
v_add_f32 v172,v172,v180
v_add_f32 v173,v173,v181
v_add_f32 v174,v174,v182
v_add_f32 v175,v175,v183
v_xor_b32 v184,64,v3
ds_bpermute_b32 v176,v184,v168
ds_bpermute_b32 v177,v184,v169
ds_bpermute_b32 v178,v184,v170
ds_bpermute_b32 v179,v184,v171
ds_bpermute_b32 v180,v184,v172
ds_bpermute_b32 v181,v184,v173
ds_bpermute_b32 v182,v184,v174
ds_bpermute_b32 v183,v184,v175
s_waitcnt lgkmcnt(0)
v_add_f32 v168,v168,v176
v_add_f32 v169,v169,v177
v_add_f32 v170,v170,v178
v_add_f32 v171,v171,v179
v_add_f32 v172,v172,v180
v_add_f32 v173,v173,v181
v_add_f32 v174,v174,v182
v_add_f32 v175,v175,v183
v_xor_b32 v184,128,v3
ds_bpermute_b32 v176,v184,v168
ds_bpermute_b32 v177,v184,v169
ds_bpermute_b32 v178,v184,v170
ds_bpermute_b32 v179,v184,v171
ds_bpermute_b32 v180,v184,v172
ds_bpermute_b32 v181,v184,v173
ds_bpermute_b32 v182,v184,v174
ds_bpermute_b32 v183,v184,v175
s_waitcnt lgkmcnt(0)
v_add_f32 v168,v168,v176
v_add_f32 v169,v169,v177
v_add_f32 v170,v170,v178
v_add_f32 v171,v171,v179
v_add_f32 v172,v172,v180
v_add_f32 v173,v173,v181
v_add_f32 v174,v174,v182
v_add_f32 v175,v175,v183
v_mul_f32 v168,0x3acccccd,v168
v_sub_f32 v20,v20,v168
v_sub_f32 v21,v21,v168
v_sub_f32 v22,v22,v168
v_sub_f32 v23,v23,v168
v_sub_f32 v24,v24,v168
v_sub_f32 v25,v25,v168
v_sub_f32 v26,v26,v168
v_sub_f32 v27,v27,v168
v_sub_f32 v28,v28,v168
v_sub_f32 v29,v29,v168
v_mul_f32 v168,v20,v20
v_fmac_f32 v168,v21,v21
v_fmac_f32 v168,v22,v22
v_fmac_f32 v168,v23,v23
v_fmac_f32 v168,v24,v24
v_fmac_f32 v168,v25,v25
v_fmac_f32 v168,v26,v26
v_fmac_f32 v168,v27,v27
v_fmac_f32 v168,v28,v28
v_fmac_f32 v168,v29,v29
v_mul_f32 v169,0x3acccccd,v169
v_sub_f32 v30,v30,v169
v_sub_f32 v31,v31,v169
v_sub_f32 v32,v32,v169
v_sub_f32 v33,v33,v169
v_sub_f32 v34,v34,v169
v_sub_f32 v35,v35,v169
v_sub_f32 v36,v36,v169
v_sub_f32 v37,v37,v169
v_sub_f32 v38,v38,v169
v_sub_f32 v39,v39,v169
v_mul_f32 v169,v30,v30
v_fmac_f32 v169,v31,v31
v_fmac_f32 v169,v32,v32
v_fmac_f32 v169,v33,v33
v_fmac_f32 v169,v34,v34
v_fmac_f32 v169,v35,v35
v_fmac_f32 v169,v36,v36
v_fmac_f32 v169,v37,v37
v_fmac_f32 v169,v38,v38
v_fmac_f32 v169,v39,v39
v_mul_f32 v170,0x3acccccd,v170
v_sub_f32 v40,v40,v170
v_sub_f32 v41,v41,v170
v_sub_f32 v42,v42,v170
v_sub_f32 v43,v43,v170
v_sub_f32 v44,v44,v170
v_sub_f32 v45,v45,v170
v_sub_f32 v46,v46,v170
v_sub_f32 v47,v47,v170
v_sub_f32 v48,v48,v170
v_sub_f32 v49,v49,v170
v_mul_f32 v170,v40,v40
v_fmac_f32 v170,v41,v41
v_fmac_f32 v170,v42,v42
v_fmac_f32 v170,v43,v43
v_fmac_f32 v170,v44,v44
v_fmac_f32 v170,v45,v45
v_fmac_f32 v170,v46,v46
v_fmac_f32 v170,v47,v47
v_fmac_f32 v170,v48,v48
v_fmac_f32 v170,v49,v49
v_mul_f32 v171,0x3acccccd,v171
v_sub_f32 v50,v50,v171
v_sub_f32 v51,v51,v171
v_sub_f32 v52,v52,v171
v_sub_f32 v53,v53,v171
v_sub_f32 v54,v54,v171
v_sub_f32 v55,v55,v171
v_sub_f32 v56,v56,v171
v_sub_f32 v57,v57,v171
v_sub_f32 v58,v58,v171
v_sub_f32 v59,v59,v171
v_mul_f32 v171,v50,v50
v_fmac_f32 v171,v51,v51
v_fmac_f32 v171,v52,v52
v_fmac_f32 v171,v53,v53
v_fmac_f32 v171,v54,v54
v_fmac_f32 v171,v55,v55
v_fmac_f32 v171,v56,v56
v_fmac_f32 v171,v57,v57
v_fmac_f32 v171,v58,v58
v_fmac_f32 v171,v59,v59
v_mul_f32 v172,0x3acccccd,v172
v_sub_f32 v60,v60,v172
v_sub_f32 v61,v61,v172
v_sub_f32 v62,v62,v172
v_sub_f32 v63,v63,v172
v_sub_f32 v64,v64,v172
v_sub_f32 v65,v65,v172
v_sub_f32 v66,v66,v172
v_sub_f32 v67,v67,v172
v_sub_f32 v68,v68,v172
v_sub_f32 v69,v69,v172
v_mul_f32 v172,v60,v60
v_fmac_f32 v172,v61,v61
v_fmac_f32 v172,v62,v62
v_fmac_f32 v172,v63,v63
v_fmac_f32 v172,v64,v64
v_fmac_f32 v172,v65,v65
v_fmac_f32 v172,v66,v66
v_fmac_f32 v172,v67,v67
v_fmac_f32 v172,v68,v68
v_fmac_f32 v172,v69,v69
v_mul_f32 v173,0x3acccccd,v173
v_sub_f32 v70,v70,v173
v_sub_f32 v71,v71,v173
v_sub_f32 v72,v72,v173
v_sub_f32 v73,v73,v173
v_sub_f32 v74,v74,v173
v_sub_f32 v75,v75,v173
v_sub_f32 v76,v76,v173
v_sub_f32 v77,v77,v173
v_sub_f32 v78,v78,v173
v_sub_f32 v79,v79,v173
v_mul_f32 v173,v70,v70
v_fmac_f32 v173,v71,v71
v_fmac_f32 v173,v72,v72
v_fmac_f32 v173,v73,v73
v_fmac_f32 v173,v74,v74
v_fmac_f32 v173,v75,v75
v_fmac_f32 v173,v76,v76
v_fmac_f32 v173,v77,v77
v_fmac_f32 v173,v78,v78
v_fmac_f32 v173,v79,v79
v_mul_f32 v174,0x3acccccd,v174
v_sub_f32 v80,v80,v174
v_sub_f32 v81,v81,v174
v_sub_f32 v82,v82,v174
v_sub_f32 v83,v83,v174
v_sub_f32 v84,v84,v174
v_sub_f32 v85,v85,v174
v_sub_f32 v86,v86,v174
v_sub_f32 v87,v87,v174
v_sub_f32 v88,v88,v174
v_sub_f32 v89,v89,v174
v_mul_f32 v174,v80,v80
v_fmac_f32 v174,v81,v81
v_fmac_f32 v174,v82,v82
v_fmac_f32 v174,v83,v83
v_fmac_f32 v174,v84,v84
v_fmac_f32 v174,v85,v85
v_fmac_f32 v174,v86,v86
v_fmac_f32 v174,v87,v87
v_fmac_f32 v174,v88,v88
v_fmac_f32 v174,v89,v89
v_mul_f32 v175,0x3acccccd,v175
v_sub_f32 v90,v90,v175
v_sub_f32 v91,v91,v175
v_sub_f32 v92,v92,v175
v_sub_f32 v93,v93,v175
v_sub_f32 v94,v94,v175
v_sub_f32 v95,v95,v175
v_sub_f32 v96,v96,v175
v_sub_f32 v97,v97,v175
v_sub_f32 v98,v98,v175
v_sub_f32 v99,v99,v175
v_mul_f32 v175,v90,v90
v_fmac_f32 v175,v91,v91
v_fmac_f32 v175,v92,v92
v_fmac_f32 v175,v93,v93
v_fmac_f32 v175,v94,v94
v_fmac_f32 v175,v95,v95
v_fmac_f32 v175,v96,v96
v_fmac_f32 v175,v97,v97
v_fmac_f32 v175,v98,v98
v_fmac_f32 v175,v99,v99
v_xor_b32 v184,4,v3
ds_bpermute_b32 v176,v184,v168
ds_bpermute_b32 v177,v184,v169
ds_bpermute_b32 v178,v184,v170
ds_bpermute_b32 v179,v184,v171
ds_bpermute_b32 v180,v184,v172
ds_bpermute_b32 v181,v184,v173
ds_bpermute_b32 v182,v184,v174
ds_bpermute_b32 v183,v184,v175
s_waitcnt lgkmcnt(0)
v_add_f32 v168,v168,v176
v_add_f32 v169,v169,v177
v_add_f32 v170,v170,v178
v_add_f32 v171,v171,v179
v_add_f32 v172,v172,v180
v_add_f32 v173,v173,v181
v_add_f32 v174,v174,v182
v_add_f32 v175,v175,v183
v_xor_b32 v184,8,v3
ds_bpermute_b32 v176,v184,v168
ds_bpermute_b32 v177,v184,v169
ds_bpermute_b32 v178,v184,v170
ds_bpermute_b32 v179,v184,v171
ds_bpermute_b32 v180,v184,v172
ds_bpermute_b32 v181,v184,v173
ds_bpermute_b32 v182,v184,v174
ds_bpermute_b32 v183,v184,v175
s_waitcnt lgkmcnt(0)
v_add_f32 v168,v168,v176
v_add_f32 v169,v169,v177
v_add_f32 v170,v170,v178
v_add_f32 v171,v171,v179
v_add_f32 v172,v172,v180
v_add_f32 v173,v173,v181
v_add_f32 v174,v174,v182
v_add_f32 v175,v175,v183
v_xor_b32 v184,16,v3
ds_bpermute_b32 v176,v184,v168
ds_bpermute_b32 v177,v184,v169
ds_bpermute_b32 v178,v184,v170
ds_bpermute_b32 v179,v184,v171
ds_bpermute_b32 v180,v184,v172
ds_bpermute_b32 v181,v184,v173
ds_bpermute_b32 v182,v184,v174
ds_bpermute_b32 v183,v184,v175
s_waitcnt lgkmcnt(0)
v_add_f32 v168,v168,v176
v_add_f32 v169,v169,v177
v_add_f32 v170,v170,v178
v_add_f32 v171,v171,v179
v_add_f32 v172,v172,v180
v_add_f32 v173,v173,v181
v_add_f32 v174,v174,v182
v_add_f32 v175,v175,v183
v_xor_b32 v184,32,v3
ds_bpermute_b32 v176,v184,v168
ds_bpermute_b32 v177,v184,v169
ds_bpermute_b32 v178,v184,v170
ds_bpermute_b32 v179,v184,v171
ds_bpermute_b32 v180,v184,v172
ds_bpermute_b32 v181,v184,v173
ds_bpermute_b32 v182,v184,v174
ds_bpermute_b32 v183,v184,v175
s_waitcnt lgkmcnt(0)
v_add_f32 v168,v168,v176
v_add_f32 v169,v169,v177
v_add_f32 v170,v170,v178
v_add_f32 v171,v171,v179
v_add_f32 v172,v172,v180
v_add_f32 v173,v173,v181
v_add_f32 v174,v174,v182
v_add_f32 v175,v175,v183
v_xor_b32 v184,64,v3
ds_bpermute_b32 v176,v184,v168
ds_bpermute_b32 v177,v184,v169
ds_bpermute_b32 v178,v184,v170
ds_bpermute_b32 v179,v184,v171
ds_bpermute_b32 v180,v184,v172
ds_bpermute_b32 v181,v184,v173
ds_bpermute_b32 v182,v184,v174
ds_bpermute_b32 v183,v184,v175
s_waitcnt lgkmcnt(0)
v_add_f32 v168,v168,v176
v_add_f32 v169,v169,v177
v_add_f32 v170,v170,v178
v_add_f32 v171,v171,v179
v_add_f32 v172,v172,v180
v_add_f32 v173,v173,v181
v_add_f32 v174,v174,v182
v_add_f32 v175,v175,v183
v_xor_b32 v184,128,v3
ds_bpermute_b32 v176,v184,v168
ds_bpermute_b32 v177,v184,v169
ds_bpermute_b32 v178,v184,v170
ds_bpermute_b32 v179,v184,v171
ds_bpermute_b32 v180,v184,v172
ds_bpermute_b32 v181,v184,v173
ds_bpermute_b32 v182,v184,v174
ds_bpermute_b32 v183,v184,v175
s_waitcnt lgkmcnt(0)
v_add_f32 v168,v168,v176
v_add_f32 v169,v169,v177
v_add_f32 v170,v170,v178
v_add_f32 v171,v171,v179
v_add_f32 v172,v172,v180
v_add_f32 v173,v173,v181
v_add_f32 v174,v174,v182
v_add_f32 v175,v175,v183
v_add_f32 v140,1.0,v140
v_add_f32 v141,1.0,v141
v_add_f32 v142,1.0,v142
v_add_f32 v143,1.0,v143
v_add_f32 v144,1.0,v144
v_add_f32 v145,1.0,v145
v_add_f32 v146,1.0,v146
v_add_f32 v147,1.0,v147
v_add_f32 v148,1.0,v148
v_add_f32 v149,1.0,v149
v_mov_b32 v7,0x3727c5ac
v_fmac_f32 v7,0x3acccccd,v168
v_rsq_f32 v7,v7
s_nop 0
v_mul_f32 v20,v20,v7
v_fma_f32 v20,v20,v140,v150
v_mul_f32 v21,v21,v7
v_fma_f32 v21,v21,v141,v151
v_mul_f32 v22,v22,v7
v_fma_f32 v22,v22,v142,v152
v_mul_f32 v23,v23,v7
v_fma_f32 v23,v23,v143,v153
v_mul_f32 v24,v24,v7
v_fma_f32 v24,v24,v144,v154
v_mul_f32 v25,v25,v7
v_fma_f32 v25,v25,v145,v155
v_mul_f32 v26,v26,v7
v_fma_f32 v26,v26,v146,v156
v_mul_f32 v27,v27,v7
v_fma_f32 v27,v27,v147,v157
v_mul_f32 v28,v28,v7
v_fma_f32 v28,v28,v148,v158
v_mul_f32 v29,v29,v7
v_fma_f32 v29,v29,v149,v159
cv v20,v20,v21
ds_write_b32 v4,v20 offset:0
cv v21,v22,v23
ds_write_b32 v4,v21 offset:4096
cv v22,v24,v25
ds_write_b32 v4,v22 offset:8192
cv v23,v26,v27
ds_write_b32 v4,v23 offset:12288
cv v24,v28,v29
ds_write_b32 v4,v24 offset:16384
v_mov_b32 v7,0x3727c5ac
v_fmac_f32 v7,0x3acccccd,v169
v_rsq_f32 v7,v7
s_nop 0
v_mul_f32 v30,v30,v7
v_fma_f32 v30,v30,v140,v150
v_mul_f32 v31,v31,v7
v_fma_f32 v31,v31,v141,v151
v_mul_f32 v32,v32,v7
v_fma_f32 v32,v32,v142,v152
v_mul_f32 v33,v33,v7
v_fma_f32 v33,v33,v143,v153
v_mul_f32 v34,v34,v7
v_fma_f32 v34,v34,v144,v154
v_mul_f32 v35,v35,v7
v_fma_f32 v35,v35,v145,v155
v_mul_f32 v36,v36,v7
v_fma_f32 v36,v36,v146,v156
v_mul_f32 v37,v37,v7
v_fma_f32 v37,v37,v147,v157
v_mul_f32 v38,v38,v7
v_fma_f32 v38,v38,v148,v158
v_mul_f32 v39,v39,v7
v_fma_f32 v39,v39,v149,v159
cv v30,v30,v31
ds_write_b32 v4,v30 offset:16
cv v31,v32,v33
ds_write_b32 v4,v31 offset:4112
cv v32,v34,v35
ds_write_b32 v4,v32 offset:8208
cv v33,v36,v37
ds_write_b32 v4,v33 offset:12304
cv v34,v38,v39
ds_write_b32 v4,v34 offset:16400
v_mov_b32 v7,0x3727c5ac
v_fmac_f32 v7,0x3acccccd,v170
v_rsq_f32 v7,v7
s_nop 0
v_mul_f32 v40,v40,v7
v_fma_f32 v40,v40,v140,v150
v_mul_f32 v41,v41,v7
v_fma_f32 v41,v41,v141,v151
v_mul_f32 v42,v42,v7
v_fma_f32 v42,v42,v142,v152
v_mul_f32 v43,v43,v7
v_fma_f32 v43,v43,v143,v153
v_mul_f32 v44,v44,v7
v_fma_f32 v44,v44,v144,v154
v_mul_f32 v45,v45,v7
v_fma_f32 v45,v45,v145,v155
v_mul_f32 v46,v46,v7
v_fma_f32 v46,v46,v146,v156
v_mul_f32 v47,v47,v7
v_fma_f32 v47,v47,v147,v157
v_mul_f32 v48,v48,v7
v_fma_f32 v48,v48,v148,v158
v_mul_f32 v49,v49,v7
v_fma_f32 v49,v49,v149,v159
cv v40,v40,v41
ds_write_b32 v4,v40 offset:32
cv v41,v42,v43
ds_write_b32 v4,v41 offset:4128
cv v42,v44,v45
ds_write_b32 v4,v42 offset:8224
cv v43,v46,v47
ds_write_b32 v4,v43 offset:12320
cv v44,v48,v49
ds_write_b32 v4,v44 offset:16416
v_mov_b32 v7,0x3727c5ac
v_fmac_f32 v7,0x3acccccd,v171
v_rsq_f32 v7,v7
s_nop 0
v_mul_f32 v50,v50,v7
v_fma_f32 v50,v50,v140,v150
v_mul_f32 v51,v51,v7
v_fma_f32 v51,v51,v141,v151
v_mul_f32 v52,v52,v7
v_fma_f32 v52,v52,v142,v152
v_mul_f32 v53,v53,v7
v_fma_f32 v53,v53,v143,v153
v_mul_f32 v54,v54,v7
v_fma_f32 v54,v54,v144,v154
v_mul_f32 v55,v55,v7
v_fma_f32 v55,v55,v145,v155
v_mul_f32 v56,v56,v7
v_fma_f32 v56,v56,v146,v156
v_mul_f32 v57,v57,v7
v_fma_f32 v57,v57,v147,v157
v_mul_f32 v58,v58,v7
v_fma_f32 v58,v58,v148,v158
v_mul_f32 v59,v59,v7
v_fma_f32 v59,v59,v149,v159
cv v50,v50,v51
ds_write_b32 v4,v50 offset:48
cv v51,v52,v53
ds_write_b32 v4,v51 offset:4144
cv v52,v54,v55
ds_write_b32 v4,v52 offset:8240
cv v53,v56,v57
ds_write_b32 v4,v53 offset:12336
cv v54,v58,v59
ds_write_b32 v4,v54 offset:16432
v_mov_b32 v7,0x3727c5ac
v_fmac_f32 v7,0x3acccccd,v172
v_rsq_f32 v7,v7
s_nop 0
v_mul_f32 v60,v60,v7
v_fma_f32 v60,v60,v140,v150
v_mul_f32 v61,v61,v7
v_fma_f32 v61,v61,v141,v151
v_mul_f32 v62,v62,v7
v_fma_f32 v62,v62,v142,v152
v_mul_f32 v63,v63,v7
v_fma_f32 v63,v63,v143,v153
v_mul_f32 v64,v64,v7
v_fma_f32 v64,v64,v144,v154
v_mul_f32 v65,v65,v7
v_fma_f32 v65,v65,v145,v155
v_mul_f32 v66,v66,v7
v_fma_f32 v66,v66,v146,v156
v_mul_f32 v67,v67,v7
v_fma_f32 v67,v67,v147,v157
v_mul_f32 v68,v68,v7
v_fma_f32 v68,v68,v148,v158
v_mul_f32 v69,v69,v7
v_fma_f32 v69,v69,v149,v159
cv v60,v60,v61
ds_write_b32 v4,v60 offset:20480
cv v61,v62,v63
ds_write_b32 v4,v61 offset:24576
cv v62,v64,v65
ds_write_b32 v4,v62 offset:28672
cv v63,v66,v67
ds_write_b32 v4,v63 offset:32768
cv v64,v68,v69
ds_write_b32 v4,v64 offset:36864
v_mov_b32 v7,0x3727c5ac
v_fmac_f32 v7,0x3acccccd,v173
v_rsq_f32 v7,v7
s_nop 0
v_mul_f32 v70,v70,v7
v_fma_f32 v70,v70,v140,v150
v_mul_f32 v71,v71,v7
v_fma_f32 v71,v71,v141,v151
v_mul_f32 v72,v72,v7
v_fma_f32 v72,v72,v142,v152
v_mul_f32 v73,v73,v7
v_fma_f32 v73,v73,v143,v153
v_mul_f32 v74,v74,v7
v_fma_f32 v74,v74,v144,v154
v_mul_f32 v75,v75,v7
v_fma_f32 v75,v75,v145,v155
v_mul_f32 v76,v76,v7
v_fma_f32 v76,v76,v146,v156
v_mul_f32 v77,v77,v7
v_fma_f32 v77,v77,v147,v157
v_mul_f32 v78,v78,v7
v_fma_f32 v78,v78,v148,v158
v_mul_f32 v79,v79,v7
v_fma_f32 v79,v79,v149,v159
cv v70,v70,v71
ds_write_b32 v4,v70 offset:20496
cv v71,v72,v73
ds_write_b32 v4,v71 offset:24592
cv v72,v74,v75
ds_write_b32 v4,v72 offset:28688
cv v73,v76,v77
ds_write_b32 v4,v73 offset:32784
cv v74,v78,v79
ds_write_b32 v4,v74 offset:36880
v_mov_b32 v7,0x3727c5ac
v_fmac_f32 v7,0x3acccccd,v174
v_rsq_f32 v7,v7
s_nop 0
v_mul_f32 v80,v80,v7
v_fma_f32 v80,v80,v140,v150
v_mul_f32 v81,v81,v7
v_fma_f32 v81,v81,v141,v151
v_mul_f32 v82,v82,v7
v_fma_f32 v82,v82,v142,v152
v_mul_f32 v83,v83,v7
v_fma_f32 v83,v83,v143,v153
v_mul_f32 v84,v84,v7
v_fma_f32 v84,v84,v144,v154
v_mul_f32 v85,v85,v7
v_fma_f32 v85,v85,v145,v155
v_mul_f32 v86,v86,v7
v_fma_f32 v86,v86,v146,v156
v_mul_f32 v87,v87,v7
v_fma_f32 v87,v87,v147,v157
v_mul_f32 v88,v88,v7
v_fma_f32 v88,v88,v148,v158
v_mul_f32 v89,v89,v7
v_fma_f32 v89,v89,v149,v159
cv v80,v80,v81
ds_write_b32 v4,v80 offset:20512
cv v81,v82,v83
ds_write_b32 v4,v81 offset:24608
cv v82,v84,v85
ds_write_b32 v4,v82 offset:28704
cv v83,v86,v87
ds_write_b32 v4,v83 offset:32800
cv v84,v88,v89
ds_write_b32 v4,v84 offset:36896
v_mov_b32 v7,0x3727c5ac
v_fmac_f32 v7,0x3acccccd,v175
v_rsq_f32 v7,v7
s_nop 0
v_mul_f32 v90,v90,v7
v_fma_f32 v90,v90,v140,v150
v_mul_f32 v91,v91,v7
v_fma_f32 v91,v91,v141,v151
v_mul_f32 v92,v92,v7
v_fma_f32 v92,v92,v142,v152
v_mul_f32 v93,v93,v7
v_fma_f32 v93,v93,v143,v153
v_mul_f32 v94,v94,v7
v_fma_f32 v94,v94,v144,v154
v_mul_f32 v95,v95,v7
v_fma_f32 v95,v95,v145,v155
v_mul_f32 v96,v96,v7
v_fma_f32 v96,v96,v146,v156
v_mul_f32 v97,v97,v7
v_fma_f32 v97,v97,v147,v157
v_mul_f32 v98,v98,v7
v_fma_f32 v98,v98,v148,v158
v_mul_f32 v99,v99,v7
v_fma_f32 v99,v99,v149,v159
cv v90,v90,v91
ds_write_b32 v4,v90 offset:20528
cv v91,v92,v93
ds_write_b32 v4,v91 offset:24624
cv v92,v94,v95
ds_write_b32 v4,v92 offset:28720
cv v93,v96,v97
ds_write_b32 v4,v93 offset:32816
cv v94,v98,v99
ds_write_b32 v4,v94 offset:36912
s_waitcnt lgkmcnt(0)
s_barrier
v_lshlrev_b32 v5,4,v0
ds_read_b128 v[20:23],v5 offset:0
ds_read_b128 v[24:27],v5 offset:4096
ds_read_b128 v[28:31],v5 offset:8192
ds_read_b128 v[32:35],v5 offset:12288
ds_read_b128 v[36:39],v5 offset:16384
ds_read_b128 v[40:43],v5 offset:20480
ds_read_b128 v[44:47],v5 offset:24576
ds_read_b128 v[48:51],v5 offset:28672
ds_read_b128 v[52:55],v5 offset:32768
ds_read_b128 v[56:59],v5 offset:36864
s_waitcnt lgkmcnt(9)
s_add_u32 s14,s27,0
buffer_store_dwordx4 v[20:23],v5,s[36:39],s14 offen sc1
s_waitcnt lgkmcnt(8)
s_add_u32 s14,s27,4096
buffer_store_dwordx4 v[24:27],v5,s[36:39],s14 offen sc1
s_waitcnt lgkmcnt(7)
s_add_u32 s14,s27,8192
buffer_store_dwordx4 v[28:31],v5,s[36:39],s14 offen sc1
s_waitcnt lgkmcnt(6)
s_add_u32 s14,s27,12288
buffer_store_dwordx4 v[32:35],v5,s[36:39],s14 offen sc1
s_waitcnt lgkmcnt(5)
s_add_u32 s14,s27,16384
buffer_store_dwordx4 v[36:39],v5,s[36:39],s14 offen sc1
s_waitcnt lgkmcnt(4)
s_add_u32 s14,s27,20480
buffer_store_dwordx4 v[40:43],v5,s[36:39],s14 offen sc1
s_waitcnt lgkmcnt(3)
s_add_u32 s14,s27,24576
buffer_store_dwordx4 v[44:47],v5,s[36:39],s14 offen sc1
s_waitcnt lgkmcnt(2)
s_add_u32 s14,s27,28672
buffer_store_dwordx4 v[48:51],v5,s[36:39],s14 offen sc1
s_waitcnt lgkmcnt(1)
s_add_u32 s14,s27,32768
buffer_store_dwordx4 v[52:55],v5,s[36:39],s14 offen sc1
s_waitcnt lgkmcnt(0)
s_add_u32 s14,s27,36864
buffer_store_dwordx4 v[56:59],v5,s[36:39],s14 offen sc1
s_branch task_done
ln1_kernel_entry:
s_load_dwordx2 s[12:13],s[0:1],128
s_load_dwordx2 s[6:7],s[0:1],0
v_and_b32 v1,63,v0
v_lshlrev_b32 v3,2,v1
v_lshlrev_b32 v5,3,v1
s_waitcnt lgkmcnt(0)
s_mov_b32 s32,s6
s_mov_b32 s33,s7
s_mov_b32 s34,0x280000
s_mov_b32 s35,0x00020000
s_mov_b32 s36,s12
s_mov_b32 s37,s13
s_mov_b32 s38,0x2000000
s_mov_b32 s39,0x00020000
s_lshl_b32 s24,s2,5
s_lshl_b32 s25,s100,3
s_add_u32 s24,s24,s25
s_mul_i32 s26,s24,1280
s_add_u32 s23,s26,0
buffer_load_dword v100,v3,s[32:35],s23 offen offset:0
buffer_load_dword v101,v3,s[32:35],s23 offen offset:256
buffer_load_dword v102,v3,s[32:35],s23 offen offset:512
buffer_load_dword v103,v3,s[32:35],s23 offen offset:768
buffer_load_dword v104,v3,s[32:35],s23 offen offset:1024
s_add_u32 s23,s26,1280
buffer_load_dword v105,v3,s[32:35],s23 offen offset:0
buffer_load_dword v106,v3,s[32:35],s23 offen offset:256
buffer_load_dword v107,v3,s[32:35],s23 offen offset:512
buffer_load_dword v108,v3,s[32:35],s23 offen offset:768
buffer_load_dword v109,v3,s[32:35],s23 offen offset:1024
s_add_u32 s23,s26,2560
buffer_load_dword v110,v3,s[32:35],s23 offen offset:0
buffer_load_dword v111,v3,s[32:35],s23 offen offset:256
buffer_load_dword v112,v3,s[32:35],s23 offen offset:512
buffer_load_dword v113,v3,s[32:35],s23 offen offset:768
buffer_load_dword v114,v3,s[32:35],s23 offen offset:1024
s_add_u32 s23,s26,3840
buffer_load_dword v115,v3,s[32:35],s23 offen offset:0
buffer_load_dword v116,v3,s[32:35],s23 offen offset:256
buffer_load_dword v117,v3,s[32:35],s23 offen offset:512
buffer_load_dword v118,v3,s[32:35],s23 offen offset:768
buffer_load_dword v119,v3,s[32:35],s23 offen offset:1024
s_add_u32 s23,s26,5120
buffer_load_dword v120,v3,s[32:35],s23 offen offset:0
buffer_load_dword v121,v3,s[32:35],s23 offen offset:256
buffer_load_dword v122,v3,s[32:35],s23 offen offset:512
buffer_load_dword v123,v3,s[32:35],s23 offen offset:768
buffer_load_dword v124,v3,s[32:35],s23 offen offset:1024
s_add_u32 s23,s26,6400
buffer_load_dword v125,v3,s[32:35],s23 offen offset:0
buffer_load_dword v126,v3,s[32:35],s23 offen offset:256
buffer_load_dword v127,v3,s[32:35],s23 offen offset:512
buffer_load_dword v128,v3,s[32:35],s23 offen offset:768
buffer_load_dword v129,v3,s[32:35],s23 offen offset:1024
s_add_u32 s23,s26,7680
buffer_load_dword v130,v3,s[32:35],s23 offen offset:0
buffer_load_dword v131,v3,s[32:35],s23 offen offset:256
buffer_load_dword v132,v3,s[32:35],s23 offen offset:512
buffer_load_dword v133,v3,s[32:35],s23 offen offset:768
buffer_load_dword v134,v3,s[32:35],s23 offen offset:1024
s_add_u32 s23,s26,8960
buffer_load_dword v135,v3,s[32:35],s23 offen offset:0
buffer_load_dword v136,v3,s[32:35],s23 offen offset:256
buffer_load_dword v137,v3,s[32:35],s23 offen offset:512
buffer_load_dword v138,v3,s[32:35],s23 offen offset:768
buffer_load_dword v139,v3,s[32:35],s23 offen offset:1024
s_mov_b32 s14,2560
buffer_load_dwordx2 v[140:141],v5,s[36:39],s14 offen
s_mov_b32 s14,0
buffer_load_dwordx2 v[150:151],v5,s[36:39],s14 offen
s_mov_b32 s14,3072
buffer_load_dwordx2 v[142:143],v5,s[36:39],s14 offen
s_mov_b32 s14,512
buffer_load_dwordx2 v[152:153],v5,s[36:39],s14 offen
s_mov_b32 s14,3584
buffer_load_dwordx2 v[144:145],v5,s[36:39],s14 offen
s_mov_b32 s14,1024
buffer_load_dwordx2 v[154:155],v5,s[36:39],s14 offen
s_mov_b32 s14,4096
buffer_load_dwordx2 v[146:147],v5,s[36:39],s14 offen
s_mov_b32 s14,1536
buffer_load_dwordx2 v[156:157],v5,s[36:39],s14 offen
s_mov_b32 s14,4608
buffer_load_dwordx2 v[148:149],v5,s[36:39],s14 offen
s_mov_b32 s14,2048
buffer_load_dwordx2 v[158:159],v5,s[36:39],s14 offen
v_lshrrev_b32 v6,4,v1
v_lshlrev_b32 v4,10,v6
v_bfe_u32 v6,v1,2,2
v_lshl_add_u32 v4,v6,8,v4
v_and_b32 v6,3,v1
v_lshl_add_u32 v4,v6,2,v4
s_lshr_b32 s27,s2,1
s_mul_i32 s27,s27,81920
s_and_b32 s28,s2,1
s_mul_i32 s28,s28,40960
s_add_u32 s27,s27,s28
s_lshl_b32 s28,s100,6
v_add_u32 v4,s28,v4
s_add_u32 s27,s27,26214400
s_waitcnt vmcnt(0)
v_lshlrev_b32 v20,16,v100
v_and_b32 v21,0xffff0000,v100
v_lshlrev_b32 v22,16,v101
v_and_b32 v23,0xffff0000,v101
v_lshlrev_b32 v24,16,v102
v_and_b32 v25,0xffff0000,v102
v_lshlrev_b32 v26,16,v103
v_and_b32 v27,0xffff0000,v103
v_lshlrev_b32 v28,16,v104
v_and_b32 v29,0xffff0000,v104
v_add_f32 v168,v20,v21
v_add_f32 v168,v168,v22
v_add_f32 v168,v168,v23
v_add_f32 v168,v168,v24
v_add_f32 v168,v168,v25
v_add_f32 v168,v168,v26
v_add_f32 v168,v168,v27
v_add_f32 v168,v168,v28
v_add_f32 v168,v168,v29
v_lshlrev_b32 v30,16,v105
v_and_b32 v31,0xffff0000,v105
v_lshlrev_b32 v32,16,v106
v_and_b32 v33,0xffff0000,v106
v_lshlrev_b32 v34,16,v107
v_and_b32 v35,0xffff0000,v107
v_lshlrev_b32 v36,16,v108
v_and_b32 v37,0xffff0000,v108
v_lshlrev_b32 v38,16,v109
v_and_b32 v39,0xffff0000,v109
v_add_f32 v169,v30,v31
v_add_f32 v169,v169,v32
v_add_f32 v169,v169,v33
v_add_f32 v169,v169,v34
v_add_f32 v169,v169,v35
v_add_f32 v169,v169,v36
v_add_f32 v169,v169,v37
v_add_f32 v169,v169,v38
v_add_f32 v169,v169,v39
v_lshlrev_b32 v40,16,v110
v_and_b32 v41,0xffff0000,v110
v_lshlrev_b32 v42,16,v111
v_and_b32 v43,0xffff0000,v111
v_lshlrev_b32 v44,16,v112
v_and_b32 v45,0xffff0000,v112
v_lshlrev_b32 v46,16,v113
v_and_b32 v47,0xffff0000,v113
v_lshlrev_b32 v48,16,v114
v_and_b32 v49,0xffff0000,v114
v_add_f32 v170,v40,v41
v_add_f32 v170,v170,v42
v_add_f32 v170,v170,v43
v_add_f32 v170,v170,v44
v_add_f32 v170,v170,v45
v_add_f32 v170,v170,v46
v_add_f32 v170,v170,v47
v_add_f32 v170,v170,v48
v_add_f32 v170,v170,v49
v_lshlrev_b32 v50,16,v115
v_and_b32 v51,0xffff0000,v115
v_lshlrev_b32 v52,16,v116
v_and_b32 v53,0xffff0000,v116
v_lshlrev_b32 v54,16,v117
v_and_b32 v55,0xffff0000,v117
v_lshlrev_b32 v56,16,v118
v_and_b32 v57,0xffff0000,v118
v_lshlrev_b32 v58,16,v119
v_and_b32 v59,0xffff0000,v119
v_add_f32 v171,v50,v51
v_add_f32 v171,v171,v52
v_add_f32 v171,v171,v53
v_add_f32 v171,v171,v54
v_add_f32 v171,v171,v55
v_add_f32 v171,v171,v56
v_add_f32 v171,v171,v57
v_add_f32 v171,v171,v58
v_add_f32 v171,v171,v59
v_lshlrev_b32 v60,16,v120
v_and_b32 v61,0xffff0000,v120
v_lshlrev_b32 v62,16,v121
v_and_b32 v63,0xffff0000,v121
v_lshlrev_b32 v64,16,v122
v_and_b32 v65,0xffff0000,v122
v_lshlrev_b32 v66,16,v123
v_and_b32 v67,0xffff0000,v123
v_lshlrev_b32 v68,16,v124
v_and_b32 v69,0xffff0000,v124
v_add_f32 v172,v60,v61
v_add_f32 v172,v172,v62
v_add_f32 v172,v172,v63
v_add_f32 v172,v172,v64
v_add_f32 v172,v172,v65
v_add_f32 v172,v172,v66
v_add_f32 v172,v172,v67
v_add_f32 v172,v172,v68
v_add_f32 v172,v172,v69
v_lshlrev_b32 v70,16,v125
v_and_b32 v71,0xffff0000,v125
v_lshlrev_b32 v72,16,v126
v_and_b32 v73,0xffff0000,v126
v_lshlrev_b32 v74,16,v127
v_and_b32 v75,0xffff0000,v127
v_lshlrev_b32 v76,16,v128
v_and_b32 v77,0xffff0000,v128
v_lshlrev_b32 v78,16,v129
v_and_b32 v79,0xffff0000,v129
v_add_f32 v173,v70,v71
v_add_f32 v173,v173,v72
v_add_f32 v173,v173,v73
v_add_f32 v173,v173,v74
v_add_f32 v173,v173,v75
v_add_f32 v173,v173,v76
v_add_f32 v173,v173,v77
v_add_f32 v173,v173,v78
v_add_f32 v173,v173,v79
v_lshlrev_b32 v80,16,v130
v_and_b32 v81,0xffff0000,v130
v_lshlrev_b32 v82,16,v131
v_and_b32 v83,0xffff0000,v131
v_lshlrev_b32 v84,16,v132
v_and_b32 v85,0xffff0000,v132
v_lshlrev_b32 v86,16,v133
v_and_b32 v87,0xffff0000,v133
v_lshlrev_b32 v88,16,v134
v_and_b32 v89,0xffff0000,v134
v_add_f32 v174,v80,v81
v_add_f32 v174,v174,v82
v_add_f32 v174,v174,v83
v_add_f32 v174,v174,v84
v_add_f32 v174,v174,v85
v_add_f32 v174,v174,v86
v_add_f32 v174,v174,v87
v_add_f32 v174,v174,v88
v_add_f32 v174,v174,v89
v_lshlrev_b32 v90,16,v135
v_and_b32 v91,0xffff0000,v135
v_lshlrev_b32 v92,16,v136
v_and_b32 v93,0xffff0000,v136
v_lshlrev_b32 v94,16,v137
v_and_b32 v95,0xffff0000,v137
v_lshlrev_b32 v96,16,v138
v_and_b32 v97,0xffff0000,v138
v_lshlrev_b32 v98,16,v139
v_and_b32 v99,0xffff0000,v139
v_add_f32 v175,v90,v91
v_add_f32 v175,v175,v92
v_add_f32 v175,v175,v93
v_add_f32 v175,v175,v94
v_add_f32 v175,v175,v95
v_add_f32 v175,v175,v96
v_add_f32 v175,v175,v97
v_add_f32 v175,v175,v98
v_add_f32 v175,v175,v99
v_xor_b32 v184,4,v3
ds_bpermute_b32 v176,v184,v168
ds_bpermute_b32 v177,v184,v169
ds_bpermute_b32 v178,v184,v170
ds_bpermute_b32 v179,v184,v171
ds_bpermute_b32 v180,v184,v172
ds_bpermute_b32 v181,v184,v173
ds_bpermute_b32 v182,v184,v174
ds_bpermute_b32 v183,v184,v175
s_waitcnt lgkmcnt(0)
v_add_f32 v168,v168,v176
v_add_f32 v169,v169,v177
v_add_f32 v170,v170,v178
v_add_f32 v171,v171,v179
v_add_f32 v172,v172,v180
v_add_f32 v173,v173,v181
v_add_f32 v174,v174,v182
v_add_f32 v175,v175,v183
v_xor_b32 v184,8,v3
ds_bpermute_b32 v176,v184,v168
ds_bpermute_b32 v177,v184,v169
ds_bpermute_b32 v178,v184,v170
ds_bpermute_b32 v179,v184,v171
ds_bpermute_b32 v180,v184,v172
ds_bpermute_b32 v181,v184,v173
ds_bpermute_b32 v182,v184,v174
ds_bpermute_b32 v183,v184,v175
s_waitcnt lgkmcnt(0)
v_add_f32 v168,v168,v176
v_add_f32 v169,v169,v177
v_add_f32 v170,v170,v178
v_add_f32 v171,v171,v179
v_add_f32 v172,v172,v180
v_add_f32 v173,v173,v181
v_add_f32 v174,v174,v182
v_add_f32 v175,v175,v183
v_xor_b32 v184,16,v3
ds_bpermute_b32 v176,v184,v168
ds_bpermute_b32 v177,v184,v169
ds_bpermute_b32 v178,v184,v170
ds_bpermute_b32 v179,v184,v171
ds_bpermute_b32 v180,v184,v172
ds_bpermute_b32 v181,v184,v173
ds_bpermute_b32 v182,v184,v174
ds_bpermute_b32 v183,v184,v175
s_waitcnt lgkmcnt(0)
v_add_f32 v168,v168,v176
v_add_f32 v169,v169,v177
v_add_f32 v170,v170,v178
v_add_f32 v171,v171,v179
v_add_f32 v172,v172,v180
v_add_f32 v173,v173,v181
v_add_f32 v174,v174,v182
v_add_f32 v175,v175,v183
v_xor_b32 v184,32,v3
ds_bpermute_b32 v176,v184,v168
ds_bpermute_b32 v177,v184,v169
ds_bpermute_b32 v178,v184,v170
ds_bpermute_b32 v179,v184,v171
ds_bpermute_b32 v180,v184,v172
ds_bpermute_b32 v181,v184,v173
ds_bpermute_b32 v182,v184,v174
ds_bpermute_b32 v183,v184,v175
s_waitcnt lgkmcnt(0)
v_add_f32 v168,v168,v176
v_add_f32 v169,v169,v177
v_add_f32 v170,v170,v178
v_add_f32 v171,v171,v179
v_add_f32 v172,v172,v180
v_add_f32 v173,v173,v181
v_add_f32 v174,v174,v182
v_add_f32 v175,v175,v183
v_xor_b32 v184,64,v3
ds_bpermute_b32 v176,v184,v168
ds_bpermute_b32 v177,v184,v169
ds_bpermute_b32 v178,v184,v170
ds_bpermute_b32 v179,v184,v171
ds_bpermute_b32 v180,v184,v172
ds_bpermute_b32 v181,v184,v173
ds_bpermute_b32 v182,v184,v174
ds_bpermute_b32 v183,v184,v175
s_waitcnt lgkmcnt(0)
v_add_f32 v168,v168,v176
v_add_f32 v169,v169,v177
v_add_f32 v170,v170,v178
v_add_f32 v171,v171,v179
v_add_f32 v172,v172,v180
v_add_f32 v173,v173,v181
v_add_f32 v174,v174,v182
v_add_f32 v175,v175,v183
v_xor_b32 v184,128,v3
ds_bpermute_b32 v176,v184,v168
ds_bpermute_b32 v177,v184,v169
ds_bpermute_b32 v178,v184,v170
ds_bpermute_b32 v179,v184,v171
ds_bpermute_b32 v180,v184,v172
ds_bpermute_b32 v181,v184,v173
ds_bpermute_b32 v182,v184,v174
ds_bpermute_b32 v183,v184,v175
s_waitcnt lgkmcnt(0)
v_add_f32 v168,v168,v176
v_add_f32 v169,v169,v177
v_add_f32 v170,v170,v178
v_add_f32 v171,v171,v179
v_add_f32 v172,v172,v180
v_add_f32 v173,v173,v181
v_add_f32 v174,v174,v182
v_add_f32 v175,v175,v183
v_mul_f32 v168,0x3acccccd,v168
v_sub_f32 v20,v20,v168
v_sub_f32 v21,v21,v168
v_sub_f32 v22,v22,v168
v_sub_f32 v23,v23,v168
v_sub_f32 v24,v24,v168
v_sub_f32 v25,v25,v168
v_sub_f32 v26,v26,v168
v_sub_f32 v27,v27,v168
v_sub_f32 v28,v28,v168
v_sub_f32 v29,v29,v168
v_mul_f32 v168,v20,v20
v_fmac_f32 v168,v21,v21
v_fmac_f32 v168,v22,v22
v_fmac_f32 v168,v23,v23
v_fmac_f32 v168,v24,v24
v_fmac_f32 v168,v25,v25
v_fmac_f32 v168,v26,v26
v_fmac_f32 v168,v27,v27
v_fmac_f32 v168,v28,v28
v_fmac_f32 v168,v29,v29
v_mul_f32 v169,0x3acccccd,v169
v_sub_f32 v30,v30,v169
v_sub_f32 v31,v31,v169
v_sub_f32 v32,v32,v169
v_sub_f32 v33,v33,v169
v_sub_f32 v34,v34,v169
v_sub_f32 v35,v35,v169
v_sub_f32 v36,v36,v169
v_sub_f32 v37,v37,v169
v_sub_f32 v38,v38,v169
v_sub_f32 v39,v39,v169
v_mul_f32 v169,v30,v30
v_fmac_f32 v169,v31,v31
v_fmac_f32 v169,v32,v32
v_fmac_f32 v169,v33,v33
v_fmac_f32 v169,v34,v34
v_fmac_f32 v169,v35,v35
v_fmac_f32 v169,v36,v36
v_fmac_f32 v169,v37,v37
v_fmac_f32 v169,v38,v38
v_fmac_f32 v169,v39,v39
v_mul_f32 v170,0x3acccccd,v170
v_sub_f32 v40,v40,v170
v_sub_f32 v41,v41,v170
v_sub_f32 v42,v42,v170
v_sub_f32 v43,v43,v170
v_sub_f32 v44,v44,v170
v_sub_f32 v45,v45,v170
v_sub_f32 v46,v46,v170
v_sub_f32 v47,v47,v170
v_sub_f32 v48,v48,v170
v_sub_f32 v49,v49,v170
v_mul_f32 v170,v40,v40
v_fmac_f32 v170,v41,v41
v_fmac_f32 v170,v42,v42
v_fmac_f32 v170,v43,v43
v_fmac_f32 v170,v44,v44
v_fmac_f32 v170,v45,v45
v_fmac_f32 v170,v46,v46
v_fmac_f32 v170,v47,v47
v_fmac_f32 v170,v48,v48
v_fmac_f32 v170,v49,v49
v_mul_f32 v171,0x3acccccd,v171
v_sub_f32 v50,v50,v171
v_sub_f32 v51,v51,v171
v_sub_f32 v52,v52,v171
v_sub_f32 v53,v53,v171
v_sub_f32 v54,v54,v171
v_sub_f32 v55,v55,v171
v_sub_f32 v56,v56,v171
v_sub_f32 v57,v57,v171
v_sub_f32 v58,v58,v171
v_sub_f32 v59,v59,v171
v_mul_f32 v171,v50,v50
v_fmac_f32 v171,v51,v51
v_fmac_f32 v171,v52,v52
v_fmac_f32 v171,v53,v53
v_fmac_f32 v171,v54,v54
v_fmac_f32 v171,v55,v55
v_fmac_f32 v171,v56,v56
v_fmac_f32 v171,v57,v57
v_fmac_f32 v171,v58,v58
v_fmac_f32 v171,v59,v59
v_mul_f32 v172,0x3acccccd,v172
v_sub_f32 v60,v60,v172
v_sub_f32 v61,v61,v172
v_sub_f32 v62,v62,v172
v_sub_f32 v63,v63,v172
v_sub_f32 v64,v64,v172
v_sub_f32 v65,v65,v172
v_sub_f32 v66,v66,v172
v_sub_f32 v67,v67,v172
v_sub_f32 v68,v68,v172
v_sub_f32 v69,v69,v172
v_mul_f32 v172,v60,v60
v_fmac_f32 v172,v61,v61
v_fmac_f32 v172,v62,v62
v_fmac_f32 v172,v63,v63
v_fmac_f32 v172,v64,v64
v_fmac_f32 v172,v65,v65
v_fmac_f32 v172,v66,v66
v_fmac_f32 v172,v67,v67
v_fmac_f32 v172,v68,v68
v_fmac_f32 v172,v69,v69
v_mul_f32 v173,0x3acccccd,v173
v_sub_f32 v70,v70,v173
v_sub_f32 v71,v71,v173
v_sub_f32 v72,v72,v173
v_sub_f32 v73,v73,v173
v_sub_f32 v74,v74,v173
v_sub_f32 v75,v75,v173
v_sub_f32 v76,v76,v173
v_sub_f32 v77,v77,v173
v_sub_f32 v78,v78,v173
v_sub_f32 v79,v79,v173
v_mul_f32 v173,v70,v70
v_fmac_f32 v173,v71,v71
v_fmac_f32 v173,v72,v72
v_fmac_f32 v173,v73,v73
v_fmac_f32 v173,v74,v74
v_fmac_f32 v173,v75,v75
v_fmac_f32 v173,v76,v76
v_fmac_f32 v173,v77,v77
v_fmac_f32 v173,v78,v78
v_fmac_f32 v173,v79,v79
v_mul_f32 v174,0x3acccccd,v174
v_sub_f32 v80,v80,v174
v_sub_f32 v81,v81,v174
v_sub_f32 v82,v82,v174
v_sub_f32 v83,v83,v174
v_sub_f32 v84,v84,v174
v_sub_f32 v85,v85,v174
v_sub_f32 v86,v86,v174
v_sub_f32 v87,v87,v174
v_sub_f32 v88,v88,v174
v_sub_f32 v89,v89,v174
v_mul_f32 v174,v80,v80
v_fmac_f32 v174,v81,v81
v_fmac_f32 v174,v82,v82
v_fmac_f32 v174,v83,v83
v_fmac_f32 v174,v84,v84
v_fmac_f32 v174,v85,v85
v_fmac_f32 v174,v86,v86
v_fmac_f32 v174,v87,v87
v_fmac_f32 v174,v88,v88
v_fmac_f32 v174,v89,v89
v_mul_f32 v175,0x3acccccd,v175
v_sub_f32 v90,v90,v175
v_sub_f32 v91,v91,v175
v_sub_f32 v92,v92,v175
v_sub_f32 v93,v93,v175
v_sub_f32 v94,v94,v175
v_sub_f32 v95,v95,v175
v_sub_f32 v96,v96,v175
v_sub_f32 v97,v97,v175
v_sub_f32 v98,v98,v175
v_sub_f32 v99,v99,v175
v_mul_f32 v175,v90,v90
v_fmac_f32 v175,v91,v91
v_fmac_f32 v175,v92,v92
v_fmac_f32 v175,v93,v93
v_fmac_f32 v175,v94,v94
v_fmac_f32 v175,v95,v95
v_fmac_f32 v175,v96,v96
v_fmac_f32 v175,v97,v97
v_fmac_f32 v175,v98,v98
v_fmac_f32 v175,v99,v99
v_xor_b32 v184,4,v3
ds_bpermute_b32 v176,v184,v168
ds_bpermute_b32 v177,v184,v169
ds_bpermute_b32 v178,v184,v170
ds_bpermute_b32 v179,v184,v171
ds_bpermute_b32 v180,v184,v172
ds_bpermute_b32 v181,v184,v173
ds_bpermute_b32 v182,v184,v174
ds_bpermute_b32 v183,v184,v175
s_waitcnt lgkmcnt(0)
v_add_f32 v168,v168,v176
v_add_f32 v169,v169,v177
v_add_f32 v170,v170,v178
v_add_f32 v171,v171,v179
v_add_f32 v172,v172,v180
v_add_f32 v173,v173,v181
v_add_f32 v174,v174,v182
v_add_f32 v175,v175,v183
v_xor_b32 v184,8,v3
ds_bpermute_b32 v176,v184,v168
ds_bpermute_b32 v177,v184,v169
ds_bpermute_b32 v178,v184,v170
ds_bpermute_b32 v179,v184,v171
ds_bpermute_b32 v180,v184,v172
ds_bpermute_b32 v181,v184,v173
ds_bpermute_b32 v182,v184,v174
ds_bpermute_b32 v183,v184,v175
s_waitcnt lgkmcnt(0)
v_add_f32 v168,v168,v176
v_add_f32 v169,v169,v177
v_add_f32 v170,v170,v178
v_add_f32 v171,v171,v179
v_add_f32 v172,v172,v180
v_add_f32 v173,v173,v181
v_add_f32 v174,v174,v182
v_add_f32 v175,v175,v183
v_xor_b32 v184,16,v3
ds_bpermute_b32 v176,v184,v168
ds_bpermute_b32 v177,v184,v169
ds_bpermute_b32 v178,v184,v170
ds_bpermute_b32 v179,v184,v171
ds_bpermute_b32 v180,v184,v172
ds_bpermute_b32 v181,v184,v173
ds_bpermute_b32 v182,v184,v174
ds_bpermute_b32 v183,v184,v175
s_waitcnt lgkmcnt(0)
v_add_f32 v168,v168,v176
v_add_f32 v169,v169,v177
v_add_f32 v170,v170,v178
v_add_f32 v171,v171,v179
v_add_f32 v172,v172,v180
v_add_f32 v173,v173,v181
v_add_f32 v174,v174,v182
v_add_f32 v175,v175,v183
v_xor_b32 v184,32,v3
ds_bpermute_b32 v176,v184,v168
ds_bpermute_b32 v177,v184,v169
ds_bpermute_b32 v178,v184,v170
ds_bpermute_b32 v179,v184,v171
ds_bpermute_b32 v180,v184,v172
ds_bpermute_b32 v181,v184,v173
ds_bpermute_b32 v182,v184,v174
ds_bpermute_b32 v183,v184,v175
s_waitcnt lgkmcnt(0)
v_add_f32 v168,v168,v176
v_add_f32 v169,v169,v177
v_add_f32 v170,v170,v178
v_add_f32 v171,v171,v179
v_add_f32 v172,v172,v180
v_add_f32 v173,v173,v181
v_add_f32 v174,v174,v182
v_add_f32 v175,v175,v183
v_xor_b32 v184,64,v3
ds_bpermute_b32 v176,v184,v168
ds_bpermute_b32 v177,v184,v169
ds_bpermute_b32 v178,v184,v170
ds_bpermute_b32 v179,v184,v171
ds_bpermute_b32 v180,v184,v172
ds_bpermute_b32 v181,v184,v173
ds_bpermute_b32 v182,v184,v174
ds_bpermute_b32 v183,v184,v175
s_waitcnt lgkmcnt(0)
v_add_f32 v168,v168,v176
v_add_f32 v169,v169,v177
v_add_f32 v170,v170,v178
v_add_f32 v171,v171,v179
v_add_f32 v172,v172,v180
v_add_f32 v173,v173,v181
v_add_f32 v174,v174,v182
v_add_f32 v175,v175,v183
v_xor_b32 v184,128,v3
ds_bpermute_b32 v176,v184,v168
ds_bpermute_b32 v177,v184,v169
ds_bpermute_b32 v178,v184,v170
ds_bpermute_b32 v179,v184,v171
ds_bpermute_b32 v180,v184,v172
ds_bpermute_b32 v181,v184,v173
ds_bpermute_b32 v182,v184,v174
ds_bpermute_b32 v183,v184,v175
s_waitcnt lgkmcnt(0)
v_add_f32 v168,v168,v176
v_add_f32 v169,v169,v177
v_add_f32 v170,v170,v178
v_add_f32 v171,v171,v179
v_add_f32 v172,v172,v180
v_add_f32 v173,v173,v181
v_add_f32 v174,v174,v182
v_add_f32 v175,v175,v183
v_add_f32 v140,1.0,v140
v_add_f32 v141,1.0,v141
v_add_f32 v142,1.0,v142
v_add_f32 v143,1.0,v143
v_add_f32 v144,1.0,v144
v_add_f32 v145,1.0,v145
v_add_f32 v146,1.0,v146
v_add_f32 v147,1.0,v147
v_add_f32 v148,1.0,v148
v_add_f32 v149,1.0,v149
v_mov_b32 v7,0x3727c5ac
v_fmac_f32 v7,0x3acccccd,v168
v_rsq_f32 v7,v7
s_nop 0
v_mul_f32 v20,v20,v7
v_fma_f32 v20,v20,v140,v150
v_mul_f32 v21,v21,v7
v_fma_f32 v21,v21,v141,v151
v_mul_f32 v22,v22,v7
v_fma_f32 v22,v22,v142,v152
v_mul_f32 v23,v23,v7
v_fma_f32 v23,v23,v143,v153
v_mul_f32 v24,v24,v7
v_fma_f32 v24,v24,v144,v154
v_mul_f32 v25,v25,v7
v_fma_f32 v25,v25,v145,v155
v_mul_f32 v26,v26,v7
v_fma_f32 v26,v26,v146,v156
v_mul_f32 v27,v27,v7
v_fma_f32 v27,v27,v147,v157
v_mul_f32 v28,v28,v7
v_fma_f32 v28,v28,v148,v158
v_mul_f32 v29,v29,v7
v_fma_f32 v29,v29,v149,v159
cv v20,v20,v21
ds_write_b32 v4,v20 offset:0
cv v21,v22,v23
ds_write_b32 v4,v21 offset:4096
cv v22,v24,v25
ds_write_b32 v4,v22 offset:8192
cv v23,v26,v27
ds_write_b32 v4,v23 offset:12288
cv v24,v28,v29
ds_write_b32 v4,v24 offset:16384
v_mov_b32 v7,0x3727c5ac
v_fmac_f32 v7,0x3acccccd,v169
v_rsq_f32 v7,v7
s_nop 0
v_mul_f32 v30,v30,v7
v_fma_f32 v30,v30,v140,v150
v_mul_f32 v31,v31,v7
v_fma_f32 v31,v31,v141,v151
v_mul_f32 v32,v32,v7
v_fma_f32 v32,v32,v142,v152
v_mul_f32 v33,v33,v7
v_fma_f32 v33,v33,v143,v153
v_mul_f32 v34,v34,v7
v_fma_f32 v34,v34,v144,v154
v_mul_f32 v35,v35,v7
v_fma_f32 v35,v35,v145,v155
v_mul_f32 v36,v36,v7
v_fma_f32 v36,v36,v146,v156
v_mul_f32 v37,v37,v7
v_fma_f32 v37,v37,v147,v157
v_mul_f32 v38,v38,v7
v_fma_f32 v38,v38,v148,v158
v_mul_f32 v39,v39,v7
v_fma_f32 v39,v39,v149,v159
cv v30,v30,v31
ds_write_b32 v4,v30 offset:16
cv v31,v32,v33
ds_write_b32 v4,v31 offset:4112
cv v32,v34,v35
ds_write_b32 v4,v32 offset:8208
cv v33,v36,v37
ds_write_b32 v4,v33 offset:12304
cv v34,v38,v39
ds_write_b32 v4,v34 offset:16400
v_mov_b32 v7,0x3727c5ac
v_fmac_f32 v7,0x3acccccd,v170
v_rsq_f32 v7,v7
s_nop 0
v_mul_f32 v40,v40,v7
v_fma_f32 v40,v40,v140,v150
v_mul_f32 v41,v41,v7
v_fma_f32 v41,v41,v141,v151
v_mul_f32 v42,v42,v7
v_fma_f32 v42,v42,v142,v152
v_mul_f32 v43,v43,v7
v_fma_f32 v43,v43,v143,v153
v_mul_f32 v44,v44,v7
v_fma_f32 v44,v44,v144,v154
v_mul_f32 v45,v45,v7
v_fma_f32 v45,v45,v145,v155
v_mul_f32 v46,v46,v7
v_fma_f32 v46,v46,v146,v156
v_mul_f32 v47,v47,v7
v_fma_f32 v47,v47,v147,v157
v_mul_f32 v48,v48,v7
v_fma_f32 v48,v48,v148,v158
v_mul_f32 v49,v49,v7
v_fma_f32 v49,v49,v149,v159
cv v40,v40,v41
ds_write_b32 v4,v40 offset:32
cv v41,v42,v43
ds_write_b32 v4,v41 offset:4128
cv v42,v44,v45
ds_write_b32 v4,v42 offset:8224
cv v43,v46,v47
ds_write_b32 v4,v43 offset:12320
cv v44,v48,v49
ds_write_b32 v4,v44 offset:16416
v_mov_b32 v7,0x3727c5ac
v_fmac_f32 v7,0x3acccccd,v171
v_rsq_f32 v7,v7
s_nop 0
v_mul_f32 v50,v50,v7
v_fma_f32 v50,v50,v140,v150
v_mul_f32 v51,v51,v7
v_fma_f32 v51,v51,v141,v151
v_mul_f32 v52,v52,v7
v_fma_f32 v52,v52,v142,v152
v_mul_f32 v53,v53,v7
v_fma_f32 v53,v53,v143,v153
v_mul_f32 v54,v54,v7
v_fma_f32 v54,v54,v144,v154
v_mul_f32 v55,v55,v7
v_fma_f32 v55,v55,v145,v155
v_mul_f32 v56,v56,v7
v_fma_f32 v56,v56,v146,v156
v_mul_f32 v57,v57,v7
v_fma_f32 v57,v57,v147,v157
v_mul_f32 v58,v58,v7
v_fma_f32 v58,v58,v148,v158
v_mul_f32 v59,v59,v7
v_fma_f32 v59,v59,v149,v159
cv v50,v50,v51
ds_write_b32 v4,v50 offset:48
cv v51,v52,v53
ds_write_b32 v4,v51 offset:4144
cv v52,v54,v55
ds_write_b32 v4,v52 offset:8240
cv v53,v56,v57
ds_write_b32 v4,v53 offset:12336
cv v54,v58,v59
ds_write_b32 v4,v54 offset:16432
v_mov_b32 v7,0x3727c5ac
v_fmac_f32 v7,0x3acccccd,v172
v_rsq_f32 v7,v7
s_nop 0
v_mul_f32 v60,v60,v7
v_fma_f32 v60,v60,v140,v150
v_mul_f32 v61,v61,v7
v_fma_f32 v61,v61,v141,v151
v_mul_f32 v62,v62,v7
v_fma_f32 v62,v62,v142,v152
v_mul_f32 v63,v63,v7
v_fma_f32 v63,v63,v143,v153
v_mul_f32 v64,v64,v7
v_fma_f32 v64,v64,v144,v154
v_mul_f32 v65,v65,v7
v_fma_f32 v65,v65,v145,v155
v_mul_f32 v66,v66,v7
v_fma_f32 v66,v66,v146,v156
v_mul_f32 v67,v67,v7
v_fma_f32 v67,v67,v147,v157
v_mul_f32 v68,v68,v7
v_fma_f32 v68,v68,v148,v158
v_mul_f32 v69,v69,v7
v_fma_f32 v69,v69,v149,v159
cv v60,v60,v61
ds_write_b32 v4,v60 offset:20480
cv v61,v62,v63
ds_write_b32 v4,v61 offset:24576
cv v62,v64,v65
ds_write_b32 v4,v62 offset:28672
cv v63,v66,v67
ds_write_b32 v4,v63 offset:32768
cv v64,v68,v69
ds_write_b32 v4,v64 offset:36864
v_mov_b32 v7,0x3727c5ac
v_fmac_f32 v7,0x3acccccd,v173
v_rsq_f32 v7,v7
s_nop 0
v_mul_f32 v70,v70,v7
v_fma_f32 v70,v70,v140,v150
v_mul_f32 v71,v71,v7
v_fma_f32 v71,v71,v141,v151
v_mul_f32 v72,v72,v7
v_fma_f32 v72,v72,v142,v152
v_mul_f32 v73,v73,v7
v_fma_f32 v73,v73,v143,v153
v_mul_f32 v74,v74,v7
v_fma_f32 v74,v74,v144,v154
v_mul_f32 v75,v75,v7
v_fma_f32 v75,v75,v145,v155
v_mul_f32 v76,v76,v7
v_fma_f32 v76,v76,v146,v156
v_mul_f32 v77,v77,v7
v_fma_f32 v77,v77,v147,v157
v_mul_f32 v78,v78,v7
v_fma_f32 v78,v78,v148,v158
v_mul_f32 v79,v79,v7
v_fma_f32 v79,v79,v149,v159
cv v70,v70,v71
ds_write_b32 v4,v70 offset:20496
cv v71,v72,v73
ds_write_b32 v4,v71 offset:24592
cv v72,v74,v75
ds_write_b32 v4,v72 offset:28688
cv v73,v76,v77
ds_write_b32 v4,v73 offset:32784
cv v74,v78,v79
ds_write_b32 v4,v74 offset:36880
v_mov_b32 v7,0x3727c5ac
v_fmac_f32 v7,0x3acccccd,v174
v_rsq_f32 v7,v7
s_nop 0
v_mul_f32 v80,v80,v7
v_fma_f32 v80,v80,v140,v150
v_mul_f32 v81,v81,v7
v_fma_f32 v81,v81,v141,v151
v_mul_f32 v82,v82,v7
v_fma_f32 v82,v82,v142,v152
v_mul_f32 v83,v83,v7
v_fma_f32 v83,v83,v143,v153
v_mul_f32 v84,v84,v7
v_fma_f32 v84,v84,v144,v154
v_mul_f32 v85,v85,v7
v_fma_f32 v85,v85,v145,v155
v_mul_f32 v86,v86,v7
v_fma_f32 v86,v86,v146,v156
v_mul_f32 v87,v87,v7
v_fma_f32 v87,v87,v147,v157
v_mul_f32 v88,v88,v7
v_fma_f32 v88,v88,v148,v158
v_mul_f32 v89,v89,v7
v_fma_f32 v89,v89,v149,v159
cv v80,v80,v81
ds_write_b32 v4,v80 offset:20512
cv v81,v82,v83
ds_write_b32 v4,v81 offset:24608
cv v82,v84,v85
ds_write_b32 v4,v82 offset:28704
cv v83,v86,v87
ds_write_b32 v4,v83 offset:32800
cv v84,v88,v89
ds_write_b32 v4,v84 offset:36896
v_mov_b32 v7,0x3727c5ac
v_fmac_f32 v7,0x3acccccd,v175
v_rsq_f32 v7,v7
s_nop 0
v_mul_f32 v90,v90,v7
v_fma_f32 v90,v90,v140,v150
v_mul_f32 v91,v91,v7
v_fma_f32 v91,v91,v141,v151
v_mul_f32 v92,v92,v7
v_fma_f32 v92,v92,v142,v152
v_mul_f32 v93,v93,v7
v_fma_f32 v93,v93,v143,v153
v_mul_f32 v94,v94,v7
v_fma_f32 v94,v94,v144,v154
v_mul_f32 v95,v95,v7
v_fma_f32 v95,v95,v145,v155
v_mul_f32 v96,v96,v7
v_fma_f32 v96,v96,v146,v156
v_mul_f32 v97,v97,v7
v_fma_f32 v97,v97,v147,v157
v_mul_f32 v98,v98,v7
v_fma_f32 v98,v98,v148,v158
v_mul_f32 v99,v99,v7
v_fma_f32 v99,v99,v149,v159
cv v90,v90,v91
ds_write_b32 v4,v90 offset:20528
cv v91,v92,v93
ds_write_b32 v4,v91 offset:24624
cv v92,v94,v95
ds_write_b32 v4,v92 offset:28720
cv v93,v96,v97
ds_write_b32 v4,v93 offset:32816
cv v94,v98,v99
ds_write_b32 v4,v94 offset:36912
s_waitcnt lgkmcnt(0)
s_barrier
v_lshlrev_b32 v5,4,v0
ds_read_b128 v[20:23],v5 offset:0
ds_read_b128 v[24:27],v5 offset:4096
ds_read_b128 v[28:31],v5 offset:8192
ds_read_b128 v[32:35],v5 offset:12288
ds_read_b128 v[36:39],v5 offset:16384
ds_read_b128 v[40:43],v5 offset:20480
ds_read_b128 v[44:47],v5 offset:24576
ds_read_b128 v[48:51],v5 offset:28672
ds_read_b128 v[52:55],v5 offset:32768
ds_read_b128 v[56:59],v5 offset:36864
s_waitcnt lgkmcnt(9)
s_add_u32 s14,s27,0
buffer_store_dwordx4 v[20:23],v5,s[36:39],s14 offen sc1
s_waitcnt lgkmcnt(8)
s_add_u32 s14,s27,4096
buffer_store_dwordx4 v[24:27],v5,s[36:39],s14 offen sc1
s_waitcnt lgkmcnt(7)
s_add_u32 s14,s27,8192
buffer_store_dwordx4 v[28:31],v5,s[36:39],s14 offen sc1
s_waitcnt lgkmcnt(6)
s_add_u32 s14,s27,12288
buffer_store_dwordx4 v[32:35],v5,s[36:39],s14 offen sc1
s_waitcnt lgkmcnt(5)
s_add_u32 s14,s27,16384
buffer_store_dwordx4 v[36:39],v5,s[36:39],s14 offen sc1
s_waitcnt lgkmcnt(4)
s_add_u32 s14,s27,20480
buffer_store_dwordx4 v[40:43],v5,s[36:39],s14 offen sc1
s_waitcnt lgkmcnt(3)
s_add_u32 s14,s27,24576
buffer_store_dwordx4 v[44:47],v5,s[36:39],s14 offen sc1
s_waitcnt lgkmcnt(2)
s_add_u32 s14,s27,28672
buffer_store_dwordx4 v[48:51],v5,s[36:39],s14 offen sc1
s_waitcnt lgkmcnt(1)
s_add_u32 s14,s27,32768
buffer_store_dwordx4 v[52:55],v5,s[36:39],s14 offen sc1
s_waitcnt lgkmcnt(0)
s_add_u32 s14,s27,36864
buffer_store_dwordx4 v[56:59],v5,s[36:39],s14 offen sc1
s_branch task_done
vo_kernel_entry:
s_load_dwordx4 s[8:11],s[0:1],32
s_load_dwordx2 s[12:13],s[0:1],128
v_and_b32 v1,63,v0
v_lshrrev_b32 v2,4,v1
v_and_b32 v3,15,v0
v_lshrrev_b32 v4,6,v0
s_nop 0
v_readfirstlane_b32 s20,v4
s_nop 3
s_lshl_b32 s21,s20,10
v_bfe_u32 v5,v1,2,2
v_lshl_add_u32 v6,v2,3,v5
v_lshlrev_b32 v6,7,v6
v_and_b32 v7,3,v1
v_lshl_add_u32 v6,v7,3,v6
v_lshrrev_b32 v5,1,v5
v_and_b32 v7,1,v2
v_xor_b32 v11,0,v7
v_lshl_or_b32 v11,v11,1,v5
v_xor_b32 v8,0,v11
v_lshl_add_u32 v8,v8,5,v6
v_xor_b32 v9,1,v11
v_lshl_add_u32 v9,v9,5,v6
v_xor_b32 v10,2,v11
v_lshl_add_u32 v10,v10,5,v6
v_xor_b32 v11,3,v11
v_lshl_add_u32 v11,v11,5,v6
v_xor_b32 v15,1,v7
v_lshl_or_b32 v15,v15,1,v5
v_xor_b32 v12,0,v15
v_lshl_add_u32 v12,v12,5,v6
v_add_u32 v12,512,v12
v_xor_b32 v13,1,v15
v_lshl_add_u32 v13,v13,5,v6
v_add_u32 v13,512,v13
v_xor_b32 v14,2,v15
v_lshl_add_u32 v14,v14,5,v6
v_add_u32 v14,512,v14
v_xor_b32 v15,3,v15
v_lshl_add_u32 v15,v15,5,v6
v_add_u32 v15,512,v15
v_bfe_u32 v5,v1,2,2
v_lshl_add_u32 v6,v2,2,v5
v_lshlrev_b32 v6,7,v6
v_and_b32 v7,3,v1
v_lshl_add_u32 v6,v7,3,v6
v_lshrrev_b32 v5,1,v5
v_lshrrev_b32 v7,1,v2
v_xor_b32 v7,v7,v2
v_and_b32 v7,1,v7
v_lshl_or_b32 v19,v7,1,v5
v_xor_b32 v16,0,v19
v_lshl_add_u32 v16,v16,5,v6
v_xor_b32 v17,1,v19
v_lshl_add_u32 v17,v17,5,v6
v_xor_b32 v18,2,v19
v_lshl_add_u32 v18,v18,5,v6
v_xor_b32 v19,3,v19
v_lshl_add_u32 v19,v19,5,v6
s_and_b32 s24,s2,31
s_bfe_u32 s25,s2,0x10005
s_lshr_b32 s26,s2,6
s_waitcnt lgkmcnt(0)
s_lshl_b32 s27,s25,2
s_add_u32 s27,s27,s20
s_mul_i32 s27,s27,80
s_min_u32 s27,s27,544
s_mul_i32 s28,s27,12288
s_mul_i32 s29,s24,384
s_add_u32 s28,s28,s29
s_sub_u32 s29,7864320,s28
s_add_u32 s32,s8,s28
s_addc_u32 s33,s9,0
s_mov_b32 s34,s29
s_mov_b32 s35,0x00020000
s_mul_i32 s28,s24,245760
s_mul_i32 s29,s26,640
s_add_u32 s28,s28,s29
s_sub_u32 s29,7864320,s28
s_add_u32 s44,s10,s28
s_addc_u32 s45,s11,0
s_mov_b32 s46,s29
s_mov_b32 s47,0x00020000
s_mul_i32 s28,s26,13107200
s_lshr_b32 s29,s24,1
s_mul_i32 s29,s29,20480
s_add_u32 s28,s28,s29
s_and_b32 s29,s24,1
s_lshl_b32 s29,s29,7
s_add_u32 s28,s28,s29
s_lshl_b32 s29,s27,5
s_add_u32 s28,s28,s29
s_add_u32 s28,s28,83886080
s_add_u32 s60,s12,s28
s_addc_u32 s61,s13,0
s_mov_b32 s62,0xc80000
s_mov_b32 s63,0x00020000
v_lshrrev_b32 v244,3,v1
v_lshl_add_u32 v245,v4,3,v244
v_bfe_u32 v246,v245,1,1
v_lshrrev_b32 v6,2,v245
v_lshrrev_b32 v244,3,v245
v_xor_b32 v6,v6,v244
v_and_b32 v6,1,v6
v_lshl_or_b32 v246,v6,1,v246
v_bfe_u32 v244,v1,1,2
v_xor_b32 v246,v246,v244
v_and_b32 v244,1,v1
v_lshl_or_b32 v246,v246,1,v244
v_lshlrev_b32 v246,4,v246
s_mov_b32 s22,1280
v_mul_lo_u32 v6,s22,v245
v_add_u32 v6,v6,v246
v_lshrrev_b32 v244,2,v3
v_and_b32 v245,3,v3
v_lshl_add_u32 v244,v244,3,v245
v_lshlrev_b32 v245,4,v2
v_mul_u32_u24 v247,12288,v244
v_add_u32 v247,v247,v245
v_lshrrev_b32 v249,3,v3
v_mul_u32_u24 v249,327680,v249
v_and_b32 v246,7,v3
v_lshlrev_b32 v246,4,v246
v_add_u32 v249,v249,v246
v_lshl_add_u32 v249,v2,8,v249
s_mov_b32 s23,0
buffer_load_dwordx4 a[0:3],v247,s[32:35],s23 offen
s_mov_b32 s23,64
buffer_load_dwordx4 a[4:7],v247,s[32:35],s23 offen
s_mov_b32 s23,128
buffer_load_dwordx4 a[8:11],v247,s[32:35],s23 offen
s_mov_b32 s23,192
buffer_load_dwordx4 a[12:15],v247,s[32:35],s23 offen
s_mov_b32 s23,256
buffer_load_dwordx4 a[16:19],v247,s[32:35],s23 offen
s_mov_b32 s23,320
buffer_load_dwordx4 a[20:23],v247,s[32:35],s23 offen
s_mov_b32 s23,49152
buffer_load_dwordx4 a[24:27],v247,s[32:35],s23 offen
s_mov_b32 s23,49216
buffer_load_dwordx4 a[28:31],v247,s[32:35],s23 offen
s_mov_b32 s23,49280
buffer_load_dwordx4 a[32:35],v247,s[32:35],s23 offen
s_mov_b32 s23,49344
buffer_load_dwordx4 a[36:39],v247,s[32:35],s23 offen
s_mov_b32 s23,49408
buffer_load_dwordx4 a[40:43],v247,s[32:35],s23 offen
s_mov_b32 s23,49472
buffer_load_dwordx4 a[44:47],v247,s[32:35],s23 offen
s_mov_b32 s23,393216
buffer_load_dwordx4 a[48:51],v247,s[32:35],s23 offen
s_mov_b32 s23,393280
buffer_load_dwordx4 a[52:55],v247,s[32:35],s23 offen
s_mov_b32 s23,393344
buffer_load_dwordx4 a[56:59],v247,s[32:35],s23 offen
s_mov_b32 s23,393408
buffer_load_dwordx4 a[60:63],v247,s[32:35],s23 offen
s_mov_b32 s23,393472
buffer_load_dwordx4 a[64:67],v247,s[32:35],s23 offen
s_mov_b32 s23,393536
buffer_load_dwordx4 a[68:71],v247,s[32:35],s23 offen
s_mov_b32 s23,442368
buffer_load_dwordx4 a[72:75],v247,s[32:35],s23 offen
s_mov_b32 s23,442432
buffer_load_dwordx4 a[76:79],v247,s[32:35],s23 offen
s_mov_b32 s23,442496
buffer_load_dwordx4 a[80:83],v247,s[32:35],s23 offen
s_mov_b32 s23,442560
buffer_load_dwordx4 a[84:87],v247,s[32:35],s23 offen
s_mov_b32 s23,442624
buffer_load_dwordx4 a[88:91],v247,s[32:35],s23 offen
s_mov_b32 s23,442688
buffer_load_dwordx4 a[92:95],v247,s[32:35],s23 offen
s_mov_b32 s23,786432
buffer_load_dwordx4 a[96:99],v247,s[32:35],s23 offen
s_mov_b32 s23,786496
buffer_load_dwordx4 a[100:103],v247,s[32:35],s23 offen
s_mov_b32 s23,786560
buffer_load_dwordx4 a[104:107],v247,s[32:35],s23 offen
s_mov_b32 s23,786624
buffer_load_dwordx4 a[108:111],v247,s[32:35],s23 offen
s_mov_b32 s23,786688
buffer_load_dwordx4 a[112:115],v247,s[32:35],s23 offen
s_mov_b32 s23,786752
buffer_load_dwordx4 a[116:119],v247,s[32:35],s23 offen
s_mov_b32 s23,835584
buffer_load_dwordx4 a[120:123],v247,s[32:35],s23 offen
s_mov_b32 s23,835648
buffer_load_dwordx4 a[124:127],v247,s[32:35],s23 offen
s_mov_b32 s23,835712
buffer_load_dwordx4 a[128:131],v247,s[32:35],s23 offen
s_mov_b32 s23,835776
buffer_load_dwordx4 a[132:135],v247,s[32:35],s23 offen
s_mov_b32 s23,835840
buffer_load_dwordx4 a[136:139],v247,s[32:35],s23 offen
s_mov_b32 s23,835904
buffer_load_dwordx4 a[140:143],v247,s[32:35],s23 offen
s_add_u32 m0,s21,0
s_mov_b32 s23,0
buffer_load_dwordx4 v6,s[44:47],s23 offen lds
s_add_u32 m0,s21,4096
s_mov_b32 s23,40960
buffer_load_dwordx4 v6,s[44:47],s23 offen lds
s_add_u32 m0,s21,8192
s_mov_b32 s23,81920
buffer_load_dwordx4 v6,s[44:47],s23 offen lds
s_add_u32 m0,s21,12288
s_mov_b32 s23,122880
buffer_load_dwordx4 v6,s[44:47],s23 offen lds
s_add_u32 m0,s21,16384
s_mov_b32 s23,163840
buffer_load_dwordx4 v6,s[44:47],s23 offen lds
s_add_u32 m0,s21,20480
s_mov_b32 s23,204800
buffer_load_dwordx4 v6,s[44:47],s23 offen lds
s_add_u32 m0,s21,40960
s_mov_b32 s23,128
buffer_load_dwordx4 v6,s[44:47],s23 offen lds
s_add_u32 m0,s21,45056
s_mov_b32 s23,41088
buffer_load_dwordx4 v6,s[44:47],s23 offen lds
s_add_u32 m0,s21,49152
s_mov_b32 s23,82048
buffer_load_dwordx4 v6,s[44:47],s23 offen lds
s_add_u32 m0,s21,53248
s_mov_b32 s23,123008
buffer_load_dwordx4 v6,s[44:47],s23 offen lds
s_add_u32 m0,s21,57344
s_mov_b32 s23,163968
buffer_load_dwordx4 v6,s[44:47],s23 offen lds
s_add_u32 m0,s21,61440
s_mov_b32 s23,204928
buffer_load_dwordx4 v6,s[44:47],s23 offen lds
s_add_u32 m0,s21,81920
s_mov_b32 s23,256
buffer_load_dwordx4 v6,s[44:47],s23 offen lds
s_add_u32 m0,s21,86016
s_mov_b32 s23,41216
buffer_load_dwordx4 v6,s[44:47],s23 offen lds
s_add_u32 m0,s21,90112
s_mov_b32 s23,82176
buffer_load_dwordx4 v6,s[44:47],s23 offen lds
s_add_u32 m0,s21,94208
s_mov_b32 s23,123136
buffer_load_dwordx4 v6,s[44:47],s23 offen lds
s_add_u32 m0,s21,98304
s_mov_b32 s23,164096
buffer_load_dwordx4 v6,s[44:47],s23 offen lds
s_add_u32 m0,s21,102400
s_mov_b32 s23,205056
buffer_load_dwordx4 v6,s[44:47],s23 offen lds
s_add_u32 m0,s21,122880
s_mov_b32 s23,384
buffer_load_dwordx4 v6,s[44:47],s23 offen lds
s_add_u32 m0,s21,126976
s_mov_b32 s23,41344
buffer_load_dwordx4 v6,s[44:47],s23 offen lds
s_add_u32 m0,s21,131072
s_mov_b32 s23,82304
buffer_load_dwordx4 v6,s[44:47],s23 offen lds
s_add_u32 m0,s21,135168
s_mov_b32 s23,123264
buffer_load_dwordx4 v6,s[44:47],s23 offen lds
s_add_u32 m0,s21,139264
s_mov_b32 s23,164224
buffer_load_dwordx4 v6,s[44:47],s23 offen lds
s_add_u32 m0,s21,143360
s_mov_b32 s23,205184
buffer_load_dwordx4 v6,s[44:47],s23 offen lds
s_waitcnt vmcnt(18)
s_barrier
tr v[20:21],v8,0
tr v[22:23],v12,0
tr v[24:25],v9,0
tr v[26:27],v13,0
tr v[28:29],v10,0
tr v[30:31],v14,0
tr v[32:33],v11,0
tr v[34:35],v15,0
s_waitcnt lgkmcnt(0)
tr v[36:37],v8,4096
tr v[38:39],v12,4096
tr v[40:41],v9,4096
tr v[42:43],v13,4096
tr v[44:45],v10,4096
tr v[46:47],v14,4096
tr v[48:49],v11,4096
tr v[50:51],v15,4096
mf v[52:55],a[0:3],v[20:23],0
mf v[68:71],a[24:27],v[20:23],0
mf v[84:87],a[48:51],v[20:23],0
mf v[100:103],a[72:75],v[20:23],0
mf v[116:119],a[96:99],v[20:23],0
mf v[132:135],a[120:123],v[20:23],0
mf v[56:59],a[0:3],v[24:27],0
mf v[72:75],a[24:27],v[24:27],0
mf v[88:91],a[48:51],v[24:27],0
mf v[104:107],a[72:75],v[24:27],0
mf v[120:123],a[96:99],v[24:27],0
mf v[136:139],a[120:123],v[24:27],0
mf v[60:63],a[0:3],v[28:31],0
mf v[76:79],a[24:27],v[28:31],0
mf v[92:95],a[48:51],v[28:31],0
mf v[108:111],a[72:75],v[28:31],0
mf v[124:127],a[96:99],v[28:31],0
mf v[140:143],a[120:123],v[28:31],0
mf v[64:67],a[0:3],v[32:35],0
mf v[80:83],a[24:27],v[32:35],0
mf v[96:99],a[48:51],v[32:35],0
mf v[112:115],a[72:75],v[32:35],0
mf v[128:131],a[96:99],v[32:35],0
mf v[144:147],a[120:123],v[32:35],0
s_waitcnt lgkmcnt(0)
tr v[20:21],v8,8192
tr v[22:23],v12,8192
tr v[24:25],v9,8192
tr v[26:27],v13,8192
tr v[28:29],v10,8192
tr v[30:31],v14,8192
tr v[32:33],v11,8192
tr v[34:35],v15,8192
mf v[52:55],a[4:7],v[36:39],v[52:55]
mf v[68:71],a[28:31],v[36:39],v[68:71]
mf v[84:87],a[52:55],v[36:39],v[84:87]
mf v[100:103],a[76:79],v[36:39],v[100:103]
mf v[116:119],a[100:103],v[36:39],v[116:119]
mf v[132:135],a[124:127],v[36:39],v[132:135]
mf v[56:59],a[4:7],v[40:43],v[56:59]
mf v[72:75],a[28:31],v[40:43],v[72:75]
mf v[88:91],a[52:55],v[40:43],v[88:91]
mf v[104:107],a[76:79],v[40:43],v[104:107]
mf v[120:123],a[100:103],v[40:43],v[120:123]
mf v[136:139],a[124:127],v[40:43],v[136:139]
mf v[60:63],a[4:7],v[44:47],v[60:63]
mf v[76:79],a[28:31],v[44:47],v[76:79]
mf v[92:95],a[52:55],v[44:47],v[92:95]
mf v[108:111],a[76:79],v[44:47],v[108:111]
mf v[124:127],a[100:103],v[44:47],v[124:127]
mf v[140:143],a[124:127],v[44:47],v[140:143]
mf v[64:67],a[4:7],v[48:51],v[64:67]
mf v[80:83],a[28:31],v[48:51],v[80:83]
mf v[96:99],a[52:55],v[48:51],v[96:99]
mf v[112:115],a[76:79],v[48:51],v[112:115]
mf v[128:131],a[100:103],v[48:51],v[128:131]
mf v[144:147],a[124:127],v[48:51],v[144:147]
s_waitcnt lgkmcnt(0)
tr v[36:37],v8,12288
tr v[38:39],v12,12288
tr v[40:41],v9,12288
tr v[42:43],v13,12288
tr v[44:45],v10,12288
tr v[46:47],v14,12288
tr v[48:49],v11,12288
tr v[50:51],v15,12288
mf v[52:55],a[8:11],v[20:23],v[52:55]
mf v[68:71],a[32:35],v[20:23],v[68:71]
mf v[84:87],a[56:59],v[20:23],v[84:87]
mf v[100:103],a[80:83],v[20:23],v[100:103]
mf v[116:119],a[104:107],v[20:23],v[116:119]
mf v[132:135],a[128:131],v[20:23],v[132:135]
mf v[56:59],a[8:11],v[24:27],v[56:59]
mf v[72:75],a[32:35],v[24:27],v[72:75]
mf v[88:91],a[56:59],v[24:27],v[88:91]
mf v[104:107],a[80:83],v[24:27],v[104:107]
mf v[120:123],a[104:107],v[24:27],v[120:123]
mf v[136:139],a[128:131],v[24:27],v[136:139]
mf v[60:63],a[8:11],v[28:31],v[60:63]
mf v[76:79],a[32:35],v[28:31],v[76:79]
mf v[92:95],a[56:59],v[28:31],v[92:95]
mf v[108:111],a[80:83],v[28:31],v[108:111]
mf v[124:127],a[104:107],v[28:31],v[124:127]
mf v[140:143],a[128:131],v[28:31],v[140:143]
mf v[64:67],a[8:11],v[32:35],v[64:67]
mf v[80:83],a[32:35],v[32:35],v[80:83]
mf v[96:99],a[56:59],v[32:35],v[96:99]
mf v[112:115],a[80:83],v[32:35],v[112:115]
mf v[128:131],a[104:107],v[32:35],v[128:131]
mf v[144:147],a[128:131],v[32:35],v[144:147]
s_waitcnt lgkmcnt(0)
tr v[20:21],v8,16384
tr v[22:23],v12,16384
tr v[24:25],v9,16384
tr v[26:27],v13,16384
tr v[28:29],v10,16384
tr v[30:31],v14,16384
tr v[32:33],v11,16384
tr v[34:35],v15,16384
mf v[52:55],a[12:15],v[36:39],v[52:55]
mf v[68:71],a[36:39],v[36:39],v[68:71]
mf v[84:87],a[60:63],v[36:39],v[84:87]
mf v[100:103],a[84:87],v[36:39],v[100:103]
mf v[116:119],a[108:111],v[36:39],v[116:119]
mf v[132:135],a[132:135],v[36:39],v[132:135]
mf v[56:59],a[12:15],v[40:43],v[56:59]
mf v[72:75],a[36:39],v[40:43],v[72:75]
mf v[88:91],a[60:63],v[40:43],v[88:91]
mf v[104:107],a[84:87],v[40:43],v[104:107]
mf v[120:123],a[108:111],v[40:43],v[120:123]
mf v[136:139],a[132:135],v[40:43],v[136:139]
mf v[60:63],a[12:15],v[44:47],v[60:63]
mf v[76:79],a[36:39],v[44:47],v[76:79]
mf v[92:95],a[60:63],v[44:47],v[92:95]
mf v[108:111],a[84:87],v[44:47],v[108:111]
mf v[124:127],a[108:111],v[44:47],v[124:127]
mf v[140:143],a[132:135],v[44:47],v[140:143]
mf v[64:67],a[12:15],v[48:51],v[64:67]
mf v[80:83],a[36:39],v[48:51],v[80:83]
mf v[96:99],a[60:63],v[48:51],v[96:99]
mf v[112:115],a[84:87],v[48:51],v[112:115]
mf v[128:131],a[108:111],v[48:51],v[128:131]
mf v[144:147],a[132:135],v[48:51],v[144:147]
s_waitcnt lgkmcnt(0)
tr v[36:37],v8,20480
tr v[38:39],v12,20480
tr v[40:41],v9,20480
tr v[42:43],v13,20480
tr v[44:45],v10,20480
tr v[46:47],v14,20480
tr v[48:49],v11,20480
tr v[50:51],v15,20480
mf v[52:55],a[16:19],v[20:23],v[52:55]
mf v[68:71],a[40:43],v[20:23],v[68:71]
mf v[84:87],a[64:67],v[20:23],v[84:87]
mf v[100:103],a[88:91],v[20:23],v[100:103]
mf v[116:119],a[112:115],v[20:23],v[116:119]
mf v[132:135],a[136:139],v[20:23],v[132:135]
mf v[56:59],a[16:19],v[24:27],v[56:59]
mf v[72:75],a[40:43],v[24:27],v[72:75]
mf v[88:91],a[64:67],v[24:27],v[88:91]
mf v[104:107],a[88:91],v[24:27],v[104:107]
mf v[120:123],a[112:115],v[24:27],v[120:123]
mf v[136:139],a[136:139],v[24:27],v[136:139]
mf v[60:63],a[16:19],v[28:31],v[60:63]
mf v[76:79],a[40:43],v[28:31],v[76:79]
mf v[92:95],a[64:67],v[28:31],v[92:95]
mf v[108:111],a[88:91],v[28:31],v[108:111]
mf v[124:127],a[112:115],v[28:31],v[124:127]
mf v[140:143],a[136:139],v[28:31],v[140:143]
mf v[64:67],a[16:19],v[32:35],v[64:67]
mf v[80:83],a[40:43],v[32:35],v[80:83]
mf v[96:99],a[64:67],v[32:35],v[96:99]
mf v[112:115],a[88:91],v[32:35],v[112:115]
mf v[128:131],a[112:115],v[32:35],v[128:131]
mf v[144:147],a[136:139],v[32:35],v[144:147]
s_waitcnt lgkmcnt(0)
s_waitcnt vmcnt(12)
s_barrier
s_add_u32 m0,s21,0
s_mov_b32 s23,512
buffer_load_dwordx4 v6,s[44:47],s23 offen lds
s_add_u32 m0,s21,4096
s_mov_b32 s23,41472
buffer_load_dwordx4 v6,s[44:47],s23 offen lds
s_add_u32 m0,s21,8192
s_mov_b32 s23,82432
buffer_load_dwordx4 v6,s[44:47],s23 offen lds
s_add_u32 m0,s21,12288
s_mov_b32 s23,123392
buffer_load_dwordx4 v6,s[44:47],s23 offen lds
s_add_u32 m0,s21,16384
s_mov_b32 s23,164352
buffer_load_dwordx4 v6,s[44:47],s23 offen lds
s_add_u32 m0,s21,20480
s_mov_b32 s23,205312
buffer_load_dwordx4 v6,s[44:47],s23 offen lds
v_add_u32 v8,40960,v8
v_add_u32 v9,40960,v9
v_add_u32 v10,40960,v10
v_add_u32 v11,40960,v11
v_add_u32 v12,40960,v12
v_add_u32 v13,40960,v13
v_add_u32 v14,40960,v14
v_add_u32 v15,40960,v15
tr v[20:21],v8,0
tr v[22:23],v12,0
tr v[24:25],v9,0
tr v[26:27],v13,0
tr v[28:29],v10,0
tr v[30:31],v14,0
tr v[32:33],v11,0
tr v[34:35],v15,0
mf v[52:55],a[20:23],v[36:39],v[52:55]
mf v[68:71],a[44:47],v[36:39],v[68:71]
mf v[84:87],a[68:71],v[36:39],v[84:87]
mf v[100:103],a[92:95],v[36:39],v[100:103]
mf v[116:119],a[116:119],v[36:39],v[116:119]
mf v[132:135],a[140:143],v[36:39],v[132:135]
mf v[56:59],a[20:23],v[40:43],v[56:59]
mf v[72:75],a[44:47],v[40:43],v[72:75]
mf v[88:91],a[68:71],v[40:43],v[88:91]
mf v[104:107],a[92:95],v[40:43],v[104:107]
mf v[120:123],a[116:119],v[40:43],v[120:123]
mf v[136:139],a[140:143],v[40:43],v[136:139]
mf v[60:63],a[20:23],v[44:47],v[60:63]
mf v[76:79],a[44:47],v[44:47],v[76:79]
mf v[92:95],a[68:71],v[44:47],v[92:95]
mf v[108:111],a[92:95],v[44:47],v[108:111]
mf v[124:127],a[116:119],v[44:47],v[124:127]
mf v[140:143],a[140:143],v[44:47],v[140:143]
mf v[64:67],a[20:23],v[48:51],v[64:67]
mf v[80:83],a[44:47],v[48:51],v[80:83]
mf v[96:99],a[68:71],v[48:51],v[96:99]
mf v[112:115],a[92:95],v[48:51],v[112:115]
mf v[128:131],a[116:119],v[48:51],v[128:131]
mf v[144:147],a[140:143],v[48:51],v[144:147]
s_nop 7
s_nop 1
cv v52,v52,v53
cv v53,v54,v55
cv v54,v68,v69
cv v55,v70,v71
s_mov_b32 s23,0
buffer_store_dwordx4 v[52:55],v249,s[60:63],s23 offen sc1
cv v56,v56,v57
cv v57,v58,v59
cv v58,v72,v73
cv v59,v74,v75
s_mov_b32 s23,655360
buffer_store_dwordx4 v[56:59],v249,s[60:63],s23 offen sc1
cv v60,v60,v61
cv v61,v62,v63
cv v62,v76,v77
cv v63,v78,v79
s_mov_b32 s23,1310720
buffer_store_dwordx4 v[60:63],v249,s[60:63],s23 offen sc1
cv v64,v64,v65
cv v65,v66,v67
cv v66,v80,v81
cv v67,v82,v83
s_mov_b32 s23,1966080
buffer_store_dwordx4 v[64:67],v249,s[60:63],s23 offen sc1
cv v84,v84,v85
cv v85,v86,v87
cv v86,v100,v101
cv v87,v102,v103
s_mov_b32 s23,1024
buffer_store_dwordx4 v[84:87],v249,s[60:63],s23 offen sc1
cv v88,v88,v89
cv v89,v90,v91
cv v90,v104,v105
cv v91,v106,v107
s_mov_b32 s23,656384
buffer_store_dwordx4 v[88:91],v249,s[60:63],s23 offen sc1
cv v92,v92,v93
cv v93,v94,v95
cv v94,v108,v109
cv v95,v110,v111
s_mov_b32 s23,1311744
buffer_store_dwordx4 v[92:95],v249,s[60:63],s23 offen sc1
cv v96,v96,v97
cv v97,v98,v99
cv v98,v112,v113
cv v99,v114,v115
s_mov_b32 s23,1967104
buffer_store_dwordx4 v[96:99],v249,s[60:63],s23 offen sc1
cv v116,v116,v117
cv v117,v118,v119
cv v118,v132,v133
cv v119,v134,v135
s_mov_b32 s23,2048
buffer_store_dwordx4 v[116:119],v249,s[60:63],s23 offen sc1
cv v120,v120,v121
cv v121,v122,v123
cv v122,v136,v137
cv v123,v138,v139
s_mov_b32 s23,657408
buffer_store_dwordx4 v[120:123],v249,s[60:63],s23 offen sc1
cv v124,v124,v125
cv v125,v126,v127
cv v126,v140,v141
cv v127,v142,v143
s_mov_b32 s23,1312768
buffer_store_dwordx4 v[124:127],v249,s[60:63],s23 offen sc1
cv v128,v128,v129
cv v129,v130,v131
cv v130,v144,v145
cv v131,v146,v147
s_mov_b32 s23,1968128
buffer_store_dwordx4 v[128:131],v249,s[60:63],s23 offen sc1
s_nop 1
s_waitcnt lgkmcnt(0)
tr v[36:37],v8,4096
tr v[38:39],v12,4096
tr v[40:41],v9,4096
tr v[42:43],v13,4096
tr v[44:45],v10,4096
tr v[46:47],v14,4096
tr v[48:49],v11,4096
tr v[50:51],v15,4096
mf v[52:55],a[0:3],v[20:23],0
mf v[68:71],a[24:27],v[20:23],0
mf v[84:87],a[48:51],v[20:23],0
mf v[100:103],a[72:75],v[20:23],0
mf v[116:119],a[96:99],v[20:23],0
mf v[132:135],a[120:123],v[20:23],0
mf v[56:59],a[0:3],v[24:27],0
mf v[72:75],a[24:27],v[24:27],0
mf v[88:91],a[48:51],v[24:27],0
mf v[104:107],a[72:75],v[24:27],0
mf v[120:123],a[96:99],v[24:27],0
mf v[136:139],a[120:123],v[24:27],0
mf v[60:63],a[0:3],v[28:31],0
mf v[76:79],a[24:27],v[28:31],0
mf v[92:95],a[48:51],v[28:31],0
mf v[108:111],a[72:75],v[28:31],0
mf v[124:127],a[96:99],v[28:31],0
mf v[140:143],a[120:123],v[28:31],0
mf v[64:67],a[0:3],v[32:35],0
mf v[80:83],a[24:27],v[32:35],0
mf v[96:99],a[48:51],v[32:35],0
mf v[112:115],a[72:75],v[32:35],0
mf v[128:131],a[96:99],v[32:35],0
mf v[144:147],a[120:123],v[32:35],0
s_waitcnt lgkmcnt(0)
tr v[20:21],v8,8192
tr v[22:23],v12,8192
tr v[24:25],v9,8192
tr v[26:27],v13,8192
tr v[28:29],v10,8192
tr v[30:31],v14,8192
tr v[32:33],v11,8192
tr v[34:35],v15,8192
mf v[52:55],a[4:7],v[36:39],v[52:55]
mf v[68:71],a[28:31],v[36:39],v[68:71]
mf v[84:87],a[52:55],v[36:39],v[84:87]
mf v[100:103],a[76:79],v[36:39],v[100:103]
mf v[116:119],a[100:103],v[36:39],v[116:119]
mf v[132:135],a[124:127],v[36:39],v[132:135]
mf v[56:59],a[4:7],v[40:43],v[56:59]
mf v[72:75],a[28:31],v[40:43],v[72:75]
mf v[88:91],a[52:55],v[40:43],v[88:91]
mf v[104:107],a[76:79],v[40:43],v[104:107]
mf v[120:123],a[100:103],v[40:43],v[120:123]
mf v[136:139],a[124:127],v[40:43],v[136:139]
mf v[60:63],a[4:7],v[44:47],v[60:63]
mf v[76:79],a[28:31],v[44:47],v[76:79]
mf v[92:95],a[52:55],v[44:47],v[92:95]
mf v[108:111],a[76:79],v[44:47],v[108:111]
mf v[124:127],a[100:103],v[44:47],v[124:127]
mf v[140:143],a[124:127],v[44:47],v[140:143]
mf v[64:67],a[4:7],v[48:51],v[64:67]
mf v[80:83],a[28:31],v[48:51],v[80:83]
mf v[96:99],a[52:55],v[48:51],v[96:99]
mf v[112:115],a[76:79],v[48:51],v[112:115]
mf v[128:131],a[100:103],v[48:51],v[128:131]
mf v[144:147],a[124:127],v[48:51],v[144:147]
s_waitcnt lgkmcnt(0)
tr v[36:37],v8,12288
tr v[38:39],v12,12288
tr v[40:41],v9,12288
tr v[42:43],v13,12288
tr v[44:45],v10,12288
tr v[46:47],v14,12288
tr v[48:49],v11,12288
tr v[50:51],v15,12288
mf v[52:55],a[8:11],v[20:23],v[52:55]
mf v[68:71],a[32:35],v[20:23],v[68:71]
mf v[84:87],a[56:59],v[20:23],v[84:87]
mf v[100:103],a[80:83],v[20:23],v[100:103]
mf v[116:119],a[104:107],v[20:23],v[116:119]
mf v[132:135],a[128:131],v[20:23],v[132:135]
mf v[56:59],a[8:11],v[24:27],v[56:59]
mf v[72:75],a[32:35],v[24:27],v[72:75]
mf v[88:91],a[56:59],v[24:27],v[88:91]
mf v[104:107],a[80:83],v[24:27],v[104:107]
mf v[120:123],a[104:107],v[24:27],v[120:123]
mf v[136:139],a[128:131],v[24:27],v[136:139]
mf v[60:63],a[8:11],v[28:31],v[60:63]
mf v[76:79],a[32:35],v[28:31],v[76:79]
mf v[92:95],a[56:59],v[28:31],v[92:95]
mf v[108:111],a[80:83],v[28:31],v[108:111]
mf v[124:127],a[104:107],v[28:31],v[124:127]
mf v[140:143],a[128:131],v[28:31],v[140:143]
mf v[64:67],a[8:11],v[32:35],v[64:67]
mf v[80:83],a[32:35],v[32:35],v[80:83]
mf v[96:99],a[56:59],v[32:35],v[96:99]
mf v[112:115],a[80:83],v[32:35],v[112:115]
mf v[128:131],a[104:107],v[32:35],v[128:131]
mf v[144:147],a[128:131],v[32:35],v[144:147]
s_waitcnt lgkmcnt(0)
tr v[20:21],v8,16384
tr v[22:23],v12,16384
tr v[24:25],v9,16384
tr v[26:27],v13,16384
tr v[28:29],v10,16384
tr v[30:31],v14,16384
tr v[32:33],v11,16384
tr v[34:35],v15,16384
mf v[52:55],a[12:15],v[36:39],v[52:55]
mf v[68:71],a[36:39],v[36:39],v[68:71]
mf v[84:87],a[60:63],v[36:39],v[84:87]
mf v[100:103],a[84:87],v[36:39],v[100:103]
mf v[116:119],a[108:111],v[36:39],v[116:119]
mf v[132:135],a[132:135],v[36:39],v[132:135]
mf v[56:59],a[12:15],v[40:43],v[56:59]
mf v[72:75],a[36:39],v[40:43],v[72:75]
mf v[88:91],a[60:63],v[40:43],v[88:91]
mf v[104:107],a[84:87],v[40:43],v[104:107]
mf v[120:123],a[108:111],v[40:43],v[120:123]
mf v[136:139],a[132:135],v[40:43],v[136:139]
mf v[60:63],a[12:15],v[44:47],v[60:63]
mf v[76:79],a[36:39],v[44:47],v[76:79]
mf v[92:95],a[60:63],v[44:47],v[92:95]
mf v[108:111],a[84:87],v[44:47],v[108:111]
mf v[124:127],a[108:111],v[44:47],v[124:127]
mf v[140:143],a[132:135],v[44:47],v[140:143]
mf v[64:67],a[12:15],v[48:51],v[64:67]
mf v[80:83],a[36:39],v[48:51],v[80:83]
mf v[96:99],a[60:63],v[48:51],v[96:99]
mf v[112:115],a[84:87],v[48:51],v[112:115]
mf v[128:131],a[108:111],v[48:51],v[128:131]
mf v[144:147],a[132:135],v[48:51],v[144:147]
s_waitcnt lgkmcnt(0)
tr v[36:37],v8,20480
tr v[38:39],v12,20480
tr v[40:41],v9,20480
tr v[42:43],v13,20480
tr v[44:45],v10,20480
tr v[46:47],v14,20480
tr v[48:49],v11,20480
tr v[50:51],v15,20480
mf v[52:55],a[16:19],v[20:23],v[52:55]
mf v[68:71],a[40:43],v[20:23],v[68:71]
mf v[84:87],a[64:67],v[20:23],v[84:87]
mf v[100:103],a[88:91],v[20:23],v[100:103]
mf v[116:119],a[112:115],v[20:23],v[116:119]
mf v[132:135],a[136:139],v[20:23],v[132:135]
mf v[56:59],a[16:19],v[24:27],v[56:59]
mf v[72:75],a[40:43],v[24:27],v[72:75]
mf v[88:91],a[64:67],v[24:27],v[88:91]
mf v[104:107],a[88:91],v[24:27],v[104:107]
mf v[120:123],a[112:115],v[24:27],v[120:123]
mf v[136:139],a[136:139],v[24:27],v[136:139]
mf v[60:63],a[16:19],v[28:31],v[60:63]
mf v[76:79],a[40:43],v[28:31],v[76:79]
mf v[92:95],a[64:67],v[28:31],v[92:95]
mf v[108:111],a[88:91],v[28:31],v[108:111]
mf v[124:127],a[112:115],v[28:31],v[124:127]
mf v[140:143],a[136:139],v[28:31],v[140:143]
mf v[64:67],a[16:19],v[32:35],v[64:67]
mf v[80:83],a[40:43],v[32:35],v[80:83]
mf v[96:99],a[64:67],v[32:35],v[96:99]
mf v[112:115],a[88:91],v[32:35],v[112:115]
mf v[128:131],a[112:115],v[32:35],v[128:131]
mf v[144:147],a[136:139],v[32:35],v[144:147]
s_waitcnt lgkmcnt(0)
s_waitcnt vmcnt(24)
s_barrier
v_add_u32 v8,40960,v8
v_add_u32 v9,40960,v9
v_add_u32 v10,40960,v10
v_add_u32 v11,40960,v11
v_add_u32 v12,40960,v12
v_add_u32 v13,40960,v13
v_add_u32 v14,40960,v14
v_add_u32 v15,40960,v15
tr v[20:21],v8,0
tr v[22:23],v12,0
tr v[24:25],v9,0
tr v[26:27],v13,0
tr v[28:29],v10,0
tr v[30:31],v14,0
tr v[32:33],v11,0
tr v[34:35],v15,0
mf v[52:55],a[20:23],v[36:39],v[52:55]
mf v[68:71],a[44:47],v[36:39],v[68:71]
mf v[84:87],a[68:71],v[36:39],v[84:87]
mf v[100:103],a[92:95],v[36:39],v[100:103]
mf v[116:119],a[116:119],v[36:39],v[116:119]
mf v[132:135],a[140:143],v[36:39],v[132:135]
mf v[56:59],a[20:23],v[40:43],v[56:59]
mf v[72:75],a[44:47],v[40:43],v[72:75]
mf v[88:91],a[68:71],v[40:43],v[88:91]
mf v[104:107],a[92:95],v[40:43],v[104:107]
mf v[120:123],a[116:119],v[40:43],v[120:123]
mf v[136:139],a[140:143],v[40:43],v[136:139]
mf v[60:63],a[20:23],v[44:47],v[60:63]
mf v[76:79],a[44:47],v[44:47],v[76:79]
mf v[92:95],a[68:71],v[44:47],v[92:95]
mf v[108:111],a[92:95],v[44:47],v[108:111]
mf v[124:127],a[116:119],v[44:47],v[124:127]
mf v[140:143],a[140:143],v[44:47],v[140:143]
mf v[64:67],a[20:23],v[48:51],v[64:67]
mf v[80:83],a[44:47],v[48:51],v[80:83]
mf v[96:99],a[68:71],v[48:51],v[96:99]
mf v[112:115],a[92:95],v[48:51],v[112:115]
mf v[128:131],a[116:119],v[48:51],v[128:131]
mf v[144:147],a[140:143],v[48:51],v[144:147]
s_nop 7
s_nop 1
cv v52,v52,v53
cv v53,v54,v55
cv v54,v68,v69
cv v55,v70,v71
s_mov_b32 s23,2621440
buffer_store_dwordx4 v[52:55],v249,s[60:63],s23 offen sc1
cv v56,v56,v57
cv v57,v58,v59
cv v58,v72,v73
cv v59,v74,v75
s_mov_b32 s23,3276800
buffer_store_dwordx4 v[56:59],v249,s[60:63],s23 offen sc1
cv v60,v60,v61
cv v61,v62,v63
cv v62,v76,v77
cv v63,v78,v79
s_mov_b32 s23,3932160
buffer_store_dwordx4 v[60:63],v249,s[60:63],s23 offen sc1
cv v64,v64,v65
cv v65,v66,v67
cv v66,v80,v81
cv v67,v82,v83
s_mov_b32 s23,4587520
buffer_store_dwordx4 v[64:67],v249,s[60:63],s23 offen sc1
cv v84,v84,v85
cv v85,v86,v87
cv v86,v100,v101
cv v87,v102,v103
s_mov_b32 s23,2622464
buffer_store_dwordx4 v[84:87],v249,s[60:63],s23 offen sc1
cv v88,v88,v89
cv v89,v90,v91
cv v90,v104,v105
cv v91,v106,v107
s_mov_b32 s23,3277824
buffer_store_dwordx4 v[88:91],v249,s[60:63],s23 offen sc1
cv v92,v92,v93
cv v93,v94,v95
cv v94,v108,v109
cv v95,v110,v111
s_mov_b32 s23,3933184
buffer_store_dwordx4 v[92:95],v249,s[60:63],s23 offen sc1
cv v96,v96,v97
cv v97,v98,v99
cv v98,v112,v113
cv v99,v114,v115
s_mov_b32 s23,4588544
buffer_store_dwordx4 v[96:99],v249,s[60:63],s23 offen sc1
cv v116,v116,v117
cv v117,v118,v119
cv v118,v132,v133
cv v119,v134,v135
s_mov_b32 s23,2623488
buffer_store_dwordx4 v[116:119],v249,s[60:63],s23 offen sc1
cv v120,v120,v121
cv v121,v122,v123
cv v122,v136,v137
cv v123,v138,v139
s_mov_b32 s23,3278848
buffer_store_dwordx4 v[120:123],v249,s[60:63],s23 offen sc1
cv v124,v124,v125
cv v125,v126,v127
cv v126,v140,v141
cv v127,v142,v143
s_mov_b32 s23,3934208
buffer_store_dwordx4 v[124:127],v249,s[60:63],s23 offen sc1
cv v128,v128,v129
cv v129,v130,v131
cv v130,v144,v145
cv v131,v146,v147
s_mov_b32 s23,4589568
buffer_store_dwordx4 v[128:131],v249,s[60:63],s23 offen sc1
s_nop 1
s_waitcnt lgkmcnt(0)
tr v[36:37],v8,4096
tr v[38:39],v12,4096
tr v[40:41],v9,4096
tr v[42:43],v13,4096
tr v[44:45],v10,4096
tr v[46:47],v14,4096
tr v[48:49],v11,4096
tr v[50:51],v15,4096
mf v[52:55],a[0:3],v[20:23],0
mf v[68:71],a[24:27],v[20:23],0
mf v[84:87],a[48:51],v[20:23],0
mf v[100:103],a[72:75],v[20:23],0
mf v[116:119],a[96:99],v[20:23],0
mf v[132:135],a[120:123],v[20:23],0
mf v[56:59],a[0:3],v[24:27],0
mf v[72:75],a[24:27],v[24:27],0
mf v[88:91],a[48:51],v[24:27],0
mf v[104:107],a[72:75],v[24:27],0
mf v[120:123],a[96:99],v[24:27],0
mf v[136:139],a[120:123],v[24:27],0
mf v[60:63],a[0:3],v[28:31],0
mf v[76:79],a[24:27],v[28:31],0
mf v[92:95],a[48:51],v[28:31],0
mf v[108:111],a[72:75],v[28:31],0
mf v[124:127],a[96:99],v[28:31],0
mf v[140:143],a[120:123],v[28:31],0
mf v[64:67],a[0:3],v[32:35],0
mf v[80:83],a[24:27],v[32:35],0
mf v[96:99],a[48:51],v[32:35],0
mf v[112:115],a[72:75],v[32:35],0
mf v[128:131],a[96:99],v[32:35],0
mf v[144:147],a[120:123],v[32:35],0
s_waitcnt lgkmcnt(0)
tr v[20:21],v8,8192
tr v[22:23],v12,8192
tr v[24:25],v9,8192
tr v[26:27],v13,8192
tr v[28:29],v10,8192
tr v[30:31],v14,8192
tr v[32:33],v11,8192
tr v[34:35],v15,8192
mf v[52:55],a[4:7],v[36:39],v[52:55]
mf v[68:71],a[28:31],v[36:39],v[68:71]
mf v[84:87],a[52:55],v[36:39],v[84:87]
mf v[100:103],a[76:79],v[36:39],v[100:103]
mf v[116:119],a[100:103],v[36:39],v[116:119]
mf v[132:135],a[124:127],v[36:39],v[132:135]
mf v[56:59],a[4:7],v[40:43],v[56:59]
mf v[72:75],a[28:31],v[40:43],v[72:75]
mf v[88:91],a[52:55],v[40:43],v[88:91]
mf v[104:107],a[76:79],v[40:43],v[104:107]
mf v[120:123],a[100:103],v[40:43],v[120:123]
mf v[136:139],a[124:127],v[40:43],v[136:139]
mf v[60:63],a[4:7],v[44:47],v[60:63]
mf v[76:79],a[28:31],v[44:47],v[76:79]
mf v[92:95],a[52:55],v[44:47],v[92:95]
mf v[108:111],a[76:79],v[44:47],v[108:111]
mf v[124:127],a[100:103],v[44:47],v[124:127]
mf v[140:143],a[124:127],v[44:47],v[140:143]
mf v[64:67],a[4:7],v[48:51],v[64:67]
mf v[80:83],a[28:31],v[48:51],v[80:83]
mf v[96:99],a[52:55],v[48:51],v[96:99]
mf v[112:115],a[76:79],v[48:51],v[112:115]
mf v[128:131],a[100:103],v[48:51],v[128:131]
mf v[144:147],a[124:127],v[48:51],v[144:147]
s_waitcnt lgkmcnt(0)
tr v[36:37],v8,12288
tr v[38:39],v12,12288
tr v[40:41],v9,12288
tr v[42:43],v13,12288
tr v[44:45],v10,12288
tr v[46:47],v14,12288
tr v[48:49],v11,12288
tr v[50:51],v15,12288
mf v[52:55],a[8:11],v[20:23],v[52:55]
mf v[68:71],a[32:35],v[20:23],v[68:71]
mf v[84:87],a[56:59],v[20:23],v[84:87]
mf v[100:103],a[80:83],v[20:23],v[100:103]
mf v[116:119],a[104:107],v[20:23],v[116:119]
mf v[132:135],a[128:131],v[20:23],v[132:135]
mf v[56:59],a[8:11],v[24:27],v[56:59]
mf v[72:75],a[32:35],v[24:27],v[72:75]
mf v[88:91],a[56:59],v[24:27],v[88:91]
mf v[104:107],a[80:83],v[24:27],v[104:107]
mf v[120:123],a[104:107],v[24:27],v[120:123]
mf v[136:139],a[128:131],v[24:27],v[136:139]
mf v[60:63],a[8:11],v[28:31],v[60:63]
mf v[76:79],a[32:35],v[28:31],v[76:79]
mf v[92:95],a[56:59],v[28:31],v[92:95]
mf v[108:111],a[80:83],v[28:31],v[108:111]
mf v[124:127],a[104:107],v[28:31],v[124:127]
mf v[140:143],a[128:131],v[28:31],v[140:143]
mf v[64:67],a[8:11],v[32:35],v[64:67]
mf v[80:83],a[32:35],v[32:35],v[80:83]
mf v[96:99],a[56:59],v[32:35],v[96:99]
mf v[112:115],a[80:83],v[32:35],v[112:115]
mf v[128:131],a[104:107],v[32:35],v[128:131]
mf v[144:147],a[128:131],v[32:35],v[144:147]
s_waitcnt lgkmcnt(0)
tr v[20:21],v8,16384
tr v[22:23],v12,16384
tr v[24:25],v9,16384
tr v[26:27],v13,16384
tr v[28:29],v10,16384
tr v[30:31],v14,16384
tr v[32:33],v11,16384
tr v[34:35],v15,16384
mf v[52:55],a[12:15],v[36:39],v[52:55]
mf v[68:71],a[36:39],v[36:39],v[68:71]
mf v[84:87],a[60:63],v[36:39],v[84:87]
mf v[100:103],a[84:87],v[36:39],v[100:103]
mf v[116:119],a[108:111],v[36:39],v[116:119]
mf v[132:135],a[132:135],v[36:39],v[132:135]
mf v[56:59],a[12:15],v[40:43],v[56:59]
mf v[72:75],a[36:39],v[40:43],v[72:75]
mf v[88:91],a[60:63],v[40:43],v[88:91]
mf v[104:107],a[84:87],v[40:43],v[104:107]
mf v[120:123],a[108:111],v[40:43],v[120:123]
mf v[136:139],a[132:135],v[40:43],v[136:139]
mf v[60:63],a[12:15],v[44:47],v[60:63]
mf v[76:79],a[36:39],v[44:47],v[76:79]
mf v[92:95],a[60:63],v[44:47],v[92:95]
mf v[108:111],a[84:87],v[44:47],v[108:111]
mf v[124:127],a[108:111],v[44:47],v[124:127]
mf v[140:143],a[132:135],v[44:47],v[140:143]
mf v[64:67],a[12:15],v[48:51],v[64:67]
mf v[80:83],a[36:39],v[48:51],v[80:83]
mf v[96:99],a[60:63],v[48:51],v[96:99]
mf v[112:115],a[84:87],v[48:51],v[112:115]
mf v[128:131],a[108:111],v[48:51],v[128:131]
mf v[144:147],a[132:135],v[48:51],v[144:147]
s_waitcnt lgkmcnt(0)
tr v[36:37],v8,20480
tr v[38:39],v12,20480
tr v[40:41],v9,20480
tr v[42:43],v13,20480
tr v[44:45],v10,20480
tr v[46:47],v14,20480
tr v[48:49],v11,20480
tr v[50:51],v15,20480
mf v[52:55],a[16:19],v[20:23],v[52:55]
mf v[68:71],a[40:43],v[20:23],v[68:71]
mf v[84:87],a[64:67],v[20:23],v[84:87]
mf v[100:103],a[88:91],v[20:23],v[100:103]
mf v[116:119],a[112:115],v[20:23],v[116:119]
mf v[132:135],a[136:139],v[20:23],v[132:135]
mf v[56:59],a[16:19],v[24:27],v[56:59]
mf v[72:75],a[40:43],v[24:27],v[72:75]
mf v[88:91],a[64:67],v[24:27],v[88:91]
mf v[104:107],a[88:91],v[24:27],v[104:107]
mf v[120:123],a[112:115],v[24:27],v[120:123]
mf v[136:139],a[136:139],v[24:27],v[136:139]
mf v[60:63],a[16:19],v[28:31],v[60:63]
mf v[76:79],a[40:43],v[28:31],v[76:79]
mf v[92:95],a[64:67],v[28:31],v[92:95]
mf v[108:111],a[88:91],v[28:31],v[108:111]
mf v[124:127],a[112:115],v[28:31],v[124:127]
mf v[140:143],a[136:139],v[28:31],v[140:143]
mf v[64:67],a[16:19],v[32:35],v[64:67]
mf v[80:83],a[40:43],v[32:35],v[80:83]
mf v[96:99],a[64:67],v[32:35],v[96:99]
mf v[112:115],a[88:91],v[32:35],v[112:115]
mf v[128:131],a[112:115],v[32:35],v[128:131]
mf v[144:147],a[136:139],v[32:35],v[144:147]
s_waitcnt lgkmcnt(0)
s_waitcnt vmcnt(30)
s_barrier
v_add_u32 v8,40960,v8
v_add_u32 v9,40960,v9
v_add_u32 v10,40960,v10
v_add_u32 v11,40960,v11
v_add_u32 v12,40960,v12
v_add_u32 v13,40960,v13
v_add_u32 v14,40960,v14
v_add_u32 v15,40960,v15
tr v[20:21],v8,0
tr v[22:23],v12,0
tr v[24:25],v9,0
tr v[26:27],v13,0
tr v[28:29],v10,0
tr v[30:31],v14,0
tr v[32:33],v11,0
tr v[34:35],v15,0
mf v[52:55],a[20:23],v[36:39],v[52:55]
mf v[68:71],a[44:47],v[36:39],v[68:71]
mf v[84:87],a[68:71],v[36:39],v[84:87]
mf v[100:103],a[92:95],v[36:39],v[100:103]
mf v[116:119],a[116:119],v[36:39],v[116:119]
mf v[132:135],a[140:143],v[36:39],v[132:135]
mf v[56:59],a[20:23],v[40:43],v[56:59]
mf v[72:75],a[44:47],v[40:43],v[72:75]
mf v[88:91],a[68:71],v[40:43],v[88:91]
mf v[104:107],a[92:95],v[40:43],v[104:107]
mf v[120:123],a[116:119],v[40:43],v[120:123]
mf v[136:139],a[140:143],v[40:43],v[136:139]
mf v[60:63],a[20:23],v[44:47],v[60:63]
mf v[76:79],a[44:47],v[44:47],v[76:79]
mf v[92:95],a[68:71],v[44:47],v[92:95]
mf v[108:111],a[92:95],v[44:47],v[108:111]
mf v[124:127],a[116:119],v[44:47],v[124:127]
mf v[140:143],a[140:143],v[44:47],v[140:143]
mf v[64:67],a[20:23],v[48:51],v[64:67]
mf v[80:83],a[44:47],v[48:51],v[80:83]
mf v[96:99],a[68:71],v[48:51],v[96:99]
mf v[112:115],a[92:95],v[48:51],v[112:115]
mf v[128:131],a[116:119],v[48:51],v[128:131]
mf v[144:147],a[140:143],v[48:51],v[144:147]
s_nop 7
s_nop 1
cv v52,v52,v53
cv v53,v54,v55
cv v54,v68,v69
cv v55,v70,v71
s_mov_b32 s23,5242880
buffer_store_dwordx4 v[52:55],v249,s[60:63],s23 offen sc1
cv v56,v56,v57
cv v57,v58,v59
cv v58,v72,v73
cv v59,v74,v75
s_mov_b32 s23,5898240
buffer_store_dwordx4 v[56:59],v249,s[60:63],s23 offen sc1
cv v60,v60,v61
cv v61,v62,v63
cv v62,v76,v77
cv v63,v78,v79
s_mov_b32 s23,6553600
buffer_store_dwordx4 v[60:63],v249,s[60:63],s23 offen sc1
cv v64,v64,v65
cv v65,v66,v67
cv v66,v80,v81
cv v67,v82,v83
s_mov_b32 s23,7208960
buffer_store_dwordx4 v[64:67],v249,s[60:63],s23 offen sc1
cv v84,v84,v85
cv v85,v86,v87
cv v86,v100,v101
cv v87,v102,v103
s_mov_b32 s23,5243904
buffer_store_dwordx4 v[84:87],v249,s[60:63],s23 offen sc1
cv v88,v88,v89
cv v89,v90,v91
cv v90,v104,v105
cv v91,v106,v107
s_mov_b32 s23,5899264
buffer_store_dwordx4 v[88:91],v249,s[60:63],s23 offen sc1
cv v92,v92,v93
cv v93,v94,v95
cv v94,v108,v109
cv v95,v110,v111
s_mov_b32 s23,6554624
buffer_store_dwordx4 v[92:95],v249,s[60:63],s23 offen sc1
cv v96,v96,v97
cv v97,v98,v99
cv v98,v112,v113
cv v99,v114,v115
s_mov_b32 s23,7209984
buffer_store_dwordx4 v[96:99],v249,s[60:63],s23 offen sc1
cv v116,v116,v117
cv v117,v118,v119
cv v118,v132,v133
cv v119,v134,v135
s_mov_b32 s23,5244928
buffer_store_dwordx4 v[116:119],v249,s[60:63],s23 offen sc1
cv v120,v120,v121
cv v121,v122,v123
cv v122,v136,v137
cv v123,v138,v139
s_mov_b32 s23,5900288
buffer_store_dwordx4 v[120:123],v249,s[60:63],s23 offen sc1
cv v124,v124,v125
cv v125,v126,v127
cv v126,v140,v141
cv v127,v142,v143
s_mov_b32 s23,6555648
buffer_store_dwordx4 v[124:127],v249,s[60:63],s23 offen sc1
cv v128,v128,v129
cv v129,v130,v131
cv v130,v144,v145
cv v131,v146,v147
s_mov_b32 s23,7211008
buffer_store_dwordx4 v[128:131],v249,s[60:63],s23 offen sc1
s_nop 1
s_waitcnt lgkmcnt(0)
tr v[36:37],v8,4096
tr v[38:39],v12,4096
tr v[40:41],v9,4096
tr v[42:43],v13,4096
tr v[44:45],v10,4096
tr v[46:47],v14,4096
tr v[48:49],v11,4096
tr v[50:51],v15,4096
mf v[52:55],a[0:3],v[20:23],0
mf v[68:71],a[24:27],v[20:23],0
mf v[84:87],a[48:51],v[20:23],0
mf v[100:103],a[72:75],v[20:23],0
mf v[116:119],a[96:99],v[20:23],0
mf v[132:135],a[120:123],v[20:23],0
mf v[56:59],a[0:3],v[24:27],0
mf v[72:75],a[24:27],v[24:27],0
mf v[88:91],a[48:51],v[24:27],0
mf v[104:107],a[72:75],v[24:27],0
mf v[120:123],a[96:99],v[24:27],0
mf v[136:139],a[120:123],v[24:27],0
mf v[60:63],a[0:3],v[28:31],0
mf v[76:79],a[24:27],v[28:31],0
mf v[92:95],a[48:51],v[28:31],0
mf v[108:111],a[72:75],v[28:31],0
mf v[124:127],a[96:99],v[28:31],0
mf v[140:143],a[120:123],v[28:31],0
mf v[64:67],a[0:3],v[32:35],0
mf v[80:83],a[24:27],v[32:35],0
mf v[96:99],a[48:51],v[32:35],0
mf v[112:115],a[72:75],v[32:35],0
mf v[128:131],a[96:99],v[32:35],0
mf v[144:147],a[120:123],v[32:35],0
s_waitcnt lgkmcnt(0)
tr v[20:21],v8,8192
tr v[22:23],v12,8192
tr v[24:25],v9,8192
tr v[26:27],v13,8192
tr v[28:29],v10,8192
tr v[30:31],v14,8192
tr v[32:33],v11,8192
tr v[34:35],v15,8192
mf v[52:55],a[4:7],v[36:39],v[52:55]
mf v[68:71],a[28:31],v[36:39],v[68:71]
mf v[84:87],a[52:55],v[36:39],v[84:87]
mf v[100:103],a[76:79],v[36:39],v[100:103]
mf v[116:119],a[100:103],v[36:39],v[116:119]
mf v[132:135],a[124:127],v[36:39],v[132:135]
mf v[56:59],a[4:7],v[40:43],v[56:59]
mf v[72:75],a[28:31],v[40:43],v[72:75]
mf v[88:91],a[52:55],v[40:43],v[88:91]
mf v[104:107],a[76:79],v[40:43],v[104:107]
mf v[120:123],a[100:103],v[40:43],v[120:123]
mf v[136:139],a[124:127],v[40:43],v[136:139]
mf v[60:63],a[4:7],v[44:47],v[60:63]
mf v[76:79],a[28:31],v[44:47],v[76:79]
mf v[92:95],a[52:55],v[44:47],v[92:95]
mf v[108:111],a[76:79],v[44:47],v[108:111]
mf v[124:127],a[100:103],v[44:47],v[124:127]
mf v[140:143],a[124:127],v[44:47],v[140:143]
mf v[64:67],a[4:7],v[48:51],v[64:67]
mf v[80:83],a[28:31],v[48:51],v[80:83]
mf v[96:99],a[52:55],v[48:51],v[96:99]
mf v[112:115],a[76:79],v[48:51],v[112:115]
mf v[128:131],a[100:103],v[48:51],v[128:131]
mf v[144:147],a[124:127],v[48:51],v[144:147]
s_waitcnt lgkmcnt(0)
tr v[36:37],v8,12288
tr v[38:39],v12,12288
tr v[40:41],v9,12288
tr v[42:43],v13,12288
tr v[44:45],v10,12288
tr v[46:47],v14,12288
tr v[48:49],v11,12288
tr v[50:51],v15,12288
mf v[52:55],a[8:11],v[20:23],v[52:55]
mf v[68:71],a[32:35],v[20:23],v[68:71]
mf v[84:87],a[56:59],v[20:23],v[84:87]
mf v[100:103],a[80:83],v[20:23],v[100:103]
mf v[116:119],a[104:107],v[20:23],v[116:119]
mf v[132:135],a[128:131],v[20:23],v[132:135]
mf v[56:59],a[8:11],v[24:27],v[56:59]
mf v[72:75],a[32:35],v[24:27],v[72:75]
mf v[88:91],a[56:59],v[24:27],v[88:91]
mf v[104:107],a[80:83],v[24:27],v[104:107]
mf v[120:123],a[104:107],v[24:27],v[120:123]
mf v[136:139],a[128:131],v[24:27],v[136:139]
mf v[60:63],a[8:11],v[28:31],v[60:63]
mf v[76:79],a[32:35],v[28:31],v[76:79]
mf v[92:95],a[56:59],v[28:31],v[92:95]
mf v[108:111],a[80:83],v[28:31],v[108:111]
mf v[124:127],a[104:107],v[28:31],v[124:127]
mf v[140:143],a[128:131],v[28:31],v[140:143]
mf v[64:67],a[8:11],v[32:35],v[64:67]
mf v[80:83],a[32:35],v[32:35],v[80:83]
mf v[96:99],a[56:59],v[32:35],v[96:99]
mf v[112:115],a[80:83],v[32:35],v[112:115]
mf v[128:131],a[104:107],v[32:35],v[128:131]
mf v[144:147],a[128:131],v[32:35],v[144:147]
s_waitcnt lgkmcnt(0)
tr v[20:21],v8,16384
tr v[22:23],v12,16384
tr v[24:25],v9,16384
tr v[26:27],v13,16384
tr v[28:29],v10,16384
tr v[30:31],v14,16384
tr v[32:33],v11,16384
tr v[34:35],v15,16384
mf v[52:55],a[12:15],v[36:39],v[52:55]
mf v[68:71],a[36:39],v[36:39],v[68:71]
mf v[84:87],a[60:63],v[36:39],v[84:87]
mf v[100:103],a[84:87],v[36:39],v[100:103]
mf v[116:119],a[108:111],v[36:39],v[116:119]
mf v[132:135],a[132:135],v[36:39],v[132:135]
mf v[56:59],a[12:15],v[40:43],v[56:59]
mf v[72:75],a[36:39],v[40:43],v[72:75]
mf v[88:91],a[60:63],v[40:43],v[88:91]
mf v[104:107],a[84:87],v[40:43],v[104:107]
mf v[120:123],a[108:111],v[40:43],v[120:123]
mf v[136:139],a[132:135],v[40:43],v[136:139]
mf v[60:63],a[12:15],v[44:47],v[60:63]
mf v[76:79],a[36:39],v[44:47],v[76:79]
mf v[92:95],a[60:63],v[44:47],v[92:95]
mf v[108:111],a[84:87],v[44:47],v[108:111]
mf v[124:127],a[108:111],v[44:47],v[124:127]
mf v[140:143],a[132:135],v[44:47],v[140:143]
mf v[64:67],a[12:15],v[48:51],v[64:67]
mf v[80:83],a[36:39],v[48:51],v[80:83]
mf v[96:99],a[60:63],v[48:51],v[96:99]
mf v[112:115],a[84:87],v[48:51],v[112:115]
mf v[128:131],a[108:111],v[48:51],v[128:131]
mf v[144:147],a[132:135],v[48:51],v[144:147]
s_waitcnt lgkmcnt(0)
tr v[36:37],v8,20480
tr v[38:39],v12,20480
tr v[40:41],v9,20480
tr v[42:43],v13,20480
tr v[44:45],v10,20480
tr v[46:47],v14,20480
tr v[48:49],v11,20480
tr v[50:51],v15,20480
mf v[52:55],a[16:19],v[20:23],v[52:55]
mf v[68:71],a[40:43],v[20:23],v[68:71]
mf v[84:87],a[64:67],v[20:23],v[84:87]
mf v[100:103],a[88:91],v[20:23],v[100:103]
mf v[116:119],a[112:115],v[20:23],v[116:119]
mf v[132:135],a[136:139],v[20:23],v[132:135]
mf v[56:59],a[16:19],v[24:27],v[56:59]
mf v[72:75],a[40:43],v[24:27],v[72:75]
mf v[88:91],a[64:67],v[24:27],v[88:91]
mf v[104:107],a[88:91],v[24:27],v[104:107]
mf v[120:123],a[112:115],v[24:27],v[120:123]
mf v[136:139],a[136:139],v[24:27],v[136:139]
mf v[60:63],a[16:19],v[28:31],v[60:63]
mf v[76:79],a[40:43],v[28:31],v[76:79]
mf v[92:95],a[64:67],v[28:31],v[92:95]
mf v[108:111],a[88:91],v[28:31],v[108:111]
mf v[124:127],a[112:115],v[28:31],v[124:127]
mf v[140:143],a[136:139],v[28:31],v[140:143]
mf v[64:67],a[16:19],v[32:35],v[64:67]
mf v[80:83],a[40:43],v[32:35],v[80:83]
mf v[96:99],a[64:67],v[32:35],v[96:99]
mf v[112:115],a[88:91],v[32:35],v[112:115]
mf v[128:131],a[112:115],v[32:35],v[128:131]
mf v[144:147],a[136:139],v[32:35],v[144:147]
s_waitcnt lgkmcnt(0)
s_waitcnt vmcnt(36)
s_barrier
v_subrev_u32 v8,122880,v8
v_subrev_u32 v9,122880,v9
v_subrev_u32 v10,122880,v10
v_subrev_u32 v11,122880,v11
v_subrev_u32 v12,122880,v12
v_subrev_u32 v13,122880,v13
v_subrev_u32 v14,122880,v14
v_subrev_u32 v15,122880,v15
tr v[20:21],v8,0
tr v[22:23],v12,0
tr v[24:25],v9,0
tr v[26:27],v13,0
tr v[28:29],v10,0
tr v[30:31],v14,0
tr v[32:33],v11,0
tr v[34:35],v15,0
mf v[52:55],a[20:23],v[36:39],v[52:55]
mf v[68:71],a[44:47],v[36:39],v[68:71]
mf v[84:87],a[68:71],v[36:39],v[84:87]
mf v[100:103],a[92:95],v[36:39],v[100:103]
mf v[116:119],a[116:119],v[36:39],v[116:119]
mf v[132:135],a[140:143],v[36:39],v[132:135]
mf v[56:59],a[20:23],v[40:43],v[56:59]
mf v[72:75],a[44:47],v[40:43],v[72:75]
mf v[88:91],a[68:71],v[40:43],v[88:91]
mf v[104:107],a[92:95],v[40:43],v[104:107]
mf v[120:123],a[116:119],v[40:43],v[120:123]
mf v[136:139],a[140:143],v[40:43],v[136:139]
mf v[60:63],a[20:23],v[44:47],v[60:63]
mf v[76:79],a[44:47],v[44:47],v[76:79]
mf v[92:95],a[68:71],v[44:47],v[92:95]
mf v[108:111],a[92:95],v[44:47],v[108:111]
mf v[124:127],a[116:119],v[44:47],v[124:127]
mf v[140:143],a[140:143],v[44:47],v[140:143]
mf v[64:67],a[20:23],v[48:51],v[64:67]
mf v[80:83],a[44:47],v[48:51],v[80:83]
mf v[96:99],a[68:71],v[48:51],v[96:99]
mf v[112:115],a[92:95],v[48:51],v[112:115]
mf v[128:131],a[116:119],v[48:51],v[128:131]
mf v[144:147],a[140:143],v[48:51],v[144:147]
s_nop 7
s_nop 1
cv v52,v52,v53
cv v53,v54,v55
cv v54,v68,v69
cv v55,v70,v71
s_mov_b32 s23,7864320
buffer_store_dwordx4 v[52:55],v249,s[60:63],s23 offen sc1
cv v56,v56,v57
cv v57,v58,v59
cv v58,v72,v73
cv v59,v74,v75
s_mov_b32 s23,8519680
buffer_store_dwordx4 v[56:59],v249,s[60:63],s23 offen sc1
cv v60,v60,v61
cv v61,v62,v63
cv v62,v76,v77
cv v63,v78,v79
s_mov_b32 s23,9175040
buffer_store_dwordx4 v[60:63],v249,s[60:63],s23 offen sc1
cv v64,v64,v65
cv v65,v66,v67
cv v66,v80,v81
cv v67,v82,v83
s_mov_b32 s23,9830400
buffer_store_dwordx4 v[64:67],v249,s[60:63],s23 offen sc1
cv v84,v84,v85
cv v85,v86,v87
cv v86,v100,v101
cv v87,v102,v103
s_mov_b32 s23,7865344
buffer_store_dwordx4 v[84:87],v249,s[60:63],s23 offen sc1
cv v88,v88,v89
cv v89,v90,v91
cv v90,v104,v105
cv v91,v106,v107
s_mov_b32 s23,8520704
buffer_store_dwordx4 v[88:91],v249,s[60:63],s23 offen sc1
cv v92,v92,v93
cv v93,v94,v95
cv v94,v108,v109
cv v95,v110,v111
s_mov_b32 s23,9176064
buffer_store_dwordx4 v[92:95],v249,s[60:63],s23 offen sc1
cv v96,v96,v97
cv v97,v98,v99
cv v98,v112,v113
cv v99,v114,v115
s_mov_b32 s23,9831424
buffer_store_dwordx4 v[96:99],v249,s[60:63],s23 offen sc1
cv v116,v116,v117
cv v117,v118,v119
cv v118,v132,v133
cv v119,v134,v135
s_mov_b32 s23,7866368
buffer_store_dwordx4 v[116:119],v249,s[60:63],s23 offen sc1
cv v120,v120,v121
cv v121,v122,v123
cv v122,v136,v137
cv v123,v138,v139
s_mov_b32 s23,8521728
buffer_store_dwordx4 v[120:123],v249,s[60:63],s23 offen sc1
cv v124,v124,v125
cv v125,v126,v127
cv v126,v140,v141
cv v127,v142,v143
s_mov_b32 s23,9177088
buffer_store_dwordx4 v[124:127],v249,s[60:63],s23 offen sc1
cv v128,v128,v129
cv v129,v130,v131
cv v130,v144,v145
cv v131,v146,v147
s_mov_b32 s23,9832448
buffer_store_dwordx4 v[128:131],v249,s[60:63],s23 offen sc1
s_nop 1
s_waitcnt lgkmcnt(0)
tr v[36:37],v8,4096
tr v[38:39],v12,4096
tr v[40:41],v9,4096
tr v[42:43],v13,4096
tr v[44:45],v10,4096
tr v[46:47],v14,4096
tr v[48:49],v11,4096
tr v[50:51],v15,4096
mf v[52:55],a[0:3],v[20:23],0
mf v[68:71],a[24:27],v[20:23],0
mf v[84:87],a[48:51],v[20:23],0
mf v[100:103],a[72:75],v[20:23],0
mf v[116:119],a[96:99],v[20:23],0
mf v[132:135],a[120:123],v[20:23],0
mf v[56:59],a[0:3],v[24:27],0
mf v[72:75],a[24:27],v[24:27],0
mf v[88:91],a[48:51],v[24:27],0
mf v[104:107],a[72:75],v[24:27],0
mf v[120:123],a[96:99],v[24:27],0
mf v[136:139],a[120:123],v[24:27],0
mf v[60:63],a[0:3],v[28:31],0
mf v[76:79],a[24:27],v[28:31],0
mf v[92:95],a[48:51],v[28:31],0
mf v[108:111],a[72:75],v[28:31],0
mf v[124:127],a[96:99],v[28:31],0
mf v[140:143],a[120:123],v[28:31],0
mf v[64:67],a[0:3],v[32:35],0
mf v[80:83],a[24:27],v[32:35],0
mf v[96:99],a[48:51],v[32:35],0
mf v[112:115],a[72:75],v[32:35],0
mf v[128:131],a[96:99],v[32:35],0
mf v[144:147],a[120:123],v[32:35],0
s_waitcnt lgkmcnt(0)
tr v[20:21],v8,8192
tr v[22:23],v12,8192
tr v[24:25],v9,8192
tr v[26:27],v13,8192
tr v[28:29],v10,8192
tr v[30:31],v14,8192
tr v[32:33],v11,8192
tr v[34:35],v15,8192
mf v[52:55],a[4:7],v[36:39],v[52:55]
mf v[68:71],a[28:31],v[36:39],v[68:71]
mf v[84:87],a[52:55],v[36:39],v[84:87]
mf v[100:103],a[76:79],v[36:39],v[100:103]
mf v[116:119],a[100:103],v[36:39],v[116:119]
mf v[132:135],a[124:127],v[36:39],v[132:135]
mf v[56:59],a[4:7],v[40:43],v[56:59]
mf v[72:75],a[28:31],v[40:43],v[72:75]
mf v[88:91],a[52:55],v[40:43],v[88:91]
mf v[104:107],a[76:79],v[40:43],v[104:107]
mf v[120:123],a[100:103],v[40:43],v[120:123]
mf v[136:139],a[124:127],v[40:43],v[136:139]
mf v[60:63],a[4:7],v[44:47],v[60:63]
mf v[76:79],a[28:31],v[44:47],v[76:79]
mf v[92:95],a[52:55],v[44:47],v[92:95]
mf v[108:111],a[76:79],v[44:47],v[108:111]
mf v[124:127],a[100:103],v[44:47],v[124:127]
mf v[140:143],a[124:127],v[44:47],v[140:143]
mf v[64:67],a[4:7],v[48:51],v[64:67]
mf v[80:83],a[28:31],v[48:51],v[80:83]
mf v[96:99],a[52:55],v[48:51],v[96:99]
mf v[112:115],a[76:79],v[48:51],v[112:115]
mf v[128:131],a[100:103],v[48:51],v[128:131]
mf v[144:147],a[124:127],v[48:51],v[144:147]
s_waitcnt lgkmcnt(0)
tr v[36:37],v8,12288
tr v[38:39],v12,12288
tr v[40:41],v9,12288
tr v[42:43],v13,12288
tr v[44:45],v10,12288
tr v[46:47],v14,12288
tr v[48:49],v11,12288
tr v[50:51],v15,12288
mf v[52:55],a[8:11],v[20:23],v[52:55]
mf v[68:71],a[32:35],v[20:23],v[68:71]
mf v[84:87],a[56:59],v[20:23],v[84:87]
mf v[100:103],a[80:83],v[20:23],v[100:103]
mf v[116:119],a[104:107],v[20:23],v[116:119]
mf v[132:135],a[128:131],v[20:23],v[132:135]
mf v[56:59],a[8:11],v[24:27],v[56:59]
mf v[72:75],a[32:35],v[24:27],v[72:75]
mf v[88:91],a[56:59],v[24:27],v[88:91]
mf v[104:107],a[80:83],v[24:27],v[104:107]
mf v[120:123],a[104:107],v[24:27],v[120:123]
mf v[136:139],a[128:131],v[24:27],v[136:139]
mf v[60:63],a[8:11],v[28:31],v[60:63]
mf v[76:79],a[32:35],v[28:31],v[76:79]
mf v[92:95],a[56:59],v[28:31],v[92:95]
mf v[108:111],a[80:83],v[28:31],v[108:111]
mf v[124:127],a[104:107],v[28:31],v[124:127]
mf v[140:143],a[128:131],v[28:31],v[140:143]
mf v[64:67],a[8:11],v[32:35],v[64:67]
mf v[80:83],a[32:35],v[32:35],v[80:83]
mf v[96:99],a[56:59],v[32:35],v[96:99]
mf v[112:115],a[80:83],v[32:35],v[112:115]
mf v[128:131],a[104:107],v[32:35],v[128:131]
mf v[144:147],a[128:131],v[32:35],v[144:147]
s_waitcnt lgkmcnt(0)
tr v[20:21],v8,16384
tr v[22:23],v12,16384
tr v[24:25],v9,16384
tr v[26:27],v13,16384
tr v[28:29],v10,16384
tr v[30:31],v14,16384
tr v[32:33],v11,16384
tr v[34:35],v15,16384
mf v[52:55],a[12:15],v[36:39],v[52:55]
mf v[68:71],a[36:39],v[36:39],v[68:71]
mf v[84:87],a[60:63],v[36:39],v[84:87]
mf v[100:103],a[84:87],v[36:39],v[100:103]
mf v[116:119],a[108:111],v[36:39],v[116:119]
mf v[132:135],a[132:135],v[36:39],v[132:135]
mf v[56:59],a[12:15],v[40:43],v[56:59]
mf v[72:75],a[36:39],v[40:43],v[72:75]
mf v[88:91],a[60:63],v[40:43],v[88:91]
mf v[104:107],a[84:87],v[40:43],v[104:107]
mf v[120:123],a[108:111],v[40:43],v[120:123]
mf v[136:139],a[132:135],v[40:43],v[136:139]
mf v[60:63],a[12:15],v[44:47],v[60:63]
mf v[76:79],a[36:39],v[44:47],v[76:79]
mf v[92:95],a[60:63],v[44:47],v[92:95]
mf v[108:111],a[84:87],v[44:47],v[108:111]
mf v[124:127],a[108:111],v[44:47],v[124:127]
mf v[140:143],a[132:135],v[44:47],v[140:143]
mf v[64:67],a[12:15],v[48:51],v[64:67]
mf v[80:83],a[36:39],v[48:51],v[80:83]
mf v[96:99],a[60:63],v[48:51],v[96:99]
mf v[112:115],a[84:87],v[48:51],v[112:115]
mf v[128:131],a[108:111],v[48:51],v[128:131]
mf v[144:147],a[132:135],v[48:51],v[144:147]
s_waitcnt lgkmcnt(0)
tr v[36:37],v8,20480
tr v[38:39],v12,20480
tr v[40:41],v9,20480
tr v[42:43],v13,20480
tr v[44:45],v10,20480
tr v[46:47],v14,20480
tr v[48:49],v11,20480
tr v[50:51],v15,20480
mf v[52:55],a[16:19],v[20:23],v[52:55]
mf v[68:71],a[40:43],v[20:23],v[68:71]
mf v[84:87],a[64:67],v[20:23],v[84:87]
mf v[100:103],a[88:91],v[20:23],v[100:103]
mf v[116:119],a[112:115],v[20:23],v[116:119]
mf v[132:135],a[136:139],v[20:23],v[132:135]
mf v[56:59],a[16:19],v[24:27],v[56:59]
mf v[72:75],a[40:43],v[24:27],v[72:75]
mf v[88:91],a[64:67],v[24:27],v[88:91]
mf v[104:107],a[88:91],v[24:27],v[104:107]
mf v[120:123],a[112:115],v[24:27],v[120:123]
mf v[136:139],a[136:139],v[24:27],v[136:139]
mf v[60:63],a[16:19],v[28:31],v[60:63]
mf v[76:79],a[40:43],v[28:31],v[76:79]
mf v[92:95],a[64:67],v[28:31],v[92:95]
mf v[108:111],a[88:91],v[28:31],v[108:111]
mf v[124:127],a[112:115],v[28:31],v[124:127]
mf v[140:143],a[136:139],v[28:31],v[140:143]
mf v[64:67],a[16:19],v[32:35],v[64:67]
mf v[80:83],a[40:43],v[32:35],v[80:83]
mf v[96:99],a[64:67],v[32:35],v[96:99]
mf v[112:115],a[88:91],v[32:35],v[112:115]
mf v[128:131],a[112:115],v[32:35],v[128:131]
mf v[144:147],a[136:139],v[32:35],v[144:147]
s_waitcnt lgkmcnt(0)
mf v[52:55],a[20:23],v[36:39],v[52:55]
mf v[68:71],a[44:47],v[36:39],v[68:71]
mf v[84:87],a[68:71],v[36:39],v[84:87]
mf v[100:103],a[92:95],v[36:39],v[100:103]
mf v[116:119],a[116:119],v[36:39],v[116:119]
mf v[132:135],a[140:143],v[36:39],v[132:135]
mf v[56:59],a[20:23],v[40:43],v[56:59]
mf v[72:75],a[44:47],v[40:43],v[72:75]
mf v[88:91],a[68:71],v[40:43],v[88:91]
mf v[104:107],a[92:95],v[40:43],v[104:107]
mf v[120:123],a[116:119],v[40:43],v[120:123]
mf v[136:139],a[140:143],v[40:43],v[136:139]
mf v[60:63],a[20:23],v[44:47],v[60:63]
mf v[76:79],a[44:47],v[44:47],v[76:79]
mf v[92:95],a[68:71],v[44:47],v[92:95]
mf v[108:111],a[92:95],v[44:47],v[108:111]
mf v[124:127],a[116:119],v[44:47],v[124:127]
mf v[140:143],a[140:143],v[44:47],v[140:143]
mf v[64:67],a[20:23],v[48:51],v[64:67]
mf v[80:83],a[44:47],v[48:51],v[80:83]
mf v[96:99],a[68:71],v[48:51],v[96:99]
mf v[112:115],a[92:95],v[48:51],v[112:115]
mf v[128:131],a[116:119],v[48:51],v[128:131]
mf v[144:147],a[140:143],v[48:51],v[144:147]
s_nop 7
s_nop 1
cv v52,v52,v53
cv v53,v54,v55
cv v54,v68,v69
cv v55,v70,v71
s_mov_b32 s23,10485760
buffer_store_dwordx4 v[52:55],v249,s[60:63],s23 offen sc1
cv v56,v56,v57
cv v57,v58,v59
cv v58,v72,v73
cv v59,v74,v75
s_mov_b32 s23,11141120
buffer_store_dwordx4 v[56:59],v249,s[60:63],s23 offen sc1
cv v60,v60,v61
cv v61,v62,v63
cv v62,v76,v77
cv v63,v78,v79
s_mov_b32 s23,11796480
buffer_store_dwordx4 v[60:63],v249,s[60:63],s23 offen sc1
cv v64,v64,v65
cv v65,v66,v67
cv v66,v80,v81
cv v67,v82,v83
s_mov_b32 s23,12451840
buffer_store_dwordx4 v[64:67],v249,s[60:63],s23 offen sc1
cv v84,v84,v85
cv v85,v86,v87
cv v86,v100,v101
cv v87,v102,v103
s_mov_b32 s23,10486784
buffer_store_dwordx4 v[84:87],v249,s[60:63],s23 offen sc1
cv v88,v88,v89
cv v89,v90,v91
cv v90,v104,v105
cv v91,v106,v107
s_mov_b32 s23,11142144
buffer_store_dwordx4 v[88:91],v249,s[60:63],s23 offen sc1
cv v92,v92,v93
cv v93,v94,v95
cv v94,v108,v109
cv v95,v110,v111
s_mov_b32 s23,11797504
buffer_store_dwordx4 v[92:95],v249,s[60:63],s23 offen sc1
cv v96,v96,v97
cv v97,v98,v99
cv v98,v112,v113
cv v99,v114,v115
s_mov_b32 s23,12452864
buffer_store_dwordx4 v[96:99],v249,s[60:63],s23 offen sc1
cv v116,v116,v117
cv v117,v118,v119
cv v118,v132,v133
cv v119,v134,v135
s_mov_b32 s23,10487808
buffer_store_dwordx4 v[116:119],v249,s[60:63],s23 offen sc1
cv v120,v120,v121
cv v121,v122,v123
cv v122,v136,v137
cv v123,v138,v139
s_mov_b32 s23,11143168
buffer_store_dwordx4 v[120:123],v249,s[60:63],s23 offen sc1
cv v124,v124,v125
cv v125,v126,v127
cv v126,v140,v141
cv v127,v142,v143
s_mov_b32 s23,11798528
buffer_store_dwordx4 v[124:127],v249,s[60:63],s23 offen sc1
cv v128,v128,v129
cv v129,v130,v131
cv v130,v144,v145
cv v131,v146,v147
s_mov_b32 s23,12453888
buffer_store_dwordx4 v[128:131],v249,s[60:63],s23 offen sc1
s_nop 1
s_branch task_done
ffn1_kernel_entry:
s_load_dwordx4 s[4:7],s[0:1],64
s_load_dwordx2 s[12:13],s[0:1],128
v_and_b32 v1,63,v0
v_lshrrev_b32 v2,4,v1
v_and_b32 v3,15,v0
v_lshrrev_b32 v4,6,v0
s_nop 0
v_readfirstlane_b32 s20,v4
s_nop 3
s_lshl_b32 s21,s20,10
v_bfe_u32 v5,v1,2,2
v_lshl_add_u32 v6,v2,3,v5
v_lshlrev_b32 v6,7,v6
v_and_b32 v7,3,v1
v_lshl_add_u32 v6,v7,3,v6
v_lshrrev_b32 v5,1,v5
v_and_b32 v7,1,v2
v_xor_b32 v11,0,v7
v_lshl_or_b32 v11,v11,1,v5
v_xor_b32 v8,0,v11
v_lshl_add_u32 v8,v8,5,v6
v_xor_b32 v9,1,v11
v_lshl_add_u32 v9,v9,5,v6
v_xor_b32 v10,2,v11
v_lshl_add_u32 v10,v10,5,v6
v_xor_b32 v11,3,v11
v_lshl_add_u32 v11,v11,5,v6
v_xor_b32 v15,1,v7
v_lshl_or_b32 v15,v15,1,v5
v_xor_b32 v12,0,v15
v_lshl_add_u32 v12,v12,5,v6
v_add_u32 v12,512,v12
v_xor_b32 v13,1,v15
v_lshl_add_u32 v13,v13,5,v6
v_add_u32 v13,512,v13
v_xor_b32 v14,2,v15
v_lshl_add_u32 v14,v14,5,v6
v_add_u32 v14,512,v14
v_xor_b32 v15,3,v15
v_lshl_add_u32 v15,v15,5,v6
v_add_u32 v15,512,v15
s_lshr_b32 s24,s2,5
s_and_b32 s25,s2,31
s_waitcnt lgkmcnt(0)
s_lshl_b32 s26,s25,7
s_sub_u32 s27,1966080,s26
s_add_u32 s32,s4,s26
s_addc_u32 s33,s5,0
s_mov_b32 s34,s27
s_mov_b32 s35,0x00020000
s_add_u32 s36,s6,s26
s_addc_u32 s37,s7,0
s_mov_b32 s38,0x80
s_mov_b32 s39,0x00020000
s_lshl_b32 s29,s24,2
s_add_u32 s29,s29,s20
s_mul_i32 s30,s29,20480
s_add_u32 s30,s30,29360128
s_add_u32 s48,s12,s30
s_addc_u32 s49,s13,0
s_mov_b32 s50,0x5000
s_mov_b32 s51,0x00020000
s_mul_i32 s30,s29,49152
s_lshl_b32 s31,s25,11
s_add_u32 s30,s30,s31
s_add_u32 s30,s30,19922944
s_add_u32 s52,s12,s30
s_addc_u32 s53,s13,0
s_mov_b32 s54,0x800
s_mov_b32 s55,0x00020000
v_lshlrev_b32 v250,4,v1
v_lshrrev_b32 v244,3,v1
v_lshl_add_u32 v245,v4,3,v244
v_bfe_u32 v246,v245,1,1
v_lshrrev_b32 v5,2,v245
v_lshrrev_b32 v244,3,v245
v_xor_b32 v5,v5,v244
v_and_b32 v5,1,v5
v_lshl_or_b32 v246,v5,1,v246
v_bfe_u32 v244,v1,1,2
v_xor_b32 v246,v246,v244
v_and_b32 v244,1,v1
v_lshl_or_b32 v246,v246,1,v244
v_lshlrev_b32 v246,4,v246
s_mov_b32 s22,3072
v_mul_lo_u32 v5,s22,v245
v_add_u32 v5,v5,v246
v_lshrrev_b32 v244,2,v3
v_and_b32 v245,3,v3
v_lshl_add_u32 v244,v244,3,v245
v_lshlrev_b32 v245,4,v2
v_mul_u32_u24 v247,1280,v244
v_add_u32 v247,v247,v245
v_mul_u32_u24 v248,3072,v244
v_add_u32 v248,v248,v245
v_lshlrev_b32 v246,3,v2
buffer_load_dwordx2 v[180:181],v246,s[36:39],0 offen offset:0
buffer_load_dwordx2 v[182:183],v246,s[36:39],0 offen offset:32
buffer_load_dwordx2 v[184:185],v246,s[36:39],0 offen offset:64
buffer_load_dwordx2 v[186:187],v246,s[36:39],0 offen offset:96
s_add_u32 m0,s21,0
s_mov_b32 s23,0
buffer_load_dwordx4 v5,s[32:35],s23 offen lds
s_add_u32 m0,s21,4096
s_mov_b32 s23,98304
buffer_load_dwordx4 v5,s[32:35],s23 offen lds
s_add_u32 m0,s21,8192
s_mov_b32 s23,196608
buffer_load_dwordx4 v5,s[32:35],s23 offen lds
s_add_u32 m0,s21,12288
s_mov_b32 s23,294912
buffer_load_dwordx4 v5,s[32:35],s23 offen lds
s_add_u32 m0,s21,16384
s_mov_b32 s23,393216
buffer_load_dwordx4 v5,s[32:35],s23 offen lds
s_add_u32 m0,s21,20480
s_mov_b32 s23,491520
buffer_load_dwordx4 v5,s[32:35],s23 offen lds
s_add_u32 m0,s21,24576
s_mov_b32 s23,589824
buffer_load_dwordx4 v5,s[32:35],s23 offen lds
s_add_u32 m0,s21,28672
s_mov_b32 s23,688128
buffer_load_dwordx4 v5,s[32:35],s23 offen lds
s_add_u32 m0,s21,32768
s_mov_b32 s23,786432
buffer_load_dwordx4 v5,s[32:35],s23 offen lds
s_add_u32 m0,s21,36864
s_mov_b32 s23,884736
buffer_load_dwordx4 v5,s[32:35],s23 offen lds
s_add_u32 m0,s21,40960
s_mov_b32 s23,983040
buffer_load_dwordx4 v5,s[32:35],s23 offen lds
s_add_u32 m0,s21,45056
s_mov_b32 s23,1081344
buffer_load_dwordx4 v5,s[32:35],s23 offen lds
s_add_u32 m0,s21,49152
s_mov_b32 s23,1179648
buffer_load_dwordx4 v5,s[32:35],s23 offen lds
s_add_u32 m0,s21,53248
s_mov_b32 s23,1277952
buffer_load_dwordx4 v5,s[32:35],s23 offen lds
s_add_u32 m0,s21,57344
s_mov_b32 s23,1376256
buffer_load_dwordx4 v5,s[32:35],s23 offen lds
s_add_u32 m0,s21,61440
s_mov_b32 s23,1474560
buffer_load_dwordx4 v5,s[32:35],s23 offen lds
s_add_u32 m0,s21,65536
s_mov_b32 s23,1572864
buffer_load_dwordx4 v5,s[32:35],s23 offen lds
s_add_u32 m0,s21,69632
s_mov_b32 s23,1671168
buffer_load_dwordx4 v5,s[32:35],s23 offen lds
s_add_u32 m0,s21,73728
s_mov_b32 s23,1769472
buffer_load_dwordx4 v5,s[32:35],s23 offen lds
s_add_u32 m0,s21,77824
s_mov_b32 s23,1867776
buffer_load_dwordx4 v5,s[32:35],s23 offen lds
s_cmp_lg_u32 s100,0
s_cbranch_scc1 tf1_skip
v_and_b32 v200,63,v0
v_add_u32 v200,0,v200
v_min_u32 v200,1,v200
v_lshlrev_b32 v202,2,v200
s_mov_b32 s60,0
tf1:
buffer_load_dword v200,v202,s[92:95],s99 offen sc1
s_waitcnt vmcnt(0)
v_cmp_ne_u32 vcc,-1,v200
s_nop 1
s_cmp_eq_u64 vcc,exec
s_cbranch_scc1 tf1_ok
s_sleep 32
s_add_u32 s60,s60,1
s_cmp_gt_u32 s60,400000
s_cbranch_scc1 mega_exit
s_branch tf1
tf1_ok:
tf1_skip:
s_barrier
s_mov_b32 s23,0
buffer_load_dwordx4 a[0:3],v250,s[48:51],s23 offen
s_mov_b32 s23,1024
buffer_load_dwordx4 a[4:7],v250,s[48:51],s23 offen
s_mov_b32 s23,2048
buffer_load_dwordx4 a[8:11],v250,s[48:51],s23 offen
s_mov_b32 s23,3072
buffer_load_dwordx4 a[12:15],v250,s[48:51],s23 offen
s_mov_b32 s23,4096
buffer_load_dwordx4 a[16:19],v250,s[48:51],s23 offen
s_mov_b32 s23,5120
buffer_load_dwordx4 a[20:23],v250,s[48:51],s23 offen
s_mov_b32 s23,6144
buffer_load_dwordx4 a[24:27],v250,s[48:51],s23 offen
s_mov_b32 s23,7168
buffer_load_dwordx4 a[28:31],v250,s[48:51],s23 offen
s_mov_b32 s23,8192
buffer_load_dwordx4 a[32:35],v250,s[48:51],s23 offen
s_mov_b32 s23,9216
buffer_load_dwordx4 a[36:39],v250,s[48:51],s23 offen
s_mov_b32 s23,10240
buffer_load_dwordx4 a[40:43],v250,s[48:51],s23 offen
s_mov_b32 s23,11264
buffer_load_dwordx4 a[44:47],v250,s[48:51],s23 offen
s_mov_b32 s23,12288
buffer_load_dwordx4 a[48:51],v250,s[48:51],s23 offen
s_mov_b32 s23,13312
buffer_load_dwordx4 a[52:55],v250,s[48:51],s23 offen
s_mov_b32 s23,14336
buffer_load_dwordx4 a[56:59],v250,s[48:51],s23 offen
s_mov_b32 s23,15360
buffer_load_dwordx4 a[60:63],v250,s[48:51],s23 offen
s_mov_b32 s23,16384
buffer_load_dwordx4 a[64:67],v250,s[48:51],s23 offen
s_mov_b32 s23,17408
buffer_load_dwordx4 a[68:71],v250,s[48:51],s23 offen
s_mov_b32 s23,18432
buffer_load_dwordx4 a[72:75],v250,s[48:51],s23 offen
s_mov_b32 s23,19456
buffer_load_dwordx4 a[76:79],v250,s[48:51],s23 offen
s_waitcnt vmcnt(0)
s_barrier
tr v[20:21],v8,0
tr v[22:23],v12,0
tr v[24:25],v9,0
tr v[26:27],v13,0
tr v[28:29],v10,0
tr v[30:31],v14,0
tr v[32:33],v11,0
tr v[34:35],v15,0
s_waitcnt lgkmcnt(0)
tr v[36:37],v8,4096
tr v[38:39],v12,4096
tr v[40:41],v9,4096
tr v[42:43],v13,4096
tr v[44:45],v10,4096
tr v[46:47],v14,4096
tr v[48:49],v11,4096
tr v[50:51],v15,4096
mf v[52:55],v[20:23],a[0:3],0
mf v[56:59],v[24:27],a[0:3],0
mf v[60:63],v[28:31],a[0:3],0
mf v[64:67],v[32:35],a[0:3],0
s_waitcnt lgkmcnt(0)
tr v[20:21],v8,8192
tr v[22:23],v12,8192
tr v[24:25],v9,8192
tr v[26:27],v13,8192
tr v[28:29],v10,8192
tr v[30:31],v14,8192
tr v[32:33],v11,8192
tr v[34:35],v15,8192
mf v[52:55],v[36:39],a[4:7],v[52:55]
mf v[56:59],v[40:43],a[4:7],v[56:59]
mf v[60:63],v[44:47],a[4:7],v[60:63]
mf v[64:67],v[48:51],a[4:7],v[64:67]
s_waitcnt lgkmcnt(0)
tr v[36:37],v8,12288
tr v[38:39],v12,12288
tr v[40:41],v9,12288
tr v[42:43],v13,12288
tr v[44:45],v10,12288
tr v[46:47],v14,12288
tr v[48:49],v11,12288
tr v[50:51],v15,12288
mf v[52:55],v[20:23],a[8:11],v[52:55]
mf v[56:59],v[24:27],a[8:11],v[56:59]
mf v[60:63],v[28:31],a[8:11],v[60:63]
mf v[64:67],v[32:35],a[8:11],v[64:67]
s_waitcnt lgkmcnt(0)
tr v[20:21],v8,16384
tr v[22:23],v12,16384
tr v[24:25],v9,16384
tr v[26:27],v13,16384
tr v[28:29],v10,16384
tr v[30:31],v14,16384
tr v[32:33],v11,16384
tr v[34:35],v15,16384
mf v[52:55],v[36:39],a[12:15],v[52:55]
mf v[56:59],v[40:43],a[12:15],v[56:59]
mf v[60:63],v[44:47],a[12:15],v[60:63]
mf v[64:67],v[48:51],a[12:15],v[64:67]
s_waitcnt lgkmcnt(0)
tr v[36:37],v8,20480
tr v[38:39],v12,20480
tr v[40:41],v9,20480
tr v[42:43],v13,20480
tr v[44:45],v10,20480
tr v[46:47],v14,20480
tr v[48:49],v11,20480
tr v[50:51],v15,20480
mf v[52:55],v[20:23],a[16:19],v[52:55]
mf v[56:59],v[24:27],a[16:19],v[56:59]
mf v[60:63],v[28:31],a[16:19],v[60:63]
mf v[64:67],v[32:35],a[16:19],v[64:67]
s_waitcnt lgkmcnt(0)
tr v[20:21],v8,24576
tr v[22:23],v12,24576
tr v[24:25],v9,24576
tr v[26:27],v13,24576
tr v[28:29],v10,24576
tr v[30:31],v14,24576
tr v[32:33],v11,24576
tr v[34:35],v15,24576
mf v[52:55],v[36:39],a[20:23],v[52:55]
mf v[56:59],v[40:43],a[20:23],v[56:59]
mf v[60:63],v[44:47],a[20:23],v[60:63]
mf v[64:67],v[48:51],a[20:23],v[64:67]
s_waitcnt lgkmcnt(0)
tr v[36:37],v8,28672
tr v[38:39],v12,28672
tr v[40:41],v9,28672
tr v[42:43],v13,28672
tr v[44:45],v10,28672
tr v[46:47],v14,28672
tr v[48:49],v11,28672
tr v[50:51],v15,28672
mf v[52:55],v[20:23],a[24:27],v[52:55]
mf v[56:59],v[24:27],a[24:27],v[56:59]
mf v[60:63],v[28:31],a[24:27],v[60:63]
mf v[64:67],v[32:35],a[24:27],v[64:67]
s_waitcnt lgkmcnt(0)
tr v[20:21],v8,32768
tr v[22:23],v12,32768
tr v[24:25],v9,32768
tr v[26:27],v13,32768
tr v[28:29],v10,32768
tr v[30:31],v14,32768
tr v[32:33],v11,32768
tr v[34:35],v15,32768
mf v[52:55],v[36:39],a[28:31],v[52:55]
mf v[56:59],v[40:43],a[28:31],v[56:59]
mf v[60:63],v[44:47],a[28:31],v[60:63]
mf v[64:67],v[48:51],a[28:31],v[64:67]
s_waitcnt lgkmcnt(0)
tr v[36:37],v8,36864
tr v[38:39],v12,36864
tr v[40:41],v9,36864
tr v[42:43],v13,36864
tr v[44:45],v10,36864
tr v[46:47],v14,36864
tr v[48:49],v11,36864
tr v[50:51],v15,36864
mf v[52:55],v[20:23],a[32:35],v[52:55]
mf v[56:59],v[24:27],a[32:35],v[56:59]
mf v[60:63],v[28:31],a[32:35],v[60:63]
mf v[64:67],v[32:35],a[32:35],v[64:67]
s_waitcnt lgkmcnt(0)
s_waitcnt vmcnt(20)
s_barrier
v_add_u32 v8,40960,v8
v_add_u32 v9,40960,v9
v_add_u32 v10,40960,v10
v_add_u32 v11,40960,v11
v_add_u32 v12,40960,v12
v_add_u32 v13,40960,v13
v_add_u32 v14,40960,v14
v_add_u32 v15,40960,v15
tr v[20:21],v8,0
tr v[22:23],v12,0
tr v[24:25],v9,0
tr v[26:27],v13,0
tr v[28:29],v10,0
tr v[30:31],v14,0
tr v[32:33],v11,0
tr v[34:35],v15,0
mf v[52:55],v[36:39],a[36:39],v[52:55]
mf v[56:59],v[40:43],a[36:39],v[56:59]
mf v[60:63],v[44:47],a[36:39],v[60:63]
mf v[64:67],v[48:51],a[36:39],v[64:67]
s_waitcnt lgkmcnt(0)
tr v[36:37],v8,4096
tr v[38:39],v12,4096
tr v[40:41],v9,4096
tr v[42:43],v13,4096
tr v[44:45],v10,4096
tr v[46:47],v14,4096
tr v[48:49],v11,4096
tr v[50:51],v15,4096
mf v[52:55],v[20:23],a[40:43],v[52:55]
mf v[56:59],v[24:27],a[40:43],v[56:59]
mf v[60:63],v[28:31],a[40:43],v[60:63]
mf v[64:67],v[32:35],a[40:43],v[64:67]
s_waitcnt lgkmcnt(0)
tr v[20:21],v8,8192
tr v[22:23],v12,8192
tr v[24:25],v9,8192
tr v[26:27],v13,8192
tr v[28:29],v10,8192
tr v[30:31],v14,8192
tr v[32:33],v11,8192
tr v[34:35],v15,8192
mf v[52:55],v[36:39],a[44:47],v[52:55]
mf v[56:59],v[40:43],a[44:47],v[56:59]
mf v[60:63],v[44:47],a[44:47],v[60:63]
mf v[64:67],v[48:51],a[44:47],v[64:67]
s_waitcnt lgkmcnt(0)
tr v[36:37],v8,12288
tr v[38:39],v12,12288
tr v[40:41],v9,12288
tr v[42:43],v13,12288
tr v[44:45],v10,12288
tr v[46:47],v14,12288
tr v[48:49],v11,12288
tr v[50:51],v15,12288
mf v[52:55],v[20:23],a[48:51],v[52:55]
mf v[56:59],v[24:27],a[48:51],v[56:59]
mf v[60:63],v[28:31],a[48:51],v[60:63]
mf v[64:67],v[32:35],a[48:51],v[64:67]
s_waitcnt lgkmcnt(0)
tr v[20:21],v8,16384
tr v[22:23],v12,16384
tr v[24:25],v9,16384
tr v[26:27],v13,16384
tr v[28:29],v10,16384
tr v[30:31],v14,16384
tr v[32:33],v11,16384
tr v[34:35],v15,16384
mf v[52:55],v[36:39],a[52:55],v[52:55]
mf v[56:59],v[40:43],a[52:55],v[56:59]
mf v[60:63],v[44:47],a[52:55],v[60:63]
mf v[64:67],v[48:51],a[52:55],v[64:67]
s_waitcnt lgkmcnt(0)
tr v[36:37],v8,20480
tr v[38:39],v12,20480
tr v[40:41],v9,20480
tr v[42:43],v13,20480
tr v[44:45],v10,20480
tr v[46:47],v14,20480
tr v[48:49],v11,20480
tr v[50:51],v15,20480
mf v[52:55],v[20:23],a[56:59],v[52:55]
mf v[56:59],v[24:27],a[56:59],v[56:59]
mf v[60:63],v[28:31],a[56:59],v[60:63]
mf v[64:67],v[32:35],a[56:59],v[64:67]
s_waitcnt lgkmcnt(0)
tr v[20:21],v8,24576
tr v[22:23],v12,24576
tr v[24:25],v9,24576
tr v[26:27],v13,24576
tr v[28:29],v10,24576
tr v[30:31],v14,24576
tr v[32:33],v11,24576
tr v[34:35],v15,24576
mf v[52:55],v[36:39],a[60:63],v[52:55]
mf v[56:59],v[40:43],a[60:63],v[56:59]
mf v[60:63],v[44:47],a[60:63],v[60:63]
mf v[64:67],v[48:51],a[60:63],v[64:67]
s_waitcnt lgkmcnt(0)
tr v[36:37],v8,28672
tr v[38:39],v12,28672
tr v[40:41],v9,28672
tr v[42:43],v13,28672
tr v[44:45],v10,28672
tr v[46:47],v14,28672
tr v[48:49],v11,28672
tr v[50:51],v15,28672
mf v[52:55],v[20:23],a[64:67],v[52:55]
mf v[56:59],v[24:27],a[64:67],v[56:59]
mf v[60:63],v[28:31],a[64:67],v[60:63]
mf v[64:67],v[32:35],a[64:67],v[64:67]
s_waitcnt lgkmcnt(0)
tr v[20:21],v8,32768
tr v[22:23],v12,32768
tr v[24:25],v9,32768
tr v[26:27],v13,32768
tr v[28:29],v10,32768
tr v[30:31],v14,32768
tr v[32:33],v11,32768
tr v[34:35],v15,32768
mf v[52:55],v[36:39],a[68:71],v[52:55]
mf v[56:59],v[40:43],a[68:71],v[56:59]
mf v[60:63],v[44:47],a[68:71],v[60:63]
mf v[64:67],v[48:51],a[68:71],v[64:67]
s_waitcnt lgkmcnt(0)
tr v[36:37],v8,36864
tr v[38:39],v12,36864
tr v[40:41],v9,36864
tr v[42:43],v13,36864
tr v[44:45],v10,36864
tr v[46:47],v14,36864
tr v[48:49],v11,36864
tr v[50:51],v15,36864
mf v[52:55],v[20:23],a[72:75],v[52:55]
mf v[56:59],v[24:27],a[72:75],v[56:59]
mf v[60:63],v[28:31],a[72:75],v[60:63]
mf v[64:67],v[32:35],a[72:75],v[64:67]
s_waitcnt lgkmcnt(0)
mf v[52:55],v[36:39],a[76:79],v[52:55]
mf v[56:59],v[40:43],a[76:79],v[56:59]
mf v[60:63],v[44:47],a[76:79],v[60:63]
mf v[64:67],v[48:51],a[76:79],v[64:67]
s_nop 7
s_nop 1
v_lshlrev_b32 v190,16,v180
v_and_b32 v191,0xffff0000,v180
v_lshlrev_b32 v192,16,v181
v_and_b32 v193,0xffff0000,v181
v_lshlrev_b32 v194,16,v182
v_and_b32 v195,0xffff0000,v182
v_lshlrev_b32 v196,16,v183
v_and_b32 v197,0xffff0000,v183
v_lshlrev_b32 v198,16,v184
v_and_b32 v199,0xffff0000,v184
v_lshlrev_b32 v200,16,v185
v_and_b32 v201,0xffff0000,v185
v_lshlrev_b32 v202,16,v186
v_and_b32 v203,0xffff0000,v186
v_lshlrev_b32 v204,16,v187
v_and_b32 v205,0xffff0000,v187
v_add_f32 v52,v52,v190
cv v52,v52,v52
v_lshlrev_b32 v52,16,v52
v_max_f32 v52,0,v52
v_mul_f32 v52,v52,v52
v_add_f32 v53,v53,v191
cv v53,v53,v53
v_lshlrev_b32 v53,16,v53
v_max_f32 v53,0,v53
v_mul_f32 v53,v53,v53
v_add_f32 v54,v54,v192
cv v54,v54,v54
v_lshlrev_b32 v54,16,v54
v_max_f32 v54,0,v54
v_mul_f32 v54,v54,v54
v_add_f32 v55,v55,v193
cv v55,v55,v55
v_lshlrev_b32 v55,16,v55
v_max_f32 v55,0,v55
v_mul_f32 v55,v55,v55
v_add_f32 v56,v56,v194
cv v56,v56,v56
v_lshlrev_b32 v56,16,v56
v_max_f32 v56,0,v56
v_mul_f32 v56,v56,v56
v_add_f32 v57,v57,v195
cv v57,v57,v57
v_lshlrev_b32 v57,16,v57
v_max_f32 v57,0,v57
v_mul_f32 v57,v57,v57
v_add_f32 v58,v58,v196
cv v58,v58,v58
v_lshlrev_b32 v58,16,v58
v_max_f32 v58,0,v58
v_mul_f32 v58,v58,v58
v_add_f32 v59,v59,v197
cv v59,v59,v59
v_lshlrev_b32 v59,16,v59
v_max_f32 v59,0,v59
v_mul_f32 v59,v59,v59
v_add_f32 v60,v60,v198
cv v60,v60,v60
v_lshlrev_b32 v60,16,v60
v_max_f32 v60,0,v60
v_mul_f32 v60,v60,v60
v_add_f32 v61,v61,v199
cv v61,v61,v61
v_lshlrev_b32 v61,16,v61
v_max_f32 v61,0,v61
v_mul_f32 v61,v61,v61
v_add_f32 v62,v62,v200
cv v62,v62,v62
v_lshlrev_b32 v62,16,v62
v_max_f32 v62,0,v62
v_mul_f32 v62,v62,v62
v_add_f32 v63,v63,v201
cv v63,v63,v63
v_lshlrev_b32 v63,16,v63
v_max_f32 v63,0,v63
v_mul_f32 v63,v63,v63
v_add_f32 v64,v64,v202
cv v64,v64,v64
v_lshlrev_b32 v64,16,v64
v_max_f32 v64,0,v64
v_mul_f32 v64,v64,v64
v_add_f32 v65,v65,v203
cv v65,v65,v65
v_lshlrev_b32 v65,16,v65
v_max_f32 v65,0,v65
v_mul_f32 v65,v65,v65
v_add_f32 v66,v66,v204
cv v66,v66,v66
v_lshlrev_b32 v66,16,v66
v_max_f32 v66,0,v66
v_mul_f32 v66,v66,v66
v_add_f32 v67,v67,v205
cv v67,v67,v67
v_lshlrev_b32 v67,16,v67
v_max_f32 v67,0,v67
v_mul_f32 v67,v67,v67
cv v52,v52,v53
cv v53,v54,v55
cv v54,v56,v57
cv v55,v58,v59
s_mov_b32 s23,0
buffer_store_dwordx4 v[52:55],v250,s[52:55],s23 offen sc1
cv v60,v60,v61
cv v61,v62,v63
cv v62,v64,v65
cv v63,v66,v67
s_mov_b32 s23,1024
buffer_store_dwordx4 v[60:63],v250,s[52:55],s23 offen sc1
s_nop 1
s_branch task_done
ffn2_kernel_entry:
s_load_dwordx4 s[4:7],s[0:1],80
s_load_dwordx4 s[8:11],s[0:1],112
s_load_dwordx2 s[12:13],s[0:1],128
v_and_b32 v1,63,v0
v_lshrrev_b32 v2,4,v1
v_and_b32 v3,15,v0
v_lshrrev_b32 v4,6,v0
s_nop 0
v_readfirstlane_b32 s20,v4
s_nop 3
s_lshl_b32 s21,s20,10
v_bfe_u32 v5,v1,2,2
v_lshl_add_u32 v6,v2,2,v5
v_lshlrev_b32 v6,7,v6
v_and_b32 v7,3,v1
v_lshl_add_u32 v6,v7,3,v6
v_lshrrev_b32 v5,1,v5
v_lshrrev_b32 v7,1,v2
v_xor_b32 v7,v7,v2
v_and_b32 v7,1,v7
v_lshl_or_b32 v19,v7,1,v5
v_xor_b32 v16,0,v19
v_lshl_add_u32 v16,v16,5,v6
v_xor_b32 v17,1,v19
v_lshl_add_u32 v17,v17,5,v6
v_xor_b32 v18,2,v19
v_lshl_add_u32 v18,v18,5,v6
v_xor_b32 v19,3,v19
v_lshl_add_u32 v19,v19,5,v6
s_lshr_b32 s24,s2,4
s_and_b32 s25,s2,15
s_waitcnt lgkmcnt(0)
s_lshl_b32 s26,s25,7
s_sub_u32 s27,1966080,s26
s_add_u32 s32,s4,s26
s_addc_u32 s33,s5,0
s_mov_b32 s34,s27
s_mov_b32 s35,0x00020000
s_add_u32 s36,s6,s26
s_addc_u32 s37,s7,0
s_mov_b32 s38,0x80
s_mov_b32 s39,0x00020000
s_lshl_b32 s29,s24,2
s_add_u32 s29,s29,s20
s_mul_i32 s30,s29,49152
s_add_u32 s30,s30,19922944
s_add_u32 s48,s12,s30
s_addc_u32 s49,s13,0
s_mov_b32 s50,0xc000
s_mov_b32 s51,0x00020000
s_lshr_b32 s28,s29,1
s_lshl_b32 s28,s28,5
s_and_b32 s30,s29,1
s_lshl_b32 s30,s30,2
s_add_u32 s28,s28,s30
s_mul_i32 s30,s28,2560
s_lshl_b32 s31,s26,1
s_add_u32 s30,s30,s31
s_add_u32 s30,s30,9437184
s_add_u32 s52,s12,s30
s_addc_u32 s53,s13,0
s_mov_b32 s54,0x11800
s_mov_b32 s55,0x00020000
s_mul_i32 s30,s28,1280
s_add_u32 s30,s30,s26
s_add_u32 s56,s8,s30
s_addc_u32 s57,s9,0
s_mov_b32 s58,0x8c00
s_mov_b32 s59,0x00020000
s_add_u32 s30,s31,12800
s_add_u32 s60,s12,s30
s_addc_u32 s61,s13,0
s_mov_b32 s62,0x100
s_mov_b32 s63,0x00020000
v_lshrrev_b32 v244,3,v1
v_lshl_add_u32 v245,v4,3,v244
v_bfe_u32 v246,v245,1,1
v_lshrrev_b32 v6,2,v245
v_lshrrev_b32 v244,3,v245
v_xor_b32 v6,v6,v244
v_and_b32 v6,1,v6
v_lshl_or_b32 v246,v6,1,v246
v_bfe_u32 v244,v1,1,2
v_xor_b32 v246,v246,v244
v_and_b32 v244,1,v1
v_lshl_or_b32 v246,v246,1,v244
v_lshlrev_b32 v246,4,v246
s_mov_b32 s22,1280
v_mul_lo_u32 v6,s22,v245
v_add_u32 v6,v6,v246
v_lshrrev_b32 v244,2,v3
v_and_b32 v245,3,v3
v_lshl_add_u32 v244,v244,3,v245
v_lshlrev_b32 v245,4,v2
v_mul_u32_u24 v247,3072,v244
v_add_u32 v247,v247,v245
v_mul_u32_u24 v248,2560,v244
v_add_u32 v248,v248,v245
v_lshlrev_b32 v246,3,v2
v_mul_u32_u24 v249,1280,v244
v_add_u32 v249,v249,v246
v_lshlrev_b32 v250,4,v1
buffer_load_dwordx2 v[84:85],v246,s[36:39],0 offen offset:0
buffer_load_dwordx4 v[92:95],v245,s[60:63],0 offen offset:0
buffer_load_dwordx2 v[86:87],v246,s[36:39],0 offen offset:32
buffer_load_dwordx4 v[96:99],v245,s[60:63],0 offen offset:64
buffer_load_dwordx2 v[88:89],v246,s[36:39],0 offen offset:64
buffer_load_dwordx4 v[100:103],v245,s[60:63],0 offen offset:128
buffer_load_dwordx2 v[90:91],v246,s[36:39],0 offen offset:96
buffer_load_dwordx4 v[104:107],v245,s[60:63],0 offen offset:192
s_add_u32 m0,s21,0
s_mov_b32 s23,0
buffer_load_dwordx4 v6,s[32:35],s23 offen lds
s_add_u32 m0,s21,4096
s_mov_b32 s23,40960
buffer_load_dwordx4 v6,s[32:35],s23 offen lds
s_add_u32 m0,s21,8192
s_mov_b32 s23,81920
buffer_load_dwordx4 v6,s[32:35],s23 offen lds
s_add_u32 m0,s21,12288
s_mov_b32 s23,122880
buffer_load_dwordx4 v6,s[32:35],s23 offen lds
s_add_u32 m0,s21,16384
s_mov_b32 s23,163840
buffer_load_dwordx4 v6,s[32:35],s23 offen lds
s_add_u32 m0,s21,20480
s_mov_b32 s23,204800
buffer_load_dwordx4 v6,s[32:35],s23 offen lds
s_add_u32 m0,s21,24576
s_mov_b32 s23,245760
buffer_load_dwordx4 v6,s[32:35],s23 offen lds
s_add_u32 m0,s21,28672
s_mov_b32 s23,286720
buffer_load_dwordx4 v6,s[32:35],s23 offen lds
s_add_u32 m0,s21,40960
s_mov_b32 s23,327680
buffer_load_dwordx4 v6,s[32:35],s23 offen lds
s_add_u32 m0,s21,45056
s_mov_b32 s23,368640
buffer_load_dwordx4 v6,s[32:35],s23 offen lds
s_add_u32 m0,s21,49152
s_mov_b32 s23,409600
buffer_load_dwordx4 v6,s[32:35],s23 offen lds
s_add_u32 m0,s21,53248
s_mov_b32 s23,450560
buffer_load_dwordx4 v6,s[32:35],s23 offen lds
s_add_u32 m0,s21,57344
s_mov_b32 s23,491520
buffer_load_dwordx4 v6,s[32:35],s23 offen lds
s_add_u32 m0,s21,61440
s_mov_b32 s23,532480
buffer_load_dwordx4 v6,s[32:35],s23 offen lds
s_add_u32 m0,s21,65536
s_mov_b32 s23,573440
buffer_load_dwordx4 v6,s[32:35],s23 offen lds
s_add_u32 m0,s21,69632
s_mov_b32 s23,614400
buffer_load_dwordx4 v6,s[32:35],s23 offen lds
s_add_u32 m0,s21,81920
s_mov_b32 s23,655360
buffer_load_dwordx4 v6,s[32:35],s23 offen lds
s_add_u32 m0,s21,86016
s_mov_b32 s23,696320
buffer_load_dwordx4 v6,s[32:35],s23 offen lds
s_add_u32 m0,s21,90112
s_mov_b32 s23,737280
buffer_load_dwordx4 v6,s[32:35],s23 offen lds
s_add_u32 m0,s21,94208
s_mov_b32 s23,778240
buffer_load_dwordx4 v6,s[32:35],s23 offen lds
s_add_u32 m0,s21,98304
s_mov_b32 s23,819200
buffer_load_dwordx4 v6,s[32:35],s23 offen lds
s_add_u32 m0,s21,102400
s_mov_b32 s23,860160
buffer_load_dwordx4 v6,s[32:35],s23 offen lds
s_add_u32 m0,s21,106496
s_mov_b32 s23,901120
buffer_load_dwordx4 v6,s[32:35],s23 offen lds
s_add_u32 m0,s21,110592
s_mov_b32 s23,942080
buffer_load_dwordx4 v6,s[32:35],s23 offen lds
s_add_u32 m0,s21,122880
s_mov_b32 s23,983040
buffer_load_dwordx4 v6,s[32:35],s23 offen lds
s_add_u32 m0,s21,126976
s_mov_b32 s23,1024000
buffer_load_dwordx4 v6,s[32:35],s23 offen lds
s_add_u32 m0,s21,131072
s_mov_b32 s23,1064960
buffer_load_dwordx4 v6,s[32:35],s23 offen lds
s_add_u32 m0,s21,135168
s_mov_b32 s23,1105920
buffer_load_dwordx4 v6,s[32:35],s23 offen lds
s_add_u32 m0,s21,139264
s_mov_b32 s23,1146880
buffer_load_dwordx4 v6,s[32:35],s23 offen lds
s_add_u32 m0,s21,143360
s_mov_b32 s23,1187840
buffer_load_dwordx4 v6,s[32:35],s23 offen lds
s_add_u32 m0,s21,147456
s_mov_b32 s23,1228800
buffer_load_dwordx4 v6,s[32:35],s23 offen lds
s_add_u32 m0,s21,151552
s_mov_b32 s23,1269760
buffer_load_dwordx4 v6,s[32:35],s23 offen lds
s_cmp_lg_u32 s100,0
s_cbranch_scc1 tf2_skip
v_and_b32 v200,63,v0
v_add_u32 v200,0,v200
v_min_u32 v200,23,v200
v_lshlrev_b32 v202,2,v200
s_mov_b32 s60,0
tf2:
buffer_load_dword v200,v202,s[92:95],s99 offen sc1
s_waitcnt vmcnt(0)
v_cmp_ne_u32 vcc,-1,v200
s_nop 1
s_cmp_eq_u64 vcc,exec
s_cbranch_scc1 tf2_ok
s_sleep 32
s_add_u32 s60,s60,1
s_cmp_gt_u32 s60,400000
s_cbranch_scc1 mega_exit
s_branch tf2
tf2_ok:
tf2_skip:
s_barrier
s_mov_b32 s23,0
buffer_load_dwordx4 a[0:3],v250,s[48:51],s23 offen
s_mov_b32 s23,1024
buffer_load_dwordx4 a[4:7],v250,s[48:51],s23 offen
s_mov_b32 s23,2048
buffer_load_dwordx4 a[8:11],v250,s[48:51],s23 offen
s_mov_b32 s23,3072
buffer_load_dwordx4 a[12:15],v250,s[48:51],s23 offen
s_mov_b32 s23,4096
buffer_load_dwordx4 a[16:19],v250,s[48:51],s23 offen
s_mov_b32 s23,5120
buffer_load_dwordx4 a[20:23],v250,s[48:51],s23 offen
s_mov_b32 s23,6144
buffer_load_dwordx4 a[24:27],v250,s[48:51],s23 offen
s_mov_b32 s23,7168
buffer_load_dwordx4 a[28:31],v250,s[48:51],s23 offen
s_mov_b32 s23,8192
buffer_load_dwordx4 a[32:35],v250,s[48:51],s23 offen
s_mov_b32 s23,9216
buffer_load_dwordx4 a[36:39],v250,s[48:51],s23 offen
s_mov_b32 s23,10240
buffer_load_dwordx4 a[40:43],v250,s[48:51],s23 offen
s_mov_b32 s23,11264
buffer_load_dwordx4 a[44:47],v250,s[48:51],s23 offen
s_mov_b32 s23,12288
buffer_load_dwordx4 a[48:51],v250,s[48:51],s23 offen
s_mov_b32 s23,13312
buffer_load_dwordx4 a[52:55],v250,s[48:51],s23 offen
s_mov_b32 s23,14336
buffer_load_dwordx4 a[56:59],v250,s[48:51],s23 offen
s_mov_b32 s23,15360
buffer_load_dwordx4 a[60:63],v250,s[48:51],s23 offen
s_mov_b32 s23,16384
buffer_load_dwordx4 a[64:67],v250,s[48:51],s23 offen
s_mov_b32 s23,17408
buffer_load_dwordx4 a[68:71],v250,s[48:51],s23 offen
s_mov_b32 s23,18432
buffer_load_dwordx4 a[72:75],v250,s[48:51],s23 offen
s_mov_b32 s23,19456
buffer_load_dwordx4 a[76:79],v250,s[48:51],s23 offen
s_mov_b32 s23,20480
buffer_load_dwordx4 a[80:83],v250,s[48:51],s23 offen
s_mov_b32 s23,21504
buffer_load_dwordx4 a[84:87],v250,s[48:51],s23 offen
s_mov_b32 s23,22528
buffer_load_dwordx4 a[88:91],v250,s[48:51],s23 offen
s_mov_b32 s23,23552
buffer_load_dwordx4 a[92:95],v250,s[48:51],s23 offen
s_mov_b32 s23,24576
buffer_load_dwordx4 a[96:99],v250,s[48:51],s23 offen
s_mov_b32 s23,25600
buffer_load_dwordx4 a[100:103],v250,s[48:51],s23 offen
s_mov_b32 s23,26624
buffer_load_dwordx4 a[104:107],v250,s[48:51],s23 offen
s_mov_b32 s23,27648
buffer_load_dwordx4 a[108:111],v250,s[48:51],s23 offen
s_mov_b32 s23,28672
buffer_load_dwordx4 a[112:115],v250,s[48:51],s23 offen
s_mov_b32 s23,29696
buffer_load_dwordx4 a[116:119],v250,s[48:51],s23 offen
s_mov_b32 s23,30720
buffer_load_dwordx4 a[120:123],v250,s[48:51],s23 offen
s_mov_b32 s23,31744
buffer_load_dwordx4 a[124:127],v250,s[48:51],s23 offen
s_mov_b32 s23,32768
buffer_load_dwordx4 a[128:131],v250,s[48:51],s23 offen
s_mov_b32 s23,33792
buffer_load_dwordx4 a[132:135],v250,s[48:51],s23 offen
s_mov_b32 s23,34816
buffer_load_dwordx4 a[136:139],v250,s[48:51],s23 offen
s_mov_b32 s23,35840
buffer_load_dwordx4 a[140:143],v250,s[48:51],s23 offen
s_mov_b32 s23,36864
buffer_load_dwordx4 a[144:147],v250,s[48:51],s23 offen
s_mov_b32 s23,37888
buffer_load_dwordx4 a[148:151],v250,s[48:51],s23 offen
s_mov_b32 s23,38912
buffer_load_dwordx4 a[152:155],v250,s[48:51],s23 offen
s_mov_b32 s23,39936
buffer_load_dwordx4 a[156:159],v250,s[48:51],s23 offen
s_mov_b32 s23,40960
buffer_load_dwordx4 a[160:163],v250,s[48:51],s23 offen
s_mov_b32 s23,41984
buffer_load_dwordx4 a[164:167],v250,s[48:51],s23 offen
s_mov_b32 s23,43008
buffer_load_dwordx4 a[168:171],v250,s[48:51],s23 offen
s_mov_b32 s23,44032
buffer_load_dwordx4 a[172:175],v250,s[48:51],s23 offen
s_mov_b32 s23,45056
buffer_load_dwordx4 a[176:179],v250,s[48:51],s23 offen
s_mov_b32 s23,46080
buffer_load_dwordx4 a[180:183],v250,s[48:51],s23 offen
s_mov_b32 s23,47104
buffer_load_dwordx4 a[184:187],v250,s[48:51],s23 offen
s_mov_b32 s23,48128
buffer_load_dwordx4 a[188:191],v250,s[48:51],s23 offen
s_waitcnt vmcnt(0)
s_barrier
tr v[20:21],v16,0
tr v[22:23],v16,2048
tr v[24:25],v17,0
tr v[26:27],v17,2048
tr v[28:29],v18,0
tr v[30:31],v18,2048
tr v[32:33],v19,0
tr v[34:35],v19,2048
s_waitcnt lgkmcnt(0)
tr v[36:37],v16,4096
tr v[38:39],v16,6144
tr v[40:41],v17,4096
tr v[42:43],v17,6144
tr v[44:45],v18,4096
tr v[46:47],v18,6144
tr v[48:49],v19,4096
tr v[50:51],v19,6144
mf v[52:55],v[20:23],a[0:3],0
mf v[56:59],v[24:27],a[0:3],0
mf v[60:63],v[28:31],a[0:3],0
mf v[64:67],v[32:35],a[0:3],0
s_waitcnt lgkmcnt(0)
tr v[20:21],v16,8192
tr v[22:23],v16,10240
tr v[24:25],v17,8192
tr v[26:27],v17,10240
tr v[28:29],v18,8192
tr v[30:31],v18,10240
tr v[32:33],v19,8192
tr v[34:35],v19,10240
mf v[52:55],v[36:39],a[4:7],v[52:55]
mf v[56:59],v[40:43],a[4:7],v[56:59]
mf v[60:63],v[44:47],a[4:7],v[60:63]
mf v[64:67],v[48:51],a[4:7],v[64:67]
s_waitcnt lgkmcnt(0)
tr v[36:37],v16,12288
tr v[38:39],v16,14336
tr v[40:41],v17,12288
tr v[42:43],v17,14336
tr v[44:45],v18,12288
tr v[46:47],v18,14336
tr v[48:49],v19,12288
tr v[50:51],v19,14336
mf v[52:55],v[20:23],a[8:11],v[52:55]
mf v[56:59],v[24:27],a[8:11],v[56:59]
mf v[60:63],v[28:31],a[8:11],v[60:63]
mf v[64:67],v[32:35],a[8:11],v[64:67]
s_waitcnt lgkmcnt(0)
tr v[20:21],v16,16384
tr v[22:23],v16,18432
tr v[24:25],v17,16384
tr v[26:27],v17,18432
tr v[28:29],v18,16384
tr v[30:31],v18,18432
tr v[32:33],v19,16384
tr v[34:35],v19,18432
mf v[52:55],v[36:39],a[12:15],v[52:55]
mf v[56:59],v[40:43],a[12:15],v[56:59]
mf v[60:63],v[44:47],a[12:15],v[60:63]
mf v[64:67],v[48:51],a[12:15],v[64:67]
s_waitcnt lgkmcnt(0)
tr v[36:37],v16,20480
tr v[38:39],v16,22528
tr v[40:41],v17,20480
tr v[42:43],v17,22528
tr v[44:45],v18,20480
tr v[46:47],v18,22528
tr v[48:49],v19,20480
tr v[50:51],v19,22528
mf v[52:55],v[20:23],a[16:19],v[52:55]
mf v[56:59],v[24:27],a[16:19],v[56:59]
mf v[60:63],v[28:31],a[16:19],v[60:63]
mf v[64:67],v[32:35],a[16:19],v[64:67]
s_waitcnt lgkmcnt(0)
tr v[20:21],v16,24576
tr v[22:23],v16,26624
tr v[24:25],v17,24576
tr v[26:27],v17,26624
tr v[28:29],v18,24576
tr v[30:31],v18,26624
tr v[32:33],v19,24576
tr v[34:35],v19,26624
mf v[52:55],v[36:39],a[20:23],v[52:55]
mf v[56:59],v[40:43],a[20:23],v[56:59]
mf v[60:63],v[44:47],a[20:23],v[60:63]
mf v[64:67],v[48:51],a[20:23],v[64:67]
s_waitcnt lgkmcnt(0)
tr v[36:37],v16,28672
tr v[38:39],v16,30720
tr v[40:41],v17,28672
tr v[42:43],v17,30720
tr v[44:45],v18,28672
tr v[46:47],v18,30720
tr v[48:49],v19,28672
tr v[50:51],v19,30720
mf v[52:55],v[20:23],a[24:27],v[52:55]
mf v[56:59],v[24:27],a[24:27],v[56:59]
mf v[60:63],v[28:31],a[24:27],v[60:63]
mf v[64:67],v[32:35],a[24:27],v[64:67]
s_waitcnt lgkmcnt(0)
s_waitcnt vmcnt(63)
s_barrier
s_add_u32 m0,s21,0
s_mov_b32 s23,1310720
buffer_load_dwordx4 v6,s[32:35],s23 offen lds
s_add_u32 m0,s21,4096
s_mov_b32 s23,1351680
buffer_load_dwordx4 v6,s[32:35],s23 offen lds
s_add_u32 m0,s21,8192
s_mov_b32 s23,1392640
buffer_load_dwordx4 v6,s[32:35],s23 offen lds
s_add_u32 m0,s21,12288
s_mov_b32 s23,1433600
buffer_load_dwordx4 v6,s[32:35],s23 offen lds
s_add_u32 m0,s21,16384
s_mov_b32 s23,1474560
buffer_load_dwordx4 v6,s[32:35],s23 offen lds
s_add_u32 m0,s21,20480
s_mov_b32 s23,1515520
buffer_load_dwordx4 v6,s[32:35],s23 offen lds
s_add_u32 m0,s21,24576
s_mov_b32 s23,1556480
buffer_load_dwordx4 v6,s[32:35],s23 offen lds
s_add_u32 m0,s21,28672
s_mov_b32 s23,1597440
buffer_load_dwordx4 v6,s[32:35],s23 offen lds
v_add_u32 v16,40960,v16
v_add_u32 v17,40960,v17
v_add_u32 v18,40960,v18
v_add_u32 v19,40960,v19
tr v[20:21],v16,0
tr v[22:23],v16,2048
tr v[24:25],v17,0
tr v[26:27],v17,2048
tr v[28:29],v18,0
tr v[30:31],v18,2048
tr v[32:33],v19,0
tr v[34:35],v19,2048
mf v[52:55],v[36:39],a[28:31],v[52:55]
mf v[56:59],v[40:43],a[28:31],v[56:59]
mf v[60:63],v[44:47],a[28:31],v[60:63]
mf v[64:67],v[48:51],a[28:31],v[64:67]
s_waitcnt lgkmcnt(0)
tr v[36:37],v16,4096
tr v[38:39],v16,6144
tr v[40:41],v17,4096
tr v[42:43],v17,6144
tr v[44:45],v18,4096
tr v[46:47],v18,6144
tr v[48:49],v19,4096
tr v[50:51],v19,6144
mf v[52:55],v[20:23],a[32:35],v[52:55]
mf v[56:59],v[24:27],a[32:35],v[56:59]
mf v[60:63],v[28:31],a[32:35],v[60:63]
mf v[64:67],v[32:35],a[32:35],v[64:67]
s_waitcnt lgkmcnt(0)
tr v[20:21],v16,8192
tr v[22:23],v16,10240
tr v[24:25],v17,8192
tr v[26:27],v17,10240
tr v[28:29],v18,8192
tr v[30:31],v18,10240
tr v[32:33],v19,8192
tr v[34:35],v19,10240
mf v[52:55],v[36:39],a[36:39],v[52:55]
mf v[56:59],v[40:43],a[36:39],v[56:59]
mf v[60:63],v[44:47],a[36:39],v[60:63]
mf v[64:67],v[48:51],a[36:39],v[64:67]
s_waitcnt lgkmcnt(0)
tr v[36:37],v16,12288
tr v[38:39],v16,14336
tr v[40:41],v17,12288
tr v[42:43],v17,14336
tr v[44:45],v18,12288
tr v[46:47],v18,14336
tr v[48:49],v19,12288
tr v[50:51],v19,14336
mf v[52:55],v[20:23],a[40:43],v[52:55]
mf v[56:59],v[24:27],a[40:43],v[56:59]
mf v[60:63],v[28:31],a[40:43],v[60:63]
mf v[64:67],v[32:35],a[40:43],v[64:67]
s_waitcnt lgkmcnt(0)
tr v[20:21],v16,16384
tr v[22:23],v16,18432
tr v[24:25],v17,16384
tr v[26:27],v17,18432
tr v[28:29],v18,16384
tr v[30:31],v18,18432
tr v[32:33],v19,16384
tr v[34:35],v19,18432
mf v[52:55],v[36:39],a[44:47],v[52:55]
mf v[56:59],v[40:43],a[44:47],v[56:59]
mf v[60:63],v[44:47],a[44:47],v[60:63]
mf v[64:67],v[48:51],a[44:47],v[64:67]
s_waitcnt lgkmcnt(0)
tr v[36:37],v16,20480
tr v[38:39],v16,22528
tr v[40:41],v17,20480
tr v[42:43],v17,22528
tr v[44:45],v18,20480
tr v[46:47],v18,22528
tr v[48:49],v19,20480
tr v[50:51],v19,22528
mf v[52:55],v[20:23],a[48:51],v[52:55]
mf v[56:59],v[24:27],a[48:51],v[56:59]
mf v[60:63],v[28:31],a[48:51],v[60:63]
mf v[64:67],v[32:35],a[48:51],v[64:67]
s_waitcnt lgkmcnt(0)
tr v[20:21],v16,24576
tr v[22:23],v16,26624
tr v[24:25],v17,24576
tr v[26:27],v17,26624
tr v[28:29],v18,24576
tr v[30:31],v18,26624
tr v[32:33],v19,24576
tr v[34:35],v19,26624
mf v[52:55],v[36:39],a[52:55],v[52:55]
mf v[56:59],v[40:43],a[52:55],v[56:59]
mf v[60:63],v[44:47],a[52:55],v[60:63]
mf v[64:67],v[48:51],a[52:55],v[64:67]
s_waitcnt lgkmcnt(0)
tr v[36:37],v16,28672
tr v[38:39],v16,30720
tr v[40:41],v17,28672
tr v[42:43],v17,30720
tr v[44:45],v18,28672
tr v[46:47],v18,30720
tr v[48:49],v19,28672
tr v[50:51],v19,30720
mf v[52:55],v[20:23],a[56:59],v[52:55]
mf v[56:59],v[24:27],a[56:59],v[56:59]
mf v[60:63],v[28:31],a[56:59],v[60:63]
mf v[64:67],v[32:35],a[56:59],v[64:67]
s_waitcnt lgkmcnt(0)
s_waitcnt vmcnt(63)
s_barrier
s_add_u32 m0,s21,40960
s_mov_b32 s23,1638400
buffer_load_dwordx4 v6,s[32:35],s23 offen lds
s_add_u32 m0,s21,45056
s_mov_b32 s23,1679360
buffer_load_dwordx4 v6,s[32:35],s23 offen lds
s_add_u32 m0,s21,49152
s_mov_b32 s23,1720320
buffer_load_dwordx4 v6,s[32:35],s23 offen lds
s_add_u32 m0,s21,53248
s_mov_b32 s23,1761280
buffer_load_dwordx4 v6,s[32:35],s23 offen lds
s_add_u32 m0,s21,57344
s_mov_b32 s23,1802240
buffer_load_dwordx4 v6,s[32:35],s23 offen lds
s_add_u32 m0,s21,61440
s_mov_b32 s23,1843200
buffer_load_dwordx4 v6,s[32:35],s23 offen lds
s_add_u32 m0,s21,65536
s_mov_b32 s23,1884160
buffer_load_dwordx4 v6,s[32:35],s23 offen lds
s_add_u32 m0,s21,69632
s_mov_b32 s23,1925120
buffer_load_dwordx4 v6,s[32:35],s23 offen lds
v_add_u32 v16,40960,v16
v_add_u32 v17,40960,v17
v_add_u32 v18,40960,v18
v_add_u32 v19,40960,v19
tr v[20:21],v16,0
tr v[22:23],v16,2048
tr v[24:25],v17,0
tr v[26:27],v17,2048
tr v[28:29],v18,0
tr v[30:31],v18,2048
tr v[32:33],v19,0
tr v[34:35],v19,2048
mf v[52:55],v[36:39],a[60:63],v[52:55]
mf v[56:59],v[40:43],a[60:63],v[56:59]
mf v[60:63],v[44:47],a[60:63],v[60:63]
mf v[64:67],v[48:51],a[60:63],v[64:67]
s_waitcnt lgkmcnt(0)
tr v[36:37],v16,4096
tr v[38:39],v16,6144
tr v[40:41],v17,4096
tr v[42:43],v17,6144
tr v[44:45],v18,4096
tr v[46:47],v18,6144
tr v[48:49],v19,4096
tr v[50:51],v19,6144
mf v[52:55],v[20:23],a[64:67],v[52:55]
mf v[56:59],v[24:27],a[64:67],v[56:59]
mf v[60:63],v[28:31],a[64:67],v[60:63]
mf v[64:67],v[32:35],a[64:67],v[64:67]
s_waitcnt lgkmcnt(0)
tr v[20:21],v16,8192
tr v[22:23],v16,10240
tr v[24:25],v17,8192
tr v[26:27],v17,10240
tr v[28:29],v18,8192
tr v[30:31],v18,10240
tr v[32:33],v19,8192
tr v[34:35],v19,10240
mf v[52:55],v[36:39],a[68:71],v[52:55]
mf v[56:59],v[40:43],a[68:71],v[56:59]
mf v[60:63],v[44:47],a[68:71],v[60:63]
mf v[64:67],v[48:51],a[68:71],v[64:67]
s_waitcnt lgkmcnt(0)
tr v[36:37],v16,12288
tr v[38:39],v16,14336
tr v[40:41],v17,12288
tr v[42:43],v17,14336
tr v[44:45],v18,12288
tr v[46:47],v18,14336
tr v[48:49],v19,12288
tr v[50:51],v19,14336
mf v[52:55],v[20:23],a[72:75],v[52:55]
mf v[56:59],v[24:27],a[72:75],v[56:59]
mf v[60:63],v[28:31],a[72:75],v[60:63]
mf v[64:67],v[32:35],a[72:75],v[64:67]
s_waitcnt lgkmcnt(0)
tr v[20:21],v16,16384
tr v[22:23],v16,18432
tr v[24:25],v17,16384
tr v[26:27],v17,18432
tr v[28:29],v18,16384
tr v[30:31],v18,18432
tr v[32:33],v19,16384
tr v[34:35],v19,18432
mf v[52:55],v[36:39],a[76:79],v[52:55]
mf v[56:59],v[40:43],a[76:79],v[56:59]
mf v[60:63],v[44:47],a[76:79],v[60:63]
mf v[64:67],v[48:51],a[76:79],v[64:67]
s_waitcnt lgkmcnt(0)
tr v[36:37],v16,20480
tr v[38:39],v16,22528
tr v[40:41],v17,20480
tr v[42:43],v17,22528
tr v[44:45],v18,20480
tr v[46:47],v18,22528
tr v[48:49],v19,20480
tr v[50:51],v19,22528
mf v[52:55],v[20:23],a[80:83],v[52:55]
mf v[56:59],v[24:27],a[80:83],v[56:59]
mf v[60:63],v[28:31],a[80:83],v[60:63]
mf v[64:67],v[32:35],a[80:83],v[64:67]
s_waitcnt lgkmcnt(0)
tr v[20:21],v16,24576
tr v[22:23],v16,26624
tr v[24:25],v17,24576
tr v[26:27],v17,26624
tr v[28:29],v18,24576
tr v[30:31],v18,26624
tr v[32:33],v19,24576
tr v[34:35],v19,26624
mf v[52:55],v[36:39],a[84:87],v[52:55]
mf v[56:59],v[40:43],a[84:87],v[56:59]
mf v[60:63],v[44:47],a[84:87],v[60:63]
mf v[64:67],v[48:51],a[84:87],v[64:67]
s_waitcnt lgkmcnt(0)
tr v[36:37],v16,28672
tr v[38:39],v16,30720
tr v[40:41],v17,28672
tr v[42:43],v17,30720
tr v[44:45],v18,28672
tr v[46:47],v18,30720
tr v[48:49],v19,28672
tr v[50:51],v19,30720
mf v[52:55],v[20:23],a[88:91],v[52:55]
mf v[56:59],v[24:27],a[88:91],v[56:59]
mf v[60:63],v[28:31],a[88:91],v[60:63]
mf v[64:67],v[32:35],a[88:91],v[64:67]
s_waitcnt lgkmcnt(0)
s_waitcnt vmcnt(63)
s_barrier
v_add_u32 v16,40960,v16
v_add_u32 v17,40960,v17
v_add_u32 v18,40960,v18
v_add_u32 v19,40960,v19
tr v[20:21],v16,0
tr v[22:23],v16,2048
tr v[24:25],v17,0
tr v[26:27],v17,2048
tr v[28:29],v18,0
tr v[30:31],v18,2048
tr v[32:33],v19,0
tr v[34:35],v19,2048
mf v[52:55],v[36:39],a[92:95],v[52:55]
mf v[56:59],v[40:43],a[92:95],v[56:59]
mf v[60:63],v[44:47],a[92:95],v[60:63]
mf v[64:67],v[48:51],a[92:95],v[64:67]
s_waitcnt lgkmcnt(0)
tr v[36:37],v16,4096
tr v[38:39],v16,6144
tr v[40:41],v17,4096
tr v[42:43],v17,6144
tr v[44:45],v18,4096
tr v[46:47],v18,6144
tr v[48:49],v19,4096
tr v[50:51],v19,6144
mf v[52:55],v[20:23],a[96:99],v[52:55]
mf v[56:59],v[24:27],a[96:99],v[56:59]
mf v[60:63],v[28:31],a[96:99],v[60:63]
mf v[64:67],v[32:35],a[96:99],v[64:67]
s_waitcnt lgkmcnt(0)
tr v[20:21],v16,8192
tr v[22:23],v16,10240
tr v[24:25],v17,8192
tr v[26:27],v17,10240
tr v[28:29],v18,8192
tr v[30:31],v18,10240
tr v[32:33],v19,8192
tr v[34:35],v19,10240
mf v[52:55],v[36:39],a[100:103],v[52:55]
mf v[56:59],v[40:43],a[100:103],v[56:59]
mf v[60:63],v[44:47],a[100:103],v[60:63]
mf v[64:67],v[48:51],a[100:103],v[64:67]
s_waitcnt lgkmcnt(0)
tr v[36:37],v16,12288
tr v[38:39],v16,14336
tr v[40:41],v17,12288
tr v[42:43],v17,14336
tr v[44:45],v18,12288
tr v[46:47],v18,14336
tr v[48:49],v19,12288
tr v[50:51],v19,14336
mf v[52:55],v[20:23],a[104:107],v[52:55]
mf v[56:59],v[24:27],a[104:107],v[56:59]
mf v[60:63],v[28:31],a[104:107],v[60:63]
mf v[64:67],v[32:35],a[104:107],v[64:67]
s_waitcnt lgkmcnt(0)
tr v[20:21],v16,16384
tr v[22:23],v16,18432
tr v[24:25],v17,16384
tr v[26:27],v17,18432
tr v[28:29],v18,16384
tr v[30:31],v18,18432
tr v[32:33],v19,16384
tr v[34:35],v19,18432
mf v[52:55],v[36:39],a[108:111],v[52:55]
mf v[56:59],v[40:43],a[108:111],v[56:59]
mf v[60:63],v[44:47],a[108:111],v[60:63]
mf v[64:67],v[48:51],a[108:111],v[64:67]
s_waitcnt lgkmcnt(0)
tr v[36:37],v16,20480
tr v[38:39],v16,22528
tr v[40:41],v17,20480
tr v[42:43],v17,22528
tr v[44:45],v18,20480
tr v[46:47],v18,22528
tr v[48:49],v19,20480
tr v[50:51],v19,22528
mf v[52:55],v[20:23],a[112:115],v[52:55]
mf v[56:59],v[24:27],a[112:115],v[56:59]
mf v[60:63],v[28:31],a[112:115],v[60:63]
mf v[64:67],v[32:35],a[112:115],v[64:67]
s_waitcnt lgkmcnt(0)
tr v[20:21],v16,24576
tr v[22:23],v16,26624
tr v[24:25],v17,24576
tr v[26:27],v17,26624
tr v[28:29],v18,24576
tr v[30:31],v18,26624
tr v[32:33],v19,24576
tr v[34:35],v19,26624
mf v[52:55],v[36:39],a[116:119],v[52:55]
mf v[56:59],v[40:43],a[116:119],v[56:59]
mf v[60:63],v[44:47],a[116:119],v[60:63]
mf v[64:67],v[48:51],a[116:119],v[64:67]
s_waitcnt lgkmcnt(0)
tr v[36:37],v16,28672
tr v[38:39],v16,30720
tr v[40:41],v17,28672
tr v[42:43],v17,30720
tr v[44:45],v18,28672
tr v[46:47],v18,30720
tr v[48:49],v19,28672
tr v[50:51],v19,30720
mf v[52:55],v[20:23],a[120:123],v[52:55]
mf v[56:59],v[24:27],a[120:123],v[56:59]
mf v[60:63],v[28:31],a[120:123],v[60:63]
mf v[64:67],v[32:35],a[120:123],v[64:67]
s_waitcnt lgkmcnt(0)
s_waitcnt vmcnt(8)
s_barrier
v_subrev_u32 v16,122880,v16
v_subrev_u32 v17,122880,v17
v_subrev_u32 v18,122880,v18
v_subrev_u32 v19,122880,v19
tr v[20:21],v16,0
tr v[22:23],v16,2048
tr v[24:25],v17,0
tr v[26:27],v17,2048
tr v[28:29],v18,0
tr v[30:31],v18,2048
tr v[32:33],v19,0
tr v[34:35],v19,2048
mf v[52:55],v[36:39],a[124:127],v[52:55]
mf v[56:59],v[40:43],a[124:127],v[56:59]
mf v[60:63],v[44:47],a[124:127],v[60:63]
mf v[64:67],v[48:51],a[124:127],v[64:67]
s_waitcnt lgkmcnt(0)
tr v[36:37],v16,4096
tr v[38:39],v16,6144
tr v[40:41],v17,4096
tr v[42:43],v17,6144
tr v[44:45],v18,4096
tr v[46:47],v18,6144
tr v[48:49],v19,4096
tr v[50:51],v19,6144
mf v[52:55],v[20:23],a[128:131],v[52:55]
mf v[56:59],v[24:27],a[128:131],v[56:59]
mf v[60:63],v[28:31],a[128:131],v[60:63]
mf v[64:67],v[32:35],a[128:131],v[64:67]
s_waitcnt lgkmcnt(0)
tr v[20:21],v16,8192
tr v[22:23],v16,10240
tr v[24:25],v17,8192
tr v[26:27],v17,10240
tr v[28:29],v18,8192
tr v[30:31],v18,10240
tr v[32:33],v19,8192
tr v[34:35],v19,10240
mf v[52:55],v[36:39],a[132:135],v[52:55]
mf v[56:59],v[40:43],a[132:135],v[56:59]
mf v[60:63],v[44:47],a[132:135],v[60:63]
mf v[64:67],v[48:51],a[132:135],v[64:67]
s_waitcnt lgkmcnt(0)
tr v[36:37],v16,12288
tr v[38:39],v16,14336
tr v[40:41],v17,12288
tr v[42:43],v17,14336
tr v[44:45],v18,12288
tr v[46:47],v18,14336
tr v[48:49],v19,12288
tr v[50:51],v19,14336
mf v[52:55],v[20:23],a[136:139],v[52:55]
mf v[56:59],v[24:27],a[136:139],v[56:59]
mf v[60:63],v[28:31],a[136:139],v[60:63]
mf v[64:67],v[32:35],a[136:139],v[64:67]
s_waitcnt lgkmcnt(0)
tr v[20:21],v16,16384
tr v[22:23],v16,18432
tr v[24:25],v17,16384
tr v[26:27],v17,18432
tr v[28:29],v18,16384
tr v[30:31],v18,18432
tr v[32:33],v19,16384
tr v[34:35],v19,18432
mf v[52:55],v[36:39],a[140:143],v[52:55]
mf v[56:59],v[40:43],a[140:143],v[56:59]
mf v[60:63],v[44:47],a[140:143],v[60:63]
mf v[64:67],v[48:51],a[140:143],v[64:67]
s_waitcnt lgkmcnt(0)
tr v[36:37],v16,20480
tr v[38:39],v16,22528
tr v[40:41],v17,20480
tr v[42:43],v17,22528
tr v[44:45],v18,20480
tr v[46:47],v18,22528
tr v[48:49],v19,20480
tr v[50:51],v19,22528
mf v[52:55],v[20:23],a[144:147],v[52:55]
mf v[56:59],v[24:27],a[144:147],v[56:59]
mf v[60:63],v[28:31],a[144:147],v[60:63]
mf v[64:67],v[32:35],a[144:147],v[64:67]
s_waitcnt lgkmcnt(0)
tr v[20:21],v16,24576
tr v[22:23],v16,26624
tr v[24:25],v17,24576
tr v[26:27],v17,26624
tr v[28:29],v18,24576
tr v[30:31],v18,26624
tr v[32:33],v19,24576
tr v[34:35],v19,26624
mf v[52:55],v[36:39],a[148:151],v[52:55]
mf v[56:59],v[40:43],a[148:151],v[56:59]
mf v[60:63],v[44:47],a[148:151],v[60:63]
mf v[64:67],v[48:51],a[148:151],v[64:67]
s_waitcnt lgkmcnt(0)
tr v[36:37],v16,28672
tr v[38:39],v16,30720
tr v[40:41],v17,28672
tr v[42:43],v17,30720
tr v[44:45],v18,28672
tr v[46:47],v18,30720
tr v[48:49],v19,28672
tr v[50:51],v19,30720
mf v[52:55],v[20:23],a[152:155],v[52:55]
mf v[56:59],v[24:27],a[152:155],v[56:59]
mf v[60:63],v[28:31],a[152:155],v[60:63]
mf v[64:67],v[32:35],a[152:155],v[64:67]
s_waitcnt lgkmcnt(0)
s_waitcnt vmcnt(0)
s_barrier
v_add_u32 v16,40960,v16
v_add_u32 v17,40960,v17
v_add_u32 v18,40960,v18
v_add_u32 v19,40960,v19
tr v[20:21],v16,0
tr v[22:23],v16,2048
tr v[24:25],v17,0
tr v[26:27],v17,2048
tr v[28:29],v18,0
tr v[30:31],v18,2048
tr v[32:33],v19,0
tr v[34:35],v19,2048
mf v[52:55],v[36:39],a[156:159],v[52:55]
mf v[56:59],v[40:43],a[156:159],v[56:59]
mf v[60:63],v[44:47],a[156:159],v[60:63]
mf v[64:67],v[48:51],a[156:159],v[64:67]
s_waitcnt lgkmcnt(0)
tr v[36:37],v16,4096
tr v[38:39],v16,6144
tr v[40:41],v17,4096
tr v[42:43],v17,6144
tr v[44:45],v18,4096
tr v[46:47],v18,6144
tr v[48:49],v19,4096
tr v[50:51],v19,6144
mf v[52:55],v[20:23],a[160:163],v[52:55]
mf v[56:59],v[24:27],a[160:163],v[56:59]
mf v[60:63],v[28:31],a[160:163],v[60:63]
mf v[64:67],v[32:35],a[160:163],v[64:67]
s_waitcnt lgkmcnt(0)
tr v[20:21],v16,8192
tr v[22:23],v16,10240
tr v[24:25],v17,8192
tr v[26:27],v17,10240
tr v[28:29],v18,8192
tr v[30:31],v18,10240
tr v[32:33],v19,8192
tr v[34:35],v19,10240
mf v[52:55],v[36:39],a[164:167],v[52:55]
mf v[56:59],v[40:43],a[164:167],v[56:59]
mf v[60:63],v[44:47],a[164:167],v[60:63]
mf v[64:67],v[48:51],a[164:167],v[64:67]
s_waitcnt lgkmcnt(0)
tr v[36:37],v16,12288
tr v[38:39],v16,14336
tr v[40:41],v17,12288
tr v[42:43],v17,14336
tr v[44:45],v18,12288
tr v[46:47],v18,14336
tr v[48:49],v19,12288
tr v[50:51],v19,14336
mf v[52:55],v[20:23],a[168:171],v[52:55]
mf v[56:59],v[24:27],a[168:171],v[56:59]
mf v[60:63],v[28:31],a[168:171],v[60:63]
mf v[64:67],v[32:35],a[168:171],v[64:67]
s_waitcnt lgkmcnt(0)
tr v[20:21],v16,16384
tr v[22:23],v16,18432
tr v[24:25],v17,16384
tr v[26:27],v17,18432
tr v[28:29],v18,16384
tr v[30:31],v18,18432
tr v[32:33],v19,16384
tr v[34:35],v19,18432
mf v[52:55],v[36:39],a[172:175],v[52:55]
mf v[56:59],v[40:43],a[172:175],v[56:59]
mf v[60:63],v[44:47],a[172:175],v[60:63]
mf v[64:67],v[48:51],a[172:175],v[64:67]
s_waitcnt lgkmcnt(0)
tr v[36:37],v16,20480
tr v[38:39],v16,22528
tr v[40:41],v17,20480
tr v[42:43],v17,22528
tr v[44:45],v18,20480
tr v[46:47],v18,22528
tr v[48:49],v19,20480
tr v[50:51],v19,22528
mf v[52:55],v[20:23],a[176:179],v[52:55]
mf v[56:59],v[24:27],a[176:179],v[56:59]
mf v[60:63],v[28:31],a[176:179],v[60:63]
mf v[64:67],v[32:35],a[176:179],v[64:67]
s_waitcnt lgkmcnt(0)
tr v[20:21],v16,24576
tr v[22:23],v16,26624
tr v[24:25],v17,24576
tr v[26:27],v17,26624
tr v[28:29],v18,24576
tr v[30:31],v18,26624
tr v[32:33],v19,24576
tr v[34:35],v19,26624
mf v[52:55],v[36:39],a[180:183],v[52:55]
mf v[56:59],v[40:43],a[180:183],v[56:59]
mf v[60:63],v[44:47],a[180:183],v[60:63]
mf v[64:67],v[48:51],a[180:183],v[64:67]
s_waitcnt lgkmcnt(0)
tr v[36:37],v16,28672
tr v[38:39],v16,30720
tr v[40:41],v17,28672
tr v[42:43],v17,30720
tr v[44:45],v18,28672
tr v[46:47],v18,30720
tr v[48:49],v19,28672
tr v[50:51],v19,30720
mf v[52:55],v[20:23],a[184:187],v[52:55]
mf v[56:59],v[24:27],a[184:187],v[56:59]
mf v[60:63],v[28:31],a[184:187],v[60:63]
mf v[64:67],v[32:35],a[184:187],v[64:67]
s_waitcnt lgkmcnt(0)
mf v[52:55],v[36:39],a[188:191],v[52:55]
mf v[56:59],v[40:43],a[188:191],v[56:59]
mf v[60:63],v[44:47],a[188:191],v[60:63]
mf v[64:67],v[48:51],a[188:191],v[64:67]
s_nop 7
s_nop 1
s_mov_b32 s23,0
buffer_load_dwordx4 v[116:119],v248,s[52:55],s23 offen
s_mov_b32 s23,64
buffer_load_dwordx4 v[120:123],v248,s[52:55],s23 offen
s_mov_b32 s23,128
buffer_load_dwordx4 v[124:127],v248,s[52:55],s23 offen
s_mov_b32 s23,192
buffer_load_dwordx4 v[128:131],v248,s[52:55],s23 offen
v_lshlrev_b32 v150,16,v84
v_and_b32 v151,0xffff0000,v84
v_lshlrev_b32 v152,16,v85
v_and_b32 v153,0xffff0000,v85
v_lshlrev_b32 v154,16,v86
v_and_b32 v155,0xffff0000,v86
v_lshlrev_b32 v156,16,v87
v_and_b32 v157,0xffff0000,v87
v_lshlrev_b32 v158,16,v88
v_and_b32 v159,0xffff0000,v88
v_lshlrev_b32 v160,16,v89
v_and_b32 v161,0xffff0000,v89
v_lshlrev_b32 v162,16,v90
v_and_b32 v163,0xffff0000,v90
v_lshlrev_b32 v164,16,v91
v_and_b32 v165,0xffff0000,v91
s_waitcnt vmcnt(0)
v_add_f32 v52,v52,v150
v_fma_f32 v52,v52,v92,v116
v_add_f32 v53,v53,v151
v_fma_f32 v53,v53,v93,v117
v_add_f32 v54,v54,v152
v_fma_f32 v54,v54,v94,v118
v_add_f32 v55,v55,v153
v_fma_f32 v55,v55,v95,v119
cv v52,v52,v53
cv v53,v54,v55
s_mov_b32 s23,0
buffer_store_dwordx2 v[52:53],v249,s[56:59],s23 offen
v_add_f32 v56,v56,v154
v_fma_f32 v56,v56,v96,v120
v_add_f32 v57,v57,v155
v_fma_f32 v57,v57,v97,v121
v_add_f32 v58,v58,v156
v_fma_f32 v58,v58,v98,v122
v_add_f32 v59,v59,v157
v_fma_f32 v59,v59,v99,v123
cv v56,v56,v57
cv v57,v58,v59
s_mov_b32 s23,32
buffer_store_dwordx2 v[56:57],v249,s[56:59],s23 offen
v_add_f32 v60,v60,v158
v_fma_f32 v60,v60,v100,v124
v_add_f32 v61,v61,v159
v_fma_f32 v61,v61,v101,v125
v_add_f32 v62,v62,v160
v_fma_f32 v62,v62,v102,v126
v_add_f32 v63,v63,v161
v_fma_f32 v63,v63,v103,v127
cv v60,v60,v61
cv v61,v62,v63
s_mov_b32 s23,64
buffer_store_dwordx2 v[60:61],v249,s[56:59],s23 offen
v_add_f32 v64,v64,v162
v_fma_f32 v64,v64,v104,v128
v_add_f32 v65,v65,v163
v_fma_f32 v65,v65,v105,v129
v_add_f32 v66,v66,v164
v_fma_f32 v66,v66,v106,v130
v_add_f32 v67,v67,v165
v_fma_f32 v67,v67,v107,v131
cv v64,v64,v65
cv v65,v66,v67
s_mov_b32 s23,96
buffer_store_dwordx2 v[64:65],v249,s[56:59],s23 offen
s_nop 1
s_branch task_done
.section .rodata,"a"
.p2align 6
.amdhsa_kernel mega_kernel
.amdhsa_next_free_vgpr 512
.amdhsa_next_free_sgpr 102
.amdhsa_accum_offset 256
.amdhsa_group_segment_fixed_size 0
.amdhsa_kernarg_size 136
.amdhsa_user_sgpr_count 2
.amdhsa_user_sgpr_kernarg_segment_ptr 1
.amdhsa_system_sgpr_workgroup_id_x 1
.end_amdhsa_kernel
.text
```
